```python
import torch

def _softmax(x, axis=-1):
    return torch.softmax(x, dim=axis)
def _gelu(x):
    return torch.nn.functional.gelu(x, approximate="tanh")
def _silu(x):
    return torch.nn.functional.silu(x)
def _sigmoid(x):
    return torch.sigmoid(x)
def _layernorm(x, axis=-1, eps=1e-5):
    m = x.mean(dim=axis, keepdim=True)
    v = x.var(dim=axis, keepdim=True, unbiased=False)
    return (x - m) / torch.sqrt(v + eps)
def _scatter_add(tgt, idx, src, axis=0):
    return tgt.clone().index_add_(axis, idx, src)
def _segment_sum(src, seg, n):
    out = torch.zeros((n,) + src.shape[1:], dtype=src.dtype)
    return out.index_add_(0, seg, src)
def _pad(x, pw):
    flat = tuple(v for pair in reversed(pw) for v in pair)
    return torch.nn.functional.pad(x, flat)

kernel_name = 'parallel_sum__compressed_kv_cla__dense_activation_squared_relu__prompt'

def setup_inputs():

    _w = (lambda a: (lambda t: t.to(torch.bfloat16) if t.is_floating_point() else t)(torch.as_tensor(a)))
    def _A_setup():
        B, H, Sq, Sk, D, M = 1, 32, 2048, 2048, 128, 512
        Dc = 4 * D
        return {
            "x": _w((lambda *s: torch.randn(*s, dtype=torch.bfloat16) * 0.05)(B, Sq, M)),
            "c_kv": _w((lambda *s: torch.randn(*s, dtype=torch.bfloat16) * 1.6)(B, Sk, Dc)),
            "w_q": _w((lambda *s: torch.randn(*s, dtype=torch.bfloat16) * 1.6)(M, H, D) * (M ** -0.5)),
            "w_uk": _w((lambda *s: torch.randn(*s, dtype=torch.bfloat16) * 1.6)(Dc, H, D) * (Dc ** -0.5)),
            "w_uv": _w((lambda *s: torch.randn(*s, dtype=torch.bfloat16) * 1.6)(Dc, H, D) * (Dc ** -0.5)),
            "w_o": _w((lambda *s: torch.randn(*s, dtype=torch.bfloat16) * 1.6)(H, D, M) * ((H * D) ** -0.5)),
        }
    _A_in = _A_setup()

    def _B_setup():
        B, S, D, F = 1, 2048, 512, 1792
        return {
            "x": _w((lambda *s: torch.randn(*s, dtype=torch.bfloat16) * 0.05)(B, S, D)),
            "w1": _w((lambda *s: torch.randn(*s, dtype=torch.bfloat16) * 0.05)(D, F)),
            "b1": _w((lambda *s: torch.randn(*s, dtype=torch.bfloat16) * 0.4)(F)),
            "w2": _w((lambda *s: torch.randn(*s, dtype=torch.bfloat16) * 0.05)(F, D)),
            "b2": _w((lambda *s: torch.randn(*s, dtype=torch.bfloat16) * 1.6)(D)),
        }
    _B_in = _B_setup()

    return {
        "A_x": _A_in["x"],
        "A_c_kv": _A_in["c_kv"],
        "A_w_q": _A_in["w_q"],
        "A_w_uk": _A_in["w_uk"],
        "A_w_uv": _A_in["w_uv"],
        "A_w_o": _A_in["w_o"],
        "B_x": _B_in["x"],
        "B_w1": _B_in["w1"],
        "B_b1": _B_in["b1"],
        "B_w2": _B_in["w2"],
        "B_b2": _B_in["b2"],
    }

def reference(A_x, A_c_kv, A_w_q, A_w_uk, A_w_uv, A_w_o, B_x, B_w1, B_b1, B_w2, B_b2):
    def _A_ref(x, c_kv, w_q, w_uk, w_uv, w_o):
        B, Sq, M = x.shape[0], x.shape[1], x.shape[2]
        Sk = c_kv.shape[1]
        H, D = w_q.shape[1], w_q.shape[2]
        q = torch.einsum("bqm,mhd->bhqd", x, w_q)
        k = torch.einsum("bkc,chd->bhkd", c_kv, w_uk)
        v = torch.einsum("bkc,chd->bhkd", c_kv, w_uv)
        scores = torch.einsum("bhqd,bhkd->bhqk", q, k) * (D ** -0.5)
        off = Sk - Sq
        qi = torch.arange(Sq)[:, None]
        kj = torch.arange(Sk)[None, :]
        cmask = kj <= (qi + off)
        scores = torch.where(cmask[None, None], scores, -1e9)
        p = _softmax(scores, axis=-1)
        ctx = torch.einsum("bhqk,bhkd->bhqd", p, v)
        return torch.einsum("bhqd,hdm->bqm", ctx, w_o)

    def _B_ref(x, w1, b1, w2, b2):
        h = torch.einsum("bsd,df->bsf", x, w1) + b1
        zero = torch.zeros_like(h)
        r = torch.where(h > zero, h, zero)
        h = r * r
        out = torch.einsum("bsf,fd->bsd", h, w2) + b2
        return out

    x = A_x
    xn = _layernorm(x, axis=-1)
    return x + _A_ref(xn, A_c_kv, A_w_q, A_w_uk, A_w_uv, A_w_o) + _B_ref(xn, B_w1, B_b1, B_w2, B_b2)
```

```asm
; @launch kernel=mega_kernel grid=(256,1,1) block=(512,1,1) lds=163840
.amdgcn_target "amdgcn-amd-amdhsa--gfx950"
.text
.globl mega_kernel
.p2align 8
.type mega_kernel,@function
mega_kernel:
  s_cmp_lt_u32 s2, 256
  s_cbranch_scc1 proj_start
  s_endpgm
proj_start:
  s_load_dwordx2 s[8:9], s[0:1], 96
  s_load_dwordx2 s[82:83], s[0:1], 96
  s_load_dwordx16 s[24:39], s[0:1], 0
  s_load_dwordx4 s[40:43], s[0:1], 64
  s_load_dwordx2 s[44:45], s[0:1], 104
  s_bfe_u32 s3, s2, 0x10001
  s_bfe_u32 s4, s2, 0x20003
  s_lshl_b32 s4, s4, 1
  s_or_b32 s3, s3, s4
  s_bfe_u32 s4, s2, 0x10002
  s_lshr_b32 s5, s2, 5
  s_lshl_b32 s5, s5, 1
  s_or_b32 s4, s4, s5
  s_and_b32 s5, s2, 1
  s_lshl_b32 s5, s5, 4
  s_or_b32 s4, s4, s5
  v_lshrrev_b32 v1, 6, v0
  s_nop 0
  v_readfirstlane_b32 s6, v1
  v_and_b32 v1, 63, v0
  s_waitcnt lgkmcnt(0)
  s_cmp_lt_u32 s4, 16
  s_cselect_b32 s8, s24, s26
  s_cselect_b32 s9, s25, s27
  s_cselect_b32 s5, 0, 1
  s_and_b32 s4, s4, 15
  s_mov_b32 s10, 0x200000
  s_mov_b32 s11, 0x20000
  s_mov_b32 s16, s44
  s_mov_b32 s17, s45
  s_mov_b32 s18, 0x10000000
  s_mov_b32 s19, 0x20000
  s_mov_b32 s20, s40
  s_mov_b32 s21, s41
  s_mov_b32 s22, 3584
  s_mov_b32 s23, 0x20000
  s_mov_b32 s15, 0x20000
  s_mov_b32 s51, 0x20000
  s_lshl_b32 s58, s6, 12
  s_lshl_b32 s59, s3, 3
  s_add_u32 s59, s59, s6
  v_and_b32 v13, 15, v1
  v_lshlrev_b32 v13, 10, v13
  v_lshrrev_b32 v14, 4, v1
  v_lshlrev_b32 v14, 4, v14
  v_add_u32 v13, v13, v14
  s_movk_i32 s65, 0x4000
  s_lshl_b32 s60, s59, 15
  v_add_u32 v13, s60, v13
  v_mov_b32 v240, v13
  v_bfe_u32 v13, v1, 2, 2
  v_lshrrev_b32 v14, 5, v1
  v_lshl_add_u32 v14, v14, 4, v13
  v_lshlrev_b32 v14, 8, v14
  v_bfe_u32 v15, v1, 4, 1
  v_lshl_add_u32 v14, v15, 5, v14
  v_and_b32 v15, 3, v1
  v_lshl_add_u32 v14, v15, 3, v14
  v_lshlrev_b32 v13, 6, v13
  v_xor_b32 v15, 0, v13
  v_add_u32 v2, v14, v15
  v_add_u32 v6, 0x10000, v2
  v_xor_b32 v15, 64, v13
  v_add_u32 v3, v14, v15
  v_add_u32 v7, 0x10000, v3
  v_xor_b32 v15, 128, v13
  v_add_u32 v4, v14, v15
  v_add_u32 v8, 0x10000, v4
  v_xor_b32 v15, 192, v13
  v_add_u32 v5, v14, v15
  v_add_u32 v9, 0x10000, v5
  v_lshlrev_b32 v12, 4, v1
  v_lshrrev_b32 v13, 4, v1
  v_bfe_u32 v14, v1, 2, 2
  v_xor_b32 v14, v14, v13
  v_lshlrev_b32 v14, 6, v14
  v_and_b32 v15, 3, v1
  v_lshl_add_u32 v14, v15, 4, v14
  s_lshl_b32 s60, s6, 4
  v_add_u32 v13, s60, v13
  s_lshl_b32 s61, s4, 8
  s_mov_b32 s46, s61
  s_xor_b32 s62, s61, 4096
  s_lshl_b32 s63, s61, 11
  s_lshl_b32 s64, s59, 13
  s_add_u32 s63, s63, s64
  s_xor_b32 s64, s63, 0x800000
  v_and_b32 v24, 7, v1
  v_lshrrev_b32 v25, 3, v1
  v_lshrrev_b32 v26, 1, v25
  v_xor_b32 v26, v24, v26
  v_lshlrev_b32 v26, 4, v26
  v_lshl_add_u32 v26, v25, 10, v26
  s_lshl_b32 s60, s59, 15
  v_add_u32 v240, s60, v26
  s_lshl_b32 s66, s6, 12
  v_and_b32 v24, 31, v1
  v_lshrrev_b32 v25, 5, v1
  v_bfe_u32 v26, v24, 1, 3
  v_lshlrev_b32 v27, 1, v25
  v_xor_b32 v26, v26, v27
  v_lshlrev_b32 v26, 4, v26
  v_lshl_add_u32 v26, v24, 7, v26
  v_add_u32 v241, s66, v26
  v_add_u32 v242, 0x10000, v241
  v_add_u32 v243, 0x20000, v241
  s_mov_b32 s7, 0x400000
  s_cmp_eq_u32 s5, 1
  s_cbranch_scc1 proj_ckv
  s_mov_b32 s12, s28
  s_mov_b32 s13, s29
  s_mov_b32 s14, 0x400000
  s_mov_b32 s52, 8192
  s_mov_b32 s53, s61
  v_mul_lo_u32 v10, v13, s52
  v_add_u32 v10, v10, v14
  v_xor_b32 v248, 0, v240
  s_add_u32 m0, s66, 65536
  s_movk_i32 s67, 0
  buffer_load_dwordx4 v248, s[8:11], s67 offen lds
  v_xor_b32 v249, 64, v240
  s_add_u32 m0, s66, 66560
  s_movk_i32 s67, 8192
  buffer_load_dwordx4 v249, s[8:11], s67 offen lds
  v_xor_b32 v250, 0, v240
  s_add_u32 m0, s66, 67584
  s_movk_i32 s67, 16384
  buffer_load_dwordx4 v250, s[8:11], s67 offen lds
  v_xor_b32 v251, 64, v240
  s_add_u32 m0, s66, 68608
  s_movk_i32 s67, 24576
  buffer_load_dwordx4 v251, s[8:11], s67 offen lds
  v_xor_b32 v248, 0, v240
  s_add_u32 m0, s66, 98304
  s_movk_i32 s67, 128
  buffer_load_dwordx4 v248, s[8:11], s67 offen lds
  v_xor_b32 v249, 64, v240
  s_add_u32 m0, s66, 99328
  s_movk_i32 s67, 8320
  buffer_load_dwordx4 v249, s[8:11], s67 offen lds
  v_xor_b32 v250, 0, v240
  s_add_u32 m0, s66, 100352
  s_movk_i32 s67, 16512
  buffer_load_dwordx4 v250, s[8:11], s67 offen lds
  v_xor_b32 v251, 64, v240
  s_add_u32 m0, s66, 101376
  s_movk_i32 s67, 24704
  buffer_load_dwordx4 v251, s[8:11], s67 offen lds
  v_xor_b32 v248, 0, v240
  s_add_u32 m0, s66, 131072
  s_movk_i32 s67, 256
  buffer_load_dwordx4 v248, s[8:11], s67 offen lds
  v_xor_b32 v249, 64, v240
  s_add_u32 m0, s66, 132096
  s_movk_i32 s67, 8448
  buffer_load_dwordx4 v249, s[8:11], s67 offen lds
  v_xor_b32 v250, 0, v240
  s_add_u32 m0, s66, 133120
  s_movk_i32 s67, 16640
  buffer_load_dwordx4 v250, s[8:11], s67 offen lds
  v_xor_b32 v251, 64, v240
  s_add_u32 m0, s66, 134144
  s_movk_i32 s67, 24832
  buffer_load_dwordx4 v251, s[8:11], s67 offen lds
  s_add_u32 m0, s58, 0
  s_mul_i32 s57, s52, 0
  s_add_u32 s57, s57, s53
  buffer_load_dwordx4 v10, s[12:15], s57 offen lds
  s_add_u32 m0, s58, 1024
  s_mul_i32 s57, s52, 4
  s_add_u32 s57, s57, s53
  buffer_load_dwordx4 v10, s[12:15], s57 offen lds
  s_add_u32 m0, s58, 2048
  s_mul_i32 s57, s52, 8
  s_add_u32 s57, s57, s53
  buffer_load_dwordx4 v10, s[12:15], s57 offen lds
  s_add_u32 m0, s58, 3072
  s_mul_i32 s57, s52, 12
  s_add_u32 s57, s57, s53
  buffer_load_dwordx4 v10, s[12:15], s57 offen lds
  v_mov_b32 v16, 0
  v_mov_b32 v17, 0
  v_mov_b32 v18, 0
  v_mov_b32 v19, 0
  s_waitcnt vmcnt(12)
  v_xor_b32 v248, 0, v242
  ds_read_b128 v[112:115], v248 offset:0
  v_xor_b32 v249, 16, v242
  ds_read_b128 v[116:119], v249 offset:0
  v_xor_b32 v250, 64, v242
  ds_read_b128 v[120:123], v250 offset:0
  v_xor_b32 v251, 80, v242
  ds_read_b128 v[124:127], v251 offset:0
  s_waitcnt lgkmcnt(0)
  v_xor_b32 v248, 0, v240
  s_add_u32 m0, s66, 65536
  s_movk_i32 s67, 384
  buffer_load_dwordx4 v248, s[8:11], s67 offen lds
  v_xor_b32 v249, 64, v240
  s_add_u32 m0, s66, 66560
  s_movk_i32 s67, 8576
  buffer_load_dwordx4 v249, s[8:11], s67 offen lds
  v_xor_b32 v250, 0, v240
  s_add_u32 m0, s66, 67584
  s_movk_i32 s67, 16768
  buffer_load_dwordx4 v250, s[8:11], s67 offen lds
  v_xor_b32 v251, 64, v240
  s_add_u32 m0, s66, 68608
  s_movk_i32 s67, 24960
  buffer_load_dwordx4 v251, s[8:11], s67 offen lds
  s_waitcnt vmcnt(12)
  v_xor_b32 v248, 0, v242
  ds_read_b128 v[128:131], v248 offset:32768
  v_xor_b32 v249, 16, v242
  ds_read_b128 v[132:135], v249 offset:32768
  v_xor_b32 v250, 64, v242
  ds_read_b128 v[136:139], v250 offset:32768
  v_xor_b32 v251, 80, v242
  ds_read_b128 v[140:143], v251 offset:32768
  s_waitcnt lgkmcnt(0)
  v_xor_b32 v248, 0, v240
  s_add_u32 m0, s66, 98304
  s_movk_i32 s67, 512
  buffer_load_dwordx4 v248, s[8:11], s67 offen lds
  v_xor_b32 v249, 64, v240
  s_add_u32 m0, s66, 99328
  s_movk_i32 s67, 8704
  buffer_load_dwordx4 v249, s[8:11], s67 offen lds
  v_xor_b32 v250, 0, v240
  s_add_u32 m0, s66, 100352
  s_movk_i32 s67, 16896
  buffer_load_dwordx4 v250, s[8:11], s67 offen lds
  v_xor_b32 v251, 64, v240
  s_add_u32 m0, s66, 101376
  s_movk_i32 s67, 25088
  buffer_load_dwordx4 v251, s[8:11], s67 offen lds
  s_waitcnt vmcnt(12)
  v_xor_b32 v248, 0, v243
  ds_read_b128 v[144:147], v248 offset:0
  v_xor_b32 v249, 16, v243
  ds_read_b128 v[148:151], v249 offset:0
  v_xor_b32 v250, 64, v243
  ds_read_b128 v[152:155], v250 offset:0
  v_xor_b32 v251, 80, v243
  ds_read_b128 v[156:159], v251 offset:0
  s_waitcnt lgkmcnt(0)
  v_xor_b32 v248, 0, v240
  s_add_u32 m0, s66, 131072
  s_movk_i32 s67, 640
  buffer_load_dwordx4 v248, s[8:11], s67 offen lds
  v_xor_b32 v249, 64, v240
  s_add_u32 m0, s66, 132096
  s_movk_i32 s67, 8832
  buffer_load_dwordx4 v249, s[8:11], s67 offen lds
  v_xor_b32 v250, 0, v240
  s_add_u32 m0, s66, 133120
  s_movk_i32 s67, 17024
  buffer_load_dwordx4 v250, s[8:11], s67 offen lds
  v_xor_b32 v251, 64, v240
  s_add_u32 m0, s66, 134144
  s_movk_i32 s67, 25216
  buffer_load_dwordx4 v251, s[8:11], s67 offen lds
  s_add_u32 m0, s58, 32768
  s_mul_i32 s57, s52, 128
  s_add_u32 s57, s57, s53
  buffer_load_dwordx4 v10, s[12:15], s57 offen lds
  s_add_u32 m0, s58, 33792
  s_mul_i32 s57, s52, 132
  s_add_u32 s57, s57, s53
  buffer_load_dwordx4 v10, s[12:15], s57 offen lds
  s_add_u32 m0, s58, 34816
  s_mul_i32 s57, s52, 136
  s_add_u32 s57, s57, s53
  buffer_load_dwordx4 v10, s[12:15], s57 offen lds
  s_add_u32 m0, s58, 35840
  s_mul_i32 s57, s52, 140
  s_add_u32 s57, s57, s53
  buffer_load_dwordx4 v10, s[12:15], s57 offen lds
  v_lshlrev_b32 v20, 16, v112
  v_and_b32 v21, 0xffff0000, v112
  v_pk_add_f32 v[16:17], v[16:17], v[20:21]
  v_pk_fma_f32 v[18:19], v[20:21], v[20:21], v[18:19]
  v_lshlrev_b32 v22, 16, v113
  v_and_b32 v23, 0xffff0000, v113
  v_pk_add_f32 v[16:17], v[16:17], v[22:23]
  v_pk_fma_f32 v[18:19], v[22:23], v[22:23], v[18:19]
  v_lshlrev_b32 v24, 16, v114
  v_and_b32 v25, 0xffff0000, v114
  v_pk_add_f32 v[16:17], v[16:17], v[24:25]
  v_pk_fma_f32 v[18:19], v[24:25], v[24:25], v[18:19]
  v_lshlrev_b32 v26, 16, v115
  v_and_b32 v27, 0xffff0000, v115
  v_pk_add_f32 v[16:17], v[16:17], v[26:27]
  v_pk_fma_f32 v[18:19], v[26:27], v[26:27], v[18:19]
  v_lshlrev_b32 v20, 16, v116
  v_and_b32 v21, 0xffff0000, v116
  v_pk_add_f32 v[16:17], v[16:17], v[20:21]
  v_pk_fma_f32 v[18:19], v[20:21], v[20:21], v[18:19]
  v_lshlrev_b32 v22, 16, v117
  v_and_b32 v23, 0xffff0000, v117
  v_pk_add_f32 v[16:17], v[16:17], v[22:23]
  v_pk_fma_f32 v[18:19], v[22:23], v[22:23], v[18:19]
  v_lshlrev_b32 v24, 16, v118
  v_and_b32 v25, 0xffff0000, v118
  v_pk_add_f32 v[16:17], v[16:17], v[24:25]
  v_pk_fma_f32 v[18:19], v[24:25], v[24:25], v[18:19]
  v_lshlrev_b32 v26, 16, v119
  v_and_b32 v27, 0xffff0000, v119
  v_pk_add_f32 v[16:17], v[16:17], v[26:27]
  v_pk_fma_f32 v[18:19], v[26:27], v[26:27], v[18:19]
  v_lshlrev_b32 v20, 16, v120
  v_and_b32 v21, 0xffff0000, v120
  v_pk_add_f32 v[16:17], v[16:17], v[20:21]
  v_pk_fma_f32 v[18:19], v[20:21], v[20:21], v[18:19]
  v_lshlrev_b32 v22, 16, v121
  v_and_b32 v23, 0xffff0000, v121
  v_pk_add_f32 v[16:17], v[16:17], v[22:23]
  v_pk_fma_f32 v[18:19], v[22:23], v[22:23], v[18:19]
  v_lshlrev_b32 v24, 16, v122
  v_and_b32 v25, 0xffff0000, v122
  v_pk_add_f32 v[16:17], v[16:17], v[24:25]
  v_pk_fma_f32 v[18:19], v[24:25], v[24:25], v[18:19]
  v_lshlrev_b32 v26, 16, v123
  v_and_b32 v27, 0xffff0000, v123
  v_pk_add_f32 v[16:17], v[16:17], v[26:27]
  v_pk_fma_f32 v[18:19], v[26:27], v[26:27], v[18:19]
  v_lshlrev_b32 v20, 16, v124
  v_and_b32 v21, 0xffff0000, v124
  v_pk_add_f32 v[16:17], v[16:17], v[20:21]
  v_pk_fma_f32 v[18:19], v[20:21], v[20:21], v[18:19]
  v_lshlrev_b32 v22, 16, v125
  v_and_b32 v23, 0xffff0000, v125
  v_pk_add_f32 v[16:17], v[16:17], v[22:23]
  v_pk_fma_f32 v[18:19], v[22:23], v[22:23], v[18:19]
  v_lshlrev_b32 v24, 16, v126
  v_and_b32 v25, 0xffff0000, v126
  v_pk_add_f32 v[16:17], v[16:17], v[24:25]
  v_pk_fma_f32 v[18:19], v[24:25], v[24:25], v[18:19]
  v_lshlrev_b32 v26, 16, v127
  v_and_b32 v27, 0xffff0000, v127
  v_pk_add_f32 v[16:17], v[16:17], v[26:27]
  v_pk_fma_f32 v[18:19], v[26:27], v[26:27], v[18:19]
  v_lshlrev_b32 v20, 16, v128
  v_and_b32 v21, 0xffff0000, v128
  v_pk_add_f32 v[16:17], v[16:17], v[20:21]
  v_pk_fma_f32 v[18:19], v[20:21], v[20:21], v[18:19]
  v_lshlrev_b32 v22, 16, v129
  v_and_b32 v23, 0xffff0000, v129
  v_pk_add_f32 v[16:17], v[16:17], v[22:23]
  v_pk_fma_f32 v[18:19], v[22:23], v[22:23], v[18:19]
  v_lshlrev_b32 v24, 16, v130
  v_and_b32 v25, 0xffff0000, v130
  v_pk_add_f32 v[16:17], v[16:17], v[24:25]
  v_pk_fma_f32 v[18:19], v[24:25], v[24:25], v[18:19]
  v_lshlrev_b32 v26, 16, v131
  v_and_b32 v27, 0xffff0000, v131
  v_pk_add_f32 v[16:17], v[16:17], v[26:27]
  v_pk_fma_f32 v[18:19], v[26:27], v[26:27], v[18:19]
  v_lshlrev_b32 v20, 16, v132
  v_and_b32 v21, 0xffff0000, v132
  v_pk_add_f32 v[16:17], v[16:17], v[20:21]
  v_pk_fma_f32 v[18:19], v[20:21], v[20:21], v[18:19]
  v_lshlrev_b32 v22, 16, v133
  v_and_b32 v23, 0xffff0000, v133
  v_pk_add_f32 v[16:17], v[16:17], v[22:23]
  v_pk_fma_f32 v[18:19], v[22:23], v[22:23], v[18:19]
  v_lshlrev_b32 v24, 16, v134
  v_and_b32 v25, 0xffff0000, v134
  v_pk_add_f32 v[16:17], v[16:17], v[24:25]
  v_pk_fma_f32 v[18:19], v[24:25], v[24:25], v[18:19]
  v_lshlrev_b32 v26, 16, v135
  v_and_b32 v27, 0xffff0000, v135
  v_pk_add_f32 v[16:17], v[16:17], v[26:27]
  v_pk_fma_f32 v[18:19], v[26:27], v[26:27], v[18:19]
  v_lshlrev_b32 v20, 16, v136
  v_and_b32 v21, 0xffff0000, v136
  v_pk_add_f32 v[16:17], v[16:17], v[20:21]
  v_pk_fma_f32 v[18:19], v[20:21], v[20:21], v[18:19]
  v_lshlrev_b32 v22, 16, v137
  v_and_b32 v23, 0xffff0000, v137
  v_pk_add_f32 v[16:17], v[16:17], v[22:23]
  v_pk_fma_f32 v[18:19], v[22:23], v[22:23], v[18:19]
  v_lshlrev_b32 v24, 16, v138
  v_and_b32 v25, 0xffff0000, v138
  v_pk_add_f32 v[16:17], v[16:17], v[24:25]
  v_pk_fma_f32 v[18:19], v[24:25], v[24:25], v[18:19]
  v_lshlrev_b32 v26, 16, v139
  v_and_b32 v27, 0xffff0000, v139
  v_pk_add_f32 v[16:17], v[16:17], v[26:27]
  v_pk_fma_f32 v[18:19], v[26:27], v[26:27], v[18:19]
  v_lshlrev_b32 v20, 16, v140
  v_and_b32 v21, 0xffff0000, v140
  v_pk_add_f32 v[16:17], v[16:17], v[20:21]
  v_pk_fma_f32 v[18:19], v[20:21], v[20:21], v[18:19]
  v_lshlrev_b32 v22, 16, v141
  v_and_b32 v23, 0xffff0000, v141
  v_pk_add_f32 v[16:17], v[16:17], v[22:23]
  v_pk_fma_f32 v[18:19], v[22:23], v[22:23], v[18:19]
  v_lshlrev_b32 v24, 16, v142
  v_and_b32 v25, 0xffff0000, v142
  v_pk_add_f32 v[16:17], v[16:17], v[24:25]
  v_pk_fma_f32 v[18:19], v[24:25], v[24:25], v[18:19]
  v_lshlrev_b32 v26, 16, v143
  v_and_b32 v27, 0xffff0000, v143
  v_pk_add_f32 v[16:17], v[16:17], v[26:27]
  v_pk_fma_f32 v[18:19], v[26:27], v[26:27], v[18:19]
  s_waitcnt vmcnt(12)
  v_xor_b32 v248, 0, v242
  ds_read_b128 v[160:163], v248 offset:0
  v_xor_b32 v249, 16, v242
  ds_read_b128 v[164:167], v249 offset:0
  v_xor_b32 v250, 64, v242
  ds_read_b128 v[168:171], v250 offset:0
  v_xor_b32 v251, 80, v242
  ds_read_b128 v[172:175], v251 offset:0
  s_waitcnt lgkmcnt(0)
  v_xor_b32 v248, 0, v240
  s_add_u32 m0, s66, 65536
  s_movk_i32 s67, 768
  buffer_load_dwordx4 v248, s[8:11], s67 offen lds
  v_xor_b32 v249, 64, v240
  s_add_u32 m0, s66, 66560
  s_movk_i32 s67, 8960
  buffer_load_dwordx4 v249, s[8:11], s67 offen lds
  v_xor_b32 v250, 0, v240
  s_add_u32 m0, s66, 67584
  s_movk_i32 s67, 17152
  buffer_load_dwordx4 v250, s[8:11], s67 offen lds
  v_xor_b32 v251, 64, v240
  s_add_u32 m0, s66, 68608
  s_movk_i32 s67, 25344
  buffer_load_dwordx4 v251, s[8:11], s67 offen lds
  s_waitcnt vmcnt(12)
  v_xor_b32 v248, 0, v242
  ds_read_b128 v[176:179], v248 offset:32768
  v_xor_b32 v249, 16, v242
  ds_read_b128 v[180:183], v249 offset:32768
  v_xor_b32 v250, 64, v242
  ds_read_b128 v[184:187], v250 offset:32768
  v_xor_b32 v251, 80, v242
  ds_read_b128 v[188:191], v251 offset:32768
  s_waitcnt lgkmcnt(0)
  v_xor_b32 v248, 0, v240
  s_add_u32 m0, s66, 98304
  s_movk_i32 s67, 896
  buffer_load_dwordx4 v248, s[8:11], s67 offen lds
  v_xor_b32 v249, 64, v240
  s_add_u32 m0, s66, 99328
  s_movk_i32 s67, 9088
  buffer_load_dwordx4 v249, s[8:11], s67 offen lds
  v_xor_b32 v250, 0, v240
  s_add_u32 m0, s66, 100352
  s_movk_i32 s67, 17280
  buffer_load_dwordx4 v250, s[8:11], s67 offen lds
  v_xor_b32 v251, 64, v240
  s_add_u32 m0, s66, 101376
  s_movk_i32 s67, 25472
  buffer_load_dwordx4 v251, s[8:11], s67 offen lds
  v_lshlrev_b32 v20, 16, v144
  v_and_b32 v21, 0xffff0000, v144
  v_pk_add_f32 v[16:17], v[16:17], v[20:21]
  v_pk_fma_f32 v[18:19], v[20:21], v[20:21], v[18:19]
  v_lshlrev_b32 v22, 16, v145
  v_and_b32 v23, 0xffff0000, v145
  v_pk_add_f32 v[16:17], v[16:17], v[22:23]
  v_pk_fma_f32 v[18:19], v[22:23], v[22:23], v[18:19]
  v_lshlrev_b32 v24, 16, v146
  v_and_b32 v25, 0xffff0000, v146
  v_pk_add_f32 v[16:17], v[16:17], v[24:25]
  v_pk_fma_f32 v[18:19], v[24:25], v[24:25], v[18:19]
  v_lshlrev_b32 v26, 16, v147
  v_and_b32 v27, 0xffff0000, v147
  v_pk_add_f32 v[16:17], v[16:17], v[26:27]
  v_pk_fma_f32 v[18:19], v[26:27], v[26:27], v[18:19]
  v_lshlrev_b32 v20, 16, v148
  v_and_b32 v21, 0xffff0000, v148
  v_pk_add_f32 v[16:17], v[16:17], v[20:21]
  v_pk_fma_f32 v[18:19], v[20:21], v[20:21], v[18:19]
  v_lshlrev_b32 v22, 16, v149
  v_and_b32 v23, 0xffff0000, v149
  v_pk_add_f32 v[16:17], v[16:17], v[22:23]
  v_pk_fma_f32 v[18:19], v[22:23], v[22:23], v[18:19]
  v_lshlrev_b32 v24, 16, v150
  v_and_b32 v25, 0xffff0000, v150
  v_pk_add_f32 v[16:17], v[16:17], v[24:25]
  v_pk_fma_f32 v[18:19], v[24:25], v[24:25], v[18:19]
  v_lshlrev_b32 v26, 16, v151
  v_and_b32 v27, 0xffff0000, v151
  v_pk_add_f32 v[16:17], v[16:17], v[26:27]
  v_pk_fma_f32 v[18:19], v[26:27], v[26:27], v[18:19]
  v_lshlrev_b32 v20, 16, v152
  v_and_b32 v21, 0xffff0000, v152
  v_pk_add_f32 v[16:17], v[16:17], v[20:21]
  v_pk_fma_f32 v[18:19], v[20:21], v[20:21], v[18:19]
  v_lshlrev_b32 v22, 16, v153
  v_and_b32 v23, 0xffff0000, v153
  v_pk_add_f32 v[16:17], v[16:17], v[22:23]
  v_pk_fma_f32 v[18:19], v[22:23], v[22:23], v[18:19]
  v_lshlrev_b32 v24, 16, v154
  v_and_b32 v25, 0xffff0000, v154
  v_pk_add_f32 v[16:17], v[16:17], v[24:25]
  v_pk_fma_f32 v[18:19], v[24:25], v[24:25], v[18:19]
  v_lshlrev_b32 v26, 16, v155
  v_and_b32 v27, 0xffff0000, v155
  v_pk_add_f32 v[16:17], v[16:17], v[26:27]
  v_pk_fma_f32 v[18:19], v[26:27], v[26:27], v[18:19]
  v_lshlrev_b32 v20, 16, v156
  v_and_b32 v21, 0xffff0000, v156
  v_pk_add_f32 v[16:17], v[16:17], v[20:21]
  v_pk_fma_f32 v[18:19], v[20:21], v[20:21], v[18:19]
  v_lshlrev_b32 v22, 16, v157
  v_and_b32 v23, 0xffff0000, v157
  v_pk_add_f32 v[16:17], v[16:17], v[22:23]
  v_pk_fma_f32 v[18:19], v[22:23], v[22:23], v[18:19]
  v_lshlrev_b32 v24, 16, v158
  v_and_b32 v25, 0xffff0000, v158
  v_pk_add_f32 v[16:17], v[16:17], v[24:25]
  v_pk_fma_f32 v[18:19], v[24:25], v[24:25], v[18:19]
  v_lshlrev_b32 v26, 16, v159
  v_and_b32 v27, 0xffff0000, v159
  v_pk_add_f32 v[16:17], v[16:17], v[26:27]
  v_pk_fma_f32 v[18:19], v[26:27], v[26:27], v[18:19]
  v_lshlrev_b32 v20, 16, v160
  v_and_b32 v21, 0xffff0000, v160
  v_pk_add_f32 v[16:17], v[16:17], v[20:21]
  v_pk_fma_f32 v[18:19], v[20:21], v[20:21], v[18:19]
  v_lshlrev_b32 v22, 16, v161
  v_and_b32 v23, 0xffff0000, v161
  v_pk_add_f32 v[16:17], v[16:17], v[22:23]
  v_pk_fma_f32 v[18:19], v[22:23], v[22:23], v[18:19]
  v_lshlrev_b32 v24, 16, v162
  v_and_b32 v25, 0xffff0000, v162
  v_pk_add_f32 v[16:17], v[16:17], v[24:25]
  v_pk_fma_f32 v[18:19], v[24:25], v[24:25], v[18:19]
  v_lshlrev_b32 v26, 16, v163
  v_and_b32 v27, 0xffff0000, v163
  v_pk_add_f32 v[16:17], v[16:17], v[26:27]
  v_pk_fma_f32 v[18:19], v[26:27], v[26:27], v[18:19]
  v_lshlrev_b32 v20, 16, v164
  v_and_b32 v21, 0xffff0000, v164
  v_pk_add_f32 v[16:17], v[16:17], v[20:21]
  v_pk_fma_f32 v[18:19], v[20:21], v[20:21], v[18:19]
  v_lshlrev_b32 v22, 16, v165
  v_and_b32 v23, 0xffff0000, v165
  v_pk_add_f32 v[16:17], v[16:17], v[22:23]
  v_pk_fma_f32 v[18:19], v[22:23], v[22:23], v[18:19]
  v_lshlrev_b32 v24, 16, v166
  v_and_b32 v25, 0xffff0000, v166
  v_pk_add_f32 v[16:17], v[16:17], v[24:25]
  v_pk_fma_f32 v[18:19], v[24:25], v[24:25], v[18:19]
  v_lshlrev_b32 v26, 16, v167
  v_and_b32 v27, 0xffff0000, v167
  v_pk_add_f32 v[16:17], v[16:17], v[26:27]
  v_pk_fma_f32 v[18:19], v[26:27], v[26:27], v[18:19]
  v_lshlrev_b32 v20, 16, v168
  v_and_b32 v21, 0xffff0000, v168
  v_pk_add_f32 v[16:17], v[16:17], v[20:21]
  v_pk_fma_f32 v[18:19], v[20:21], v[20:21], v[18:19]
  v_lshlrev_b32 v22, 16, v169
  v_and_b32 v23, 0xffff0000, v169
  v_pk_add_f32 v[16:17], v[16:17], v[22:23]
  v_pk_fma_f32 v[18:19], v[22:23], v[22:23], v[18:19]
  v_lshlrev_b32 v24, 16, v170
  v_and_b32 v25, 0xffff0000, v170
  v_pk_add_f32 v[16:17], v[16:17], v[24:25]
  v_pk_fma_f32 v[18:19], v[24:25], v[24:25], v[18:19]
  v_lshlrev_b32 v26, 16, v171
  v_and_b32 v27, 0xffff0000, v171
  v_pk_add_f32 v[16:17], v[16:17], v[26:27]
  v_pk_fma_f32 v[18:19], v[26:27], v[26:27], v[18:19]
  v_lshlrev_b32 v20, 16, v172
  v_and_b32 v21, 0xffff0000, v172
  v_pk_add_f32 v[16:17], v[16:17], v[20:21]
  v_pk_fma_f32 v[18:19], v[20:21], v[20:21], v[18:19]
  v_lshlrev_b32 v22, 16, v173
  v_and_b32 v23, 0xffff0000, v173
  v_pk_add_f32 v[16:17], v[16:17], v[22:23]
  v_pk_fma_f32 v[18:19], v[22:23], v[22:23], v[18:19]
  v_lshlrev_b32 v24, 16, v174
  v_and_b32 v25, 0xffff0000, v174
  v_pk_add_f32 v[16:17], v[16:17], v[24:25]
  v_pk_fma_f32 v[18:19], v[24:25], v[24:25], v[18:19]
  v_lshlrev_b32 v26, 16, v175
  v_and_b32 v27, 0xffff0000, v175
  v_pk_add_f32 v[16:17], v[16:17], v[26:27]
  v_pk_fma_f32 v[18:19], v[26:27], v[26:27], v[18:19]
  s_waitcnt vmcnt(12)
  v_xor_b32 v248, 0, v243
  ds_read_b128 v[192:195], v248 offset:0
  v_xor_b32 v249, 16, v243
  ds_read_b128 v[196:199], v249 offset:0
  v_xor_b32 v250, 64, v243
  ds_read_b128 v[200:203], v250 offset:0
  v_xor_b32 v251, 80, v243
  ds_read_b128 v[204:207], v251 offset:0
  s_waitcnt lgkmcnt(0)
  v_lshlrev_b32 v20, 16, v176
  v_and_b32 v21, 0xffff0000, v176
  v_pk_add_f32 v[16:17], v[16:17], v[20:21]
  v_pk_fma_f32 v[18:19], v[20:21], v[20:21], v[18:19]
  v_lshlrev_b32 v22, 16, v177
  v_and_b32 v23, 0xffff0000, v177
  v_pk_add_f32 v[16:17], v[16:17], v[22:23]
  v_pk_fma_f32 v[18:19], v[22:23], v[22:23], v[18:19]
  v_lshlrev_b32 v24, 16, v178
  v_and_b32 v25, 0xffff0000, v178
  v_pk_add_f32 v[16:17], v[16:17], v[24:25]
  v_pk_fma_f32 v[18:19], v[24:25], v[24:25], v[18:19]
  v_lshlrev_b32 v26, 16, v179
  v_and_b32 v27, 0xffff0000, v179
  v_pk_add_f32 v[16:17], v[16:17], v[26:27]
  v_pk_fma_f32 v[18:19], v[26:27], v[26:27], v[18:19]
  v_lshlrev_b32 v20, 16, v180
  v_and_b32 v21, 0xffff0000, v180
  v_pk_add_f32 v[16:17], v[16:17], v[20:21]
  v_pk_fma_f32 v[18:19], v[20:21], v[20:21], v[18:19]
  v_lshlrev_b32 v22, 16, v181
  v_and_b32 v23, 0xffff0000, v181
  v_pk_add_f32 v[16:17], v[16:17], v[22:23]
  v_pk_fma_f32 v[18:19], v[22:23], v[22:23], v[18:19]
  v_lshlrev_b32 v24, 16, v182
  v_and_b32 v25, 0xffff0000, v182
  v_pk_add_f32 v[16:17], v[16:17], v[24:25]
  v_pk_fma_f32 v[18:19], v[24:25], v[24:25], v[18:19]
  v_lshlrev_b32 v26, 16, v183
  v_and_b32 v27, 0xffff0000, v183
  v_pk_add_f32 v[16:17], v[16:17], v[26:27]
  v_pk_fma_f32 v[18:19], v[26:27], v[26:27], v[18:19]
  v_lshlrev_b32 v20, 16, v184
  v_and_b32 v21, 0xffff0000, v184
  v_pk_add_f32 v[16:17], v[16:17], v[20:21]
  v_pk_fma_f32 v[18:19], v[20:21], v[20:21], v[18:19]
  v_lshlrev_b32 v22, 16, v185
  v_and_b32 v23, 0xffff0000, v185
  v_pk_add_f32 v[16:17], v[16:17], v[22:23]
  v_pk_fma_f32 v[18:19], v[22:23], v[22:23], v[18:19]
  v_lshlrev_b32 v24, 16, v186
  v_and_b32 v25, 0xffff0000, v186
  v_pk_add_f32 v[16:17], v[16:17], v[24:25]
  v_pk_fma_f32 v[18:19], v[24:25], v[24:25], v[18:19]
  v_lshlrev_b32 v26, 16, v187
  v_and_b32 v27, 0xffff0000, v187
  v_pk_add_f32 v[16:17], v[16:17], v[26:27]
  v_pk_fma_f32 v[18:19], v[26:27], v[26:27], v[18:19]
  v_lshlrev_b32 v20, 16, v188
  v_and_b32 v21, 0xffff0000, v188
  v_pk_add_f32 v[16:17], v[16:17], v[20:21]
  v_pk_fma_f32 v[18:19], v[20:21], v[20:21], v[18:19]
  v_lshlrev_b32 v22, 16, v189
  v_and_b32 v23, 0xffff0000, v189
  v_pk_add_f32 v[16:17], v[16:17], v[22:23]
  v_pk_fma_f32 v[18:19], v[22:23], v[22:23], v[18:19]
  v_lshlrev_b32 v24, 16, v190
  v_and_b32 v25, 0xffff0000, v190
  v_pk_add_f32 v[16:17], v[16:17], v[24:25]
  v_pk_fma_f32 v[18:19], v[24:25], v[24:25], v[18:19]
  v_lshlrev_b32 v26, 16, v191
  v_and_b32 v27, 0xffff0000, v191
  v_pk_add_f32 v[16:17], v[16:17], v[26:27]
  v_pk_fma_f32 v[18:19], v[26:27], v[26:27], v[18:19]
  v_lshlrev_b32 v20, 16, v192
  v_and_b32 v21, 0xffff0000, v192
  v_pk_add_f32 v[16:17], v[16:17], v[20:21]
  v_pk_fma_f32 v[18:19], v[20:21], v[20:21], v[18:19]
  v_lshlrev_b32 v22, 16, v193
  v_and_b32 v23, 0xffff0000, v193
  v_pk_add_f32 v[16:17], v[16:17], v[22:23]
  v_pk_fma_f32 v[18:19], v[22:23], v[22:23], v[18:19]
  v_lshlrev_b32 v24, 16, v194
  v_and_b32 v25, 0xffff0000, v194
  v_pk_add_f32 v[16:17], v[16:17], v[24:25]
  v_pk_fma_f32 v[18:19], v[24:25], v[24:25], v[18:19]
  v_lshlrev_b32 v26, 16, v195
  v_and_b32 v27, 0xffff0000, v195
  v_pk_add_f32 v[16:17], v[16:17], v[26:27]
  v_pk_fma_f32 v[18:19], v[26:27], v[26:27], v[18:19]
  v_lshlrev_b32 v20, 16, v196
  v_and_b32 v21, 0xffff0000, v196
  v_pk_add_f32 v[16:17], v[16:17], v[20:21]
  v_pk_fma_f32 v[18:19], v[20:21], v[20:21], v[18:19]
  v_lshlrev_b32 v22, 16, v197
  v_and_b32 v23, 0xffff0000, v197
  v_pk_add_f32 v[16:17], v[16:17], v[22:23]
  v_pk_fma_f32 v[18:19], v[22:23], v[22:23], v[18:19]
  v_lshlrev_b32 v24, 16, v198
  v_and_b32 v25, 0xffff0000, v198
  v_pk_add_f32 v[16:17], v[16:17], v[24:25]
  v_pk_fma_f32 v[18:19], v[24:25], v[24:25], v[18:19]
  v_lshlrev_b32 v26, 16, v199
  v_and_b32 v27, 0xffff0000, v199
  v_pk_add_f32 v[16:17], v[16:17], v[26:27]
  v_pk_fma_f32 v[18:19], v[26:27], v[26:27], v[18:19]
  v_lshlrev_b32 v20, 16, v200
  v_and_b32 v21, 0xffff0000, v200
  v_pk_add_f32 v[16:17], v[16:17], v[20:21]
  v_pk_fma_f32 v[18:19], v[20:21], v[20:21], v[18:19]
  v_lshlrev_b32 v22, 16, v201
  v_and_b32 v23, 0xffff0000, v201
  v_pk_add_f32 v[16:17], v[16:17], v[22:23]
  v_pk_fma_f32 v[18:19], v[22:23], v[22:23], v[18:19]
  v_lshlrev_b32 v24, 16, v202
  v_and_b32 v25, 0xffff0000, v202
  v_pk_add_f32 v[16:17], v[16:17], v[24:25]
  v_pk_fma_f32 v[18:19], v[24:25], v[24:25], v[18:19]
  v_lshlrev_b32 v26, 16, v203
  v_and_b32 v27, 0xffff0000, v203
  v_pk_add_f32 v[16:17], v[16:17], v[26:27]
  v_pk_fma_f32 v[18:19], v[26:27], v[26:27], v[18:19]
  v_lshlrev_b32 v20, 16, v204
  v_and_b32 v21, 0xffff0000, v204
  v_pk_add_f32 v[16:17], v[16:17], v[20:21]
  v_pk_fma_f32 v[18:19], v[20:21], v[20:21], v[18:19]
  v_lshlrev_b32 v22, 16, v205
  v_and_b32 v23, 0xffff0000, v205
  v_pk_add_f32 v[16:17], v[16:17], v[22:23]
  v_pk_fma_f32 v[18:19], v[22:23], v[22:23], v[18:19]
  v_lshlrev_b32 v24, 16, v206
  v_and_b32 v25, 0xffff0000, v206
  v_pk_add_f32 v[16:17], v[16:17], v[24:25]
  v_pk_fma_f32 v[18:19], v[24:25], v[24:25], v[18:19]
  v_lshlrev_b32 v26, 16, v207
  v_and_b32 v27, 0xffff0000, v207
  v_pk_add_f32 v[16:17], v[16:17], v[26:27]
  v_pk_fma_f32 v[18:19], v[26:27], v[26:27], v[18:19]
  s_waitcnt vmcnt(4)
  v_xor_b32 v248, 0, v242
  ds_read_b128 v[208:211], v248 offset:0
  v_xor_b32 v249, 16, v242
  ds_read_b128 v[212:215], v249 offset:0
  v_xor_b32 v250, 64, v242
  ds_read_b128 v[216:219], v250 offset:0
  v_xor_b32 v251, 80, v242
  ds_read_b128 v[220:223], v251 offset:0
  s_waitcnt vmcnt(0)
  v_xor_b32 v248, 0, v242
  ds_read_b128 v[224:227], v248 offset:32768
  v_xor_b32 v249, 16, v242
  ds_read_b128 v[228:231], v249 offset:32768
  v_xor_b32 v250, 64, v242
  ds_read_b128 v[232:235], v250 offset:32768
  v_xor_b32 v251, 80, v242
  ds_read_b128 v[236:239], v251 offset:32768
  s_waitcnt lgkmcnt(0)
  s_barrier
  s_add_u32 m0, s58, 65536
  s_mul_i32 s57, s52, 256
  s_add_u32 s57, s57, s53
  buffer_load_dwordx4 v10, s[12:15], s57 offen lds
  s_add_u32 m0, s58, 66560
  s_mul_i32 s57, s52, 260
  s_add_u32 s57, s57, s53
  buffer_load_dwordx4 v10, s[12:15], s57 offen lds
  s_add_u32 m0, s58, 67584
  s_mul_i32 s57, s52, 264
  s_add_u32 s57, s57, s53
  buffer_load_dwordx4 v10, s[12:15], s57 offen lds
  s_add_u32 m0, s58, 68608
  s_mul_i32 s57, s52, 268
  s_add_u32 s57, s57, s53
  buffer_load_dwordx4 v10, s[12:15], s57 offen lds
  s_add_u32 m0, s58, 98304
  s_mul_i32 s57, s52, 384
  s_add_u32 s57, s57, s53
  buffer_load_dwordx4 v10, s[12:15], s57 offen lds
  s_add_u32 m0, s58, 99328
  s_mul_i32 s57, s52, 388
  s_add_u32 s57, s57, s53
  buffer_load_dwordx4 v10, s[12:15], s57 offen lds
  s_add_u32 m0, s58, 100352
  s_mul_i32 s57, s52, 392
  s_add_u32 s57, s57, s53
  buffer_load_dwordx4 v10, s[12:15], s57 offen lds
  s_add_u32 m0, s58, 101376
  s_mul_i32 s57, s52, 396
  s_add_u32 s57, s57, s53
  buffer_load_dwordx4 v10, s[12:15], s57 offen lds
  v_lshlrev_b32 v20, 16, v208
  v_and_b32 v21, 0xffff0000, v208
  v_pk_add_f32 v[16:17], v[16:17], v[20:21]
  v_pk_fma_f32 v[18:19], v[20:21], v[20:21], v[18:19]
  v_lshlrev_b32 v22, 16, v209
  v_and_b32 v23, 0xffff0000, v209
  v_pk_add_f32 v[16:17], v[16:17], v[22:23]
  v_pk_fma_f32 v[18:19], v[22:23], v[22:23], v[18:19]
  v_lshlrev_b32 v24, 16, v210
  v_and_b32 v25, 0xffff0000, v210
  v_pk_add_f32 v[16:17], v[16:17], v[24:25]
  v_pk_fma_f32 v[18:19], v[24:25], v[24:25], v[18:19]
  v_lshlrev_b32 v26, 16, v211
  v_and_b32 v27, 0xffff0000, v211
  v_pk_add_f32 v[16:17], v[16:17], v[26:27]
  v_pk_fma_f32 v[18:19], v[26:27], v[26:27], v[18:19]
  v_lshlrev_b32 v20, 16, v212
  v_and_b32 v21, 0xffff0000, v212
  v_pk_add_f32 v[16:17], v[16:17], v[20:21]
  v_pk_fma_f32 v[18:19], v[20:21], v[20:21], v[18:19]
  v_lshlrev_b32 v22, 16, v213
  v_and_b32 v23, 0xffff0000, v213
  v_pk_add_f32 v[16:17], v[16:17], v[22:23]
  v_pk_fma_f32 v[18:19], v[22:23], v[22:23], v[18:19]
  v_lshlrev_b32 v24, 16, v214
  v_and_b32 v25, 0xffff0000, v214
  v_pk_add_f32 v[16:17], v[16:17], v[24:25]
  v_pk_fma_f32 v[18:19], v[24:25], v[24:25], v[18:19]
  v_lshlrev_b32 v26, 16, v215
  v_and_b32 v27, 0xffff0000, v215
  v_pk_add_f32 v[16:17], v[16:17], v[26:27]
  v_pk_fma_f32 v[18:19], v[26:27], v[26:27], v[18:19]
  v_lshlrev_b32 v20, 16, v216
  v_and_b32 v21, 0xffff0000, v216
  v_pk_add_f32 v[16:17], v[16:17], v[20:21]
  v_pk_fma_f32 v[18:19], v[20:21], v[20:21], v[18:19]
  v_lshlrev_b32 v22, 16, v217
  v_and_b32 v23, 0xffff0000, v217
  v_pk_add_f32 v[16:17], v[16:17], v[22:23]
  v_pk_fma_f32 v[18:19], v[22:23], v[22:23], v[18:19]
  v_lshlrev_b32 v24, 16, v218
  v_and_b32 v25, 0xffff0000, v218
  v_pk_add_f32 v[16:17], v[16:17], v[24:25]
  v_pk_fma_f32 v[18:19], v[24:25], v[24:25], v[18:19]
  v_lshlrev_b32 v26, 16, v219
  v_and_b32 v27, 0xffff0000, v219
  v_pk_add_f32 v[16:17], v[16:17], v[26:27]
  v_pk_fma_f32 v[18:19], v[26:27], v[26:27], v[18:19]
  v_lshlrev_b32 v20, 16, v220
  v_and_b32 v21, 0xffff0000, v220
  v_pk_add_f32 v[16:17], v[16:17], v[20:21]
  v_pk_fma_f32 v[18:19], v[20:21], v[20:21], v[18:19]
  v_lshlrev_b32 v22, 16, v221
  v_and_b32 v23, 0xffff0000, v221
  v_pk_add_f32 v[16:17], v[16:17], v[22:23]
  v_pk_fma_f32 v[18:19], v[22:23], v[22:23], v[18:19]
  v_lshlrev_b32 v24, 16, v222
  v_and_b32 v25, 0xffff0000, v222
  v_pk_add_f32 v[16:17], v[16:17], v[24:25]
  v_pk_fma_f32 v[18:19], v[24:25], v[24:25], v[18:19]
  v_lshlrev_b32 v26, 16, v223
  v_and_b32 v27, 0xffff0000, v223
  v_pk_add_f32 v[16:17], v[16:17], v[26:27]
  v_pk_fma_f32 v[18:19], v[26:27], v[26:27], v[18:19]
  v_lshlrev_b32 v20, 16, v224
  v_and_b32 v21, 0xffff0000, v224
  v_pk_add_f32 v[16:17], v[16:17], v[20:21]
  v_pk_fma_f32 v[18:19], v[20:21], v[20:21], v[18:19]
  v_lshlrev_b32 v22, 16, v225
  v_and_b32 v23, 0xffff0000, v225
  v_pk_add_f32 v[16:17], v[16:17], v[22:23]
  v_pk_fma_f32 v[18:19], v[22:23], v[22:23], v[18:19]
  v_lshlrev_b32 v24, 16, v226
  v_and_b32 v25, 0xffff0000, v226
  v_pk_add_f32 v[16:17], v[16:17], v[24:25]
  v_pk_fma_f32 v[18:19], v[24:25], v[24:25], v[18:19]
  v_lshlrev_b32 v26, 16, v227
  v_and_b32 v27, 0xffff0000, v227
  v_pk_add_f32 v[16:17], v[16:17], v[26:27]
  v_pk_fma_f32 v[18:19], v[26:27], v[26:27], v[18:19]
  v_lshlrev_b32 v20, 16, v228
  v_and_b32 v21, 0xffff0000, v228
  v_pk_add_f32 v[16:17], v[16:17], v[20:21]
  v_pk_fma_f32 v[18:19], v[20:21], v[20:21], v[18:19]
  v_lshlrev_b32 v22, 16, v229
  v_and_b32 v23, 0xffff0000, v229
  v_pk_add_f32 v[16:17], v[16:17], v[22:23]
  v_pk_fma_f32 v[18:19], v[22:23], v[22:23], v[18:19]
  v_lshlrev_b32 v24, 16, v230
  v_and_b32 v25, 0xffff0000, v230
  v_pk_add_f32 v[16:17], v[16:17], v[24:25]
  v_pk_fma_f32 v[18:19], v[24:25], v[24:25], v[18:19]
  v_lshlrev_b32 v26, 16, v231
  v_and_b32 v27, 0xffff0000, v231
  v_pk_add_f32 v[16:17], v[16:17], v[26:27]
  v_pk_fma_f32 v[18:19], v[26:27], v[26:27], v[18:19]
  v_lshlrev_b32 v20, 16, v232
  v_and_b32 v21, 0xffff0000, v232
  v_pk_add_f32 v[16:17], v[16:17], v[20:21]
  v_pk_fma_f32 v[18:19], v[20:21], v[20:21], v[18:19]
  v_lshlrev_b32 v22, 16, v233
  v_and_b32 v23, 0xffff0000, v233
  v_pk_add_f32 v[16:17], v[16:17], v[22:23]
  v_pk_fma_f32 v[18:19], v[22:23], v[22:23], v[18:19]
  v_lshlrev_b32 v24, 16, v234
  v_and_b32 v25, 0xffff0000, v234
  v_pk_add_f32 v[16:17], v[16:17], v[24:25]
  v_pk_fma_f32 v[18:19], v[24:25], v[24:25], v[18:19]
  v_lshlrev_b32 v26, 16, v235
  v_and_b32 v27, 0xffff0000, v235
  v_pk_add_f32 v[16:17], v[16:17], v[26:27]
  v_pk_fma_f32 v[18:19], v[26:27], v[26:27], v[18:19]
  v_lshlrev_b32 v20, 16, v236
  v_and_b32 v21, 0xffff0000, v236
  v_pk_add_f32 v[16:17], v[16:17], v[20:21]
  v_pk_fma_f32 v[18:19], v[20:21], v[20:21], v[18:19]
  v_lshlrev_b32 v22, 16, v237
  v_and_b32 v23, 0xffff0000, v237
  v_pk_add_f32 v[16:17], v[16:17], v[22:23]
  v_pk_fma_f32 v[18:19], v[22:23], v[22:23], v[18:19]
  v_lshlrev_b32 v24, 16, v238
  v_and_b32 v25, 0xffff0000, v238
  v_pk_add_f32 v[16:17], v[16:17], v[24:25]
  v_pk_fma_f32 v[18:19], v[24:25], v[24:25], v[18:19]
  v_lshlrev_b32 v26, 16, v239
  v_and_b32 v27, 0xffff0000, v239
  v_pk_add_f32 v[16:17], v[16:17], v[26:27]
  v_pk_fma_f32 v[18:19], v[26:27], v[26:27], v[18:19]
  v_add_f32 v16, v16, v17
  v_add_f32 v18, v18, v19
  v_mov_b32 v17, v16
  v_mov_b32 v19, v18
  s_nop 1
  v_permlane32_swap_b32 v16, v17
  v_permlane32_swap_b32 v18, v19
  s_nop 1
  v_add_f32 v16, v16, v17
  v_add_f32 v18, v18, v19
  v_mul_f32 v16, 0x3b000000, v16
  v_mul_f32 v18, 0x3b000000, v18
  v_fma_f32 v18, -v16, v16, v18
  v_max_f32 v18, 0, v18
  v_cvt_pk_bf16_f32 v16, v16, v18
  v_and_b32 v18, 0xffff0000, v16
  v_lshlrev_b32 v16, 16, v16
  v_add_f32 v18, 0x3727c5ac, v18
  v_cvt_pk_bf16_f32 v18, v18, v18
  v_lshlrev_b32 v18, 16, v18
  v_sqrt_f32 v18, v18
  s_nop 0
  v_cvt_pk_bf16_f32 v18, v18, v18
  v_lshlrev_b32 v18, 16, v18
  v_rcp_f32 v18, v18
  v_mov_b32 v244, v16
  v_mov_b32 v245, v16
  v_mov_b32 v246, v18
  v_mul_f32 v247, 0x3e0293ee, v18
  ds_read_b64_tr_b16 v[16:17], v2 offset:0
  ds_read_b64_tr_b16 v[18:19], v2 offset:1024
  ds_read_b64_tr_b16 v[20:21], v3 offset:0
  ds_read_b64_tr_b16 v[22:23], v3 offset:1024
  ds_read_b64_tr_b16 v[24:25], v4 offset:0
  ds_read_b64_tr_b16 v[26:27], v4 offset:1024
  ds_read_b64_tr_b16 v[28:29], v5 offset:0
  ds_read_b64_tr_b16 v[30:31], v5 offset:1024
  v_lshlrev_b32 v248, 16, v112
  v_and_b32 v249, 0xffff0000, v112
  v_pk_add_f32 v[248:249], v[248:249], v[244:245] neg_lo:[0,1] neg_hi:[0,1]
  v_cvt_pk_bf16_f32 v112, v248, v249
  v_lshlrev_b32 v250, 16, v113
  v_and_b32 v251, 0xffff0000, v113
  v_pk_add_f32 v[250:251], v[250:251], v[244:245] neg_lo:[0,1] neg_hi:[0,1]
  v_cvt_pk_bf16_f32 v113, v250, v251
  v_lshlrev_b32 v252, 16, v114
  v_and_b32 v253, 0xffff0000, v114
  v_pk_add_f32 v[252:253], v[252:253], v[244:245] neg_lo:[0,1] neg_hi:[0,1]
  v_cvt_pk_bf16_f32 v114, v252, v253
  v_lshlrev_b32 v248, 16, v115
  v_and_b32 v249, 0xffff0000, v115
  v_pk_add_f32 v[248:249], v[248:249], v[244:245] neg_lo:[0,1] neg_hi:[0,1]
  v_cvt_pk_bf16_f32 v115, v248, v249
  v_lshlrev_b32 v250, 16, v116
  v_and_b32 v251, 0xffff0000, v116
  v_pk_add_f32 v[250:251], v[250:251], v[244:245] neg_lo:[0,1] neg_hi:[0,1]
  v_cvt_pk_bf16_f32 v116, v250, v251
  v_lshlrev_b32 v252, 16, v117
  v_and_b32 v253, 0xffff0000, v117
  v_pk_add_f32 v[252:253], v[252:253], v[244:245] neg_lo:[0,1] neg_hi:[0,1]
  v_cvt_pk_bf16_f32 v117, v252, v253
  v_lshlrev_b32 v248, 16, v118
  v_and_b32 v249, 0xffff0000, v118
  v_pk_add_f32 v[248:249], v[248:249], v[244:245] neg_lo:[0,1] neg_hi:[0,1]
  v_cvt_pk_bf16_f32 v118, v248, v249
  v_lshlrev_b32 v250, 16, v119
  v_and_b32 v251, 0xffff0000, v119
  v_pk_add_f32 v[250:251], v[250:251], v[244:245] neg_lo:[0,1] neg_hi:[0,1]
  v_cvt_pk_bf16_f32 v119, v250, v251
  v_lshlrev_b32 v252, 16, v120
  v_and_b32 v253, 0xffff0000, v120
  v_pk_add_f32 v[252:253], v[252:253], v[244:245] neg_lo:[0,1] neg_hi:[0,1]
  v_cvt_pk_bf16_f32 v120, v252, v253
  v_lshlrev_b32 v248, 16, v121
  v_and_b32 v249, 0xffff0000, v121
  v_pk_add_f32 v[248:249], v[248:249], v[244:245] neg_lo:[0,1] neg_hi:[0,1]
  v_cvt_pk_bf16_f32 v121, v248, v249
  v_lshlrev_b32 v250, 16, v122
  v_and_b32 v251, 0xffff0000, v122
  v_pk_add_f32 v[250:251], v[250:251], v[244:245] neg_lo:[0,1] neg_hi:[0,1]
  v_cvt_pk_bf16_f32 v122, v250, v251
  v_lshlrev_b32 v252, 16, v123
  v_and_b32 v253, 0xffff0000, v123
  v_pk_add_f32 v[252:253], v[252:253], v[244:245] neg_lo:[0,1] neg_hi:[0,1]
  v_cvt_pk_bf16_f32 v123, v252, v253
  v_lshlrev_b32 v248, 16, v124
  v_and_b32 v249, 0xffff0000, v124
  v_pk_add_f32 v[248:249], v[248:249], v[244:245] neg_lo:[0,1] neg_hi:[0,1]
  v_cvt_pk_bf16_f32 v124, v248, v249
  v_lshlrev_b32 v250, 16, v125
  v_and_b32 v251, 0xffff0000, v125
  v_pk_add_f32 v[250:251], v[250:251], v[244:245] neg_lo:[0,1] neg_hi:[0,1]
  v_cvt_pk_bf16_f32 v125, v250, v251
  v_lshlrev_b32 v252, 16, v126
  v_and_b32 v253, 0xffff0000, v126
  v_pk_add_f32 v[252:253], v[252:253], v[244:245] neg_lo:[0,1] neg_hi:[0,1]
  v_cvt_pk_bf16_f32 v126, v252, v253
  v_lshlrev_b32 v248, 16, v127
  v_and_b32 v249, 0xffff0000, v127
  v_pk_add_f32 v[248:249], v[248:249], v[244:245] neg_lo:[0,1] neg_hi:[0,1]
  v_cvt_pk_bf16_f32 v127, v248, v249
  v_lshlrev_b32 v250, 16, v128
  v_and_b32 v251, 0xffff0000, v128
  v_pk_add_f32 v[250:251], v[250:251], v[244:245] neg_lo:[0,1] neg_hi:[0,1]
  v_cvt_pk_bf16_f32 v128, v250, v251
  v_lshlrev_b32 v252, 16, v129
  v_and_b32 v253, 0xffff0000, v129
  v_pk_add_f32 v[252:253], v[252:253], v[244:245] neg_lo:[0,1] neg_hi:[0,1]
  v_cvt_pk_bf16_f32 v129, v252, v253
  v_lshlrev_b32 v248, 16, v130
  v_and_b32 v249, 0xffff0000, v130
  v_pk_add_f32 v[248:249], v[248:249], v[244:245] neg_lo:[0,1] neg_hi:[0,1]
  v_cvt_pk_bf16_f32 v130, v248, v249
  v_lshlrev_b32 v250, 16, v131
  v_and_b32 v251, 0xffff0000, v131
  v_pk_add_f32 v[250:251], v[250:251], v[244:245] neg_lo:[0,1] neg_hi:[0,1]
  v_cvt_pk_bf16_f32 v131, v250, v251
  v_lshlrev_b32 v252, 16, v132
  v_and_b32 v253, 0xffff0000, v132
  v_pk_add_f32 v[252:253], v[252:253], v[244:245] neg_lo:[0,1] neg_hi:[0,1]
  v_cvt_pk_bf16_f32 v132, v252, v253
  v_lshlrev_b32 v248, 16, v133
  v_and_b32 v249, 0xffff0000, v133
  v_pk_add_f32 v[248:249], v[248:249], v[244:245] neg_lo:[0,1] neg_hi:[0,1]
  v_cvt_pk_bf16_f32 v133, v248, v249
  v_lshlrev_b32 v250, 16, v134
  v_and_b32 v251, 0xffff0000, v134
  v_pk_add_f32 v[250:251], v[250:251], v[244:245] neg_lo:[0,1] neg_hi:[0,1]
  v_cvt_pk_bf16_f32 v134, v250, v251
  v_lshlrev_b32 v252, 16, v135
  v_and_b32 v253, 0xffff0000, v135
  v_pk_add_f32 v[252:253], v[252:253], v[244:245] neg_lo:[0,1] neg_hi:[0,1]
  v_cvt_pk_bf16_f32 v135, v252, v253
  v_lshlrev_b32 v248, 16, v136
  v_and_b32 v249, 0xffff0000, v136
  v_pk_add_f32 v[248:249], v[248:249], v[244:245] neg_lo:[0,1] neg_hi:[0,1]
  v_cvt_pk_bf16_f32 v136, v248, v249
  v_lshlrev_b32 v250, 16, v137
  v_and_b32 v251, 0xffff0000, v137
  v_pk_add_f32 v[250:251], v[250:251], v[244:245] neg_lo:[0,1] neg_hi:[0,1]
  v_cvt_pk_bf16_f32 v137, v250, v251
  v_lshlrev_b32 v252, 16, v138
  v_and_b32 v253, 0xffff0000, v138
  v_pk_add_f32 v[252:253], v[252:253], v[244:245] neg_lo:[0,1] neg_hi:[0,1]
  v_cvt_pk_bf16_f32 v138, v252, v253
  v_lshlrev_b32 v248, 16, v139
  v_and_b32 v249, 0xffff0000, v139
  v_pk_add_f32 v[248:249], v[248:249], v[244:245] neg_lo:[0,1] neg_hi:[0,1]
  v_cvt_pk_bf16_f32 v139, v248, v249
  v_lshlrev_b32 v250, 16, v140
  v_and_b32 v251, 0xffff0000, v140
  v_pk_add_f32 v[250:251], v[250:251], v[244:245] neg_lo:[0,1] neg_hi:[0,1]
  v_cvt_pk_bf16_f32 v140, v250, v251
  v_lshlrev_b32 v252, 16, v141
  v_and_b32 v253, 0xffff0000, v141
  v_pk_add_f32 v[252:253], v[252:253], v[244:245] neg_lo:[0,1] neg_hi:[0,1]
  v_cvt_pk_bf16_f32 v141, v252, v253
  v_lshlrev_b32 v248, 16, v142
  v_and_b32 v249, 0xffff0000, v142
  v_pk_add_f32 v[248:249], v[248:249], v[244:245] neg_lo:[0,1] neg_hi:[0,1]
  v_cvt_pk_bf16_f32 v142, v248, v249
  v_lshlrev_b32 v250, 16, v143
  v_and_b32 v251, 0xffff0000, v143
  v_pk_add_f32 v[250:251], v[250:251], v[244:245] neg_lo:[0,1] neg_hi:[0,1]
  v_cvt_pk_bf16_f32 v143, v250, v251
  s_mov_b32 s48, s28
  s_mov_b32 s49, s29
  s_mov_b32 s50, 0x400000
  s_mov_b32 s54, 8192
  s_mov_b32 s55, s62
  v_mul_lo_u32 v11, v13, s54
  v_add_u32 v11, v11, v14
  s_add_u32 s56, s63, 0x0
  s_waitcnt vmcnt(8)
  s_barrier
  s_waitcnt lgkmcnt(6)
  v_mfma_f32_32x32x16_bf16 v[48:63], v[16:19], v[112:115], 0
  ds_read_b64_tr_b16 v[32:33], v2 offset:2048
  ds_read_b64_tr_b16 v[34:35], v2 offset:3072
  v_lshlrev_b32 v252, 16, v144
  v_and_b32 v253, 0xffff0000, v144
  v_pk_add_f32 v[252:253], v[252:253], v[244:245] neg_lo:[0,1] neg_hi:[0,1]
  v_cvt_pk_bf16_f32 v144, v252, v253
  s_waitcnt lgkmcnt(6)
  v_mfma_f32_32x32x16_bf16 v[64:79], v[20:23], v[112:115], 0
  ds_read_b64_tr_b16 v[36:37], v3 offset:2048
  ds_read_b64_tr_b16 v[38:39], v3 offset:3072
  v_lshlrev_b32 v248, 16, v145
  v_and_b32 v249, 0xffff0000, v145
  v_pk_add_f32 v[248:249], v[248:249], v[244:245] neg_lo:[0,1] neg_hi:[0,1]
  v_cvt_pk_bf16_f32 v145, v248, v249
  s_waitcnt lgkmcnt(6)
  v_mfma_f32_32x32x16_bf16 v[80:95], v[24:27], v[112:115], 0
  ds_read_b64_tr_b16 v[40:41], v4 offset:2048
  ds_read_b64_tr_b16 v[42:43], v4 offset:3072
  v_lshlrev_b32 v250, 16, v146
  v_and_b32 v251, 0xffff0000, v146
  v_pk_add_f32 v[250:251], v[250:251], v[244:245] neg_lo:[0,1] neg_hi:[0,1]
  v_cvt_pk_bf16_f32 v146, v250, v251
  s_waitcnt lgkmcnt(6)
  v_mfma_f32_32x32x16_bf16 v[96:111], v[28:31], v[112:115], 0
  ds_read_b64_tr_b16 v[44:45], v5 offset:2048
  ds_read_b64_tr_b16 v[46:47], v5 offset:3072
  v_lshlrev_b32 v252, 16, v147
  v_and_b32 v253, 0xffff0000, v147
  v_pk_add_f32 v[252:253], v[252:253], v[244:245] neg_lo:[0,1] neg_hi:[0,1]
  v_cvt_pk_bf16_f32 v147, v252, v253
  s_waitcnt lgkmcnt(6)
  v_mfma_f32_32x32x16_bf16 v[48:63], v[32:35], v[116:119], v[48:63]
  ds_read_b64_tr_b16 v[16:17], v2 offset:8192
  ds_read_b64_tr_b16 v[18:19], v2 offset:9216
  v_lshlrev_b32 v248, 16, v148
  v_and_b32 v249, 0xffff0000, v148
  v_pk_add_f32 v[248:249], v[248:249], v[244:245] neg_lo:[0,1] neg_hi:[0,1]
  v_cvt_pk_bf16_f32 v148, v248, v249
  s_waitcnt lgkmcnt(6)
  v_mfma_f32_32x32x16_bf16 v[64:79], v[36:39], v[116:119], v[64:79]
  ds_read_b64_tr_b16 v[20:21], v3 offset:8192
  ds_read_b64_tr_b16 v[22:23], v3 offset:9216
  v_lshlrev_b32 v250, 16, v149
  v_and_b32 v251, 0xffff0000, v149
  v_pk_add_f32 v[250:251], v[250:251], v[244:245] neg_lo:[0,1] neg_hi:[0,1]
  v_cvt_pk_bf16_f32 v149, v250, v251
  s_waitcnt lgkmcnt(6)
  v_mfma_f32_32x32x16_bf16 v[80:95], v[40:43], v[116:119], v[80:95]
  ds_read_b64_tr_b16 v[24:25], v4 offset:8192
  ds_read_b64_tr_b16 v[26:27], v4 offset:9216
  v_lshlrev_b32 v252, 16, v150
  v_and_b32 v253, 0xffff0000, v150
  v_pk_add_f32 v[252:253], v[252:253], v[244:245] neg_lo:[0,1] neg_hi:[0,1]
  v_cvt_pk_bf16_f32 v150, v252, v253
  s_waitcnt lgkmcnt(6)
  v_mfma_f32_32x32x16_bf16 v[96:111], v[44:47], v[116:119], v[96:111]
  ds_read_b64_tr_b16 v[28:29], v5 offset:8192
  ds_read_b64_tr_b16 v[30:31], v5 offset:9216
  v_lshlrev_b32 v248, 16, v151
  v_and_b32 v249, 0xffff0000, v151
  v_pk_add_f32 v[248:249], v[248:249], v[244:245] neg_lo:[0,1] neg_hi:[0,1]
  v_cvt_pk_bf16_f32 v151, v248, v249
  s_waitcnt lgkmcnt(6)
  v_mfma_f32_32x32x16_bf16 v[48:63], v[16:19], v[120:123], v[48:63]
  ds_read_b64_tr_b16 v[32:33], v2 offset:10240
  ds_read_b64_tr_b16 v[34:35], v2 offset:11264
  v_lshlrev_b32 v250, 16, v152
  v_and_b32 v251, 0xffff0000, v152
  v_pk_add_f32 v[250:251], v[250:251], v[244:245] neg_lo:[0,1] neg_hi:[0,1]
  v_cvt_pk_bf16_f32 v152, v250, v251
  s_waitcnt lgkmcnt(6)
  v_mfma_f32_32x32x16_bf16 v[64:79], v[20:23], v[120:123], v[64:79]
  ds_read_b64_tr_b16 v[36:37], v3 offset:10240
  ds_read_b64_tr_b16 v[38:39], v3 offset:11264
  v_lshlrev_b32 v252, 16, v153
  v_and_b32 v253, 0xffff0000, v153
  v_pk_add_f32 v[252:253], v[252:253], v[244:245] neg_lo:[0,1] neg_hi:[0,1]
  v_cvt_pk_bf16_f32 v153, v252, v253
  s_waitcnt lgkmcnt(6)
  v_mfma_f32_32x32x16_bf16 v[80:95], v[24:27], v[120:123], v[80:95]
  ds_read_b64_tr_b16 v[40:41], v4 offset:10240
  ds_read_b64_tr_b16 v[42:43], v4 offset:11264
  v_lshlrev_b32 v248, 16, v154
  v_and_b32 v249, 0xffff0000, v154
  v_pk_add_f32 v[248:249], v[248:249], v[244:245] neg_lo:[0,1] neg_hi:[0,1]
  v_cvt_pk_bf16_f32 v154, v248, v249
  s_waitcnt lgkmcnt(6)
  v_mfma_f32_32x32x16_bf16 v[96:111], v[28:31], v[120:123], v[96:111]
  ds_read_b64_tr_b16 v[44:45], v5 offset:10240
  ds_read_b64_tr_b16 v[46:47], v5 offset:11264
  v_lshlrev_b32 v250, 16, v155
  v_and_b32 v251, 0xffff0000, v155
  v_pk_add_f32 v[250:251], v[250:251], v[244:245] neg_lo:[0,1] neg_hi:[0,1]
  v_cvt_pk_bf16_f32 v155, v250, v251
  s_waitcnt lgkmcnt(6)
  v_mfma_f32_32x32x16_bf16 v[48:63], v[32:35], v[124:127], v[48:63]
  ds_read_b64_tr_b16 v[16:17], v2 offset:16384
  ds_read_b64_tr_b16 v[18:19], v2 offset:17408
  v_lshlrev_b32 v252, 16, v156
  v_and_b32 v253, 0xffff0000, v156
  v_pk_add_f32 v[252:253], v[252:253], v[244:245] neg_lo:[0,1] neg_hi:[0,1]
  v_cvt_pk_bf16_f32 v156, v252, v253
  s_waitcnt lgkmcnt(6)
  v_mfma_f32_32x32x16_bf16 v[64:79], v[36:39], v[124:127], v[64:79]
  ds_read_b64_tr_b16 v[20:21], v3 offset:16384
  ds_read_b64_tr_b16 v[22:23], v3 offset:17408
  v_lshlrev_b32 v248, 16, v157
  v_and_b32 v249, 0xffff0000, v157
  v_pk_add_f32 v[248:249], v[248:249], v[244:245] neg_lo:[0,1] neg_hi:[0,1]
  v_cvt_pk_bf16_f32 v157, v248, v249
  s_waitcnt lgkmcnt(6)
  v_mfma_f32_32x32x16_bf16 v[80:95], v[40:43], v[124:127], v[80:95]
  ds_read_b64_tr_b16 v[24:25], v4 offset:16384
  ds_read_b64_tr_b16 v[26:27], v4 offset:17408
  v_lshlrev_b32 v250, 16, v158
  v_and_b32 v251, 0xffff0000, v158
  v_pk_add_f32 v[250:251], v[250:251], v[244:245] neg_lo:[0,1] neg_hi:[0,1]
  v_cvt_pk_bf16_f32 v158, v250, v251
  s_waitcnt lgkmcnt(6)
  v_mfma_f32_32x32x16_bf16 v[96:111], v[44:47], v[124:127], v[96:111]
  ds_read_b64_tr_b16 v[28:29], v5 offset:16384
  ds_read_b64_tr_b16 v[30:31], v5 offset:17408
  v_lshlrev_b32 v252, 16, v159
  v_and_b32 v253, 0xffff0000, v159
  v_pk_add_f32 v[252:253], v[252:253], v[244:245] neg_lo:[0,1] neg_hi:[0,1]
  v_cvt_pk_bf16_f32 v159, v252, v253
  s_waitcnt lgkmcnt(6)
  v_mfma_f32_32x32x16_bf16 v[48:63], v[16:19], v[128:131], v[48:63]
  ds_read_b64_tr_b16 v[32:33], v2 offset:18432
  ds_read_b64_tr_b16 v[34:35], v2 offset:19456
  v_lshlrev_b32 v248, 16, v160
  v_and_b32 v249, 0xffff0000, v160
  v_pk_add_f32 v[248:249], v[248:249], v[244:245] neg_lo:[0,1] neg_hi:[0,1]
  v_cvt_pk_bf16_f32 v160, v248, v249
  s_waitcnt lgkmcnt(6)
  v_mfma_f32_32x32x16_bf16 v[64:79], v[20:23], v[128:131], v[64:79]
  ds_read_b64_tr_b16 v[36:37], v3 offset:18432
  ds_read_b64_tr_b16 v[38:39], v3 offset:19456
  v_lshlrev_b32 v250, 16, v161
  v_and_b32 v251, 0xffff0000, v161
  v_pk_add_f32 v[250:251], v[250:251], v[244:245] neg_lo:[0,1] neg_hi:[0,1]
  v_cvt_pk_bf16_f32 v161, v250, v251
  s_waitcnt lgkmcnt(6)
  v_mfma_f32_32x32x16_bf16 v[80:95], v[24:27], v[128:131], v[80:95]
  ds_read_b64_tr_b16 v[40:41], v4 offset:18432
  ds_read_b64_tr_b16 v[42:43], v4 offset:19456
  v_lshlrev_b32 v252, 16, v162
  v_and_b32 v253, 0xffff0000, v162
  v_pk_add_f32 v[252:253], v[252:253], v[244:245] neg_lo:[0,1] neg_hi:[0,1]
  v_cvt_pk_bf16_f32 v162, v252, v253
  s_waitcnt lgkmcnt(6)
  v_mfma_f32_32x32x16_bf16 v[96:111], v[28:31], v[128:131], v[96:111]
  ds_read_b64_tr_b16 v[44:45], v5 offset:18432
  ds_read_b64_tr_b16 v[46:47], v5 offset:19456
  v_lshlrev_b32 v248, 16, v163
  v_and_b32 v249, 0xffff0000, v163
  v_pk_add_f32 v[248:249], v[248:249], v[244:245] neg_lo:[0,1] neg_hi:[0,1]
  v_cvt_pk_bf16_f32 v163, v248, v249
  s_waitcnt lgkmcnt(6)
  v_mfma_f32_32x32x16_bf16 v[48:63], v[32:35], v[132:135], v[48:63]
  ds_read_b64_tr_b16 v[16:17], v2 offset:24576
  ds_read_b64_tr_b16 v[18:19], v2 offset:25600
  v_lshlrev_b32 v250, 16, v164
  v_and_b32 v251, 0xffff0000, v164
  v_pk_add_f32 v[250:251], v[250:251], v[244:245] neg_lo:[0,1] neg_hi:[0,1]
  v_cvt_pk_bf16_f32 v164, v250, v251
  s_waitcnt lgkmcnt(6)
  v_mfma_f32_32x32x16_bf16 v[64:79], v[36:39], v[132:135], v[64:79]
  ds_read_b64_tr_b16 v[20:21], v3 offset:24576
  ds_read_b64_tr_b16 v[22:23], v3 offset:25600
  v_lshlrev_b32 v252, 16, v165
  v_and_b32 v253, 0xffff0000, v165
  v_pk_add_f32 v[252:253], v[252:253], v[244:245] neg_lo:[0,1] neg_hi:[0,1]
  v_cvt_pk_bf16_f32 v165, v252, v253
  s_waitcnt lgkmcnt(6)
  v_mfma_f32_32x32x16_bf16 v[80:95], v[40:43], v[132:135], v[80:95]
  ds_read_b64_tr_b16 v[24:25], v4 offset:24576
  ds_read_b64_tr_b16 v[26:27], v4 offset:25600
  v_lshlrev_b32 v248, 16, v166
  v_and_b32 v249, 0xffff0000, v166
  v_pk_add_f32 v[248:249], v[248:249], v[244:245] neg_lo:[0,1] neg_hi:[0,1]
  v_cvt_pk_bf16_f32 v166, v248, v249
  s_waitcnt lgkmcnt(6)
  v_mfma_f32_32x32x16_bf16 v[96:111], v[44:47], v[132:135], v[96:111]
  ds_read_b64_tr_b16 v[28:29], v5 offset:24576
  ds_read_b64_tr_b16 v[30:31], v5 offset:25600
  v_lshlrev_b32 v250, 16, v167
  v_and_b32 v251, 0xffff0000, v167
  v_pk_add_f32 v[250:251], v[250:251], v[244:245] neg_lo:[0,1] neg_hi:[0,1]
  v_cvt_pk_bf16_f32 v167, v250, v251
  s_waitcnt lgkmcnt(6)
  v_mfma_f32_32x32x16_bf16 v[48:63], v[16:19], v[136:139], v[48:63]
  ds_read_b64_tr_b16 v[32:33], v2 offset:26624
  ds_read_b64_tr_b16 v[34:35], v2 offset:27648
  v_lshlrev_b32 v252, 16, v168
  v_and_b32 v253, 0xffff0000, v168
  v_pk_add_f32 v[252:253], v[252:253], v[244:245] neg_lo:[0,1] neg_hi:[0,1]
  v_cvt_pk_bf16_f32 v168, v252, v253
  s_waitcnt lgkmcnt(6)
  v_mfma_f32_32x32x16_bf16 v[64:79], v[20:23], v[136:139], v[64:79]
  ds_read_b64_tr_b16 v[36:37], v3 offset:26624
  ds_read_b64_tr_b16 v[38:39], v3 offset:27648
  v_lshlrev_b32 v248, 16, v169
  v_and_b32 v249, 0xffff0000, v169
  v_pk_add_f32 v[248:249], v[248:249], v[244:245] neg_lo:[0,1] neg_hi:[0,1]
  v_cvt_pk_bf16_f32 v169, v248, v249
  s_waitcnt lgkmcnt(6)
  v_mfma_f32_32x32x16_bf16 v[80:95], v[24:27], v[136:139], v[80:95]
  ds_read_b64_tr_b16 v[40:41], v4 offset:26624
  ds_read_b64_tr_b16 v[42:43], v4 offset:27648
  v_lshlrev_b32 v250, 16, v170
  v_and_b32 v251, 0xffff0000, v170
  v_pk_add_f32 v[250:251], v[250:251], v[244:245] neg_lo:[0,1] neg_hi:[0,1]
  v_cvt_pk_bf16_f32 v170, v250, v251
  s_waitcnt lgkmcnt(6)
  v_mfma_f32_32x32x16_bf16 v[96:111], v[28:31], v[136:139], v[96:111]
  ds_read_b64_tr_b16 v[44:45], v5 offset:26624
  ds_read_b64_tr_b16 v[46:47], v5 offset:27648
  v_lshlrev_b32 v252, 16, v171
  v_and_b32 v253, 0xffff0000, v171
  v_pk_add_f32 v[252:253], v[252:253], v[244:245] neg_lo:[0,1] neg_hi:[0,1]
  v_cvt_pk_bf16_f32 v171, v252, v253
  s_waitcnt lgkmcnt(6)
  v_mfma_f32_32x32x16_bf16 v[48:63], v[32:35], v[140:143], v[48:63]
  ds_read_b64_tr_b16 v[16:17], v2 offset:32768
  ds_read_b64_tr_b16 v[18:19], v2 offset:33792
  v_lshlrev_b32 v248, 16, v172
  v_and_b32 v249, 0xffff0000, v172
  v_pk_add_f32 v[248:249], v[248:249], v[244:245] neg_lo:[0,1] neg_hi:[0,1]
  v_cvt_pk_bf16_f32 v172, v248, v249
  s_waitcnt lgkmcnt(6)
  v_mfma_f32_32x32x16_bf16 v[64:79], v[36:39], v[140:143], v[64:79]
  ds_read_b64_tr_b16 v[20:21], v3 offset:32768
  ds_read_b64_tr_b16 v[22:23], v3 offset:33792
  v_lshlrev_b32 v250, 16, v173
  v_and_b32 v251, 0xffff0000, v173
  v_pk_add_f32 v[250:251], v[250:251], v[244:245] neg_lo:[0,1] neg_hi:[0,1]
  v_cvt_pk_bf16_f32 v173, v250, v251
  s_waitcnt lgkmcnt(6)
  v_mfma_f32_32x32x16_bf16 v[80:95], v[40:43], v[140:143], v[80:95]
  ds_read_b64_tr_b16 v[24:25], v4 offset:32768
  ds_read_b64_tr_b16 v[26:27], v4 offset:33792
  v_lshlrev_b32 v252, 16, v174
  v_and_b32 v253, 0xffff0000, v174
  v_pk_add_f32 v[252:253], v[252:253], v[244:245] neg_lo:[0,1] neg_hi:[0,1]
  v_cvt_pk_bf16_f32 v174, v252, v253
  s_waitcnt lgkmcnt(6)
  v_mfma_f32_32x32x16_bf16 v[96:111], v[44:47], v[140:143], v[96:111]
  ds_read_b64_tr_b16 v[28:29], v5 offset:32768
  ds_read_b64_tr_b16 v[30:31], v5 offset:33792
  v_lshlrev_b32 v248, 16, v175
  v_and_b32 v249, 0xffff0000, v175
  v_pk_add_f32 v[248:249], v[248:249], v[244:245] neg_lo:[0,1] neg_hi:[0,1]
  v_cvt_pk_bf16_f32 v175, v248, v249
  s_waitcnt vmcnt(4)
  s_barrier
  s_waitcnt lgkmcnt(6)
  v_mfma_f32_32x32x16_bf16 v[48:63], v[16:19], v[144:147], v[48:63]
  ds_read_b64_tr_b16 v[32:33], v2 offset:34816
  ds_read_b64_tr_b16 v[34:35], v2 offset:35840
  v_lshlrev_b32 v250, 16, v176
  v_and_b32 v251, 0xffff0000, v176
  v_pk_add_f32 v[250:251], v[250:251], v[244:245] neg_lo:[0,1] neg_hi:[0,1]
  v_cvt_pk_bf16_f32 v176, v250, v251
  s_waitcnt lgkmcnt(6)
  v_mfma_f32_32x32x16_bf16 v[64:79], v[20:23], v[144:147], v[64:79]
  ds_read_b64_tr_b16 v[36:37], v3 offset:34816
  ds_read_b64_tr_b16 v[38:39], v3 offset:35840
  v_lshlrev_b32 v252, 16, v177
  v_and_b32 v253, 0xffff0000, v177
  v_pk_add_f32 v[252:253], v[252:253], v[244:245] neg_lo:[0,1] neg_hi:[0,1]
  v_cvt_pk_bf16_f32 v177, v252, v253
  s_waitcnt lgkmcnt(6)
  v_mfma_f32_32x32x16_bf16 v[80:95], v[24:27], v[144:147], v[80:95]
  ds_read_b64_tr_b16 v[40:41], v4 offset:34816
  ds_read_b64_tr_b16 v[42:43], v4 offset:35840
  v_lshlrev_b32 v248, 16, v178
  v_and_b32 v249, 0xffff0000, v178
  v_pk_add_f32 v[248:249], v[248:249], v[244:245] neg_lo:[0,1] neg_hi:[0,1]
  v_cvt_pk_bf16_f32 v178, v248, v249
  s_waitcnt lgkmcnt(6)
  v_mfma_f32_32x32x16_bf16 v[96:111], v[28:31], v[144:147], v[96:111]
  ds_read_b64_tr_b16 v[44:45], v5 offset:34816
  ds_read_b64_tr_b16 v[46:47], v5 offset:35840
  v_lshlrev_b32 v250, 16, v179
  v_and_b32 v251, 0xffff0000, v179
  v_pk_add_f32 v[250:251], v[250:251], v[244:245] neg_lo:[0,1] neg_hi:[0,1]
  v_cvt_pk_bf16_f32 v179, v250, v251
  s_waitcnt lgkmcnt(6)
  v_mfma_f32_32x32x16_bf16 v[48:63], v[32:35], v[148:151], v[48:63]
  ds_read_b64_tr_b16 v[16:17], v2 offset:40960
  ds_read_b64_tr_b16 v[18:19], v2 offset:41984
  s_add_u32 m0, s58, 0
  s_mul_i32 s57, s54, 0
  s_add_u32 s57, s57, s55
  buffer_load_dwordx4 v11, s[48:51], s57 offen lds
  v_lshlrev_b32 v252, 16, v180
  v_and_b32 v253, 0xffff0000, v180
  v_pk_add_f32 v[252:253], v[252:253], v[244:245] neg_lo:[0,1] neg_hi:[0,1]
  v_cvt_pk_bf16_f32 v180, v252, v253
  s_waitcnt lgkmcnt(6)
  v_mfma_f32_32x32x16_bf16 v[64:79], v[36:39], v[148:151], v[64:79]
  ds_read_b64_tr_b16 v[20:21], v3 offset:40960
  ds_read_b64_tr_b16 v[22:23], v3 offset:41984
  v_lshlrev_b32 v248, 16, v181
  v_and_b32 v249, 0xffff0000, v181
  v_pk_add_f32 v[248:249], v[248:249], v[244:245] neg_lo:[0,1] neg_hi:[0,1]
  v_cvt_pk_bf16_f32 v181, v248, v249
  s_waitcnt lgkmcnt(6)
  v_mfma_f32_32x32x16_bf16 v[80:95], v[40:43], v[148:151], v[80:95]
  ds_read_b64_tr_b16 v[24:25], v4 offset:40960
  ds_read_b64_tr_b16 v[26:27], v4 offset:41984
  v_lshlrev_b32 v250, 16, v182
  v_and_b32 v251, 0xffff0000, v182
  v_pk_add_f32 v[250:251], v[250:251], v[244:245] neg_lo:[0,1] neg_hi:[0,1]
  v_cvt_pk_bf16_f32 v182, v250, v251
  s_waitcnt lgkmcnt(6)
  v_mfma_f32_32x32x16_bf16 v[96:111], v[44:47], v[148:151], v[96:111]
  ds_read_b64_tr_b16 v[28:29], v5 offset:40960
  ds_read_b64_tr_b16 v[30:31], v5 offset:41984
  v_lshlrev_b32 v252, 16, v183
  v_and_b32 v253, 0xffff0000, v183
  v_pk_add_f32 v[252:253], v[252:253], v[244:245] neg_lo:[0,1] neg_hi:[0,1]
  v_cvt_pk_bf16_f32 v183, v252, v253
  s_waitcnt lgkmcnt(6)
  v_mfma_f32_32x32x16_bf16 v[48:63], v[16:19], v[152:155], v[48:63]
  ds_read_b64_tr_b16 v[32:33], v2 offset:43008
  ds_read_b64_tr_b16 v[34:35], v2 offset:44032
  v_lshlrev_b32 v248, 16, v184
  v_and_b32 v249, 0xffff0000, v184
  v_pk_add_f32 v[248:249], v[248:249], v[244:245] neg_lo:[0,1] neg_hi:[0,1]
  v_cvt_pk_bf16_f32 v184, v248, v249
  s_waitcnt lgkmcnt(6)
  v_mfma_f32_32x32x16_bf16 v[64:79], v[20:23], v[152:155], v[64:79]
  ds_read_b64_tr_b16 v[36:37], v3 offset:43008
  ds_read_b64_tr_b16 v[38:39], v3 offset:44032
  v_lshlrev_b32 v250, 16, v185
  v_and_b32 v251, 0xffff0000, v185
  v_pk_add_f32 v[250:251], v[250:251], v[244:245] neg_lo:[0,1] neg_hi:[0,1]
  v_cvt_pk_bf16_f32 v185, v250, v251
  s_waitcnt lgkmcnt(6)
  v_mfma_f32_32x32x16_bf16 v[80:95], v[24:27], v[152:155], v[80:95]
  ds_read_b64_tr_b16 v[40:41], v4 offset:43008
  ds_read_b64_tr_b16 v[42:43], v4 offset:44032
  v_lshlrev_b32 v252, 16, v186
  v_and_b32 v253, 0xffff0000, v186
  v_pk_add_f32 v[252:253], v[252:253], v[244:245] neg_lo:[0,1] neg_hi:[0,1]
  v_cvt_pk_bf16_f32 v186, v252, v253
  s_waitcnt lgkmcnt(6)
  v_mfma_f32_32x32x16_bf16 v[96:111], v[28:31], v[152:155], v[96:111]
  ds_read_b64_tr_b16 v[44:45], v5 offset:43008
  ds_read_b64_tr_b16 v[46:47], v5 offset:44032
  v_lshlrev_b32 v248, 16, v187
  v_and_b32 v249, 0xffff0000, v187
  v_pk_add_f32 v[248:249], v[248:249], v[244:245] neg_lo:[0,1] neg_hi:[0,1]
  v_cvt_pk_bf16_f32 v187, v248, v249
  s_waitcnt lgkmcnt(6)
  v_mfma_f32_32x32x16_bf16 v[48:63], v[32:35], v[156:159], v[48:63]
  ds_read_b64_tr_b16 v[16:17], v2 offset:49152
  ds_read_b64_tr_b16 v[18:19], v2 offset:50176
  s_add_u32 m0, s58, 1024
  s_mul_i32 s57, s54, 4
  s_add_u32 s57, s57, s55
  buffer_load_dwordx4 v11, s[48:51], s57 offen lds
  v_lshlrev_b32 v250, 16, v188
  v_and_b32 v251, 0xffff0000, v188
  v_pk_add_f32 v[250:251], v[250:251], v[244:245] neg_lo:[0,1] neg_hi:[0,1]
  v_cvt_pk_bf16_f32 v188, v250, v251
  s_waitcnt lgkmcnt(6)
  v_mfma_f32_32x32x16_bf16 v[64:79], v[36:39], v[156:159], v[64:79]
  ds_read_b64_tr_b16 v[20:21], v3 offset:49152
  ds_read_b64_tr_b16 v[22:23], v3 offset:50176
  v_lshlrev_b32 v252, 16, v189
  v_and_b32 v253, 0xffff0000, v189
  v_pk_add_f32 v[252:253], v[252:253], v[244:245] neg_lo:[0,1] neg_hi:[0,1]
  v_cvt_pk_bf16_f32 v189, v252, v253
  s_waitcnt lgkmcnt(6)
  v_mfma_f32_32x32x16_bf16 v[80:95], v[40:43], v[156:159], v[80:95]
  ds_read_b64_tr_b16 v[24:25], v4 offset:49152
  ds_read_b64_tr_b16 v[26:27], v4 offset:50176
  v_lshlrev_b32 v248, 16, v190
  v_and_b32 v249, 0xffff0000, v190
  v_pk_add_f32 v[248:249], v[248:249], v[244:245] neg_lo:[0,1] neg_hi:[0,1]
  v_cvt_pk_bf16_f32 v190, v248, v249
  s_waitcnt lgkmcnt(6)
  v_mfma_f32_32x32x16_bf16 v[96:111], v[44:47], v[156:159], v[96:111]
  ds_read_b64_tr_b16 v[28:29], v5 offset:49152
  ds_read_b64_tr_b16 v[30:31], v5 offset:50176
  v_lshlrev_b32 v250, 16, v191
  v_and_b32 v251, 0xffff0000, v191
  v_pk_add_f32 v[250:251], v[250:251], v[244:245] neg_lo:[0,1] neg_hi:[0,1]
  v_cvt_pk_bf16_f32 v191, v250, v251
  s_waitcnt lgkmcnt(6)
  v_mfma_f32_32x32x16_bf16 v[48:63], v[16:19], v[160:163], v[48:63]
  ds_read_b64_tr_b16 v[32:33], v2 offset:51200
  ds_read_b64_tr_b16 v[34:35], v2 offset:52224
  v_lshlrev_b32 v252, 16, v192
  v_and_b32 v253, 0xffff0000, v192
  v_pk_add_f32 v[252:253], v[252:253], v[244:245] neg_lo:[0,1] neg_hi:[0,1]
  v_cvt_pk_bf16_f32 v192, v252, v253
  s_waitcnt lgkmcnt(6)
  v_mfma_f32_32x32x16_bf16 v[64:79], v[20:23], v[160:163], v[64:79]
  ds_read_b64_tr_b16 v[36:37], v3 offset:51200
  ds_read_b64_tr_b16 v[38:39], v3 offset:52224
  v_lshlrev_b32 v248, 16, v193
  v_and_b32 v249, 0xffff0000, v193
  v_pk_add_f32 v[248:249], v[248:249], v[244:245] neg_lo:[0,1] neg_hi:[0,1]
  v_cvt_pk_bf16_f32 v193, v248, v249
  s_waitcnt lgkmcnt(6)
  v_mfma_f32_32x32x16_bf16 v[80:95], v[24:27], v[160:163], v[80:95]
  ds_read_b64_tr_b16 v[40:41], v4 offset:51200
  ds_read_b64_tr_b16 v[42:43], v4 offset:52224
  v_lshlrev_b32 v250, 16, v194
  v_and_b32 v251, 0xffff0000, v194
  v_pk_add_f32 v[250:251], v[250:251], v[244:245] neg_lo:[0,1] neg_hi:[0,1]
  v_cvt_pk_bf16_f32 v194, v250, v251
  s_waitcnt lgkmcnt(6)
  v_mfma_f32_32x32x16_bf16 v[96:111], v[28:31], v[160:163], v[96:111]
  ds_read_b64_tr_b16 v[44:45], v5 offset:51200
  ds_read_b64_tr_b16 v[46:47], v5 offset:52224
  v_lshlrev_b32 v252, 16, v195
  v_and_b32 v253, 0xffff0000, v195
  v_pk_add_f32 v[252:253], v[252:253], v[244:245] neg_lo:[0,1] neg_hi:[0,1]
  v_cvt_pk_bf16_f32 v195, v252, v253
  s_waitcnt lgkmcnt(6)
  v_mfma_f32_32x32x16_bf16 v[48:63], v[32:35], v[164:167], v[48:63]
  ds_read_b64_tr_b16 v[16:17], v2 offset:57344
  ds_read_b64_tr_b16 v[18:19], v2 offset:58368
  s_add_u32 m0, s58, 2048
  s_mul_i32 s57, s54, 8
  s_add_u32 s57, s57, s55
  buffer_load_dwordx4 v11, s[48:51], s57 offen lds
  v_lshlrev_b32 v248, 16, v196
  v_and_b32 v249, 0xffff0000, v196
  v_pk_add_f32 v[248:249], v[248:249], v[244:245] neg_lo:[0,1] neg_hi:[0,1]
  v_cvt_pk_bf16_f32 v196, v248, v249
  s_waitcnt lgkmcnt(6)
  v_mfma_f32_32x32x16_bf16 v[64:79], v[36:39], v[164:167], v[64:79]
  ds_read_b64_tr_b16 v[20:21], v3 offset:57344
  ds_read_b64_tr_b16 v[22:23], v3 offset:58368
  v_lshlrev_b32 v250, 16, v197
  v_and_b32 v251, 0xffff0000, v197
  v_pk_add_f32 v[250:251], v[250:251], v[244:245] neg_lo:[0,1] neg_hi:[0,1]
  v_cvt_pk_bf16_f32 v197, v250, v251
  s_waitcnt lgkmcnt(6)
  v_mfma_f32_32x32x16_bf16 v[80:95], v[40:43], v[164:167], v[80:95]
  ds_read_b64_tr_b16 v[24:25], v4 offset:57344
  ds_read_b64_tr_b16 v[26:27], v4 offset:58368
  v_lshlrev_b32 v252, 16, v198
  v_and_b32 v253, 0xffff0000, v198
  v_pk_add_f32 v[252:253], v[252:253], v[244:245] neg_lo:[0,1] neg_hi:[0,1]
  v_cvt_pk_bf16_f32 v198, v252, v253
  s_waitcnt lgkmcnt(6)
  v_mfma_f32_32x32x16_bf16 v[96:111], v[44:47], v[164:167], v[96:111]
  ds_read_b64_tr_b16 v[28:29], v5 offset:57344
  ds_read_b64_tr_b16 v[30:31], v5 offset:58368
  v_lshlrev_b32 v248, 16, v199
  v_and_b32 v249, 0xffff0000, v199
  v_pk_add_f32 v[248:249], v[248:249], v[244:245] neg_lo:[0,1] neg_hi:[0,1]
  v_cvt_pk_bf16_f32 v199, v248, v249
  s_waitcnt lgkmcnt(6)
  v_mfma_f32_32x32x16_bf16 v[48:63], v[16:19], v[168:171], v[48:63]
  ds_read_b64_tr_b16 v[32:33], v2 offset:59392
  ds_read_b64_tr_b16 v[34:35], v2 offset:60416
  v_lshlrev_b32 v250, 16, v200
  v_and_b32 v251, 0xffff0000, v200
  v_pk_add_f32 v[250:251], v[250:251], v[244:245] neg_lo:[0,1] neg_hi:[0,1]
  v_cvt_pk_bf16_f32 v200, v250, v251
  s_waitcnt lgkmcnt(6)
  v_mfma_f32_32x32x16_bf16 v[64:79], v[20:23], v[168:171], v[64:79]
  ds_read_b64_tr_b16 v[36:37], v3 offset:59392
  ds_read_b64_tr_b16 v[38:39], v3 offset:60416
  v_lshlrev_b32 v252, 16, v201
  v_and_b32 v253, 0xffff0000, v201
  v_pk_add_f32 v[252:253], v[252:253], v[244:245] neg_lo:[0,1] neg_hi:[0,1]
  v_cvt_pk_bf16_f32 v201, v252, v253
  s_waitcnt lgkmcnt(6)
  v_mfma_f32_32x32x16_bf16 v[80:95], v[24:27], v[168:171], v[80:95]
  ds_read_b64_tr_b16 v[40:41], v4 offset:59392
  ds_read_b64_tr_b16 v[42:43], v4 offset:60416
  v_lshlrev_b32 v248, 16, v202
  v_and_b32 v249, 0xffff0000, v202
  v_pk_add_f32 v[248:249], v[248:249], v[244:245] neg_lo:[0,1] neg_hi:[0,1]
  v_cvt_pk_bf16_f32 v202, v248, v249
  s_waitcnt lgkmcnt(6)
  v_mfma_f32_32x32x16_bf16 v[96:111], v[28:31], v[168:171], v[96:111]
  ds_read_b64_tr_b16 v[44:45], v5 offset:59392
  ds_read_b64_tr_b16 v[46:47], v5 offset:60416
  v_lshlrev_b32 v250, 16, v203
  v_and_b32 v251, 0xffff0000, v203
  v_pk_add_f32 v[250:251], v[250:251], v[244:245] neg_lo:[0,1] neg_hi:[0,1]
  v_cvt_pk_bf16_f32 v203, v250, v251
  s_waitcnt lgkmcnt(6)
  v_mfma_f32_32x32x16_bf16 v[48:63], v[32:35], v[172:175], v[48:63]
  ds_read_b64_tr_b16 v[16:17], v6 offset:0
  ds_read_b64_tr_b16 v[18:19], v6 offset:1024
  s_add_u32 m0, s58, 3072
  s_mul_i32 s57, s54, 12
  s_add_u32 s57, s57, s55
  buffer_load_dwordx4 v11, s[48:51], s57 offen lds
  v_lshlrev_b32 v252, 16, v204
  v_and_b32 v253, 0xffff0000, v204
  v_pk_add_f32 v[252:253], v[252:253], v[244:245] neg_lo:[0,1] neg_hi:[0,1]
  v_cvt_pk_bf16_f32 v204, v252, v253
  s_waitcnt lgkmcnt(6)
  v_mfma_f32_32x32x16_bf16 v[64:79], v[36:39], v[172:175], v[64:79]
  ds_read_b64_tr_b16 v[20:21], v7 offset:0
  ds_read_b64_tr_b16 v[22:23], v7 offset:1024
  v_lshlrev_b32 v248, 16, v205
  v_and_b32 v249, 0xffff0000, v205
  v_pk_add_f32 v[248:249], v[248:249], v[244:245] neg_lo:[0,1] neg_hi:[0,1]
  v_cvt_pk_bf16_f32 v205, v248, v249
  s_waitcnt lgkmcnt(6)
  v_mfma_f32_32x32x16_bf16 v[80:95], v[40:43], v[172:175], v[80:95]
  ds_read_b64_tr_b16 v[24:25], v8 offset:0
  ds_read_b64_tr_b16 v[26:27], v8 offset:1024
  v_lshlrev_b32 v250, 16, v206
  v_and_b32 v251, 0xffff0000, v206
  v_pk_add_f32 v[250:251], v[250:251], v[244:245] neg_lo:[0,1] neg_hi:[0,1]
  v_cvt_pk_bf16_f32 v206, v250, v251
  s_waitcnt lgkmcnt(6)
  v_mfma_f32_32x32x16_bf16 v[96:111], v[44:47], v[172:175], v[96:111]
  ds_read_b64_tr_b16 v[28:29], v9 offset:0
  ds_read_b64_tr_b16 v[30:31], v9 offset:1024
  v_lshlrev_b32 v252, 16, v207
  v_and_b32 v253, 0xffff0000, v207
  v_pk_add_f32 v[252:253], v[252:253], v[244:245] neg_lo:[0,1] neg_hi:[0,1]
  v_cvt_pk_bf16_f32 v207, v252, v253
  s_waitcnt vmcnt(4)
  s_barrier
  s_waitcnt lgkmcnt(6)
  v_mfma_f32_32x32x16_bf16 v[48:63], v[16:19], v[176:179], v[48:63]
  ds_read_b64_tr_b16 v[32:33], v6 offset:2048
  ds_read_b64_tr_b16 v[34:35], v6 offset:3072
  v_lshlrev_b32 v248, 16, v208
  v_and_b32 v249, 0xffff0000, v208
  v_pk_add_f32 v[248:249], v[248:249], v[244:245] neg_lo:[0,1] neg_hi:[0,1]
  v_cvt_pk_bf16_f32 v208, v248, v249
  s_waitcnt lgkmcnt(6)
  v_mfma_f32_32x32x16_bf16 v[64:79], v[20:23], v[176:179], v[64:79]
  ds_read_b64_tr_b16 v[36:37], v7 offset:2048
  ds_read_b64_tr_b16 v[38:39], v7 offset:3072
  v_lshlrev_b32 v250, 16, v209
  v_and_b32 v251, 0xffff0000, v209
  v_pk_add_f32 v[250:251], v[250:251], v[244:245] neg_lo:[0,1] neg_hi:[0,1]
  v_cvt_pk_bf16_f32 v209, v250, v251
  s_waitcnt lgkmcnt(6)
  v_mfma_f32_32x32x16_bf16 v[80:95], v[24:27], v[176:179], v[80:95]
  ds_read_b64_tr_b16 v[40:41], v8 offset:2048
  ds_read_b64_tr_b16 v[42:43], v8 offset:3072
  v_lshlrev_b32 v252, 16, v210
  v_and_b32 v253, 0xffff0000, v210
  v_pk_add_f32 v[252:253], v[252:253], v[244:245] neg_lo:[0,1] neg_hi:[0,1]
  v_cvt_pk_bf16_f32 v210, v252, v253
  s_waitcnt lgkmcnt(6)
  v_mfma_f32_32x32x16_bf16 v[96:111], v[28:31], v[176:179], v[96:111]
  ds_read_b64_tr_b16 v[44:45], v9 offset:2048
  ds_read_b64_tr_b16 v[46:47], v9 offset:3072
  v_lshlrev_b32 v248, 16, v211
  v_and_b32 v249, 0xffff0000, v211
  v_pk_add_f32 v[248:249], v[248:249], v[244:245] neg_lo:[0,1] neg_hi:[0,1]
  v_cvt_pk_bf16_f32 v211, v248, v249
  s_waitcnt lgkmcnt(6)
  v_mfma_f32_32x32x16_bf16 v[48:63], v[32:35], v[180:183], v[48:63]
  ds_read_b64_tr_b16 v[16:17], v6 offset:8192
  ds_read_b64_tr_b16 v[18:19], v6 offset:9216
  s_add_u32 m0, s58, 32768
  s_mul_i32 s57, s54, 128
  s_add_u32 s57, s57, s55
  buffer_load_dwordx4 v11, s[48:51], s57 offen lds
  v_lshlrev_b32 v250, 16, v212
  v_and_b32 v251, 0xffff0000, v212
  v_pk_add_f32 v[250:251], v[250:251], v[244:245] neg_lo:[0,1] neg_hi:[0,1]
  v_cvt_pk_bf16_f32 v212, v250, v251
  s_waitcnt lgkmcnt(6)
  v_mfma_f32_32x32x16_bf16 v[64:79], v[36:39], v[180:183], v[64:79]
  ds_read_b64_tr_b16 v[20:21], v7 offset:8192
  ds_read_b64_tr_b16 v[22:23], v7 offset:9216
  v_lshlrev_b32 v252, 16, v213
  v_and_b32 v253, 0xffff0000, v213
  v_pk_add_f32 v[252:253], v[252:253], v[244:245] neg_lo:[0,1] neg_hi:[0,1]
  v_cvt_pk_bf16_f32 v213, v252, v253
  s_waitcnt lgkmcnt(6)
  v_mfma_f32_32x32x16_bf16 v[80:95], v[40:43], v[180:183], v[80:95]
  ds_read_b64_tr_b16 v[24:25], v8 offset:8192
  ds_read_b64_tr_b16 v[26:27], v8 offset:9216
  v_lshlrev_b32 v248, 16, v214
  v_and_b32 v249, 0xffff0000, v214
  v_pk_add_f32 v[248:249], v[248:249], v[244:245] neg_lo:[0,1] neg_hi:[0,1]
  v_cvt_pk_bf16_f32 v214, v248, v249
  s_waitcnt lgkmcnt(6)
  v_mfma_f32_32x32x16_bf16 v[96:111], v[44:47], v[180:183], v[96:111]
  ds_read_b64_tr_b16 v[28:29], v9 offset:8192
  ds_read_b64_tr_b16 v[30:31], v9 offset:9216
  v_lshlrev_b32 v250, 16, v215
  v_and_b32 v251, 0xffff0000, v215
  v_pk_add_f32 v[250:251], v[250:251], v[244:245] neg_lo:[0,1] neg_hi:[0,1]
  v_cvt_pk_bf16_f32 v215, v250, v251
  s_waitcnt lgkmcnt(6)
  v_mfma_f32_32x32x16_bf16 v[48:63], v[16:19], v[184:187], v[48:63]
  ds_read_b64_tr_b16 v[32:33], v6 offset:10240
  ds_read_b64_tr_b16 v[34:35], v6 offset:11264
  v_lshlrev_b32 v252, 16, v216
  v_and_b32 v253, 0xffff0000, v216
  v_pk_add_f32 v[252:253], v[252:253], v[244:245] neg_lo:[0,1] neg_hi:[0,1]
  v_cvt_pk_bf16_f32 v216, v252, v253
  s_waitcnt lgkmcnt(6)
  v_mfma_f32_32x32x16_bf16 v[64:79], v[20:23], v[184:187], v[64:79]
  ds_read_b64_tr_b16 v[36:37], v7 offset:10240
  ds_read_b64_tr_b16 v[38:39], v7 offset:11264
  v_lshlrev_b32 v248, 16, v217
  v_and_b32 v249, 0xffff0000, v217
  v_pk_add_f32 v[248:249], v[248:249], v[244:245] neg_lo:[0,1] neg_hi:[0,1]
  v_cvt_pk_bf16_f32 v217, v248, v249
  s_waitcnt lgkmcnt(6)
  v_mfma_f32_32x32x16_bf16 v[80:95], v[24:27], v[184:187], v[80:95]
  ds_read_b64_tr_b16 v[40:41], v8 offset:10240
  ds_read_b64_tr_b16 v[42:43], v8 offset:11264
  v_lshlrev_b32 v250, 16, v218
  v_and_b32 v251, 0xffff0000, v218
  v_pk_add_f32 v[250:251], v[250:251], v[244:245] neg_lo:[0,1] neg_hi:[0,1]
  v_cvt_pk_bf16_f32 v218, v250, v251
  s_waitcnt lgkmcnt(6)
  v_mfma_f32_32x32x16_bf16 v[96:111], v[28:31], v[184:187], v[96:111]
  ds_read_b64_tr_b16 v[44:45], v9 offset:10240
  ds_read_b64_tr_b16 v[46:47], v9 offset:11264
  v_lshlrev_b32 v252, 16, v219
  v_and_b32 v253, 0xffff0000, v219
  v_pk_add_f32 v[252:253], v[252:253], v[244:245] neg_lo:[0,1] neg_hi:[0,1]
  v_cvt_pk_bf16_f32 v219, v252, v253
  s_waitcnt lgkmcnt(6)
  v_mfma_f32_32x32x16_bf16 v[48:63], v[32:35], v[188:191], v[48:63]
  ds_read_b64_tr_b16 v[16:17], v6 offset:16384
  ds_read_b64_tr_b16 v[18:19], v6 offset:17408
  s_add_u32 m0, s58, 33792
  s_mul_i32 s57, s54, 132
  s_add_u32 s57, s57, s55
  buffer_load_dwordx4 v11, s[48:51], s57 offen lds
  v_lshlrev_b32 v248, 16, v220
  v_and_b32 v249, 0xffff0000, v220
  v_pk_add_f32 v[248:249], v[248:249], v[244:245] neg_lo:[0,1] neg_hi:[0,1]
  v_cvt_pk_bf16_f32 v220, v248, v249
  s_waitcnt lgkmcnt(6)
  v_mfma_f32_32x32x16_bf16 v[64:79], v[36:39], v[188:191], v[64:79]
  ds_read_b64_tr_b16 v[20:21], v7 offset:16384
  ds_read_b64_tr_b16 v[22:23], v7 offset:17408
  v_lshlrev_b32 v250, 16, v221
  v_and_b32 v251, 0xffff0000, v221
  v_pk_add_f32 v[250:251], v[250:251], v[244:245] neg_lo:[0,1] neg_hi:[0,1]
  v_cvt_pk_bf16_f32 v221, v250, v251
  s_waitcnt lgkmcnt(6)
  v_mfma_f32_32x32x16_bf16 v[80:95], v[40:43], v[188:191], v[80:95]
  ds_read_b64_tr_b16 v[24:25], v8 offset:16384
  ds_read_b64_tr_b16 v[26:27], v8 offset:17408
  v_lshlrev_b32 v252, 16, v222
  v_and_b32 v253, 0xffff0000, v222
  v_pk_add_f32 v[252:253], v[252:253], v[244:245] neg_lo:[0,1] neg_hi:[0,1]
  v_cvt_pk_bf16_f32 v222, v252, v253
  s_waitcnt lgkmcnt(6)
  v_mfma_f32_32x32x16_bf16 v[96:111], v[44:47], v[188:191], v[96:111]
  ds_read_b64_tr_b16 v[28:29], v9 offset:16384
  ds_read_b64_tr_b16 v[30:31], v9 offset:17408
  v_lshlrev_b32 v248, 16, v223
  v_and_b32 v249, 0xffff0000, v223
  v_pk_add_f32 v[248:249], v[248:249], v[244:245] neg_lo:[0,1] neg_hi:[0,1]
  v_cvt_pk_bf16_f32 v223, v248, v249
  s_waitcnt lgkmcnt(6)
  v_mfma_f32_32x32x16_bf16 v[48:63], v[16:19], v[192:195], v[48:63]
  ds_read_b64_tr_b16 v[32:33], v6 offset:18432
  ds_read_b64_tr_b16 v[34:35], v6 offset:19456
  v_lshlrev_b32 v250, 16, v224
  v_and_b32 v251, 0xffff0000, v224
  v_pk_add_f32 v[250:251], v[250:251], v[244:245] neg_lo:[0,1] neg_hi:[0,1]
  v_cvt_pk_bf16_f32 v224, v250, v251
  s_waitcnt lgkmcnt(6)
  v_mfma_f32_32x32x16_bf16 v[64:79], v[20:23], v[192:195], v[64:79]
  ds_read_b64_tr_b16 v[36:37], v7 offset:18432
  ds_read_b64_tr_b16 v[38:39], v7 offset:19456
  v_lshlrev_b32 v252, 16, v225
  v_and_b32 v253, 0xffff0000, v225
  v_pk_add_f32 v[252:253], v[252:253], v[244:245] neg_lo:[0,1] neg_hi:[0,1]
  v_cvt_pk_bf16_f32 v225, v252, v253
  s_waitcnt lgkmcnt(6)
  v_mfma_f32_32x32x16_bf16 v[80:95], v[24:27], v[192:195], v[80:95]
  ds_read_b64_tr_b16 v[40:41], v8 offset:18432
  ds_read_b64_tr_b16 v[42:43], v8 offset:19456
  v_lshlrev_b32 v248, 16, v226
  v_and_b32 v249, 0xffff0000, v226
  v_pk_add_f32 v[248:249], v[248:249], v[244:245] neg_lo:[0,1] neg_hi:[0,1]
  v_cvt_pk_bf16_f32 v226, v248, v249
  s_waitcnt lgkmcnt(6)
  v_mfma_f32_32x32x16_bf16 v[96:111], v[28:31], v[192:195], v[96:111]
  ds_read_b64_tr_b16 v[44:45], v9 offset:18432
  ds_read_b64_tr_b16 v[46:47], v9 offset:19456
  v_lshlrev_b32 v250, 16, v227
  v_and_b32 v251, 0xffff0000, v227
  v_pk_add_f32 v[250:251], v[250:251], v[244:245] neg_lo:[0,1] neg_hi:[0,1]
  v_cvt_pk_bf16_f32 v227, v250, v251
  s_waitcnt lgkmcnt(6)
  v_mfma_f32_32x32x16_bf16 v[48:63], v[32:35], v[196:199], v[48:63]
  ds_read_b64_tr_b16 v[16:17], v6 offset:24576
  ds_read_b64_tr_b16 v[18:19], v6 offset:25600
  s_add_u32 m0, s58, 34816
  s_mul_i32 s57, s54, 136
  s_add_u32 s57, s57, s55
  buffer_load_dwordx4 v11, s[48:51], s57 offen lds
  v_lshlrev_b32 v252, 16, v228
  v_and_b32 v253, 0xffff0000, v228
  v_pk_add_f32 v[252:253], v[252:253], v[244:245] neg_lo:[0,1] neg_hi:[0,1]
  v_cvt_pk_bf16_f32 v228, v252, v253
  s_waitcnt lgkmcnt(6)
  v_mfma_f32_32x32x16_bf16 v[64:79], v[36:39], v[196:199], v[64:79]
  ds_read_b64_tr_b16 v[20:21], v7 offset:24576
  ds_read_b64_tr_b16 v[22:23], v7 offset:25600
  v_lshlrev_b32 v248, 16, v229
  v_and_b32 v249, 0xffff0000, v229
  v_pk_add_f32 v[248:249], v[248:249], v[244:245] neg_lo:[0,1] neg_hi:[0,1]
  v_cvt_pk_bf16_f32 v229, v248, v249
  s_waitcnt lgkmcnt(6)
  v_mfma_f32_32x32x16_bf16 v[80:95], v[40:43], v[196:199], v[80:95]
  ds_read_b64_tr_b16 v[24:25], v8 offset:24576
  ds_read_b64_tr_b16 v[26:27], v8 offset:25600
  v_lshlrev_b32 v250, 16, v230
  v_and_b32 v251, 0xffff0000, v230
  v_pk_add_f32 v[250:251], v[250:251], v[244:245] neg_lo:[0,1] neg_hi:[0,1]
  v_cvt_pk_bf16_f32 v230, v250, v251
  s_waitcnt lgkmcnt(6)
  v_mfma_f32_32x32x16_bf16 v[96:111], v[44:47], v[196:199], v[96:111]
  ds_read_b64_tr_b16 v[28:29], v9 offset:24576
  ds_read_b64_tr_b16 v[30:31], v9 offset:25600
  v_lshlrev_b32 v252, 16, v231
  v_and_b32 v253, 0xffff0000, v231
  v_pk_add_f32 v[252:253], v[252:253], v[244:245] neg_lo:[0,1] neg_hi:[0,1]
  v_cvt_pk_bf16_f32 v231, v252, v253
  s_waitcnt lgkmcnt(6)
  v_mfma_f32_32x32x16_bf16 v[48:63], v[16:19], v[200:203], v[48:63]
  ds_read_b64_tr_b16 v[32:33], v6 offset:26624
  ds_read_b64_tr_b16 v[34:35], v6 offset:27648
  v_lshlrev_b32 v248, 16, v232
  v_and_b32 v249, 0xffff0000, v232
  v_pk_add_f32 v[248:249], v[248:249], v[244:245] neg_lo:[0,1] neg_hi:[0,1]
  v_cvt_pk_bf16_f32 v232, v248, v249
  s_waitcnt lgkmcnt(6)
  v_mfma_f32_32x32x16_bf16 v[64:79], v[20:23], v[200:203], v[64:79]
  ds_read_b64_tr_b16 v[36:37], v7 offset:26624
  ds_read_b64_tr_b16 v[38:39], v7 offset:27648
  v_lshlrev_b32 v250, 16, v233
  v_and_b32 v251, 0xffff0000, v233
  v_pk_add_f32 v[250:251], v[250:251], v[244:245] neg_lo:[0,1] neg_hi:[0,1]
  v_cvt_pk_bf16_f32 v233, v250, v251
  s_waitcnt lgkmcnt(6)
  v_mfma_f32_32x32x16_bf16 v[80:95], v[24:27], v[200:203], v[80:95]
  ds_read_b64_tr_b16 v[40:41], v8 offset:26624
  ds_read_b64_tr_b16 v[42:43], v8 offset:27648
  v_lshlrev_b32 v252, 16, v234
  v_and_b32 v253, 0xffff0000, v234
  v_pk_add_f32 v[252:253], v[252:253], v[244:245] neg_lo:[0,1] neg_hi:[0,1]
  v_cvt_pk_bf16_f32 v234, v252, v253
  s_waitcnt lgkmcnt(6)
  v_mfma_f32_32x32x16_bf16 v[96:111], v[28:31], v[200:203], v[96:111]
  ds_read_b64_tr_b16 v[44:45], v9 offset:26624
  ds_read_b64_tr_b16 v[46:47], v9 offset:27648
  v_lshlrev_b32 v248, 16, v235
  v_and_b32 v249, 0xffff0000, v235
  v_pk_add_f32 v[248:249], v[248:249], v[244:245] neg_lo:[0,1] neg_hi:[0,1]
  v_cvt_pk_bf16_f32 v235, v248, v249
  s_waitcnt lgkmcnt(6)
  v_mfma_f32_32x32x16_bf16 v[48:63], v[32:35], v[204:207], v[48:63]
  ds_read_b64_tr_b16 v[16:17], v6 offset:32768
  ds_read_b64_tr_b16 v[18:19], v6 offset:33792
  s_add_u32 m0, s58, 35840
  s_mul_i32 s57, s54, 140
  s_add_u32 s57, s57, s55
  buffer_load_dwordx4 v11, s[48:51], s57 offen lds
  v_lshlrev_b32 v250, 16, v236
  v_and_b32 v251, 0xffff0000, v236
  v_pk_add_f32 v[250:251], v[250:251], v[244:245] neg_lo:[0,1] neg_hi:[0,1]
  v_cvt_pk_bf16_f32 v236, v250, v251
  s_waitcnt lgkmcnt(6)
  v_mfma_f32_32x32x16_bf16 v[64:79], v[36:39], v[204:207], v[64:79]
  ds_read_b64_tr_b16 v[20:21], v7 offset:32768
  ds_read_b64_tr_b16 v[22:23], v7 offset:33792
  v_lshlrev_b32 v252, 16, v237
  v_and_b32 v253, 0xffff0000, v237
  v_pk_add_f32 v[252:253], v[252:253], v[244:245] neg_lo:[0,1] neg_hi:[0,1]
  v_cvt_pk_bf16_f32 v237, v252, v253
  s_waitcnt lgkmcnt(6)
  v_mfma_f32_32x32x16_bf16 v[80:95], v[40:43], v[204:207], v[80:95]
  ds_read_b64_tr_b16 v[24:25], v8 offset:32768
  ds_read_b64_tr_b16 v[26:27], v8 offset:33792
  v_lshlrev_b32 v248, 16, v238
  v_and_b32 v249, 0xffff0000, v238
  v_pk_add_f32 v[248:249], v[248:249], v[244:245] neg_lo:[0,1] neg_hi:[0,1]
  v_cvt_pk_bf16_f32 v238, v248, v249
  s_waitcnt lgkmcnt(6)
  v_mfma_f32_32x32x16_bf16 v[96:111], v[44:47], v[204:207], v[96:111]
  ds_read_b64_tr_b16 v[28:29], v9 offset:32768
  ds_read_b64_tr_b16 v[30:31], v9 offset:33792
  v_lshlrev_b32 v250, 16, v239
  v_and_b32 v251, 0xffff0000, v239
  v_pk_add_f32 v[250:251], v[250:251], v[244:245] neg_lo:[0,1] neg_hi:[0,1]
  v_cvt_pk_bf16_f32 v239, v250, v251
  s_waitcnt vmcnt(4)
  s_barrier
  s_waitcnt lgkmcnt(6)
  v_mfma_f32_32x32x16_bf16 v[48:63], v[16:19], v[208:211], v[48:63]
  ds_read_b64_tr_b16 v[32:33], v6 offset:34816
  ds_read_b64_tr_b16 v[34:35], v6 offset:35840
  s_waitcnt lgkmcnt(6)
  v_mfma_f32_32x32x16_bf16 v[64:79], v[20:23], v[208:211], v[64:79]
  ds_read_b64_tr_b16 v[36:37], v7 offset:34816
  ds_read_b64_tr_b16 v[38:39], v7 offset:35840
  s_waitcnt lgkmcnt(6)
  v_mfma_f32_32x32x16_bf16 v[80:95], v[24:27], v[208:211], v[80:95]
  ds_read_b64_tr_b16 v[40:41], v8 offset:34816
  ds_read_b64_tr_b16 v[42:43], v8 offset:35840
  s_waitcnt lgkmcnt(6)
  v_mfma_f32_32x32x16_bf16 v[96:111], v[28:31], v[208:211], v[96:111]
  ds_read_b64_tr_b16 v[44:45], v9 offset:34816
  ds_read_b64_tr_b16 v[46:47], v9 offset:35840
  s_waitcnt lgkmcnt(6)
  v_mfma_f32_32x32x16_bf16 v[48:63], v[32:35], v[212:215], v[48:63]
  ds_read_b64_tr_b16 v[16:17], v6 offset:40960
  ds_read_b64_tr_b16 v[18:19], v6 offset:41984
  s_add_u32 m0, s58, 65536
  s_mul_i32 s57, s54, 256
  s_add_u32 s57, s57, s55
  buffer_load_dwordx4 v11, s[48:51], s57 offen lds
  s_waitcnt lgkmcnt(6)
  v_mfma_f32_32x32x16_bf16 v[64:79], v[36:39], v[212:215], v[64:79]
  ds_read_b64_tr_b16 v[20:21], v7 offset:40960
  ds_read_b64_tr_b16 v[22:23], v7 offset:41984
  s_waitcnt lgkmcnt(6)
  v_mfma_f32_32x32x16_bf16 v[80:95], v[40:43], v[212:215], v[80:95]
  ds_read_b64_tr_b16 v[24:25], v8 offset:40960
  ds_read_b64_tr_b16 v[26:27], v8 offset:41984
  s_waitcnt lgkmcnt(6)
  v_mfma_f32_32x32x16_bf16 v[96:111], v[44:47], v[212:215], v[96:111]
  ds_read_b64_tr_b16 v[28:29], v9 offset:40960
  ds_read_b64_tr_b16 v[30:31], v9 offset:41984
  s_waitcnt lgkmcnt(6)
  v_mfma_f32_32x32x16_bf16 v[48:63], v[16:19], v[216:219], v[48:63]
  ds_read_b64_tr_b16 v[32:33], v6 offset:43008
  ds_read_b64_tr_b16 v[34:35], v6 offset:44032
  s_waitcnt lgkmcnt(6)
  v_mfma_f32_32x32x16_bf16 v[64:79], v[20:23], v[216:219], v[64:79]
  ds_read_b64_tr_b16 v[36:37], v7 offset:43008
  ds_read_b64_tr_b16 v[38:39], v7 offset:44032
  s_waitcnt lgkmcnt(6)
  v_mfma_f32_32x32x16_bf16 v[80:95], v[24:27], v[216:219], v[80:95]
  ds_read_b64_tr_b16 v[40:41], v8 offset:43008
  ds_read_b64_tr_b16 v[42:43], v8 offset:44032
  s_waitcnt lgkmcnt(6)
  v_mfma_f32_32x32x16_bf16 v[96:111], v[28:31], v[216:219], v[96:111]
  ds_read_b64_tr_b16 v[44:45], v9 offset:43008
  ds_read_b64_tr_b16 v[46:47], v9 offset:44032
  s_waitcnt lgkmcnt(6)
  v_mfma_f32_32x32x16_bf16 v[48:63], v[32:35], v[220:223], v[48:63]
  ds_read_b64_tr_b16 v[16:17], v6 offset:49152
  ds_read_b64_tr_b16 v[18:19], v6 offset:50176
  s_add_u32 m0, s58, 66560
  s_mul_i32 s57, s54, 260
  s_add_u32 s57, s57, s55
  buffer_load_dwordx4 v11, s[48:51], s57 offen lds
  s_waitcnt lgkmcnt(6)
  v_mfma_f32_32x32x16_bf16 v[64:79], v[36:39], v[220:223], v[64:79]
  ds_read_b64_tr_b16 v[20:21], v7 offset:49152
  ds_read_b64_tr_b16 v[22:23], v7 offset:50176
  s_waitcnt lgkmcnt(6)
  v_mfma_f32_32x32x16_bf16 v[80:95], v[40:43], v[220:223], v[80:95]
  ds_read_b64_tr_b16 v[24:25], v8 offset:49152
  ds_read_b64_tr_b16 v[26:27], v8 offset:50176
  s_waitcnt lgkmcnt(6)
  v_mfma_f32_32x32x16_bf16 v[96:111], v[44:47], v[220:223], v[96:111]
  ds_read_b64_tr_b16 v[28:29], v9 offset:49152
  ds_read_b64_tr_b16 v[30:31], v9 offset:50176
  s_waitcnt lgkmcnt(6)
  v_mfma_f32_32x32x16_bf16 v[48:63], v[16:19], v[224:227], v[48:63]
  ds_read_b64_tr_b16 v[32:33], v6 offset:51200
  ds_read_b64_tr_b16 v[34:35], v6 offset:52224
  s_waitcnt lgkmcnt(6)
  v_mfma_f32_32x32x16_bf16 v[64:79], v[20:23], v[224:227], v[64:79]
  ds_read_b64_tr_b16 v[36:37], v7 offset:51200
  ds_read_b64_tr_b16 v[38:39], v7 offset:52224
  s_waitcnt lgkmcnt(6)
  v_mfma_f32_32x32x16_bf16 v[80:95], v[24:27], v[224:227], v[80:95]
  ds_read_b64_tr_b16 v[40:41], v8 offset:51200
  ds_read_b64_tr_b16 v[42:43], v8 offset:52224
  s_waitcnt lgkmcnt(6)
  v_mfma_f32_32x32x16_bf16 v[96:111], v[28:31], v[224:227], v[96:111]
  ds_read_b64_tr_b16 v[44:45], v9 offset:51200
  ds_read_b64_tr_b16 v[46:47], v9 offset:52224
  s_waitcnt lgkmcnt(6)
  v_mfma_f32_32x32x16_bf16 v[48:63], v[32:35], v[228:231], v[48:63]
  ds_read_b64_tr_b16 v[16:17], v6 offset:57344
  ds_read_b64_tr_b16 v[18:19], v6 offset:58368
  s_add_u32 m0, s58, 67584
  s_mul_i32 s57, s54, 264
  s_add_u32 s57, s57, s55
  buffer_load_dwordx4 v11, s[48:51], s57 offen lds
  s_waitcnt lgkmcnt(6)
  v_mfma_f32_32x32x16_bf16 v[64:79], v[36:39], v[228:231], v[64:79]
  ds_read_b64_tr_b16 v[20:21], v7 offset:57344
  ds_read_b64_tr_b16 v[22:23], v7 offset:58368
  s_waitcnt lgkmcnt(6)
  v_mfma_f32_32x32x16_bf16 v[80:95], v[40:43], v[228:231], v[80:95]
  ds_read_b64_tr_b16 v[24:25], v8 offset:57344
  ds_read_b64_tr_b16 v[26:27], v8 offset:58368
  s_waitcnt lgkmcnt(6)
  v_mfma_f32_32x32x16_bf16 v[96:111], v[44:47], v[228:231], v[96:111]
  ds_read_b64_tr_b16 v[28:29], v9 offset:57344
  ds_read_b64_tr_b16 v[30:31], v9 offset:58368
  s_waitcnt lgkmcnt(6)
  v_mfma_f32_32x32x16_bf16 v[48:63], v[16:19], v[232:235], v[48:63]
  ds_read_b64_tr_b16 v[32:33], v6 offset:59392
  ds_read_b64_tr_b16 v[34:35], v6 offset:60416
  s_waitcnt lgkmcnt(6)
  v_mfma_f32_32x32x16_bf16 v[64:79], v[20:23], v[232:235], v[64:79]
  ds_read_b64_tr_b16 v[36:37], v7 offset:59392
  ds_read_b64_tr_b16 v[38:39], v7 offset:60416
  s_waitcnt lgkmcnt(6)
  v_mfma_f32_32x32x16_bf16 v[80:95], v[24:27], v[232:235], v[80:95]
  ds_read_b64_tr_b16 v[40:41], v8 offset:59392
  ds_read_b64_tr_b16 v[42:43], v8 offset:60416
  s_waitcnt lgkmcnt(6)
  v_mfma_f32_32x32x16_bf16 v[96:111], v[28:31], v[232:235], v[96:111]
  ds_read_b64_tr_b16 v[44:45], v9 offset:59392
  ds_read_b64_tr_b16 v[46:47], v9 offset:60416
  s_waitcnt lgkmcnt(6)
  v_mfma_f32_32x32x16_bf16 v[48:63], v[32:35], v[236:239], v[48:63]
  ds_read_b64_tr_b16 v[16:17], v2 offset:0
  ds_read_b64_tr_b16 v[18:19], v2 offset:1024
  s_add_u32 m0, s58, 68608
  s_mul_i32 s57, s54, 268
  s_add_u32 s57, s57, s55
  buffer_load_dwordx4 v11, s[48:51], s57 offen lds
  s_waitcnt lgkmcnt(6)
  v_mfma_f32_32x32x16_bf16 v[64:79], v[36:39], v[236:239], v[64:79]
  ds_read_b64_tr_b16 v[20:21], v2 offset:2048
  ds_read_b64_tr_b16 v[22:23], v2 offset:3072
  s_waitcnt lgkmcnt(6)
  v_mfma_f32_32x32x16_bf16 v[80:95], v[40:43], v[236:239], v[80:95]
  ds_read_b64_tr_b16 v[24:25], v2 offset:8192
  ds_read_b64_tr_b16 v[26:27], v2 offset:9216
  s_waitcnt lgkmcnt(6)
  v_mfma_f32_32x32x16_bf16 v[96:111], v[44:47], v[236:239], v[96:111]
  ds_read_b64_tr_b16 v[28:29], v2 offset:10240
  ds_read_b64_tr_b16 v[30:31], v2 offset:11264
  s_mov_b32 s12, s48
  s_mov_b32 s13, s49
  s_mov_b32 s14, s50
  s_mov_b32 s52, s54
  s_mov_b32 s53, s55
  v_mov_b32 v10, v11
  s_mov_b32 s90, s56
  s_add_u32 s91, s56, 4096
  s_cmp_lt_u32 s4, 14
  s_cselect_b32 s66, 0x1c0000, 0
  s_mov_b32 s48, s38
  s_mov_b32 s49, s39
  s_mov_b32 s50, s66
  s_mov_b32 s54, 3584
  s_mov_b32 s55, s46
  v_mul_lo_u32 v11, v13, s54
  v_add_u32 v11, v11, v14
  s_add_u32 s56, s64, 0x0
  s_waitcnt vmcnt(4)
  s_barrier
  v_mul_f32 v48, v247, v48
  v_mul_f32 v49, v247, v49
  v_mul_f32 v50, v247, v50
  v_mul_f32 v51, v247, v51
  v_mul_f32 v52, v247, v52
  v_mul_f32 v53, v247, v53
  v_mul_f32 v54, v247, v54
  v_mul_f32 v55, v247, v55
  v_mul_f32 v56, v247, v56
  v_mul_f32 v57, v247, v57
  v_mul_f32 v58, v247, v58
  v_mul_f32 v59, v247, v59
  v_mul_f32 v60, v247, v60
  v_mul_f32 v61, v247, v61
  v_mul_f32 v62, v247, v62
  v_mul_f32 v63, v247, v63
  v_cvt_pk_bf16_f32 v48, v48, v49
  v_cvt_pk_bf16_f32 v49, v50, v51
  v_cvt_pk_bf16_f32 v50, v52, v53
  v_cvt_pk_bf16_f32 v51, v54, v55
  buffer_store_dwordx4 v[48:51], v12, s[16:19], s90 offen offset:0 sc1
  v_cvt_pk_bf16_f32 v56, v56, v57
  v_cvt_pk_bf16_f32 v57, v58, v59
  v_cvt_pk_bf16_f32 v58, v60, v61
  v_cvt_pk_bf16_f32 v59, v62, v63
  buffer_store_dwordx4 v[56:59], v12, s[16:19], s90 offen offset:1024 sc1
  s_nop 1
  s_waitcnt lgkmcnt(6)
  v_mfma_f32_32x32x16_bf16 v[48:63], v[16:19], v[112:115], 0
  ds_read_b64_tr_b16 v[32:33], v3 offset:0
  ds_read_b64_tr_b16 v[34:35], v3 offset:1024
  s_waitcnt lgkmcnt(6)
  v_mfma_f32_32x32x16_bf16 v[48:63], v[20:23], v[116:119], v[48:63]
  ds_read_b64_tr_b16 v[36:37], v3 offset:2048
  ds_read_b64_tr_b16 v[38:39], v3 offset:3072
  s_waitcnt lgkmcnt(6)
  v_mfma_f32_32x32x16_bf16 v[48:63], v[24:27], v[120:123], v[48:63]
  ds_read_b64_tr_b16 v[40:41], v3 offset:8192
  ds_read_b64_tr_b16 v[42:43], v3 offset:9216
  s_waitcnt lgkmcnt(6)
  v_mfma_f32_32x32x16_bf16 v[48:63], v[28:31], v[124:127], v[48:63]
  ds_read_b64_tr_b16 v[44:45], v3 offset:10240
  ds_read_b64_tr_b16 v[46:47], v3 offset:11264
  v_mul_f32 v64, v247, v64
  v_mul_f32 v65, v247, v65
  v_mul_f32 v66, v247, v66
  v_mul_f32 v67, v247, v67
  v_mul_f32 v68, v247, v68
  v_mul_f32 v69, v247, v69
  v_mul_f32 v70, v247, v70
  v_mul_f32 v71, v247, v71
  v_mul_f32 v72, v247, v72
  v_mul_f32 v73, v247, v73
  v_mul_f32 v74, v247, v74
  v_mul_f32 v75, v247, v75
  v_mul_f32 v76, v247, v76
  v_mul_f32 v77, v247, v77
  v_mul_f32 v78, v247, v78
  v_mul_f32 v79, v247, v79
  v_cvt_pk_bf16_f32 v64, v64, v65
  v_cvt_pk_bf16_f32 v65, v66, v67
  v_cvt_pk_bf16_f32 v66, v68, v69
  v_cvt_pk_bf16_f32 v67, v70, v71
  buffer_store_dwordx4 v[64:67], v12, s[16:19], s90 offen offset:2048 sc1
  v_cvt_pk_bf16_f32 v72, v72, v73
  v_cvt_pk_bf16_f32 v73, v74, v75
  v_cvt_pk_bf16_f32 v74, v76, v77
  v_cvt_pk_bf16_f32 v75, v78, v79
  buffer_store_dwordx4 v[72:75], v12, s[16:19], s90 offen offset:3072 sc1
  s_nop 1
  s_waitcnt lgkmcnt(6)
  v_mfma_f32_32x32x16_bf16 v[64:79], v[32:35], v[112:115], 0
  ds_read_b64_tr_b16 v[16:17], v4 offset:0
  ds_read_b64_tr_b16 v[18:19], v4 offset:1024
  s_add_u32 m0, s58, 98304
  s_mul_i32 s57, s52, 384
  s_add_u32 s57, s57, s53
  buffer_load_dwordx4 v10, s[12:15], s57 offen lds
  s_waitcnt lgkmcnt(6)
  v_mfma_f32_32x32x16_bf16 v[64:79], v[36:39], v[116:119], v[64:79]
  ds_read_b64_tr_b16 v[20:21], v4 offset:2048
  ds_read_b64_tr_b16 v[22:23], v4 offset:3072
  s_waitcnt lgkmcnt(6)
  v_mfma_f32_32x32x16_bf16 v[64:79], v[40:43], v[120:123], v[64:79]
  ds_read_b64_tr_b16 v[24:25], v4 offset:8192
  ds_read_b64_tr_b16 v[26:27], v4 offset:9216
  s_waitcnt lgkmcnt(6)
  v_mfma_f32_32x32x16_bf16 v[64:79], v[44:47], v[124:127], v[64:79]
  ds_read_b64_tr_b16 v[28:29], v4 offset:10240
  ds_read_b64_tr_b16 v[30:31], v4 offset:11264
  v_mul_f32 v80, v247, v80
  v_mul_f32 v81, v247, v81
  v_mul_f32 v82, v247, v82
  v_mul_f32 v83, v247, v83
  v_mul_f32 v84, v247, v84
  v_mul_f32 v85, v247, v85
  v_mul_f32 v86, v247, v86
  v_mul_f32 v87, v247, v87
  v_mul_f32 v88, v247, v88
  v_mul_f32 v89, v247, v89
  v_mul_f32 v90, v247, v90
  v_mul_f32 v91, v247, v91
  v_mul_f32 v92, v247, v92
  v_mul_f32 v93, v247, v93
  v_mul_f32 v94, v247, v94
  v_mul_f32 v95, v247, v95
  v_cvt_pk_bf16_f32 v80, v80, v81
  v_cvt_pk_bf16_f32 v81, v82, v83
  v_cvt_pk_bf16_f32 v82, v84, v85
  v_cvt_pk_bf16_f32 v83, v86, v87
  buffer_store_dwordx4 v[80:83], v12, s[16:19], s91 offen offset:0 sc1
  v_cvt_pk_bf16_f32 v88, v88, v89
  v_cvt_pk_bf16_f32 v89, v90, v91
  v_cvt_pk_bf16_f32 v90, v92, v93
  v_cvt_pk_bf16_f32 v91, v94, v95
  buffer_store_dwordx4 v[88:91], v12, s[16:19], s91 offen offset:1024 sc1
  s_nop 1
  s_waitcnt lgkmcnt(6)
  v_mfma_f32_32x32x16_bf16 v[80:95], v[16:19], v[112:115], 0
  ds_read_b64_tr_b16 v[32:33], v5 offset:0
  ds_read_b64_tr_b16 v[34:35], v5 offset:1024
  s_waitcnt lgkmcnt(6)
  v_mfma_f32_32x32x16_bf16 v[80:95], v[20:23], v[116:119], v[80:95]
  ds_read_b64_tr_b16 v[36:37], v5 offset:2048
  ds_read_b64_tr_b16 v[38:39], v5 offset:3072
  s_waitcnt lgkmcnt(6)
  v_mfma_f32_32x32x16_bf16 v[80:95], v[24:27], v[120:123], v[80:95]
  ds_read_b64_tr_b16 v[40:41], v5 offset:8192
  ds_read_b64_tr_b16 v[42:43], v5 offset:9216
  s_waitcnt lgkmcnt(6)
  v_mfma_f32_32x32x16_bf16 v[80:95], v[28:31], v[124:127], v[80:95]
  ds_read_b64_tr_b16 v[44:45], v5 offset:10240
  ds_read_b64_tr_b16 v[46:47], v5 offset:11264
  v_mul_f32 v96, v247, v96
  v_mul_f32 v97, v247, v97
  v_mul_f32 v98, v247, v98
  v_mul_f32 v99, v247, v99
  v_mul_f32 v100, v247, v100
  v_mul_f32 v101, v247, v101
  v_mul_f32 v102, v247, v102
  v_mul_f32 v103, v247, v103
  v_mul_f32 v104, v247, v104
  v_mul_f32 v105, v247, v105
  v_mul_f32 v106, v247, v106
  v_mul_f32 v107, v247, v107
  v_mul_f32 v108, v247, v108
  v_mul_f32 v109, v247, v109
  v_mul_f32 v110, v247, v110
  v_mul_f32 v111, v247, v111
  v_cvt_pk_bf16_f32 v96, v96, v97
  v_cvt_pk_bf16_f32 v97, v98, v99
  v_cvt_pk_bf16_f32 v98, v100, v101
  v_cvt_pk_bf16_f32 v99, v102, v103
  buffer_store_dwordx4 v[96:99], v12, s[16:19], s91 offen offset:2048 sc1
  v_cvt_pk_bf16_f32 v104, v104, v105
  v_cvt_pk_bf16_f32 v105, v106, v107
  v_cvt_pk_bf16_f32 v106, v108, v109
  v_cvt_pk_bf16_f32 v107, v110, v111
  buffer_store_dwordx4 v[104:107], v12, s[16:19], s91 offen offset:3072 sc1
  s_nop 1
  s_waitcnt lgkmcnt(6)
  v_mfma_f32_32x32x16_bf16 v[96:111], v[32:35], v[112:115], 0
  ds_read_b64_tr_b16 v[16:17], v2 offset:16384
  ds_read_b64_tr_b16 v[18:19], v2 offset:17408
  s_add_u32 m0, s58, 99328
  s_mul_i32 s57, s52, 388
  s_add_u32 s57, s57, s53
  buffer_load_dwordx4 v10, s[12:15], s57 offen lds
  s_waitcnt lgkmcnt(6)
  v_mfma_f32_32x32x16_bf16 v[96:111], v[36:39], v[116:119], v[96:111]
  ds_read_b64_tr_b16 v[20:21], v3 offset:16384
  ds_read_b64_tr_b16 v[22:23], v3 offset:17408
  s_waitcnt lgkmcnt(6)
  v_mfma_f32_32x32x16_bf16 v[96:111], v[40:43], v[120:123], v[96:111]
  ds_read_b64_tr_b16 v[24:25], v4 offset:16384
  ds_read_b64_tr_b16 v[26:27], v4 offset:17408
  s_waitcnt lgkmcnt(6)
  v_mfma_f32_32x32x16_bf16 v[96:111], v[44:47], v[124:127], v[96:111]
  ds_read_b64_tr_b16 v[28:29], v5 offset:16384
  ds_read_b64_tr_b16 v[30:31], v5 offset:17408
  s_waitcnt lgkmcnt(6)
  v_mfma_f32_32x32x16_bf16 v[48:63], v[16:19], v[128:131], v[48:63]
  ds_read_b64_tr_b16 v[32:33], v2 offset:18432
  ds_read_b64_tr_b16 v[34:35], v2 offset:19456
  s_waitcnt lgkmcnt(6)
  v_mfma_f32_32x32x16_bf16 v[64:79], v[20:23], v[128:131], v[64:79]
  ds_read_b64_tr_b16 v[36:37], v3 offset:18432
  ds_read_b64_tr_b16 v[38:39], v3 offset:19456
  s_waitcnt lgkmcnt(6)
  v_mfma_f32_32x32x16_bf16 v[80:95], v[24:27], v[128:131], v[80:95]
  ds_read_b64_tr_b16 v[40:41], v4 offset:18432
  ds_read_b64_tr_b16 v[42:43], v4 offset:19456
  s_waitcnt lgkmcnt(6)
  v_mfma_f32_32x32x16_bf16 v[96:111], v[28:31], v[128:131], v[96:111]
  ds_read_b64_tr_b16 v[44:45], v5 offset:18432
  ds_read_b64_tr_b16 v[46:47], v5 offset:19456
  s_waitcnt lgkmcnt(6)
  v_mfma_f32_32x32x16_bf16 v[48:63], v[32:35], v[132:135], v[48:63]
  ds_read_b64_tr_b16 v[16:17], v2 offset:24576
  ds_read_b64_tr_b16 v[18:19], v2 offset:25600
  s_add_u32 m0, s58, 100352
  s_mul_i32 s57, s52, 392
  s_add_u32 s57, s57, s53
  buffer_load_dwordx4 v10, s[12:15], s57 offen lds
  s_waitcnt lgkmcnt(6)
  v_mfma_f32_32x32x16_bf16 v[64:79], v[36:39], v[132:135], v[64:79]
  ds_read_b64_tr_b16 v[20:21], v3 offset:24576
  ds_read_b64_tr_b16 v[22:23], v3 offset:25600
  s_waitcnt lgkmcnt(6)
  v_mfma_f32_32x32x16_bf16 v[80:95], v[40:43], v[132:135], v[80:95]
  ds_read_b64_tr_b16 v[24:25], v4 offset:24576
  ds_read_b64_tr_b16 v[26:27], v4 offset:25600
  s_waitcnt lgkmcnt(6)
  v_mfma_f32_32x32x16_bf16 v[96:111], v[44:47], v[132:135], v[96:111]
  ds_read_b64_tr_b16 v[28:29], v5 offset:24576
  ds_read_b64_tr_b16 v[30:31], v5 offset:25600
  s_waitcnt lgkmcnt(6)
  v_mfma_f32_32x32x16_bf16 v[48:63], v[16:19], v[136:139], v[48:63]
  ds_read_b64_tr_b16 v[32:33], v2 offset:26624
  ds_read_b64_tr_b16 v[34:35], v2 offset:27648
  s_waitcnt lgkmcnt(6)
  v_mfma_f32_32x32x16_bf16 v[64:79], v[20:23], v[136:139], v[64:79]
  ds_read_b64_tr_b16 v[36:37], v3 offset:26624
  ds_read_b64_tr_b16 v[38:39], v3 offset:27648
  s_waitcnt lgkmcnt(6)
  v_mfma_f32_32x32x16_bf16 v[80:95], v[24:27], v[136:139], v[80:95]
  ds_read_b64_tr_b16 v[40:41], v4 offset:26624
  ds_read_b64_tr_b16 v[42:43], v4 offset:27648
  s_waitcnt lgkmcnt(6)
  v_mfma_f32_32x32x16_bf16 v[96:111], v[28:31], v[136:139], v[96:111]
  ds_read_b64_tr_b16 v[44:45], v5 offset:26624
  ds_read_b64_tr_b16 v[46:47], v5 offset:27648
  s_waitcnt lgkmcnt(6)
  v_mfma_f32_32x32x16_bf16 v[48:63], v[32:35], v[140:143], v[48:63]
  ds_read_b64_tr_b16 v[16:17], v2 offset:32768
  ds_read_b64_tr_b16 v[18:19], v2 offset:33792
  s_add_u32 m0, s58, 101376
  s_mul_i32 s57, s52, 396
  s_add_u32 s57, s57, s53
  buffer_load_dwordx4 v10, s[12:15], s57 offen lds
  s_waitcnt lgkmcnt(6)
  v_mfma_f32_32x32x16_bf16 v[64:79], v[36:39], v[140:143], v[64:79]
  ds_read_b64_tr_b16 v[20:21], v3 offset:32768
  ds_read_b64_tr_b16 v[22:23], v3 offset:33792
  s_waitcnt lgkmcnt(6)
  v_mfma_f32_32x32x16_bf16 v[80:95], v[40:43], v[140:143], v[80:95]
  ds_read_b64_tr_b16 v[24:25], v4 offset:32768
  ds_read_b64_tr_b16 v[26:27], v4 offset:33792
  s_lshr_b32 s88, s2, 1
  s_lshl_b32 s88, s88, 3
  s_add_u32 s88, s88, s6
  v_lshlrev_b32 v255, 6, v1
  s_mov_b32 s84, s32
  s_mov_b32 s85, s33
  s_mov_b32 s86, 0x400000
  s_mov_b32 s87, 0x20000
  s_lshl_b32 s89, s88, 12
  buffer_load_dword v254, v255, s[84:87], s89 offen
  s_waitcnt lgkmcnt(6)
  v_mfma_f32_32x32x16_bf16 v[96:111], v[44:47], v[140:143], v[96:111]
  ds_read_b64_tr_b16 v[28:29], v5 offset:32768
  ds_read_b64_tr_b16 v[30:31], v5 offset:33792
  s_waitcnt vmcnt(13)
  s_barrier
  s_waitcnt lgkmcnt(6)
  v_mfma_f32_32x32x16_bf16 v[48:63], v[16:19], v[144:147], v[48:63]
  ds_read_b64_tr_b16 v[32:33], v2 offset:34816
  ds_read_b64_tr_b16 v[34:35], v2 offset:35840
  s_waitcnt lgkmcnt(6)
  v_mfma_f32_32x32x16_bf16 v[64:79], v[20:23], v[144:147], v[64:79]
  ds_read_b64_tr_b16 v[36:37], v3 offset:34816
  ds_read_b64_tr_b16 v[38:39], v3 offset:35840
  s_waitcnt lgkmcnt(6)
  v_mfma_f32_32x32x16_bf16 v[80:95], v[24:27], v[144:147], v[80:95]
  ds_read_b64_tr_b16 v[40:41], v4 offset:34816
  ds_read_b64_tr_b16 v[42:43], v4 offset:35840
  s_waitcnt lgkmcnt(6)
  v_mfma_f32_32x32x16_bf16 v[96:111], v[28:31], v[144:147], v[96:111]
  ds_read_b64_tr_b16 v[44:45], v5 offset:34816
  ds_read_b64_tr_b16 v[46:47], v5 offset:35840
  s_waitcnt lgkmcnt(6)
  v_mfma_f32_32x32x16_bf16 v[48:63], v[32:35], v[148:151], v[48:63]
  ds_read_b64_tr_b16 v[16:17], v2 offset:40960
  ds_read_b64_tr_b16 v[18:19], v2 offset:41984
  s_add_u32 m0, s58, 0
  s_mul_i32 s57, s54, 0
  s_add_u32 s57, s57, s55
  buffer_load_dwordx4 v11, s[48:51], s57 offen lds
  s_waitcnt lgkmcnt(6)
  v_mfma_f32_32x32x16_bf16 v[64:79], v[36:39], v[148:151], v[64:79]
  ds_read_b64_tr_b16 v[20:21], v3 offset:40960
  ds_read_b64_tr_b16 v[22:23], v3 offset:41984
  s_waitcnt lgkmcnt(6)
  v_mfma_f32_32x32x16_bf16 v[80:95], v[40:43], v[148:151], v[80:95]
  ds_read_b64_tr_b16 v[24:25], v4 offset:40960
  ds_read_b64_tr_b16 v[26:27], v4 offset:41984
  s_waitcnt lgkmcnt(6)
  v_mfma_f32_32x32x16_bf16 v[96:111], v[44:47], v[148:151], v[96:111]
  ds_read_b64_tr_b16 v[28:29], v5 offset:40960
  ds_read_b64_tr_b16 v[30:31], v5 offset:41984
  s_waitcnt lgkmcnt(6)
  v_mfma_f32_32x32x16_bf16 v[48:63], v[16:19], v[152:155], v[48:63]
  ds_read_b64_tr_b16 v[32:33], v2 offset:43008
  ds_read_b64_tr_b16 v[34:35], v2 offset:44032
  s_waitcnt lgkmcnt(6)
  v_mfma_f32_32x32x16_bf16 v[64:79], v[20:23], v[152:155], v[64:79]
  ds_read_b64_tr_b16 v[36:37], v3 offset:43008
  ds_read_b64_tr_b16 v[38:39], v3 offset:44032
  s_waitcnt lgkmcnt(6)
  v_mfma_f32_32x32x16_bf16 v[80:95], v[24:27], v[152:155], v[80:95]
  ds_read_b64_tr_b16 v[40:41], v4 offset:43008
  ds_read_b64_tr_b16 v[42:43], v4 offset:44032
  s_waitcnt lgkmcnt(6)
  v_mfma_f32_32x32x16_bf16 v[96:111], v[28:31], v[152:155], v[96:111]
  ds_read_b64_tr_b16 v[44:45], v5 offset:43008
  ds_read_b64_tr_b16 v[46:47], v5 offset:44032
  s_waitcnt lgkmcnt(6)
  v_mfma_f32_32x32x16_bf16 v[48:63], v[32:35], v[156:159], v[48:63]
  ds_read_b64_tr_b16 v[16:17], v2 offset:49152
  ds_read_b64_tr_b16 v[18:19], v2 offset:50176
  s_add_u32 m0, s58, 1024
  s_mul_i32 s57, s54, 4
  s_add_u32 s57, s57, s55
  buffer_load_dwordx4 v11, s[48:51], s57 offen lds
  s_waitcnt lgkmcnt(6)
  v_mfma_f32_32x32x16_bf16 v[64:79], v[36:39], v[156:159], v[64:79]
  ds_read_b64_tr_b16 v[20:21], v3 offset:49152
  ds_read_b64_tr_b16 v[22:23], v3 offset:50176
  s_waitcnt lgkmcnt(6)
  v_mfma_f32_32x32x16_bf16 v[80:95], v[40:43], v[156:159], v[80:95]
  ds_read_b64_tr_b16 v[24:25], v4 offset:49152
  ds_read_b64_tr_b16 v[26:27], v4 offset:50176
  s_waitcnt lgkmcnt(6)
  v_mfma_f32_32x32x16_bf16 v[96:111], v[44:47], v[156:159], v[96:111]
  ds_read_b64_tr_b16 v[28:29], v5 offset:49152
  ds_read_b64_tr_b16 v[30:31], v5 offset:50176
  s_waitcnt lgkmcnt(6)
  v_mfma_f32_32x32x16_bf16 v[48:63], v[16:19], v[160:163], v[48:63]
  ds_read_b64_tr_b16 v[32:33], v2 offset:51200
  ds_read_b64_tr_b16 v[34:35], v2 offset:52224
  s_waitcnt lgkmcnt(6)
  v_mfma_f32_32x32x16_bf16 v[64:79], v[20:23], v[160:163], v[64:79]
  ds_read_b64_tr_b16 v[36:37], v3 offset:51200
  ds_read_b64_tr_b16 v[38:39], v3 offset:52224
  s_waitcnt lgkmcnt(6)
  v_mfma_f32_32x32x16_bf16 v[80:95], v[24:27], v[160:163], v[80:95]
  ds_read_b64_tr_b16 v[40:41], v4 offset:51200
  ds_read_b64_tr_b16 v[42:43], v4 offset:52224
  s_waitcnt lgkmcnt(6)
  v_mfma_f32_32x32x16_bf16 v[96:111], v[28:31], v[160:163], v[96:111]
  ds_read_b64_tr_b16 v[44:45], v5 offset:51200
  ds_read_b64_tr_b16 v[46:47], v5 offset:52224
  s_waitcnt lgkmcnt(6)
  v_mfma_f32_32x32x16_bf16 v[48:63], v[32:35], v[164:167], v[48:63]
  ds_read_b64_tr_b16 v[16:17], v2 offset:57344
  ds_read_b64_tr_b16 v[18:19], v2 offset:58368
  s_add_u32 m0, s58, 2048
  s_mul_i32 s57, s54, 8
  s_add_u32 s57, s57, s55
  buffer_load_dwordx4 v11, s[48:51], s57 offen lds
  s_waitcnt lgkmcnt(6)
  v_mfma_f32_32x32x16_bf16 v[64:79], v[36:39], v[164:167], v[64:79]
  ds_read_b64_tr_b16 v[20:21], v3 offset:57344
  ds_read_b64_tr_b16 v[22:23], v3 offset:58368
  s_waitcnt lgkmcnt(6)
  v_mfma_f32_32x32x16_bf16 v[80:95], v[40:43], v[164:167], v[80:95]
  ds_read_b64_tr_b16 v[24:25], v4 offset:57344
  ds_read_b64_tr_b16 v[26:27], v4 offset:58368
  s_waitcnt lgkmcnt(6)
  v_mfma_f32_32x32x16_bf16 v[96:111], v[44:47], v[164:167], v[96:111]
  ds_read_b64_tr_b16 v[28:29], v5 offset:57344
  ds_read_b64_tr_b16 v[30:31], v5 offset:58368
  s_waitcnt lgkmcnt(6)
  v_mfma_f32_32x32x16_bf16 v[48:63], v[16:19], v[168:171], v[48:63]
  ds_read_b64_tr_b16 v[32:33], v2 offset:59392
  ds_read_b64_tr_b16 v[34:35], v2 offset:60416
  s_waitcnt lgkmcnt(6)
  v_mfma_f32_32x32x16_bf16 v[64:79], v[20:23], v[168:171], v[64:79]
  ds_read_b64_tr_b16 v[36:37], v3 offset:59392
  ds_read_b64_tr_b16 v[38:39], v3 offset:60416
  s_waitcnt lgkmcnt(6)
  v_mfma_f32_32x32x16_bf16 v[80:95], v[24:27], v[168:171], v[80:95]
  ds_read_b64_tr_b16 v[40:41], v4 offset:59392
  ds_read_b64_tr_b16 v[42:43], v4 offset:60416
  s_waitcnt lgkmcnt(6)
  v_mfma_f32_32x32x16_bf16 v[96:111], v[28:31], v[168:171], v[96:111]
  ds_read_b64_tr_b16 v[44:45], v5 offset:59392
  ds_read_b64_tr_b16 v[46:47], v5 offset:60416
  s_waitcnt lgkmcnt(6)
  v_mfma_f32_32x32x16_bf16 v[48:63], v[32:35], v[172:175], v[48:63]
  ds_read_b64_tr_b16 v[16:17], v6 offset:0
  ds_read_b64_tr_b16 v[18:19], v6 offset:1024
  s_add_u32 m0, s58, 3072
  s_mul_i32 s57, s54, 12
  s_add_u32 s57, s57, s55
  buffer_load_dwordx4 v11, s[48:51], s57 offen lds
  s_waitcnt lgkmcnt(6)
  v_mfma_f32_32x32x16_bf16 v[64:79], v[36:39], v[172:175], v[64:79]
  ds_read_b64_tr_b16 v[20:21], v7 offset:0
  ds_read_b64_tr_b16 v[22:23], v7 offset:1024
  s_waitcnt lgkmcnt(6)
  v_mfma_f32_32x32x16_bf16 v[80:95], v[40:43], v[172:175], v[80:95]
  ds_read_b64_tr_b16 v[24:25], v8 offset:0
  ds_read_b64_tr_b16 v[26:27], v8 offset:1024
  s_lshr_b32 s88, s2, 1
  s_lshl_b32 s88, s88, 3
  s_add_u32 s88, s88, s6
  s_sub_u32 s88, 1023, s88
  v_lshlrev_b32 v255, 6, v1
  s_mov_b32 s84, s38
  s_mov_b32 s85, s39
  s_mov_b32 s86, 0x1c0000
  s_mov_b32 s87, 0x20000
  s_lshl_b32 s89, s88, 12
  buffer_load_dword v254, v255, s[84:87], s89 offen
  s_waitcnt lgkmcnt(6)
  v_mfma_f32_32x32x16_bf16 v[96:111], v[44:47], v[172:175], v[96:111]
  ds_read_b64_tr_b16 v[28:29], v9 offset:0
  ds_read_b64_tr_b16 v[30:31], v9 offset:1024
  s_waitcnt vmcnt(6)
  s_barrier
  s_waitcnt lgkmcnt(6)
  v_mfma_f32_32x32x16_bf16 v[48:63], v[16:19], v[176:179], v[48:63]
  ds_read_b64_tr_b16 v[32:33], v6 offset:2048
  ds_read_b64_tr_b16 v[34:35], v6 offset:3072
  s_waitcnt lgkmcnt(6)
  v_mfma_f32_32x32x16_bf16 v[64:79], v[20:23], v[176:179], v[64:79]
  ds_read_b64_tr_b16 v[36:37], v7 offset:2048
  ds_read_b64_tr_b16 v[38:39], v7 offset:3072
  s_waitcnt lgkmcnt(6)
  v_mfma_f32_32x32x16_bf16 v[80:95], v[24:27], v[176:179], v[80:95]
  ds_read_b64_tr_b16 v[40:41], v8 offset:2048
  ds_read_b64_tr_b16 v[42:43], v8 offset:3072
  s_waitcnt lgkmcnt(6)
  v_mfma_f32_32x32x16_bf16 v[96:111], v[28:31], v[176:179], v[96:111]
  ds_read_b64_tr_b16 v[44:45], v9 offset:2048
  ds_read_b64_tr_b16 v[46:47], v9 offset:3072
  s_waitcnt lgkmcnt(6)
  v_mfma_f32_32x32x16_bf16 v[48:63], v[32:35], v[180:183], v[48:63]
  ds_read_b64_tr_b16 v[16:17], v6 offset:8192
  ds_read_b64_tr_b16 v[18:19], v6 offset:9216
  s_add_u32 m0, s58, 32768
  s_mul_i32 s57, s54, 128
  s_add_u32 s57, s57, s55
  buffer_load_dwordx4 v11, s[48:51], s57 offen lds
  s_waitcnt lgkmcnt(6)
  v_mfma_f32_32x32x16_bf16 v[64:79], v[36:39], v[180:183], v[64:79]
  ds_read_b64_tr_b16 v[20:21], v7 offset:8192
  ds_read_b64_tr_b16 v[22:23], v7 offset:9216
  s_waitcnt lgkmcnt(6)
  v_mfma_f32_32x32x16_bf16 v[80:95], v[40:43], v[180:183], v[80:95]
  ds_read_b64_tr_b16 v[24:25], v8 offset:8192
  ds_read_b64_tr_b16 v[26:27], v8 offset:9216
  s_waitcnt lgkmcnt(6)
  v_mfma_f32_32x32x16_bf16 v[96:111], v[44:47], v[180:183], v[96:111]
  ds_read_b64_tr_b16 v[28:29], v9 offset:8192
  ds_read_b64_tr_b16 v[30:31], v9 offset:9216
  s_waitcnt lgkmcnt(6)
  v_mfma_f32_32x32x16_bf16 v[48:63], v[16:19], v[184:187], v[48:63]
  ds_read_b64_tr_b16 v[32:33], v6 offset:10240
  ds_read_b64_tr_b16 v[34:35], v6 offset:11264
  s_waitcnt lgkmcnt(6)
  v_mfma_f32_32x32x16_bf16 v[64:79], v[20:23], v[184:187], v[64:79]
  ds_read_b64_tr_b16 v[36:37], v7 offset:10240
  ds_read_b64_tr_b16 v[38:39], v7 offset:11264
  s_waitcnt lgkmcnt(6)
  v_mfma_f32_32x32x16_bf16 v[80:95], v[24:27], v[184:187], v[80:95]
  ds_read_b64_tr_b16 v[40:41], v8 offset:10240
  ds_read_b64_tr_b16 v[42:43], v8 offset:11264
  s_waitcnt lgkmcnt(6)
  v_mfma_f32_32x32x16_bf16 v[96:111], v[28:31], v[184:187], v[96:111]
  ds_read_b64_tr_b16 v[44:45], v9 offset:10240
  ds_read_b64_tr_b16 v[46:47], v9 offset:11264
  s_waitcnt lgkmcnt(6)
  v_mfma_f32_32x32x16_bf16 v[48:63], v[32:35], v[188:191], v[48:63]
  ds_read_b64_tr_b16 v[16:17], v6 offset:16384
  ds_read_b64_tr_b16 v[18:19], v6 offset:17408
  s_add_u32 m0, s58, 33792
  s_mul_i32 s57, s54, 132
  s_add_u32 s57, s57, s55
  buffer_load_dwordx4 v11, s[48:51], s57 offen lds
  s_waitcnt lgkmcnt(6)
  v_mfma_f32_32x32x16_bf16 v[64:79], v[36:39], v[188:191], v[64:79]
  ds_read_b64_tr_b16 v[20:21], v7 offset:16384
  ds_read_b64_tr_b16 v[22:23], v7 offset:17408
  s_waitcnt lgkmcnt(6)
  v_mfma_f32_32x32x16_bf16 v[80:95], v[40:43], v[188:191], v[80:95]
  ds_read_b64_tr_b16 v[24:25], v8 offset:16384
  ds_read_b64_tr_b16 v[26:27], v8 offset:17408
  s_waitcnt lgkmcnt(6)
  v_mfma_f32_32x32x16_bf16 v[96:111], v[44:47], v[188:191], v[96:111]
  ds_read_b64_tr_b16 v[28:29], v9 offset:16384
  ds_read_b64_tr_b16 v[30:31], v9 offset:17408
  s_waitcnt lgkmcnt(6)
  v_mfma_f32_32x32x16_bf16 v[48:63], v[16:19], v[192:195], v[48:63]
  ds_read_b64_tr_b16 v[32:33], v6 offset:18432
  ds_read_b64_tr_b16 v[34:35], v6 offset:19456
  s_waitcnt lgkmcnt(6)
  v_mfma_f32_32x32x16_bf16 v[64:79], v[20:23], v[192:195], v[64:79]
  ds_read_b64_tr_b16 v[36:37], v7 offset:18432
  ds_read_b64_tr_b16 v[38:39], v7 offset:19456
  s_waitcnt lgkmcnt(6)
  v_mfma_f32_32x32x16_bf16 v[80:95], v[24:27], v[192:195], v[80:95]
  ds_read_b64_tr_b16 v[40:41], v8 offset:18432
  ds_read_b64_tr_b16 v[42:43], v8 offset:19456
  s_waitcnt lgkmcnt(6)
  v_mfma_f32_32x32x16_bf16 v[96:111], v[28:31], v[192:195], v[96:111]
  ds_read_b64_tr_b16 v[44:45], v9 offset:18432
  ds_read_b64_tr_b16 v[46:47], v9 offset:19456
  s_waitcnt lgkmcnt(6)
  v_mfma_f32_32x32x16_bf16 v[48:63], v[32:35], v[196:199], v[48:63]
  ds_read_b64_tr_b16 v[16:17], v6 offset:24576
  ds_read_b64_tr_b16 v[18:19], v6 offset:25600
  s_add_u32 m0, s58, 34816
  s_mul_i32 s57, s54, 136
  s_add_u32 s57, s57, s55
  buffer_load_dwordx4 v11, s[48:51], s57 offen lds
  s_waitcnt lgkmcnt(6)
  v_mfma_f32_32x32x16_bf16 v[64:79], v[36:39], v[196:199], v[64:79]
  ds_read_b64_tr_b16 v[20:21], v7 offset:24576
  ds_read_b64_tr_b16 v[22:23], v7 offset:25600
  s_waitcnt lgkmcnt(6)
  v_mfma_f32_32x32x16_bf16 v[80:95], v[40:43], v[196:199], v[80:95]
  ds_read_b64_tr_b16 v[24:25], v8 offset:24576
  ds_read_b64_tr_b16 v[26:27], v8 offset:25600
  s_waitcnt lgkmcnt(6)
  v_mfma_f32_32x32x16_bf16 v[96:111], v[44:47], v[196:199], v[96:111]
  ds_read_b64_tr_b16 v[28:29], v9 offset:24576
  ds_read_b64_tr_b16 v[30:31], v9 offset:25600
  s_waitcnt lgkmcnt(6)
  v_mfma_f32_32x32x16_bf16 v[48:63], v[16:19], v[200:203], v[48:63]
  ds_read_b64_tr_b16 v[32:33], v6 offset:26624
  ds_read_b64_tr_b16 v[34:35], v6 offset:27648
  s_waitcnt lgkmcnt(6)
  v_mfma_f32_32x32x16_bf16 v[64:79], v[20:23], v[200:203], v[64:79]
  ds_read_b64_tr_b16 v[36:37], v7 offset:26624
  ds_read_b64_tr_b16 v[38:39], v7 offset:27648
  s_waitcnt lgkmcnt(6)
  v_mfma_f32_32x32x16_bf16 v[80:95], v[24:27], v[200:203], v[80:95]
  ds_read_b64_tr_b16 v[40:41], v8 offset:26624
  ds_read_b64_tr_b16 v[42:43], v8 offset:27648
  s_waitcnt lgkmcnt(6)
  v_mfma_f32_32x32x16_bf16 v[96:111], v[28:31], v[200:203], v[96:111]
  ds_read_b64_tr_b16 v[44:45], v9 offset:26624
  ds_read_b64_tr_b16 v[46:47], v9 offset:27648
  s_waitcnt lgkmcnt(6)
  v_mfma_f32_32x32x16_bf16 v[48:63], v[32:35], v[204:207], v[48:63]
  ds_read_b64_tr_b16 v[16:17], v6 offset:32768
  ds_read_b64_tr_b16 v[18:19], v6 offset:33792
  s_add_u32 m0, s58, 35840
  s_mul_i32 s57, s54, 140
  s_add_u32 s57, s57, s55
  buffer_load_dwordx4 v11, s[48:51], s57 offen lds
  s_waitcnt lgkmcnt(6)
  v_mfma_f32_32x32x16_bf16 v[64:79], v[36:39], v[204:207], v[64:79]
  ds_read_b64_tr_b16 v[20:21], v7 offset:32768
  ds_read_b64_tr_b16 v[22:23], v7 offset:33792
  s_waitcnt lgkmcnt(6)
  v_mfma_f32_32x32x16_bf16 v[80:95], v[40:43], v[204:207], v[80:95]
  ds_read_b64_tr_b16 v[24:25], v8 offset:32768
  ds_read_b64_tr_b16 v[26:27], v8 offset:33792
  s_waitcnt lgkmcnt(6)
  v_mfma_f32_32x32x16_bf16 v[96:111], v[44:47], v[204:207], v[96:111]
  ds_read_b64_tr_b16 v[28:29], v9 offset:32768
  ds_read_b64_tr_b16 v[30:31], v9 offset:33792
  s_waitcnt vmcnt(5)
  s_barrier
  s_waitcnt lgkmcnt(6)
  v_mfma_f32_32x32x16_bf16 v[48:63], v[16:19], v[208:211], v[48:63]
  ds_read_b64_tr_b16 v[32:33], v6 offset:34816
  ds_read_b64_tr_b16 v[34:35], v6 offset:35840
  s_waitcnt lgkmcnt(6)
  v_mfma_f32_32x32x16_bf16 v[64:79], v[20:23], v[208:211], v[64:79]
  ds_read_b64_tr_b16 v[36:37], v7 offset:34816
  ds_read_b64_tr_b16 v[38:39], v7 offset:35840
  s_waitcnt lgkmcnt(6)
  v_mfma_f32_32x32x16_bf16 v[80:95], v[24:27], v[208:211], v[80:95]
  ds_read_b64_tr_b16 v[40:41], v8 offset:34816
  ds_read_b64_tr_b16 v[42:43], v8 offset:35840
  s_waitcnt lgkmcnt(6)
  v_mfma_f32_32x32x16_bf16 v[96:111], v[28:31], v[208:211], v[96:111]
  ds_read_b64_tr_b16 v[44:45], v9 offset:34816
  ds_read_b64_tr_b16 v[46:47], v9 offset:35840
  s_waitcnt lgkmcnt(6)
  v_mfma_f32_32x32x16_bf16 v[48:63], v[32:35], v[212:215], v[48:63]
  ds_read_b64_tr_b16 v[16:17], v6 offset:40960
  ds_read_b64_tr_b16 v[18:19], v6 offset:41984
  s_add_u32 m0, s58, 65536
  s_mul_i32 s57, s54, 256
  s_add_u32 s57, s57, s55
  buffer_load_dwordx4 v11, s[48:51], s57 offen lds
  s_waitcnt lgkmcnt(6)
  v_mfma_f32_32x32x16_bf16 v[64:79], v[36:39], v[212:215], v[64:79]
  ds_read_b64_tr_b16 v[20:21], v7 offset:40960
  ds_read_b64_tr_b16 v[22:23], v7 offset:41984
  s_waitcnt lgkmcnt(6)
  v_mfma_f32_32x32x16_bf16 v[80:95], v[40:43], v[212:215], v[80:95]
  ds_read_b64_tr_b16 v[24:25], v8 offset:40960
  ds_read_b64_tr_b16 v[26:27], v8 offset:41984
  s_waitcnt lgkmcnt(6)
  v_mfma_f32_32x32x16_bf16 v[96:111], v[44:47], v[212:215], v[96:111]
  ds_read_b64_tr_b16 v[28:29], v9 offset:40960
  ds_read_b64_tr_b16 v[30:31], v9 offset:41984
  s_waitcnt lgkmcnt(6)
  v_mfma_f32_32x32x16_bf16 v[48:63], v[16:19], v[216:219], v[48:63]
  ds_read_b64_tr_b16 v[32:33], v6 offset:43008
  ds_read_b64_tr_b16 v[34:35], v6 offset:44032
  s_waitcnt lgkmcnt(6)
  v_mfma_f32_32x32x16_bf16 v[64:79], v[20:23], v[216:219], v[64:79]
  ds_read_b64_tr_b16 v[36:37], v7 offset:43008
  ds_read_b64_tr_b16 v[38:39], v7 offset:44032
  s_waitcnt lgkmcnt(6)
  v_mfma_f32_32x32x16_bf16 v[80:95], v[24:27], v[216:219], v[80:95]
  ds_read_b64_tr_b16 v[40:41], v8 offset:43008
  ds_read_b64_tr_b16 v[42:43], v8 offset:44032
  s_waitcnt lgkmcnt(6)
  v_mfma_f32_32x32x16_bf16 v[96:111], v[28:31], v[216:219], v[96:111]
  ds_read_b64_tr_b16 v[44:45], v9 offset:43008
  ds_read_b64_tr_b16 v[46:47], v9 offset:44032
  s_waitcnt lgkmcnt(6)
  v_mfma_f32_32x32x16_bf16 v[48:63], v[32:35], v[220:223], v[48:63]
  ds_read_b64_tr_b16 v[16:17], v6 offset:49152
  ds_read_b64_tr_b16 v[18:19], v6 offset:50176
  s_add_u32 m0, s58, 66560
  s_mul_i32 s57, s54, 260
  s_add_u32 s57, s57, s55
  buffer_load_dwordx4 v11, s[48:51], s57 offen lds
  s_waitcnt lgkmcnt(6)
  v_mfma_f32_32x32x16_bf16 v[64:79], v[36:39], v[220:223], v[64:79]
  ds_read_b64_tr_b16 v[20:21], v7 offset:49152
  ds_read_b64_tr_b16 v[22:23], v7 offset:50176
  s_waitcnt lgkmcnt(6)
  v_mfma_f32_32x32x16_bf16 v[80:95], v[40:43], v[220:223], v[80:95]
  ds_read_b64_tr_b16 v[24:25], v8 offset:49152
  ds_read_b64_tr_b16 v[26:27], v8 offset:50176
  s_waitcnt lgkmcnt(6)
  v_mfma_f32_32x32x16_bf16 v[96:111], v[44:47], v[220:223], v[96:111]
  ds_read_b64_tr_b16 v[28:29], v9 offset:49152
  ds_read_b64_tr_b16 v[30:31], v9 offset:50176
  s_waitcnt lgkmcnt(6)
  v_mfma_f32_32x32x16_bf16 v[48:63], v[16:19], v[224:227], v[48:63]
  ds_read_b64_tr_b16 v[32:33], v6 offset:51200
  ds_read_b64_tr_b16 v[34:35], v6 offset:52224
  s_waitcnt lgkmcnt(6)
  v_mfma_f32_32x32x16_bf16 v[64:79], v[20:23], v[224:227], v[64:79]
  ds_read_b64_tr_b16 v[36:37], v7 offset:51200
  ds_read_b64_tr_b16 v[38:39], v7 offset:52224
  s_waitcnt lgkmcnt(6)
  v_mfma_f32_32x32x16_bf16 v[80:95], v[24:27], v[224:227], v[80:95]
  ds_read_b64_tr_b16 v[40:41], v8 offset:51200
  ds_read_b64_tr_b16 v[42:43], v8 offset:52224
  s_waitcnt lgkmcnt(6)
  v_mfma_f32_32x32x16_bf16 v[96:111], v[28:31], v[224:227], v[96:111]
  ds_read_b64_tr_b16 v[44:45], v9 offset:51200
  ds_read_b64_tr_b16 v[46:47], v9 offset:52224
  s_waitcnt lgkmcnt(6)
  v_mfma_f32_32x32x16_bf16 v[48:63], v[32:35], v[228:231], v[48:63]
  ds_read_b64_tr_b16 v[16:17], v6 offset:57344
  ds_read_b64_tr_b16 v[18:19], v6 offset:58368
  s_add_u32 m0, s58, 67584
  s_mul_i32 s57, s54, 264
  s_add_u32 s57, s57, s55
  buffer_load_dwordx4 v11, s[48:51], s57 offen lds
  s_waitcnt lgkmcnt(6)
  v_mfma_f32_32x32x16_bf16 v[64:79], v[36:39], v[228:231], v[64:79]
  ds_read_b64_tr_b16 v[20:21], v7 offset:57344
  ds_read_b64_tr_b16 v[22:23], v7 offset:58368
  s_waitcnt lgkmcnt(6)
  v_mfma_f32_32x32x16_bf16 v[80:95], v[40:43], v[228:231], v[80:95]
  ds_read_b64_tr_b16 v[24:25], v8 offset:57344
  ds_read_b64_tr_b16 v[26:27], v8 offset:58368
  s_waitcnt lgkmcnt(6)
  v_mfma_f32_32x32x16_bf16 v[96:111], v[44:47], v[228:231], v[96:111]
  ds_read_b64_tr_b16 v[28:29], v9 offset:57344
  ds_read_b64_tr_b16 v[30:31], v9 offset:58368
  s_waitcnt lgkmcnt(6)
  v_mfma_f32_32x32x16_bf16 v[48:63], v[16:19], v[232:235], v[48:63]
  ds_read_b64_tr_b16 v[32:33], v6 offset:59392
  ds_read_b64_tr_b16 v[34:35], v6 offset:60416
  s_waitcnt lgkmcnt(6)
  v_mfma_f32_32x32x16_bf16 v[64:79], v[20:23], v[232:235], v[64:79]
  ds_read_b64_tr_b16 v[36:37], v7 offset:59392
  ds_read_b64_tr_b16 v[38:39], v7 offset:60416
  s_waitcnt lgkmcnt(6)
  v_mfma_f32_32x32x16_bf16 v[80:95], v[24:27], v[232:235], v[80:95]
  ds_read_b64_tr_b16 v[40:41], v8 offset:59392
  ds_read_b64_tr_b16 v[42:43], v8 offset:60416
  s_waitcnt lgkmcnt(6)
  v_mfma_f32_32x32x16_bf16 v[96:111], v[28:31], v[232:235], v[96:111]
  ds_read_b64_tr_b16 v[44:45], v9 offset:59392
  ds_read_b64_tr_b16 v[46:47], v9 offset:60416
  s_waitcnt lgkmcnt(6)
  v_mfma_f32_32x32x16_bf16 v[48:63], v[32:35], v[236:239], v[48:63]
  ds_read_b64_tr_b16 v[16:17], v2 offset:0
  ds_read_b64_tr_b16 v[18:19], v2 offset:1024
  s_add_u32 m0, s58, 68608
  s_mul_i32 s57, s54, 268
  s_add_u32 s57, s57, s55
  buffer_load_dwordx4 v11, s[48:51], s57 offen lds
  s_waitcnt lgkmcnt(6)
  v_mfma_f32_32x32x16_bf16 v[64:79], v[36:39], v[236:239], v[64:79]
  ds_read_b64_tr_b16 v[20:21], v2 offset:2048
  ds_read_b64_tr_b16 v[22:23], v2 offset:3072
  s_waitcnt lgkmcnt(6)
  v_mfma_f32_32x32x16_bf16 v[80:95], v[40:43], v[236:239], v[80:95]
  ds_read_b64_tr_b16 v[24:25], v2 offset:8192
  ds_read_b64_tr_b16 v[26:27], v2 offset:9216
  s_waitcnt lgkmcnt(6)
  v_mfma_f32_32x32x16_bf16 v[96:111], v[44:47], v[236:239], v[96:111]
  ds_read_b64_tr_b16 v[28:29], v2 offset:10240
  ds_read_b64_tr_b16 v[30:31], v2 offset:11264
  s_mov_b32 s12, s48
  s_mov_b32 s13, s49
  s_mov_b32 s14, s50
  s_mov_b32 s52, s54
  s_mov_b32 s53, s55
  v_mov_b32 v10, v11
  s_cmp_lt_u32 s4, 14
  s_cbranch_scc1 proj_h
  s_nop 11
  v_mul_f32 v48, v247, v48
  v_mul_f32 v49, v247, v49
  v_mul_f32 v50, v247, v50
  v_mul_f32 v51, v247, v51
  v_mul_f32 v52, v247, v52
  v_mul_f32 v53, v247, v53
  v_mul_f32 v54, v247, v54
  v_mul_f32 v55, v247, v55
  v_mul_f32 v56, v247, v56
  v_mul_f32 v57, v247, v57
  v_mul_f32 v58, v247, v58
  v_mul_f32 v59, v247, v59
  v_mul_f32 v60, v247, v60
  v_mul_f32 v61, v247, v61
  v_mul_f32 v62, v247, v62
  v_mul_f32 v63, v247, v63
  v_mul_f32 v64, v247, v64
  v_mul_f32 v65, v247, v65
  v_mul_f32 v66, v247, v66
  v_mul_f32 v67, v247, v67
  v_mul_f32 v68, v247, v68
  v_mul_f32 v69, v247, v69
  v_mul_f32 v70, v247, v70
  v_mul_f32 v71, v247, v71
  v_mul_f32 v72, v247, v72
  v_mul_f32 v73, v247, v73
  v_mul_f32 v74, v247, v74
  v_mul_f32 v75, v247, v75
  v_mul_f32 v76, v247, v76
  v_mul_f32 v77, v247, v77
  v_mul_f32 v78, v247, v78
  v_mul_f32 v79, v247, v79
  v_mul_f32 v80, v247, v80
  v_mul_f32 v81, v247, v81
  v_mul_f32 v82, v247, v82
  v_mul_f32 v83, v247, v83
  v_mul_f32 v84, v247, v84
  v_mul_f32 v85, v247, v85
  v_mul_f32 v86, v247, v86
  v_mul_f32 v87, v247, v87
  v_mul_f32 v88, v247, v88
  v_mul_f32 v89, v247, v89
  v_mul_f32 v90, v247, v90
  v_mul_f32 v91, v247, v91
  v_mul_f32 v92, v247, v92
  v_mul_f32 v93, v247, v93
  v_mul_f32 v94, v247, v94
  v_mul_f32 v95, v247, v95
  v_mul_f32 v96, v247, v96
  v_mul_f32 v97, v247, v97
  v_mul_f32 v98, v247, v98
  v_mul_f32 v99, v247, v99
  v_mul_f32 v100, v247, v100
  v_mul_f32 v101, v247, v101
  v_mul_f32 v102, v247, v102
  v_mul_f32 v103, v247, v103
  v_mul_f32 v104, v247, v104
  v_mul_f32 v105, v247, v105
  v_mul_f32 v106, v247, v106
  v_mul_f32 v107, v247, v107
  v_mul_f32 v108, v247, v108
  v_mul_f32 v109, v247, v109
  v_mul_f32 v110, v247, v110
  v_mul_f32 v111, v247, v111
  s_add_u32 s67, s56, 4096
  v_cvt_pk_bf16_f32 v48, v48, v49
  v_cvt_pk_bf16_f32 v49, v50, v51
  v_cvt_pk_bf16_f32 v50, v52, v53
  v_cvt_pk_bf16_f32 v51, v54, v55
  buffer_store_dwordx4 v[48:51], v12, s[16:19], s56 offen offset:0 sc1
  v_cvt_pk_bf16_f32 v56, v56, v57
  v_cvt_pk_bf16_f32 v57, v58, v59
  v_cvt_pk_bf16_f32 v58, v60, v61
  v_cvt_pk_bf16_f32 v59, v62, v63
  buffer_store_dwordx4 v[56:59], v12, s[16:19], s56 offen offset:1024 sc1
  v_cvt_pk_bf16_f32 v64, v64, v65
  v_cvt_pk_bf16_f32 v65, v66, v67
  v_cvt_pk_bf16_f32 v66, v68, v69
  v_cvt_pk_bf16_f32 v67, v70, v71
  buffer_store_dwordx4 v[64:67], v12, s[16:19], s56 offen offset:2048 sc1
  v_cvt_pk_bf16_f32 v72, v72, v73
  v_cvt_pk_bf16_f32 v73, v74, v75
  v_cvt_pk_bf16_f32 v74, v76, v77
  v_cvt_pk_bf16_f32 v75, v78, v79
  buffer_store_dwordx4 v[72:75], v12, s[16:19], s56 offen offset:3072 sc1
  v_cvt_pk_bf16_f32 v80, v80, v81
  v_cvt_pk_bf16_f32 v81, v82, v83
  v_cvt_pk_bf16_f32 v82, v84, v85
  v_cvt_pk_bf16_f32 v83, v86, v87
  buffer_store_dwordx4 v[80:83], v12, s[16:19], s67 offen offset:0 sc1
  v_cvt_pk_bf16_f32 v88, v88, v89
  v_cvt_pk_bf16_f32 v89, v90, v91
  v_cvt_pk_bf16_f32 v90, v92, v93
  v_cvt_pk_bf16_f32 v91, v94, v95
  buffer_store_dwordx4 v[88:91], v12, s[16:19], s67 offen offset:1024 sc1
  v_cvt_pk_bf16_f32 v96, v96, v97
  v_cvt_pk_bf16_f32 v97, v98, v99
  v_cvt_pk_bf16_f32 v98, v100, v101
  v_cvt_pk_bf16_f32 v99, v102, v103
  buffer_store_dwordx4 v[96:99], v12, s[16:19], s67 offen offset:2048 sc1
  v_cvt_pk_bf16_f32 v104, v104, v105
  v_cvt_pk_bf16_f32 v105, v106, v107
  v_cvt_pk_bf16_f32 v106, v108, v109
  v_cvt_pk_bf16_f32 v107, v110, v111
  buffer_store_dwordx4 v[104:107], v12, s[16:19], s67 offen offset:3072 sc1
  s_nop 1
  s_branch proj_end
proj_h:
  s_mov_b32 s90, s56
  s_add_u32 s91, s56, 4096
  s_mov_b32 s66, 0
  s_mov_b32 s48, s38
  s_mov_b32 s49, s39
  s_mov_b32 s50, s66
  s_mov_b32 s54, 3584
  s_mov_b32 s55, s46
  v_mul_lo_u32 v11, v13, s54
  v_add_u32 v11, v11, v14
  s_mul_i32 s56, s59, 376832
  s_lshl_b32 s66, s4, 13
  s_add_u32 s56, s56, s66
  s_add_u32 s56, s56, 0x3140000
  s_waitcnt vmcnt(4)
  s_barrier
  v_mul_f32 v48, v247, v48
  v_mul_f32 v49, v247, v49
  v_mul_f32 v50, v247, v50
  v_mul_f32 v51, v247, v51
  v_mul_f32 v52, v247, v52
  v_mul_f32 v53, v247, v53
  v_mul_f32 v54, v247, v54
  v_mul_f32 v55, v247, v55
  v_mul_f32 v56, v247, v56
  v_mul_f32 v57, v247, v57
  v_mul_f32 v58, v247, v58
  v_mul_f32 v59, v247, v59
  v_mul_f32 v60, v247, v60
  v_mul_f32 v61, v247, v61
  v_mul_f32 v62, v247, v62
  v_mul_f32 v63, v247, v63
  v_cvt_pk_bf16_f32 v48, v48, v49
  v_cvt_pk_bf16_f32 v49, v50, v51
  v_cvt_pk_bf16_f32 v50, v52, v53
  v_cvt_pk_bf16_f32 v51, v54, v55
  buffer_store_dwordx4 v[48:51], v12, s[16:19], s90 offen offset:0 sc1
  v_cvt_pk_bf16_f32 v56, v56, v57
  v_cvt_pk_bf16_f32 v57, v58, v59
  v_cvt_pk_bf16_f32 v58, v60, v61
  v_cvt_pk_bf16_f32 v59, v62, v63
  buffer_store_dwordx4 v[56:59], v12, s[16:19], s90 offen offset:1024 sc1
  s_nop 1
  s_waitcnt lgkmcnt(6)
  v_mfma_f32_32x32x16_bf16 v[48:63], v[16:19], v[112:115], 0
  ds_read_b64_tr_b16 v[32:33], v3 offset:0
  ds_read_b64_tr_b16 v[34:35], v3 offset:1024
  s_waitcnt lgkmcnt(6)
  v_mfma_f32_32x32x16_bf16 v[48:63], v[20:23], v[116:119], v[48:63]
  ds_read_b64_tr_b16 v[36:37], v3 offset:2048
  ds_read_b64_tr_b16 v[38:39], v3 offset:3072
  s_waitcnt lgkmcnt(6)
  v_mfma_f32_32x32x16_bf16 v[48:63], v[24:27], v[120:123], v[48:63]
  ds_read_b64_tr_b16 v[40:41], v3 offset:8192
  ds_read_b64_tr_b16 v[42:43], v3 offset:9216
  s_waitcnt lgkmcnt(6)
  v_mfma_f32_32x32x16_bf16 v[48:63], v[28:31], v[124:127], v[48:63]
  ds_read_b64_tr_b16 v[44:45], v3 offset:10240
  ds_read_b64_tr_b16 v[46:47], v3 offset:11264
  v_mul_f32 v64, v247, v64
  v_mul_f32 v65, v247, v65
  v_mul_f32 v66, v247, v66
  v_mul_f32 v67, v247, v67
  v_mul_f32 v68, v247, v68
  v_mul_f32 v69, v247, v69
  v_mul_f32 v70, v247, v70
  v_mul_f32 v71, v247, v71
  v_mul_f32 v72, v247, v72
  v_mul_f32 v73, v247, v73
  v_mul_f32 v74, v247, v74
  v_mul_f32 v75, v247, v75
  v_mul_f32 v76, v247, v76
  v_mul_f32 v77, v247, v77
  v_mul_f32 v78, v247, v78
  v_mul_f32 v79, v247, v79
  v_cvt_pk_bf16_f32 v64, v64, v65
  v_cvt_pk_bf16_f32 v65, v66, v67
  v_cvt_pk_bf16_f32 v66, v68, v69
  v_cvt_pk_bf16_f32 v67, v70, v71
  buffer_store_dwordx4 v[64:67], v12, s[16:19], s90 offen offset:2048 sc1
  v_cvt_pk_bf16_f32 v72, v72, v73
  v_cvt_pk_bf16_f32 v73, v74, v75
  v_cvt_pk_bf16_f32 v74, v76, v77
  v_cvt_pk_bf16_f32 v75, v78, v79
  buffer_store_dwordx4 v[72:75], v12, s[16:19], s90 offen offset:3072 sc1
  s_nop 1
  s_waitcnt lgkmcnt(6)
  v_mfma_f32_32x32x16_bf16 v[64:79], v[32:35], v[112:115], 0
  ds_read_b64_tr_b16 v[16:17], v4 offset:0
  ds_read_b64_tr_b16 v[18:19], v4 offset:1024
  s_add_u32 m0, s58, 98304
  s_mul_i32 s57, s52, 384
  s_add_u32 s57, s57, s53
  buffer_load_dwordx4 v10, s[12:15], s57 offen lds
  s_waitcnt lgkmcnt(6)
  v_mfma_f32_32x32x16_bf16 v[64:79], v[36:39], v[116:119], v[64:79]
  ds_read_b64_tr_b16 v[20:21], v4 offset:2048
  ds_read_b64_tr_b16 v[22:23], v4 offset:3072
  s_waitcnt lgkmcnt(6)
  v_mfma_f32_32x32x16_bf16 v[64:79], v[40:43], v[120:123], v[64:79]
  ds_read_b64_tr_b16 v[24:25], v4 offset:8192
  ds_read_b64_tr_b16 v[26:27], v4 offset:9216
  s_waitcnt lgkmcnt(6)
  v_mfma_f32_32x32x16_bf16 v[64:79], v[44:47], v[124:127], v[64:79]
  ds_read_b64_tr_b16 v[28:29], v4 offset:10240
  ds_read_b64_tr_b16 v[30:31], v4 offset:11264
  v_mul_f32 v80, v247, v80
  v_mul_f32 v81, v247, v81
  v_mul_f32 v82, v247, v82
  v_mul_f32 v83, v247, v83
  v_mul_f32 v84, v247, v84
  v_mul_f32 v85, v247, v85
  v_mul_f32 v86, v247, v86
  v_mul_f32 v87, v247, v87
  v_mul_f32 v88, v247, v88
  v_mul_f32 v89, v247, v89
  v_mul_f32 v90, v247, v90
  v_mul_f32 v91, v247, v91
  v_mul_f32 v92, v247, v92
  v_mul_f32 v93, v247, v93
  v_mul_f32 v94, v247, v94
  v_mul_f32 v95, v247, v95
  v_cvt_pk_bf16_f32 v80, v80, v81
  v_cvt_pk_bf16_f32 v81, v82, v83
  v_cvt_pk_bf16_f32 v82, v84, v85
  v_cvt_pk_bf16_f32 v83, v86, v87
  buffer_store_dwordx4 v[80:83], v12, s[16:19], s91 offen offset:0 sc1
  v_cvt_pk_bf16_f32 v88, v88, v89
  v_cvt_pk_bf16_f32 v89, v90, v91
  v_cvt_pk_bf16_f32 v90, v92, v93
  v_cvt_pk_bf16_f32 v91, v94, v95
  buffer_store_dwordx4 v[88:91], v12, s[16:19], s91 offen offset:1024 sc1
  s_nop 1
  s_waitcnt lgkmcnt(6)
  v_mfma_f32_32x32x16_bf16 v[80:95], v[16:19], v[112:115], 0
  ds_read_b64_tr_b16 v[32:33], v5 offset:0
  ds_read_b64_tr_b16 v[34:35], v5 offset:1024
  s_waitcnt lgkmcnt(6)
  v_mfma_f32_32x32x16_bf16 v[80:95], v[20:23], v[116:119], v[80:95]
  ds_read_b64_tr_b16 v[36:37], v5 offset:2048
  ds_read_b64_tr_b16 v[38:39], v5 offset:3072
  s_waitcnt lgkmcnt(6)
  v_mfma_f32_32x32x16_bf16 v[80:95], v[24:27], v[120:123], v[80:95]
  ds_read_b64_tr_b16 v[40:41], v5 offset:8192
  ds_read_b64_tr_b16 v[42:43], v5 offset:9216
  s_waitcnt lgkmcnt(6)
  v_mfma_f32_32x32x16_bf16 v[80:95], v[28:31], v[124:127], v[80:95]
  ds_read_b64_tr_b16 v[44:45], v5 offset:10240
  ds_read_b64_tr_b16 v[46:47], v5 offset:11264
  v_mul_f32 v96, v247, v96
  v_mul_f32 v97, v247, v97
  v_mul_f32 v98, v247, v98
  v_mul_f32 v99, v247, v99
  v_mul_f32 v100, v247, v100
  v_mul_f32 v101, v247, v101
  v_mul_f32 v102, v247, v102
  v_mul_f32 v103, v247, v103
  v_mul_f32 v104, v247, v104
  v_mul_f32 v105, v247, v105
  v_mul_f32 v106, v247, v106
  v_mul_f32 v107, v247, v107
  v_mul_f32 v108, v247, v108
  v_mul_f32 v109, v247, v109
  v_mul_f32 v110, v247, v110
  v_mul_f32 v111, v247, v111
  v_cvt_pk_bf16_f32 v96, v96, v97
  v_cvt_pk_bf16_f32 v97, v98, v99
  v_cvt_pk_bf16_f32 v98, v100, v101
  v_cvt_pk_bf16_f32 v99, v102, v103
  buffer_store_dwordx4 v[96:99], v12, s[16:19], s91 offen offset:2048 sc1
  v_cvt_pk_bf16_f32 v104, v104, v105
  v_cvt_pk_bf16_f32 v105, v106, v107
  v_cvt_pk_bf16_f32 v106, v108, v109
  v_cvt_pk_bf16_f32 v107, v110, v111
  buffer_store_dwordx4 v[104:107], v12, s[16:19], s91 offen offset:3072 sc1
  s_nop 1
  s_waitcnt lgkmcnt(6)
  v_mfma_f32_32x32x16_bf16 v[96:111], v[32:35], v[112:115], 0
  ds_read_b64_tr_b16 v[16:17], v2 offset:16384
  ds_read_b64_tr_b16 v[18:19], v2 offset:17408
  s_add_u32 m0, s58, 99328
  s_mul_i32 s57, s52, 388
  s_add_u32 s57, s57, s53
  buffer_load_dwordx4 v10, s[12:15], s57 offen lds
  s_waitcnt lgkmcnt(6)
  v_mfma_f32_32x32x16_bf16 v[96:111], v[36:39], v[116:119], v[96:111]
  ds_read_b64_tr_b16 v[20:21], v3 offset:16384
  ds_read_b64_tr_b16 v[22:23], v3 offset:17408
  s_waitcnt lgkmcnt(6)
  v_mfma_f32_32x32x16_bf16 v[96:111], v[40:43], v[120:123], v[96:111]
  ds_read_b64_tr_b16 v[24:25], v4 offset:16384
  ds_read_b64_tr_b16 v[26:27], v4 offset:17408
  s_waitcnt lgkmcnt(6)
  v_mfma_f32_32x32x16_bf16 v[96:111], v[44:47], v[124:127], v[96:111]
  ds_read_b64_tr_b16 v[28:29], v5 offset:16384
  ds_read_b64_tr_b16 v[30:31], v5 offset:17408
  s_waitcnt lgkmcnt(6)
  v_mfma_f32_32x32x16_bf16 v[48:63], v[16:19], v[128:131], v[48:63]
  ds_read_b64_tr_b16 v[32:33], v2 offset:18432
  ds_read_b64_tr_b16 v[34:35], v2 offset:19456
  s_waitcnt lgkmcnt(6)
  v_mfma_f32_32x32x16_bf16 v[64:79], v[20:23], v[128:131], v[64:79]
  ds_read_b64_tr_b16 v[36:37], v3 offset:18432
  ds_read_b64_tr_b16 v[38:39], v3 offset:19456
  s_waitcnt lgkmcnt(6)
  v_mfma_f32_32x32x16_bf16 v[80:95], v[24:27], v[128:131], v[80:95]
  ds_read_b64_tr_b16 v[40:41], v4 offset:18432
  ds_read_b64_tr_b16 v[42:43], v4 offset:19456
  s_waitcnt lgkmcnt(6)
  v_mfma_f32_32x32x16_bf16 v[96:111], v[28:31], v[128:131], v[96:111]
  ds_read_b64_tr_b16 v[44:45], v5 offset:18432
  ds_read_b64_tr_b16 v[46:47], v5 offset:19456
  s_waitcnt lgkmcnt(6)
  v_mfma_f32_32x32x16_bf16 v[48:63], v[32:35], v[132:135], v[48:63]
  ds_read_b64_tr_b16 v[16:17], v2 offset:24576
  ds_read_b64_tr_b16 v[18:19], v2 offset:25600
  s_add_u32 m0, s58, 100352
  s_mul_i32 s57, s52, 392
  s_add_u32 s57, s57, s53
  buffer_load_dwordx4 v10, s[12:15], s57 offen lds
  s_waitcnt lgkmcnt(6)
  v_mfma_f32_32x32x16_bf16 v[64:79], v[36:39], v[132:135], v[64:79]
  ds_read_b64_tr_b16 v[20:21], v3 offset:24576
  ds_read_b64_tr_b16 v[22:23], v3 offset:25600
  s_waitcnt lgkmcnt(6)
  v_mfma_f32_32x32x16_bf16 v[80:95], v[40:43], v[132:135], v[80:95]
  ds_read_b64_tr_b16 v[24:25], v4 offset:24576
  ds_read_b64_tr_b16 v[26:27], v4 offset:25600
  s_waitcnt lgkmcnt(6)
  v_mfma_f32_32x32x16_bf16 v[96:111], v[44:47], v[132:135], v[96:111]
  ds_read_b64_tr_b16 v[28:29], v5 offset:24576
  ds_read_b64_tr_b16 v[30:31], v5 offset:25600
  s_waitcnt lgkmcnt(6)
  v_mfma_f32_32x32x16_bf16 v[48:63], v[16:19], v[136:139], v[48:63]
  ds_read_b64_tr_b16 v[32:33], v2 offset:26624
  ds_read_b64_tr_b16 v[34:35], v2 offset:27648
  s_waitcnt lgkmcnt(6)
  v_mfma_f32_32x32x16_bf16 v[64:79], v[20:23], v[136:139], v[64:79]
  ds_read_b64_tr_b16 v[36:37], v3 offset:26624
  ds_read_b64_tr_b16 v[38:39], v3 offset:27648
  s_waitcnt lgkmcnt(6)
  v_mfma_f32_32x32x16_bf16 v[80:95], v[24:27], v[136:139], v[80:95]
  ds_read_b64_tr_b16 v[40:41], v4 offset:26624
  ds_read_b64_tr_b16 v[42:43], v4 offset:27648
  s_waitcnt lgkmcnt(6)
  v_mfma_f32_32x32x16_bf16 v[96:111], v[28:31], v[136:139], v[96:111]
  ds_read_b64_tr_b16 v[44:45], v5 offset:26624
  ds_read_b64_tr_b16 v[46:47], v5 offset:27648
  s_waitcnt lgkmcnt(6)
  v_mfma_f32_32x32x16_bf16 v[48:63], v[32:35], v[140:143], v[48:63]
  ds_read_b64_tr_b16 v[16:17], v2 offset:32768
  ds_read_b64_tr_b16 v[18:19], v2 offset:33792
  s_add_u32 m0, s58, 101376
  s_mul_i32 s57, s52, 396
  s_add_u32 s57, s57, s53
  buffer_load_dwordx4 v10, s[12:15], s57 offen lds
  s_waitcnt lgkmcnt(6)
  v_mfma_f32_32x32x16_bf16 v[64:79], v[36:39], v[140:143], v[64:79]
  ds_read_b64_tr_b16 v[20:21], v3 offset:32768
  ds_read_b64_tr_b16 v[22:23], v3 offset:33792
  s_waitcnt lgkmcnt(6)
  v_mfma_f32_32x32x16_bf16 v[80:95], v[40:43], v[140:143], v[80:95]
  ds_read_b64_tr_b16 v[24:25], v4 offset:32768
  ds_read_b64_tr_b16 v[26:27], v4 offset:33792
  s_lshl_b32 s88, s2, 3
  s_add_u32 s88, s88, s6
  v_lshlrev_b32 v255, 6, v1
  s_cmp_lt_u32 s88, 1024
  s_cselect_b32 s84, s34, s42
  s_cselect_b32 s85, s35, s43
  s_cselect_b32 s86, s7, 0x1c0000
  s_mov_b32 s87, 0x20000
  s_and_b32 s89, s88, 1023
  s_lshl_b32 s89, s89, 12
  buffer_load_dword v254, v255, s[84:87], s89 offen
  s_waitcnt lgkmcnt(6)
  v_mfma_f32_32x32x16_bf16 v[96:111], v[44:47], v[140:143], v[96:111]
  ds_read_b64_tr_b16 v[28:29], v5 offset:32768
  ds_read_b64_tr_b16 v[30:31], v5 offset:33792
  s_waitcnt vmcnt(13)
  s_barrier
  s_waitcnt lgkmcnt(6)
  v_mfma_f32_32x32x16_bf16 v[48:63], v[16:19], v[144:147], v[48:63]
  ds_read_b64_tr_b16 v[32:33], v2 offset:34816
  ds_read_b64_tr_b16 v[34:35], v2 offset:35840
  s_waitcnt lgkmcnt(6)
  v_mfma_f32_32x32x16_bf16 v[64:79], v[20:23], v[144:147], v[64:79]
  ds_read_b64_tr_b16 v[36:37], v3 offset:34816
  ds_read_b64_tr_b16 v[38:39], v3 offset:35840
  s_waitcnt lgkmcnt(6)
  v_mfma_f32_32x32x16_bf16 v[80:95], v[24:27], v[144:147], v[80:95]
  ds_read_b64_tr_b16 v[40:41], v4 offset:34816
  ds_read_b64_tr_b16 v[42:43], v4 offset:35840
  s_waitcnt lgkmcnt(6)
  v_mfma_f32_32x32x16_bf16 v[96:111], v[28:31], v[144:147], v[96:111]
  ds_read_b64_tr_b16 v[44:45], v5 offset:34816
  ds_read_b64_tr_b16 v[46:47], v5 offset:35840
  s_waitcnt lgkmcnt(6)
  v_mfma_f32_32x32x16_bf16 v[48:63], v[32:35], v[148:151], v[48:63]
  ds_read_b64_tr_b16 v[16:17], v2 offset:40960
  ds_read_b64_tr_b16 v[18:19], v2 offset:41984
  s_add_u32 m0, s58, 0
  s_mul_i32 s57, s54, 0
  s_add_u32 s57, s57, s55
  buffer_load_dwordx4 v11, s[48:51], s57 offen lds
  s_waitcnt lgkmcnt(6)
  v_mfma_f32_32x32x16_bf16 v[64:79], v[36:39], v[148:151], v[64:79]
  ds_read_b64_tr_b16 v[20:21], v3 offset:40960
  ds_read_b64_tr_b16 v[22:23], v3 offset:41984
  s_waitcnt lgkmcnt(6)
  v_mfma_f32_32x32x16_bf16 v[80:95], v[40:43], v[148:151], v[80:95]
  ds_read_b64_tr_b16 v[24:25], v4 offset:40960
  ds_read_b64_tr_b16 v[26:27], v4 offset:41984
  s_waitcnt lgkmcnt(6)
  v_mfma_f32_32x32x16_bf16 v[96:111], v[44:47], v[148:151], v[96:111]
  ds_read_b64_tr_b16 v[28:29], v5 offset:40960
  ds_read_b64_tr_b16 v[30:31], v5 offset:41984
  s_waitcnt lgkmcnt(6)
  v_mfma_f32_32x32x16_bf16 v[48:63], v[16:19], v[152:155], v[48:63]
  ds_read_b64_tr_b16 v[32:33], v2 offset:43008
  ds_read_b64_tr_b16 v[34:35], v2 offset:44032
  s_waitcnt lgkmcnt(6)
  v_mfma_f32_32x32x16_bf16 v[64:79], v[20:23], v[152:155], v[64:79]
  ds_read_b64_tr_b16 v[36:37], v3 offset:43008
  ds_read_b64_tr_b16 v[38:39], v3 offset:44032
  s_waitcnt lgkmcnt(6)
  v_mfma_f32_32x32x16_bf16 v[80:95], v[24:27], v[152:155], v[80:95]
  ds_read_b64_tr_b16 v[40:41], v4 offset:43008
  ds_read_b64_tr_b16 v[42:43], v4 offset:44032
  s_waitcnt lgkmcnt(6)
  v_mfma_f32_32x32x16_bf16 v[96:111], v[28:31], v[152:155], v[96:111]
  ds_read_b64_tr_b16 v[44:45], v5 offset:43008
  ds_read_b64_tr_b16 v[46:47], v5 offset:44032
  s_waitcnt lgkmcnt(6)
  v_mfma_f32_32x32x16_bf16 v[48:63], v[32:35], v[156:159], v[48:63]
  ds_read_b64_tr_b16 v[16:17], v2 offset:49152
  ds_read_b64_tr_b16 v[18:19], v2 offset:50176
  s_add_u32 m0, s58, 1024
  s_mul_i32 s57, s54, 4
  s_add_u32 s57, s57, s55
  buffer_load_dwordx4 v11, s[48:51], s57 offen lds
  s_waitcnt lgkmcnt(6)
  v_mfma_f32_32x32x16_bf16 v[64:79], v[36:39], v[156:159], v[64:79]
  ds_read_b64_tr_b16 v[20:21], v3 offset:49152
  ds_read_b64_tr_b16 v[22:23], v3 offset:50176
  s_waitcnt lgkmcnt(6)
  v_mfma_f32_32x32x16_bf16 v[80:95], v[40:43], v[156:159], v[80:95]
  ds_read_b64_tr_b16 v[24:25], v4 offset:49152
  ds_read_b64_tr_b16 v[26:27], v4 offset:50176
  s_waitcnt lgkmcnt(6)
  v_mfma_f32_32x32x16_bf16 v[96:111], v[44:47], v[156:159], v[96:111]
  ds_read_b64_tr_b16 v[28:29], v5 offset:49152
  ds_read_b64_tr_b16 v[30:31], v5 offset:50176
  s_waitcnt lgkmcnt(6)
  v_mfma_f32_32x32x16_bf16 v[48:63], v[16:19], v[160:163], v[48:63]
  ds_read_b64_tr_b16 v[32:33], v2 offset:51200
  ds_read_b64_tr_b16 v[34:35], v2 offset:52224
  s_waitcnt lgkmcnt(6)
  v_mfma_f32_32x32x16_bf16 v[64:79], v[20:23], v[160:163], v[64:79]
  ds_read_b64_tr_b16 v[36:37], v3 offset:51200
  ds_read_b64_tr_b16 v[38:39], v3 offset:52224
  s_waitcnt lgkmcnt(6)
  v_mfma_f32_32x32x16_bf16 v[80:95], v[24:27], v[160:163], v[80:95]
  ds_read_b64_tr_b16 v[40:41], v4 offset:51200
  ds_read_b64_tr_b16 v[42:43], v4 offset:52224
  s_waitcnt lgkmcnt(6)
  v_mfma_f32_32x32x16_bf16 v[96:111], v[28:31], v[160:163], v[96:111]
  ds_read_b64_tr_b16 v[44:45], v5 offset:51200
  ds_read_b64_tr_b16 v[46:47], v5 offset:52224
  s_waitcnt lgkmcnt(6)
  v_mfma_f32_32x32x16_bf16 v[48:63], v[32:35], v[164:167], v[48:63]
  ds_read_b64_tr_b16 v[16:17], v2 offset:57344
  ds_read_b64_tr_b16 v[18:19], v2 offset:58368
  s_add_u32 m0, s58, 2048
  s_mul_i32 s57, s54, 8
  s_add_u32 s57, s57, s55
  buffer_load_dwordx4 v11, s[48:51], s57 offen lds
  s_waitcnt lgkmcnt(6)
  v_mfma_f32_32x32x16_bf16 v[64:79], v[36:39], v[164:167], v[64:79]
  ds_read_b64_tr_b16 v[20:21], v3 offset:57344
  ds_read_b64_tr_b16 v[22:23], v3 offset:58368
  s_waitcnt lgkmcnt(6)
  v_mfma_f32_32x32x16_bf16 v[80:95], v[40:43], v[164:167], v[80:95]
  ds_read_b64_tr_b16 v[24:25], v4 offset:57344
  ds_read_b64_tr_b16 v[26:27], v4 offset:58368
  s_waitcnt lgkmcnt(6)
  v_mfma_f32_32x32x16_bf16 v[96:111], v[44:47], v[164:167], v[96:111]
  ds_read_b64_tr_b16 v[28:29], v5 offset:57344
  ds_read_b64_tr_b16 v[30:31], v5 offset:58368
  s_waitcnt lgkmcnt(6)
  v_mfma_f32_32x32x16_bf16 v[48:63], v[16:19], v[168:171], v[48:63]
  ds_read_b64_tr_b16 v[32:33], v2 offset:59392
  ds_read_b64_tr_b16 v[34:35], v2 offset:60416
  s_waitcnt lgkmcnt(6)
  v_mfma_f32_32x32x16_bf16 v[64:79], v[20:23], v[168:171], v[64:79]
  ds_read_b64_tr_b16 v[36:37], v3 offset:59392
  ds_read_b64_tr_b16 v[38:39], v3 offset:60416
  s_waitcnt lgkmcnt(6)
  v_mfma_f32_32x32x16_bf16 v[80:95], v[24:27], v[168:171], v[80:95]
  ds_read_b64_tr_b16 v[40:41], v4 offset:59392
  ds_read_b64_tr_b16 v[42:43], v4 offset:60416
  s_waitcnt lgkmcnt(6)
  v_mfma_f32_32x32x16_bf16 v[96:111], v[28:31], v[168:171], v[96:111]
  ds_read_b64_tr_b16 v[44:45], v5 offset:59392
  ds_read_b64_tr_b16 v[46:47], v5 offset:60416
  s_waitcnt lgkmcnt(6)
  v_mfma_f32_32x32x16_bf16 v[48:63], v[32:35], v[172:175], v[48:63]
  ds_read_b64_tr_b16 v[16:17], v6 offset:0
  ds_read_b64_tr_b16 v[18:19], v6 offset:1024
  s_add_u32 m0, s58, 3072
  s_mul_i32 s57, s54, 12
  s_add_u32 s57, s57, s55
  buffer_load_dwordx4 v11, s[48:51], s57 offen lds
  s_waitcnt lgkmcnt(6)
  v_mfma_f32_32x32x16_bf16 v[64:79], v[36:39], v[172:175], v[64:79]
  ds_read_b64_tr_b16 v[20:21], v7 offset:0
  ds_read_b64_tr_b16 v[22:23], v7 offset:1024
  s_waitcnt lgkmcnt(6)
  v_mfma_f32_32x32x16_bf16 v[80:95], v[40:43], v[172:175], v[80:95]
  ds_read_b64_tr_b16 v[24:25], v8 offset:0
  ds_read_b64_tr_b16 v[26:27], v8 offset:1024
  s_waitcnt lgkmcnt(6)
  v_mfma_f32_32x32x16_bf16 v[96:111], v[44:47], v[172:175], v[96:111]
  ds_read_b64_tr_b16 v[28:29], v9 offset:0
  ds_read_b64_tr_b16 v[30:31], v9 offset:1024
  s_waitcnt vmcnt(5)
  s_barrier
  s_waitcnt lgkmcnt(6)
  v_mfma_f32_32x32x16_bf16 v[48:63], v[16:19], v[176:179], v[48:63]
  ds_read_b64_tr_b16 v[32:33], v6 offset:2048
  ds_read_b64_tr_b16 v[34:35], v6 offset:3072
  s_waitcnt lgkmcnt(6)
  v_mfma_f32_32x32x16_bf16 v[64:79], v[20:23], v[176:179], v[64:79]
  ds_read_b64_tr_b16 v[36:37], v7 offset:2048
  ds_read_b64_tr_b16 v[38:39], v7 offset:3072
  s_waitcnt lgkmcnt(6)
  v_mfma_f32_32x32x16_bf16 v[80:95], v[24:27], v[176:179], v[80:95]
  ds_read_b64_tr_b16 v[40:41], v8 offset:2048
  ds_read_b64_tr_b16 v[42:43], v8 offset:3072
  s_waitcnt lgkmcnt(6)
  v_mfma_f32_32x32x16_bf16 v[96:111], v[28:31], v[176:179], v[96:111]
  ds_read_b64_tr_b16 v[44:45], v9 offset:2048
  ds_read_b64_tr_b16 v[46:47], v9 offset:3072
  s_waitcnt lgkmcnt(6)
  v_mfma_f32_32x32x16_bf16 v[48:63], v[32:35], v[180:183], v[48:63]
  ds_read_b64_tr_b16 v[16:17], v6 offset:8192
  ds_read_b64_tr_b16 v[18:19], v6 offset:9216
  s_add_u32 m0, s58, 32768
  s_mul_i32 s57, s54, 128
  s_add_u32 s57, s57, s55
  buffer_load_dwordx4 v11, s[48:51], s57 offen lds
  s_waitcnt lgkmcnt(6)
  v_mfma_f32_32x32x16_bf16 v[64:79], v[36:39], v[180:183], v[64:79]
  ds_read_b64_tr_b16 v[20:21], v7 offset:8192
  ds_read_b64_tr_b16 v[22:23], v7 offset:9216
  s_waitcnt lgkmcnt(6)
  v_mfma_f32_32x32x16_bf16 v[80:95], v[40:43], v[180:183], v[80:95]
  ds_read_b64_tr_b16 v[24:25], v8 offset:8192
  ds_read_b64_tr_b16 v[26:27], v8 offset:9216
  s_waitcnt lgkmcnt(6)
  v_mfma_f32_32x32x16_bf16 v[96:111], v[44:47], v[180:183], v[96:111]
  ds_read_b64_tr_b16 v[28:29], v9 offset:8192
  ds_read_b64_tr_b16 v[30:31], v9 offset:9216
  s_waitcnt lgkmcnt(6)
  v_mfma_f32_32x32x16_bf16 v[48:63], v[16:19], v[184:187], v[48:63]
  ds_read_b64_tr_b16 v[32:33], v6 offset:10240
  ds_read_b64_tr_b16 v[34:35], v6 offset:11264
  s_waitcnt lgkmcnt(6)
  v_mfma_f32_32x32x16_bf16 v[64:79], v[20:23], v[184:187], v[64:79]
  ds_read_b64_tr_b16 v[36:37], v7 offset:10240
  ds_read_b64_tr_b16 v[38:39], v7 offset:11264
  s_waitcnt lgkmcnt(6)
  v_mfma_f32_32x32x16_bf16 v[80:95], v[24:27], v[184:187], v[80:95]
  ds_read_b64_tr_b16 v[40:41], v8 offset:10240
  ds_read_b64_tr_b16 v[42:43], v8 offset:11264
  s_waitcnt lgkmcnt(6)
  v_mfma_f32_32x32x16_bf16 v[96:111], v[28:31], v[184:187], v[96:111]
  ds_read_b64_tr_b16 v[44:45], v9 offset:10240
  ds_read_b64_tr_b16 v[46:47], v9 offset:11264
  s_waitcnt lgkmcnt(6)
  v_mfma_f32_32x32x16_bf16 v[48:63], v[32:35], v[188:191], v[48:63]
  ds_read_b64_tr_b16 v[16:17], v6 offset:16384
  ds_read_b64_tr_b16 v[18:19], v6 offset:17408
  s_add_u32 m0, s58, 33792
  s_mul_i32 s57, s54, 132
  s_add_u32 s57, s57, s55
  buffer_load_dwordx4 v11, s[48:51], s57 offen lds
  s_waitcnt lgkmcnt(6)
  v_mfma_f32_32x32x16_bf16 v[64:79], v[36:39], v[188:191], v[64:79]
  ds_read_b64_tr_b16 v[20:21], v7 offset:16384
  ds_read_b64_tr_b16 v[22:23], v7 offset:17408
  s_waitcnt lgkmcnt(6)
  v_mfma_f32_32x32x16_bf16 v[80:95], v[40:43], v[188:191], v[80:95]
  ds_read_b64_tr_b16 v[24:25], v8 offset:16384
  ds_read_b64_tr_b16 v[26:27], v8 offset:17408
  s_waitcnt lgkmcnt(6)
  v_mfma_f32_32x32x16_bf16 v[96:111], v[44:47], v[188:191], v[96:111]
  ds_read_b64_tr_b16 v[28:29], v9 offset:16384
  ds_read_b64_tr_b16 v[30:31], v9 offset:17408
  s_waitcnt lgkmcnt(6)
  v_mfma_f32_32x32x16_bf16 v[48:63], v[16:19], v[192:195], v[48:63]
  ds_read_b64_tr_b16 v[32:33], v6 offset:18432
  ds_read_b64_tr_b16 v[34:35], v6 offset:19456
  s_waitcnt lgkmcnt(6)
  v_mfma_f32_32x32x16_bf16 v[64:79], v[20:23], v[192:195], v[64:79]
  ds_read_b64_tr_b16 v[36:37], v7 offset:18432
  ds_read_b64_tr_b16 v[38:39], v7 offset:19456
  s_waitcnt lgkmcnt(6)
  v_mfma_f32_32x32x16_bf16 v[80:95], v[24:27], v[192:195], v[80:95]
  ds_read_b64_tr_b16 v[40:41], v8 offset:18432
  ds_read_b64_tr_b16 v[42:43], v8 offset:19456
  s_waitcnt lgkmcnt(6)
  v_mfma_f32_32x32x16_bf16 v[96:111], v[28:31], v[192:195], v[96:111]
  ds_read_b64_tr_b16 v[44:45], v9 offset:18432
  ds_read_b64_tr_b16 v[46:47], v9 offset:19456
  s_waitcnt lgkmcnt(6)
  v_mfma_f32_32x32x16_bf16 v[48:63], v[32:35], v[196:199], v[48:63]
  ds_read_b64_tr_b16 v[16:17], v6 offset:24576
  ds_read_b64_tr_b16 v[18:19], v6 offset:25600
  s_add_u32 m0, s58, 34816
  s_mul_i32 s57, s54, 136
  s_add_u32 s57, s57, s55
  buffer_load_dwordx4 v11, s[48:51], s57 offen lds
  s_waitcnt lgkmcnt(6)
  v_mfma_f32_32x32x16_bf16 v[64:79], v[36:39], v[196:199], v[64:79]
  ds_read_b64_tr_b16 v[20:21], v7 offset:24576
  ds_read_b64_tr_b16 v[22:23], v7 offset:25600
  s_waitcnt lgkmcnt(6)
  v_mfma_f32_32x32x16_bf16 v[80:95], v[40:43], v[196:199], v[80:95]
  ds_read_b64_tr_b16 v[24:25], v8 offset:24576
  ds_read_b64_tr_b16 v[26:27], v8 offset:25600
  s_waitcnt lgkmcnt(6)
  v_mfma_f32_32x32x16_bf16 v[96:111], v[44:47], v[196:199], v[96:111]
  ds_read_b64_tr_b16 v[28:29], v9 offset:24576
  ds_read_b64_tr_b16 v[30:31], v9 offset:25600
  s_waitcnt lgkmcnt(6)
  v_mfma_f32_32x32x16_bf16 v[48:63], v[16:19], v[200:203], v[48:63]
  ds_read_b64_tr_b16 v[32:33], v6 offset:26624
  ds_read_b64_tr_b16 v[34:35], v6 offset:27648
  s_waitcnt lgkmcnt(6)
  v_mfma_f32_32x32x16_bf16 v[64:79], v[20:23], v[200:203], v[64:79]
  ds_read_b64_tr_b16 v[36:37], v7 offset:26624
  ds_read_b64_tr_b16 v[38:39], v7 offset:27648
  s_waitcnt lgkmcnt(6)
  v_mfma_f32_32x32x16_bf16 v[80:95], v[24:27], v[200:203], v[80:95]
  ds_read_b64_tr_b16 v[40:41], v8 offset:26624
  ds_read_b64_tr_b16 v[42:43], v8 offset:27648
  s_waitcnt lgkmcnt(6)
  v_mfma_f32_32x32x16_bf16 v[96:111], v[28:31], v[200:203], v[96:111]
  ds_read_b64_tr_b16 v[44:45], v9 offset:26624
  ds_read_b64_tr_b16 v[46:47], v9 offset:27648
  s_waitcnt lgkmcnt(6)
  v_mfma_f32_32x32x16_bf16 v[48:63], v[32:35], v[204:207], v[48:63]
  ds_read_b64_tr_b16 v[16:17], v6 offset:32768
  ds_read_b64_tr_b16 v[18:19], v6 offset:33792
  s_add_u32 m0, s58, 35840
  s_mul_i32 s57, s54, 140
  s_add_u32 s57, s57, s55
  buffer_load_dwordx4 v11, s[48:51], s57 offen lds
  s_waitcnt lgkmcnt(6)
  v_mfma_f32_32x32x16_bf16 v[64:79], v[36:39], v[204:207], v[64:79]
  ds_read_b64_tr_b16 v[20:21], v7 offset:32768
  ds_read_b64_tr_b16 v[22:23], v7 offset:33792
  s_waitcnt lgkmcnt(6)
  v_mfma_f32_32x32x16_bf16 v[80:95], v[40:43], v[204:207], v[80:95]
  ds_read_b64_tr_b16 v[24:25], v8 offset:32768
  ds_read_b64_tr_b16 v[26:27], v8 offset:33792
  s_waitcnt lgkmcnt(6)
  v_mfma_f32_32x32x16_bf16 v[96:111], v[44:47], v[204:207], v[96:111]
  ds_read_b64_tr_b16 v[28:29], v9 offset:32768
  ds_read_b64_tr_b16 v[30:31], v9 offset:33792
  s_waitcnt vmcnt(4)
  s_barrier
  v_lshrrev_b32 v15, 5, v1
  v_lshlrev_b32 v15, 3, v15
  s_waitcnt lgkmcnt(6)
  v_mfma_f32_32x32x16_bf16 v[48:63], v[16:19], v[208:211], v[48:63]
  ds_read_b64_tr_b16 v[32:33], v6 offset:34816
  ds_read_b64_tr_b16 v[34:35], v6 offset:35840
  buffer_load_dwordx2 v[112:113], v15, s[20:23], s53 offen offset:0
  s_waitcnt lgkmcnt(6)
  v_mfma_f32_32x32x16_bf16 v[64:79], v[20:23], v[208:211], v[64:79]
  ds_read_b64_tr_b16 v[36:37], v7 offset:34816
  ds_read_b64_tr_b16 v[38:39], v7 offset:35840
  buffer_load_dwordx2 v[114:115], v15, s[20:23], s53 offen offset:16
  s_waitcnt lgkmcnt(6)
  v_mfma_f32_32x32x16_bf16 v[80:95], v[24:27], v[208:211], v[80:95]
  ds_read_b64_tr_b16 v[40:41], v8 offset:34816
  ds_read_b64_tr_b16 v[42:43], v8 offset:35840
  buffer_load_dwordx2 v[116:117], v15, s[20:23], s53 offen offset:32
  s_waitcnt lgkmcnt(6)
  v_mfma_f32_32x32x16_bf16 v[96:111], v[28:31], v[208:211], v[96:111]
  ds_read_b64_tr_b16 v[44:45], v9 offset:34816
  ds_read_b64_tr_b16 v[46:47], v9 offset:35840
  buffer_load_dwordx2 v[118:119], v15, s[20:23], s53 offen offset:48
  s_waitcnt lgkmcnt(6)
  v_mfma_f32_32x32x16_bf16 v[48:63], v[32:35], v[212:215], v[48:63]
  ds_read_b64_tr_b16 v[16:17], v6 offset:40960
  ds_read_b64_tr_b16 v[18:19], v6 offset:41984
  buffer_load_dwordx2 v[120:121], v15, s[20:23], s53 offen offset:64
  s_waitcnt lgkmcnt(6)
  v_mfma_f32_32x32x16_bf16 v[64:79], v[36:39], v[212:215], v[64:79]
  ds_read_b64_tr_b16 v[20:21], v7 offset:40960
  ds_read_b64_tr_b16 v[22:23], v7 offset:41984
  buffer_load_dwordx2 v[122:123], v15, s[20:23], s53 offen offset:80
  s_waitcnt lgkmcnt(6)
  v_mfma_f32_32x32x16_bf16 v[80:95], v[40:43], v[212:215], v[80:95]
  ds_read_b64_tr_b16 v[24:25], v8 offset:40960
  ds_read_b64_tr_b16 v[26:27], v8 offset:41984
  buffer_load_dwordx2 v[124:125], v15, s[20:23], s53 offen offset:96
  s_waitcnt lgkmcnt(6)
  v_mfma_f32_32x32x16_bf16 v[96:111], v[44:47], v[212:215], v[96:111]
  ds_read_b64_tr_b16 v[28:29], v9 offset:40960
  ds_read_b64_tr_b16 v[30:31], v9 offset:41984
  buffer_load_dwordx2 v[126:127], v15, s[20:23], s53 offen offset:112
  s_waitcnt lgkmcnt(6)
  v_mfma_f32_32x32x16_bf16 v[48:63], v[16:19], v[216:219], v[48:63]
  ds_read_b64_tr_b16 v[32:33], v6 offset:43008
  ds_read_b64_tr_b16 v[34:35], v6 offset:44032
  buffer_load_dwordx2 v[128:129], v15, s[20:23], s53 offen offset:128
  s_waitcnt lgkmcnt(6)
  v_mfma_f32_32x32x16_bf16 v[64:79], v[20:23], v[216:219], v[64:79]
  ds_read_b64_tr_b16 v[36:37], v7 offset:43008
  ds_read_b64_tr_b16 v[38:39], v7 offset:44032
  buffer_load_dwordx2 v[130:131], v15, s[20:23], s53 offen offset:144
  s_waitcnt lgkmcnt(6)
  v_mfma_f32_32x32x16_bf16 v[80:95], v[24:27], v[216:219], v[80:95]
  ds_read_b64_tr_b16 v[40:41], v8 offset:43008
  ds_read_b64_tr_b16 v[42:43], v8 offset:44032
  buffer_load_dwordx2 v[132:133], v15, s[20:23], s53 offen offset:160
  s_waitcnt lgkmcnt(6)
  v_mfma_f32_32x32x16_bf16 v[96:111], v[28:31], v[216:219], v[96:111]
  ds_read_b64_tr_b16 v[44:45], v9 offset:43008
  ds_read_b64_tr_b16 v[46:47], v9 offset:44032
  buffer_load_dwordx2 v[134:135], v15, s[20:23], s53 offen offset:176
  s_waitcnt lgkmcnt(6)
  v_mfma_f32_32x32x16_bf16 v[48:63], v[32:35], v[220:223], v[48:63]
  ds_read_b64_tr_b16 v[16:17], v6 offset:49152
  ds_read_b64_tr_b16 v[18:19], v6 offset:50176
  buffer_load_dwordx2 v[136:137], v15, s[20:23], s53 offen offset:192
  s_waitcnt lgkmcnt(6)
  v_mfma_f32_32x32x16_bf16 v[64:79], v[36:39], v[220:223], v[64:79]
  ds_read_b64_tr_b16 v[20:21], v7 offset:49152
  ds_read_b64_tr_b16 v[22:23], v7 offset:50176
  buffer_load_dwordx2 v[138:139], v15, s[20:23], s53 offen offset:208
  s_waitcnt lgkmcnt(6)
  v_mfma_f32_32x32x16_bf16 v[80:95], v[40:43], v[220:223], v[80:95]
  ds_read_b64_tr_b16 v[24:25], v8 offset:49152
  ds_read_b64_tr_b16 v[26:27], v8 offset:50176
  buffer_load_dwordx2 v[140:141], v15, s[20:23], s53 offen offset:224
  s_waitcnt lgkmcnt(6)
  v_mfma_f32_32x32x16_bf16 v[96:111], v[44:47], v[220:223], v[96:111]
  ds_read_b64_tr_b16 v[28:29], v9 offset:49152
  ds_read_b64_tr_b16 v[30:31], v9 offset:50176
  buffer_load_dwordx2 v[142:143], v15, s[20:23], s53 offen offset:240
  s_waitcnt lgkmcnt(6)
  v_mfma_f32_32x32x16_bf16 v[48:63], v[16:19], v[224:227], v[48:63]
  ds_read_b64_tr_b16 v[32:33], v6 offset:51200
  ds_read_b64_tr_b16 v[34:35], v6 offset:52224
  s_add_u32 m0, s58, 65536
  s_mul_i32 s57, s54, 256
  s_add_u32 s57, s57, s55
  buffer_load_dwordx4 v11, s[48:51], s57 offen lds
  s_waitcnt lgkmcnt(6)
  v_mfma_f32_32x32x16_bf16 v[64:79], v[20:23], v[224:227], v[64:79]
  ds_read_b64_tr_b16 v[36:37], v7 offset:51200
  ds_read_b64_tr_b16 v[38:39], v7 offset:52224
  s_add_u32 m0, s58, 66560
  s_mul_i32 s57, s54, 260
  s_add_u32 s57, s57, s55
  buffer_load_dwordx4 v11, s[48:51], s57 offen lds
  s_waitcnt lgkmcnt(6)
  v_mfma_f32_32x32x16_bf16 v[80:95], v[24:27], v[224:227], v[80:95]
  ds_read_b64_tr_b16 v[40:41], v8 offset:51200
  ds_read_b64_tr_b16 v[42:43], v8 offset:52224
  s_add_u32 m0, s58, 67584
  s_mul_i32 s57, s54, 264
  s_add_u32 s57, s57, s55
  buffer_load_dwordx4 v11, s[48:51], s57 offen lds
  s_waitcnt lgkmcnt(6)
  v_mfma_f32_32x32x16_bf16 v[96:111], v[28:31], v[224:227], v[96:111]
  ds_read_b64_tr_b16 v[44:45], v9 offset:51200
  ds_read_b64_tr_b16 v[46:47], v9 offset:52224
  s_add_u32 m0, s58, 68608
  s_mul_i32 s57, s54, 268
  s_add_u32 s57, s57, s55
  buffer_load_dwordx4 v11, s[48:51], s57 offen lds
  s_waitcnt lgkmcnt(6)
  v_mfma_f32_32x32x16_bf16 v[48:63], v[32:35], v[228:231], v[48:63]
  ds_read_b64_tr_b16 v[16:17], v6 offset:57344
  ds_read_b64_tr_b16 v[18:19], v6 offset:58368
  s_waitcnt lgkmcnt(6)
  v_mfma_f32_32x32x16_bf16 v[64:79], v[36:39], v[228:231], v[64:79]
  ds_read_b64_tr_b16 v[20:21], v7 offset:57344
  ds_read_b64_tr_b16 v[22:23], v7 offset:58368
  s_waitcnt lgkmcnt(6)
  v_mfma_f32_32x32x16_bf16 v[80:95], v[40:43], v[228:231], v[80:95]
  ds_read_b64_tr_b16 v[24:25], v8 offset:57344
  ds_read_b64_tr_b16 v[26:27], v8 offset:58368
  s_waitcnt lgkmcnt(6)
  v_mfma_f32_32x32x16_bf16 v[96:111], v[44:47], v[228:231], v[96:111]
  ds_read_b64_tr_b16 v[28:29], v9 offset:57344
  ds_read_b64_tr_b16 v[30:31], v9 offset:58368
  s_waitcnt lgkmcnt(6)
  v_mfma_f32_32x32x16_bf16 v[48:63], v[16:19], v[232:235], v[48:63]
  ds_read_b64_tr_b16 v[32:33], v6 offset:59392
  ds_read_b64_tr_b16 v[34:35], v6 offset:60416
  s_waitcnt lgkmcnt(6)
  v_mfma_f32_32x32x16_bf16 v[64:79], v[20:23], v[232:235], v[64:79]
  ds_read_b64_tr_b16 v[36:37], v7 offset:59392
  ds_read_b64_tr_b16 v[38:39], v7 offset:60416
  s_waitcnt lgkmcnt(6)
  v_mfma_f32_32x32x16_bf16 v[80:95], v[24:27], v[232:235], v[80:95]
  ds_read_b64_tr_b16 v[40:41], v8 offset:59392
  ds_read_b64_tr_b16 v[42:43], v8 offset:60416
  s_waitcnt lgkmcnt(6)
  v_mfma_f32_32x32x16_bf16 v[96:111], v[28:31], v[232:235], v[96:111]
  ds_read_b64_tr_b16 v[44:45], v9 offset:59392
  ds_read_b64_tr_b16 v[46:47], v9 offset:60416
  s_waitcnt lgkmcnt(6)
  v_mfma_f32_32x32x16_bf16 v[48:63], v[32:35], v[236:239], v[48:63]
  ds_read_b64_tr_b16 v[16:17], v2 offset:0
  ds_read_b64_tr_b16 v[18:19], v2 offset:1024
  s_waitcnt lgkmcnt(6)
  v_mfma_f32_32x32x16_bf16 v[64:79], v[36:39], v[236:239], v[64:79]
  ds_read_b64_tr_b16 v[20:21], v3 offset:0
  ds_read_b64_tr_b16 v[22:23], v3 offset:1024
  s_waitcnt lgkmcnt(6)
  v_mfma_f32_32x32x16_bf16 v[80:95], v[40:43], v[236:239], v[80:95]
  ds_read_b64_tr_b16 v[24:25], v4 offset:0
  ds_read_b64_tr_b16 v[26:27], v4 offset:1024
  s_waitcnt lgkmcnt(6)
  v_mfma_f32_32x32x16_bf16 v[96:111], v[44:47], v[236:239], v[96:111]
  ds_read_b64_tr_b16 v[28:29], v5 offset:0
  ds_read_b64_tr_b16 v[30:31], v5 offset:1024
  s_waitcnt lgkmcnt(0)
  s_nop 11
  v_mul_f32 v48, v246, v48
  v_mul_f32 v49, v246, v49
  v_mul_f32 v50, v246, v50
  v_mul_f32 v51, v246, v51
  v_mul_f32 v52, v246, v52
  v_mul_f32 v53, v246, v53
  v_mul_f32 v54, v246, v54
  v_mul_f32 v55, v246, v55
  v_mul_f32 v56, v246, v56
  v_mul_f32 v57, v246, v57
  v_mul_f32 v58, v246, v58
  v_mul_f32 v59, v246, v59
  v_mul_f32 v60, v246, v60
  v_mul_f32 v61, v246, v61
  v_mul_f32 v62, v246, v62
  v_mul_f32 v63, v246, v63
  v_mul_f32 v64, v246, v64
  v_mul_f32 v65, v246, v65
  v_mul_f32 v66, v246, v66
  v_mul_f32 v67, v246, v67
  v_mul_f32 v68, v246, v68
  v_mul_f32 v69, v246, v69
  v_mul_f32 v70, v246, v70
  v_mul_f32 v71, v246, v71
  v_mul_f32 v72, v246, v72
  v_mul_f32 v73, v246, v73
  v_mul_f32 v74, v246, v74
  v_mul_f32 v75, v246, v75
  v_mul_f32 v76, v246, v76
  v_mul_f32 v77, v246, v77
  v_mul_f32 v78, v246, v78
  v_mul_f32 v79, v246, v79
  v_mul_f32 v80, v246, v80
  v_mul_f32 v81, v246, v81
  v_mul_f32 v82, v246, v82
  v_mul_f32 v83, v246, v83
  v_mul_f32 v84, v246, v84
  v_mul_f32 v85, v246, v85
  v_mul_f32 v86, v246, v86
  v_mul_f32 v87, v246, v87
  v_mul_f32 v88, v246, v88
  v_mul_f32 v89, v246, v89
  v_mul_f32 v90, v246, v90
  v_mul_f32 v91, v246, v91
  v_mul_f32 v92, v246, v92
  v_mul_f32 v93, v246, v93
  v_mul_f32 v94, v246, v94
  v_mul_f32 v95, v246, v95
  v_mul_f32 v96, v246, v96
  v_mul_f32 v97, v246, v97
  v_mul_f32 v98, v246, v98
  v_mul_f32 v99, v246, v99
  v_mul_f32 v100, v246, v100
  v_mul_f32 v101, v246, v101
  v_mul_f32 v102, v246, v102
  v_mul_f32 v103, v246, v103
  v_mul_f32 v104, v246, v104
  v_mul_f32 v105, v246, v105
  v_mul_f32 v106, v246, v106
  v_mul_f32 v107, v246, v107
  v_mul_f32 v108, v246, v108
  v_mul_f32 v109, v246, v109
  v_mul_f32 v110, v246, v110
  v_mul_f32 v111, v246, v111
  s_waitcnt vmcnt(0)
  v_cvt_pk_bf16_f32 v15, v48, v49
  v_lshlrev_b32 v48, 16, v15
  v_and_b32 v49, 0xffff0000, v15
  v_lshlrev_b32 v15, 16, v112
  v_add_f32 v48, v48, v15
  v_and_b32 v15, 0xffff0000, v112
  v_add_f32 v49, v49, v15
  v_cvt_pk_bf16_f32 v15, v48, v49
  v_lshlrev_b32 v48, 16, v15
  v_and_b32 v49, 0xffff0000, v15
  v_max_f32 v48, 0, v48
  v_max_f32 v49, 0, v49
  v_mul_f32 v48, v48, v48
  v_mul_f32 v49, v49, v49
  v_cvt_pk_bf16_f32 v15, v50, v51
  v_lshlrev_b32 v50, 16, v15
  v_and_b32 v51, 0xffff0000, v15
  v_lshlrev_b32 v15, 16, v113
  v_add_f32 v50, v50, v15
  v_and_b32 v15, 0xffff0000, v113
  v_add_f32 v51, v51, v15
  v_cvt_pk_bf16_f32 v15, v50, v51
  v_lshlrev_b32 v50, 16, v15
  v_and_b32 v51, 0xffff0000, v15
  v_max_f32 v50, 0, v50
  v_max_f32 v51, 0, v51
  v_mul_f32 v50, v50, v50
  v_mul_f32 v51, v51, v51
  v_cvt_pk_bf16_f32 v15, v52, v53
  v_lshlrev_b32 v52, 16, v15
  v_and_b32 v53, 0xffff0000, v15
  v_lshlrev_b32 v15, 16, v114
  v_add_f32 v52, v52, v15
  v_and_b32 v15, 0xffff0000, v114
  v_add_f32 v53, v53, v15
  v_cvt_pk_bf16_f32 v15, v52, v53
  v_lshlrev_b32 v52, 16, v15
  v_and_b32 v53, 0xffff0000, v15
  v_max_f32 v52, 0, v52
  v_max_f32 v53, 0, v53
  v_mul_f32 v52, v52, v52
  v_mul_f32 v53, v53, v53
  v_cvt_pk_bf16_f32 v15, v54, v55
  v_lshlrev_b32 v54, 16, v15
  v_and_b32 v55, 0xffff0000, v15
  v_lshlrev_b32 v15, 16, v115
  v_add_f32 v54, v54, v15
  v_and_b32 v15, 0xffff0000, v115
  v_add_f32 v55, v55, v15
  v_cvt_pk_bf16_f32 v15, v54, v55
  v_lshlrev_b32 v54, 16, v15
  v_and_b32 v55, 0xffff0000, v15
  v_max_f32 v54, 0, v54
  v_max_f32 v55, 0, v55
  v_mul_f32 v54, v54, v54
  v_mul_f32 v55, v55, v55
  v_cvt_pk_bf16_f32 v15, v56, v57
  v_lshlrev_b32 v56, 16, v15
  v_and_b32 v57, 0xffff0000, v15
  v_lshlrev_b32 v15, 16, v116
  v_add_f32 v56, v56, v15
  v_and_b32 v15, 0xffff0000, v116
  v_add_f32 v57, v57, v15
  v_cvt_pk_bf16_f32 v15, v56, v57
  v_lshlrev_b32 v56, 16, v15
  v_and_b32 v57, 0xffff0000, v15
  v_max_f32 v56, 0, v56
  v_max_f32 v57, 0, v57
  v_mul_f32 v56, v56, v56
  v_mul_f32 v57, v57, v57
  v_cvt_pk_bf16_f32 v15, v58, v59
  v_lshlrev_b32 v58, 16, v15
  v_and_b32 v59, 0xffff0000, v15
  v_lshlrev_b32 v15, 16, v117
  v_add_f32 v58, v58, v15
  v_and_b32 v15, 0xffff0000, v117
  v_add_f32 v59, v59, v15
  v_cvt_pk_bf16_f32 v15, v58, v59
  v_lshlrev_b32 v58, 16, v15
  v_and_b32 v59, 0xffff0000, v15
  v_max_f32 v58, 0, v58
  v_max_f32 v59, 0, v59
  v_mul_f32 v58, v58, v58
  v_mul_f32 v59, v59, v59
  v_cvt_pk_bf16_f32 v15, v60, v61
  v_lshlrev_b32 v60, 16, v15
  v_and_b32 v61, 0xffff0000, v15
  v_lshlrev_b32 v15, 16, v118
  v_add_f32 v60, v60, v15
  v_and_b32 v15, 0xffff0000, v118
  v_add_f32 v61, v61, v15
  v_cvt_pk_bf16_f32 v15, v60, v61
  v_lshlrev_b32 v60, 16, v15
  v_and_b32 v61, 0xffff0000, v15
  v_max_f32 v60, 0, v60
  v_max_f32 v61, 0, v61
  v_mul_f32 v60, v60, v60
  v_mul_f32 v61, v61, v61
  v_cvt_pk_bf16_f32 v15, v62, v63
  v_lshlrev_b32 v62, 16, v15
  v_and_b32 v63, 0xffff0000, v15
  v_lshlrev_b32 v15, 16, v119
  v_add_f32 v62, v62, v15
  v_and_b32 v15, 0xffff0000, v119
  v_add_f32 v63, v63, v15
  v_cvt_pk_bf16_f32 v15, v62, v63
  v_lshlrev_b32 v62, 16, v15
  v_and_b32 v63, 0xffff0000, v15
  v_max_f32 v62, 0, v62
  v_max_f32 v63, 0, v63
  v_mul_f32 v62, v62, v62
  v_mul_f32 v63, v63, v63
  v_cvt_pk_bf16_f32 v15, v64, v65
  v_lshlrev_b32 v64, 16, v15
  v_and_b32 v65, 0xffff0000, v15
  v_lshlrev_b32 v15, 16, v120
  v_add_f32 v64, v64, v15
  v_and_b32 v15, 0xffff0000, v120
  v_add_f32 v65, v65, v15
  v_cvt_pk_bf16_f32 v15, v64, v65
  v_lshlrev_b32 v64, 16, v15
  v_and_b32 v65, 0xffff0000, v15
  v_max_f32 v64, 0, v64
  v_max_f32 v65, 0, v65
  v_mul_f32 v64, v64, v64
  v_mul_f32 v65, v65, v65
  v_cvt_pk_bf16_f32 v15, v66, v67
  v_lshlrev_b32 v66, 16, v15
  v_and_b32 v67, 0xffff0000, v15
  v_lshlrev_b32 v15, 16, v121
  v_add_f32 v66, v66, v15
  v_and_b32 v15, 0xffff0000, v121
  v_add_f32 v67, v67, v15
  v_cvt_pk_bf16_f32 v15, v66, v67
  v_lshlrev_b32 v66, 16, v15
  v_and_b32 v67, 0xffff0000, v15
  v_max_f32 v66, 0, v66
  v_max_f32 v67, 0, v67
  v_mul_f32 v66, v66, v66
  v_mul_f32 v67, v67, v67
  v_cvt_pk_bf16_f32 v15, v68, v69
  v_lshlrev_b32 v68, 16, v15
  v_and_b32 v69, 0xffff0000, v15
  v_lshlrev_b32 v15, 16, v122
  v_add_f32 v68, v68, v15
  v_and_b32 v15, 0xffff0000, v122
  v_add_f32 v69, v69, v15
  v_cvt_pk_bf16_f32 v15, v68, v69
  v_lshlrev_b32 v68, 16, v15
  v_and_b32 v69, 0xffff0000, v15
  v_max_f32 v68, 0, v68
  v_max_f32 v69, 0, v69
  v_mul_f32 v68, v68, v68
  v_mul_f32 v69, v69, v69
  v_cvt_pk_bf16_f32 v15, v70, v71
  v_lshlrev_b32 v70, 16, v15
  v_and_b32 v71, 0xffff0000, v15
  v_lshlrev_b32 v15, 16, v123
  v_add_f32 v70, v70, v15
  v_and_b32 v15, 0xffff0000, v123
  v_add_f32 v71, v71, v15
  v_cvt_pk_bf16_f32 v15, v70, v71
  v_lshlrev_b32 v70, 16, v15
  v_and_b32 v71, 0xffff0000, v15
  v_max_f32 v70, 0, v70
  v_max_f32 v71, 0, v71
  v_mul_f32 v70, v70, v70
  v_mul_f32 v71, v71, v71
  v_cvt_pk_bf16_f32 v15, v72, v73
  v_lshlrev_b32 v72, 16, v15
  v_and_b32 v73, 0xffff0000, v15
  v_lshlrev_b32 v15, 16, v124
  v_add_f32 v72, v72, v15
  v_and_b32 v15, 0xffff0000, v124
  v_add_f32 v73, v73, v15
  v_cvt_pk_bf16_f32 v15, v72, v73
  v_lshlrev_b32 v72, 16, v15
  v_and_b32 v73, 0xffff0000, v15
  v_max_f32 v72, 0, v72
  v_max_f32 v73, 0, v73
  v_mul_f32 v72, v72, v72
  v_mul_f32 v73, v73, v73
  v_cvt_pk_bf16_f32 v15, v74, v75
  v_lshlrev_b32 v74, 16, v15
  v_and_b32 v75, 0xffff0000, v15
  v_lshlrev_b32 v15, 16, v125
  v_add_f32 v74, v74, v15
  v_and_b32 v15, 0xffff0000, v125
  v_add_f32 v75, v75, v15
  v_cvt_pk_bf16_f32 v15, v74, v75
  v_lshlrev_b32 v74, 16, v15
  v_and_b32 v75, 0xffff0000, v15
  v_max_f32 v74, 0, v74
  v_max_f32 v75, 0, v75
  v_mul_f32 v74, v74, v74
  v_mul_f32 v75, v75, v75
  v_cvt_pk_bf16_f32 v15, v76, v77
  v_lshlrev_b32 v76, 16, v15
  v_and_b32 v77, 0xffff0000, v15
  v_lshlrev_b32 v15, 16, v126
  v_add_f32 v76, v76, v15
  v_and_b32 v15, 0xffff0000, v126
  v_add_f32 v77, v77, v15
  v_cvt_pk_bf16_f32 v15, v76, v77
  v_lshlrev_b32 v76, 16, v15
  v_and_b32 v77, 0xffff0000, v15
  v_max_f32 v76, 0, v76
  v_max_f32 v77, 0, v77
  v_mul_f32 v76, v76, v76
  v_mul_f32 v77, v77, v77
  v_cvt_pk_bf16_f32 v15, v78, v79
  v_lshlrev_b32 v78, 16, v15
  v_and_b32 v79, 0xffff0000, v15
  v_lshlrev_b32 v15, 16, v127
  v_add_f32 v78, v78, v15
  v_and_b32 v15, 0xffff0000, v127
  v_add_f32 v79, v79, v15
  v_cvt_pk_bf16_f32 v15, v78, v79
  v_lshlrev_b32 v78, 16, v15
  v_and_b32 v79, 0xffff0000, v15
  v_max_f32 v78, 0, v78
  v_max_f32 v79, 0, v79
  v_mul_f32 v78, v78, v78
  v_mul_f32 v79, v79, v79
  v_cvt_pk_bf16_f32 v15, v80, v81
  v_lshlrev_b32 v80, 16, v15
  v_and_b32 v81, 0xffff0000, v15
  v_lshlrev_b32 v15, 16, v128
  v_add_f32 v80, v80, v15
  v_and_b32 v15, 0xffff0000, v128
  v_add_f32 v81, v81, v15
  v_cvt_pk_bf16_f32 v15, v80, v81
  v_lshlrev_b32 v80, 16, v15
  v_and_b32 v81, 0xffff0000, v15
  v_max_f32 v80, 0, v80
  v_max_f32 v81, 0, v81
  v_mul_f32 v80, v80, v80
  v_mul_f32 v81, v81, v81
  v_cvt_pk_bf16_f32 v15, v82, v83
  v_lshlrev_b32 v82, 16, v15
  v_and_b32 v83, 0xffff0000, v15
  v_lshlrev_b32 v15, 16, v129
  v_add_f32 v82, v82, v15
  v_and_b32 v15, 0xffff0000, v129
  v_add_f32 v83, v83, v15
  v_cvt_pk_bf16_f32 v15, v82, v83
  v_lshlrev_b32 v82, 16, v15
  v_and_b32 v83, 0xffff0000, v15
  v_max_f32 v82, 0, v82
  v_max_f32 v83, 0, v83
  v_mul_f32 v82, v82, v82
  v_mul_f32 v83, v83, v83
  v_cvt_pk_bf16_f32 v15, v84, v85
  v_lshlrev_b32 v84, 16, v15
  v_and_b32 v85, 0xffff0000, v15
  v_lshlrev_b32 v15, 16, v130
  v_add_f32 v84, v84, v15
  v_and_b32 v15, 0xffff0000, v130
  v_add_f32 v85, v85, v15
  v_cvt_pk_bf16_f32 v15, v84, v85
  v_lshlrev_b32 v84, 16, v15
  v_and_b32 v85, 0xffff0000, v15
  v_max_f32 v84, 0, v84
  v_max_f32 v85, 0, v85
  v_mul_f32 v84, v84, v84
  v_mul_f32 v85, v85, v85
  v_cvt_pk_bf16_f32 v15, v86, v87
  v_lshlrev_b32 v86, 16, v15
  v_and_b32 v87, 0xffff0000, v15
  v_lshlrev_b32 v15, 16, v131
  v_add_f32 v86, v86, v15
  v_and_b32 v15, 0xffff0000, v131
  v_add_f32 v87, v87, v15
  v_cvt_pk_bf16_f32 v15, v86, v87
  v_lshlrev_b32 v86, 16, v15
  v_and_b32 v87, 0xffff0000, v15
  v_max_f32 v86, 0, v86
  v_max_f32 v87, 0, v87
  v_mul_f32 v86, v86, v86
  v_mul_f32 v87, v87, v87
  v_cvt_pk_bf16_f32 v15, v88, v89
  v_lshlrev_b32 v88, 16, v15
  v_and_b32 v89, 0xffff0000, v15
  v_lshlrev_b32 v15, 16, v132
  v_add_f32 v88, v88, v15
  v_and_b32 v15, 0xffff0000, v132
  v_add_f32 v89, v89, v15
  v_cvt_pk_bf16_f32 v15, v88, v89
  v_lshlrev_b32 v88, 16, v15
  v_and_b32 v89, 0xffff0000, v15
  v_max_f32 v88, 0, v88
  v_max_f32 v89, 0, v89
  v_mul_f32 v88, v88, v88
  v_mul_f32 v89, v89, v89
  v_cvt_pk_bf16_f32 v15, v90, v91
  v_lshlrev_b32 v90, 16, v15
  v_and_b32 v91, 0xffff0000, v15
  v_lshlrev_b32 v15, 16, v133
  v_add_f32 v90, v90, v15
  v_and_b32 v15, 0xffff0000, v133
  v_add_f32 v91, v91, v15
  v_cvt_pk_bf16_f32 v15, v90, v91
  v_lshlrev_b32 v90, 16, v15
  v_and_b32 v91, 0xffff0000, v15
  v_max_f32 v90, 0, v90
  v_max_f32 v91, 0, v91
  v_mul_f32 v90, v90, v90
  v_mul_f32 v91, v91, v91
  v_cvt_pk_bf16_f32 v15, v92, v93
  v_lshlrev_b32 v92, 16, v15
  v_and_b32 v93, 0xffff0000, v15
  v_lshlrev_b32 v15, 16, v134
  v_add_f32 v92, v92, v15
  v_and_b32 v15, 0xffff0000, v134
  v_add_f32 v93, v93, v15
  v_cvt_pk_bf16_f32 v15, v92, v93
  v_lshlrev_b32 v92, 16, v15
  v_and_b32 v93, 0xffff0000, v15
  v_max_f32 v92, 0, v92
  v_max_f32 v93, 0, v93
  v_mul_f32 v92, v92, v92
  v_mul_f32 v93, v93, v93
  v_cvt_pk_bf16_f32 v15, v94, v95
  v_lshlrev_b32 v94, 16, v15
  v_and_b32 v95, 0xffff0000, v15
  v_lshlrev_b32 v15, 16, v135
  v_add_f32 v94, v94, v15
  v_and_b32 v15, 0xffff0000, v135
  v_add_f32 v95, v95, v15
  v_cvt_pk_bf16_f32 v15, v94, v95
  v_lshlrev_b32 v94, 16, v15
  v_and_b32 v95, 0xffff0000, v15
  v_max_f32 v94, 0, v94
  v_max_f32 v95, 0, v95
  v_mul_f32 v94, v94, v94
  v_mul_f32 v95, v95, v95
  v_cvt_pk_bf16_f32 v15, v96, v97
  v_lshlrev_b32 v96, 16, v15
  v_and_b32 v97, 0xffff0000, v15
  v_lshlrev_b32 v15, 16, v136
  v_add_f32 v96, v96, v15
  v_and_b32 v15, 0xffff0000, v136
  v_add_f32 v97, v97, v15
  v_cvt_pk_bf16_f32 v15, v96, v97
  v_lshlrev_b32 v96, 16, v15
  v_and_b32 v97, 0xffff0000, v15
  v_max_f32 v96, 0, v96
  v_max_f32 v97, 0, v97
  v_mul_f32 v96, v96, v96
  v_mul_f32 v97, v97, v97
  v_cvt_pk_bf16_f32 v15, v98, v99
  v_lshlrev_b32 v98, 16, v15
  v_and_b32 v99, 0xffff0000, v15
  v_lshlrev_b32 v15, 16, v137
  v_add_f32 v98, v98, v15
  v_and_b32 v15, 0xffff0000, v137
  v_add_f32 v99, v99, v15
  v_cvt_pk_bf16_f32 v15, v98, v99
  v_lshlrev_b32 v98, 16, v15
  v_and_b32 v99, 0xffff0000, v15
  v_max_f32 v98, 0, v98
  v_max_f32 v99, 0, v99
  v_mul_f32 v98, v98, v98
  v_mul_f32 v99, v99, v99
  v_cvt_pk_bf16_f32 v15, v100, v101
  v_lshlrev_b32 v100, 16, v15
  v_and_b32 v101, 0xffff0000, v15
  v_lshlrev_b32 v15, 16, v138
  v_add_f32 v100, v100, v15
  v_and_b32 v15, 0xffff0000, v138
  v_add_f32 v101, v101, v15
  v_cvt_pk_bf16_f32 v15, v100, v101
  v_lshlrev_b32 v100, 16, v15
  v_and_b32 v101, 0xffff0000, v15
  v_max_f32 v100, 0, v100
  v_max_f32 v101, 0, v101
  v_mul_f32 v100, v100, v100
  v_mul_f32 v101, v101, v101
  v_cvt_pk_bf16_f32 v15, v102, v103
  v_lshlrev_b32 v102, 16, v15
  v_and_b32 v103, 0xffff0000, v15
  v_lshlrev_b32 v15, 16, v139
  v_add_f32 v102, v102, v15
  v_and_b32 v15, 0xffff0000, v139
  v_add_f32 v103, v103, v15
  v_cvt_pk_bf16_f32 v15, v102, v103
  v_lshlrev_b32 v102, 16, v15
  v_and_b32 v103, 0xffff0000, v15
  v_max_f32 v102, 0, v102
  v_max_f32 v103, 0, v103
  v_mul_f32 v102, v102, v102
  v_mul_f32 v103, v103, v103
  v_cvt_pk_bf16_f32 v15, v104, v105
  v_lshlrev_b32 v104, 16, v15
  v_and_b32 v105, 0xffff0000, v15
  v_lshlrev_b32 v15, 16, v140
  v_add_f32 v104, v104, v15
  v_and_b32 v15, 0xffff0000, v140
  v_add_f32 v105, v105, v15
  v_cvt_pk_bf16_f32 v15, v104, v105
  v_lshlrev_b32 v104, 16, v15
  v_and_b32 v105, 0xffff0000, v15
  v_max_f32 v104, 0, v104
  v_max_f32 v105, 0, v105
  v_mul_f32 v104, v104, v104
  v_mul_f32 v105, v105, v105
  v_cvt_pk_bf16_f32 v15, v106, v107
  v_lshlrev_b32 v106, 16, v15
  v_and_b32 v107, 0xffff0000, v15
  v_lshlrev_b32 v15, 16, v141
  v_add_f32 v106, v106, v15
  v_and_b32 v15, 0xffff0000, v141
  v_add_f32 v107, v107, v15
  v_cvt_pk_bf16_f32 v15, v106, v107
  v_lshlrev_b32 v106, 16, v15
  v_and_b32 v107, 0xffff0000, v15
  v_max_f32 v106, 0, v106
  v_max_f32 v107, 0, v107
  v_mul_f32 v106, v106, v106
  v_mul_f32 v107, v107, v107
  v_cvt_pk_bf16_f32 v15, v108, v109
  v_lshlrev_b32 v108, 16, v15
  v_and_b32 v109, 0xffff0000, v15
  v_lshlrev_b32 v15, 16, v142
  v_add_f32 v108, v108, v15
  v_and_b32 v15, 0xffff0000, v142
  v_add_f32 v109, v109, v15
  v_cvt_pk_bf16_f32 v15, v108, v109
  v_lshlrev_b32 v108, 16, v15
  v_and_b32 v109, 0xffff0000, v15
  v_max_f32 v108, 0, v108
  v_max_f32 v109, 0, v109
  v_mul_f32 v108, v108, v108
  v_mul_f32 v109, v109, v109
  v_cvt_pk_bf16_f32 v15, v110, v111
  v_lshlrev_b32 v110, 16, v15
  v_and_b32 v111, 0xffff0000, v15
  v_lshlrev_b32 v15, 16, v143
  v_add_f32 v110, v110, v15
  v_and_b32 v15, 0xffff0000, v143
  v_add_f32 v111, v111, v15
  v_cvt_pk_bf16_f32 v15, v110, v111
  v_lshlrev_b32 v110, 16, v15
  v_and_b32 v111, 0xffff0000, v15
  v_max_f32 v110, 0, v110
  v_max_f32 v111, 0, v111
  v_mul_f32 v110, v110, v110
  v_mul_f32 v111, v111, v111
  s_add_u32 s67, s56, 4096
  v_cvt_pk_bf16_f32 v48, v48, v49
  v_cvt_pk_bf16_f32 v49, v50, v51
  v_cvt_pk_bf16_f32 v50, v52, v53
  v_cvt_pk_bf16_f32 v51, v54, v55
  buffer_store_dwordx4 v[48:51], v12, s[16:19], s56 offen offset:0 sc1
  v_cvt_pk_bf16_f32 v56, v56, v57
  v_cvt_pk_bf16_f32 v57, v58, v59
  v_cvt_pk_bf16_f32 v58, v60, v61
  v_cvt_pk_bf16_f32 v59, v62, v63
  buffer_store_dwordx4 v[56:59], v12, s[16:19], s56 offen offset:1024 sc1
  v_cvt_pk_bf16_f32 v64, v64, v65
  v_cvt_pk_bf16_f32 v65, v66, v67
  v_cvt_pk_bf16_f32 v66, v68, v69
  v_cvt_pk_bf16_f32 v67, v70, v71
  buffer_store_dwordx4 v[64:67], v12, s[16:19], s56 offen offset:2048 sc1
  v_cvt_pk_bf16_f32 v72, v72, v73
  v_cvt_pk_bf16_f32 v73, v74, v75
  v_cvt_pk_bf16_f32 v74, v76, v77
  v_cvt_pk_bf16_f32 v75, v78, v79
  buffer_store_dwordx4 v[72:75], v12, s[16:19], s56 offen offset:3072 sc1
  v_cvt_pk_bf16_f32 v80, v80, v81
  v_cvt_pk_bf16_f32 v81, v82, v83
  v_cvt_pk_bf16_f32 v82, v84, v85
  v_cvt_pk_bf16_f32 v83, v86, v87
  buffer_store_dwordx4 v[80:83], v12, s[16:19], s67 offen offset:0 sc1
  v_cvt_pk_bf16_f32 v88, v88, v89
  v_cvt_pk_bf16_f32 v89, v90, v91
  v_cvt_pk_bf16_f32 v90, v92, v93
  v_cvt_pk_bf16_f32 v91, v94, v95
  buffer_store_dwordx4 v[88:91], v12, s[16:19], s67 offen offset:1024 sc1
  v_cvt_pk_bf16_f32 v96, v96, v97
  v_cvt_pk_bf16_f32 v97, v98, v99
  v_cvt_pk_bf16_f32 v98, v100, v101
  v_cvt_pk_bf16_f32 v99, v102, v103
  buffer_store_dwordx4 v[96:99], v12, s[16:19], s67 offen offset:2048 sc1
  v_cvt_pk_bf16_f32 v104, v104, v105
  v_cvt_pk_bf16_f32 v105, v106, v107
  v_cvt_pk_bf16_f32 v106, v108, v109
  v_cvt_pk_bf16_f32 v107, v110, v111
  buffer_store_dwordx4 v[104:107], v12, s[16:19], s67 offen offset:3072 sc1
  s_nop 1
  s_mov_b32 s12, s48
  s_mov_b32 s13, s49
  s_mov_b32 s14, s50
  s_mov_b32 s52, s54
  s_mov_b32 s53, s55
  v_mov_b32 v10, v11
  s_branch proj_end
proj_ckv:
  s_mov_b32 s12, s30
  s_mov_b32 s13, s31
  s_mov_b32 s14, 0x400000
  s_mov_b32 s52, 8192
  s_mov_b32 s53, s61
  v_mul_lo_u32 v10, v13, s52
  v_add_u32 v10, v10, v14
  s_add_u32 m0, s58, 0
  s_mul_i32 s57, s52, 0
  s_add_u32 s57, s57, s53
  buffer_load_dwordx4 v10, s[12:15], s57 offen lds
  s_add_u32 m0, s58, 1024
  s_mul_i32 s57, s52, 4
  s_add_u32 s57, s57, s53
  buffer_load_dwordx4 v10, s[12:15], s57 offen lds
  s_add_u32 m0, s58, 2048
  s_mul_i32 s57, s52, 8
  s_add_u32 s57, s57, s53
  buffer_load_dwordx4 v10, s[12:15], s57 offen lds
  s_add_u32 m0, s58, 3072
  s_mul_i32 s57, s52, 12
  s_add_u32 s57, s57, s53
  buffer_load_dwordx4 v10, s[12:15], s57 offen lds
  v_xor_b32 v248, 0, v240
  s_add_u32 m0, s66, 65536
  s_movk_i32 s67, 0
  buffer_load_dwordx4 v248, s[8:11], s67 offen lds
  v_xor_b32 v249, 64, v240
  s_add_u32 m0, s66, 66560
  s_movk_i32 s67, 8192
  buffer_load_dwordx4 v249, s[8:11], s67 offen lds
  v_xor_b32 v250, 0, v240
  s_add_u32 m0, s66, 67584
  s_movk_i32 s67, 16384
  buffer_load_dwordx4 v250, s[8:11], s67 offen lds
  v_xor_b32 v251, 64, v240
  s_add_u32 m0, s66, 68608
  s_movk_i32 s67, 24576
  buffer_load_dwordx4 v251, s[8:11], s67 offen lds
  v_xor_b32 v248, 0, v240
  s_add_u32 m0, s66, 98304
  s_movk_i32 s67, 128
  buffer_load_dwordx4 v248, s[8:11], s67 offen lds
  v_xor_b32 v249, 64, v240
  s_add_u32 m0, s66, 99328
  s_movk_i32 s67, 8320
  buffer_load_dwordx4 v249, s[8:11], s67 offen lds
  v_xor_b32 v250, 0, v240
  s_add_u32 m0, s66, 100352
  s_movk_i32 s67, 16512
  buffer_load_dwordx4 v250, s[8:11], s67 offen lds
  v_xor_b32 v251, 64, v240
  s_add_u32 m0, s66, 101376
  s_movk_i32 s67, 24704
  buffer_load_dwordx4 v251, s[8:11], s67 offen lds
  v_xor_b32 v248, 0, v240
  s_add_u32 m0, s66, 131072
  s_movk_i32 s67, 256
  buffer_load_dwordx4 v248, s[8:11], s67 offen lds
  v_xor_b32 v249, 64, v240
  s_add_u32 m0, s66, 132096
  s_movk_i32 s67, 8448
  buffer_load_dwordx4 v249, s[8:11], s67 offen lds
  v_xor_b32 v250, 0, v240
  s_add_u32 m0, s66, 133120
  s_movk_i32 s67, 16640
  buffer_load_dwordx4 v250, s[8:11], s67 offen lds
  v_xor_b32 v251, 64, v240
  s_add_u32 m0, s66, 134144
  s_movk_i32 s67, 24832
  buffer_load_dwordx4 v251, s[8:11], s67 offen lds
  s_add_u32 m0, s58, 32768
  s_mul_i32 s57, s52, 128
  s_add_u32 s57, s57, s53
  buffer_load_dwordx4 v10, s[12:15], s57 offen lds
  s_add_u32 m0, s58, 33792
  s_mul_i32 s57, s52, 132
  s_add_u32 s57, s57, s53
  buffer_load_dwordx4 v10, s[12:15], s57 offen lds
  s_add_u32 m0, s58, 34816
  s_mul_i32 s57, s52, 136
  s_add_u32 s57, s57, s53
  buffer_load_dwordx4 v10, s[12:15], s57 offen lds
  s_add_u32 m0, s58, 35840
  s_mul_i32 s57, s52, 140
  s_add_u32 s57, s57, s53
  buffer_load_dwordx4 v10, s[12:15], s57 offen lds
  s_waitcnt vmcnt(12)
  v_xor_b32 v248, 0, v242
  ds_read_b128 v[112:115], v248 offset:0
  v_xor_b32 v249, 16, v242
  ds_read_b128 v[116:119], v249 offset:0
  v_xor_b32 v250, 64, v242
  ds_read_b128 v[120:123], v250 offset:0
  v_xor_b32 v251, 80, v242
  ds_read_b128 v[124:127], v251 offset:0
  s_waitcnt lgkmcnt(0)
  v_xor_b32 v248, 0, v240
  s_add_u32 m0, s66, 65536
  s_movk_i32 s67, 384
  buffer_load_dwordx4 v248, s[8:11], s67 offen lds
  v_xor_b32 v249, 64, v240
  s_add_u32 m0, s66, 66560
  s_movk_i32 s67, 8576
  buffer_load_dwordx4 v249, s[8:11], s67 offen lds
  v_xor_b32 v250, 0, v240
  s_add_u32 m0, s66, 67584
  s_movk_i32 s67, 16768
  buffer_load_dwordx4 v250, s[8:11], s67 offen lds
  v_xor_b32 v251, 64, v240
  s_add_u32 m0, s66, 68608
  s_movk_i32 s67, 24960
  buffer_load_dwordx4 v251, s[8:11], s67 offen lds
  s_waitcnt vmcnt(12)
  v_xor_b32 v248, 0, v242
  ds_read_b128 v[128:131], v248 offset:32768
  v_xor_b32 v249, 16, v242
  ds_read_b128 v[132:135], v249 offset:32768
  v_xor_b32 v250, 64, v242
  ds_read_b128 v[136:139], v250 offset:32768
  v_xor_b32 v251, 80, v242
  ds_read_b128 v[140:143], v251 offset:32768
  s_waitcnt lgkmcnt(0)
  v_xor_b32 v248, 0, v240
  s_add_u32 m0, s66, 98304
  s_movk_i32 s67, 512
  buffer_load_dwordx4 v248, s[8:11], s67 offen lds
  v_xor_b32 v249, 64, v240
  s_add_u32 m0, s66, 99328
  s_movk_i32 s67, 8704
  buffer_load_dwordx4 v249, s[8:11], s67 offen lds
  v_xor_b32 v250, 0, v240
  s_add_u32 m0, s66, 100352
  s_movk_i32 s67, 16896
  buffer_load_dwordx4 v250, s[8:11], s67 offen lds
  v_xor_b32 v251, 64, v240
  s_add_u32 m0, s66, 101376
  s_movk_i32 s67, 25088
  buffer_load_dwordx4 v251, s[8:11], s67 offen lds
  s_barrier
  ds_read_b64_tr_b16 v[16:17], v2 offset:0
  ds_read_b64_tr_b16 v[18:19], v2 offset:1024
  ds_read_b64_tr_b16 v[20:21], v3 offset:0
  ds_read_b64_tr_b16 v[22:23], v3 offset:1024
  ds_read_b64_tr_b16 v[24:25], v4 offset:0
  ds_read_b64_tr_b16 v[26:27], v4 offset:1024
  ds_read_b64_tr_b16 v[28:29], v5 offset:0
  ds_read_b64_tr_b16 v[30:31], v5 offset:1024
  s_mov_b32 s48, s30
  s_mov_b32 s49, s31
  s_mov_b32 s50, 0x400000
  s_mov_b32 s54, 8192
  s_mov_b32 s55, s62
  v_mul_lo_u32 v11, v13, s54
  v_add_u32 v11, v11, v14
  s_add_u32 s56, s63, 0x1000000
  s_waitcnt lgkmcnt(6)
  v_mfma_f32_32x32x16_bf16 v[48:63], v[16:19], v[112:115], 0
  ds_read_b64_tr_b16 v[32:33], v2 offset:2048
  ds_read_b64_tr_b16 v[34:35], v2 offset:3072
  s_waitcnt lgkmcnt(6)
  v_mfma_f32_32x32x16_bf16 v[64:79], v[20:23], v[112:115], 0
  ds_read_b64_tr_b16 v[36:37], v3 offset:2048
  ds_read_b64_tr_b16 v[38:39], v3 offset:3072
  s_waitcnt lgkmcnt(6)
  v_mfma_f32_32x32x16_bf16 v[80:95], v[24:27], v[112:115], 0
  ds_read_b64_tr_b16 v[40:41], v4 offset:2048
  ds_read_b64_tr_b16 v[42:43], v4 offset:3072
  s_waitcnt lgkmcnt(6)
  v_mfma_f32_32x32x16_bf16 v[96:111], v[28:31], v[112:115], 0
  ds_read_b64_tr_b16 v[44:45], v5 offset:2048
  ds_read_b64_tr_b16 v[46:47], v5 offset:3072
  s_waitcnt vmcnt(12)
  v_xor_b32 v248, 0, v243
  ds_read_b128 v[144:147], v248 offset:0
  v_xor_b32 v249, 16, v243
  ds_read_b128 v[148:151], v249 offset:0
  v_xor_b32 v250, 64, v243
  ds_read_b128 v[152:155], v250 offset:0
  v_xor_b32 v251, 80, v243
  ds_read_b128 v[156:159], v251 offset:0
  s_waitcnt lgkmcnt(6)
  v_mfma_f32_32x32x16_bf16 v[48:63], v[32:35], v[116:119], v[48:63]
  ds_read_b64_tr_b16 v[16:17], v2 offset:8192
  ds_read_b64_tr_b16 v[18:19], v2 offset:9216
  s_waitcnt lgkmcnt(6)
  v_mfma_f32_32x32x16_bf16 v[64:79], v[36:39], v[116:119], v[64:79]
  ds_read_b64_tr_b16 v[20:21], v3 offset:8192
  ds_read_b64_tr_b16 v[22:23], v3 offset:9216
  s_waitcnt lgkmcnt(6)
  v_mfma_f32_32x32x16_bf16 v[80:95], v[40:43], v[116:119], v[80:95]
  ds_read_b64_tr_b16 v[24:25], v4 offset:8192
  ds_read_b64_tr_b16 v[26:27], v4 offset:9216
  s_waitcnt lgkmcnt(6)
  v_mfma_f32_32x32x16_bf16 v[96:111], v[44:47], v[116:119], v[96:111]
  ds_read_b64_tr_b16 v[28:29], v5 offset:8192
  ds_read_b64_tr_b16 v[30:31], v5 offset:9216
  v_xor_b32 v248, 0, v240
  s_add_u32 m0, s66, 131072
  s_movk_i32 s67, 640
  buffer_load_dwordx4 v248, s[8:11], s67 offen lds
  v_xor_b32 v249, 64, v240
  s_add_u32 m0, s66, 132096
  s_movk_i32 s67, 8832
  buffer_load_dwordx4 v249, s[8:11], s67 offen lds
  v_xor_b32 v250, 0, v240
  s_add_u32 m0, s66, 133120
  s_movk_i32 s67, 17024
  buffer_load_dwordx4 v250, s[8:11], s67 offen lds
  v_xor_b32 v251, 64, v240
  s_add_u32 m0, s66, 134144
  s_movk_i32 s67, 25216
  buffer_load_dwordx4 v251, s[8:11], s67 offen lds
  s_waitcnt lgkmcnt(6)
  v_mfma_f32_32x32x16_bf16 v[48:63], v[16:19], v[120:123], v[48:63]
  ds_read_b64_tr_b16 v[32:33], v2 offset:10240
  ds_read_b64_tr_b16 v[34:35], v2 offset:11264
  s_waitcnt lgkmcnt(6)
  v_mfma_f32_32x32x16_bf16 v[64:79], v[20:23], v[120:123], v[64:79]
  ds_read_b64_tr_b16 v[36:37], v3 offset:10240
  ds_read_b64_tr_b16 v[38:39], v3 offset:11264
  s_waitcnt lgkmcnt(6)
  v_mfma_f32_32x32x16_bf16 v[80:95], v[24:27], v[120:123], v[80:95]
  ds_read_b64_tr_b16 v[40:41], v4 offset:10240
  ds_read_b64_tr_b16 v[42:43], v4 offset:11264
  s_waitcnt lgkmcnt(6)
  v_mfma_f32_32x32x16_bf16 v[96:111], v[28:31], v[120:123], v[96:111]
  ds_read_b64_tr_b16 v[44:45], v5 offset:10240
  ds_read_b64_tr_b16 v[46:47], v5 offset:11264
  s_waitcnt lgkmcnt(6)
  v_mfma_f32_32x32x16_bf16 v[48:63], v[32:35], v[124:127], v[48:63]
  ds_read_b64_tr_b16 v[16:17], v2 offset:16384
  ds_read_b64_tr_b16 v[18:19], v2 offset:17408
  s_waitcnt lgkmcnt(6)
  v_mfma_f32_32x32x16_bf16 v[64:79], v[36:39], v[124:127], v[64:79]
  ds_read_b64_tr_b16 v[20:21], v3 offset:16384
  ds_read_b64_tr_b16 v[22:23], v3 offset:17408
  s_waitcnt lgkmcnt(6)
  v_mfma_f32_32x32x16_bf16 v[80:95], v[40:43], v[124:127], v[80:95]
  ds_read_b64_tr_b16 v[24:25], v4 offset:16384
  ds_read_b64_tr_b16 v[26:27], v4 offset:17408
  s_waitcnt lgkmcnt(6)
  v_mfma_f32_32x32x16_bf16 v[96:111], v[44:47], v[124:127], v[96:111]
  ds_read_b64_tr_b16 v[28:29], v5 offset:16384
  ds_read_b64_tr_b16 v[30:31], v5 offset:17408
  s_waitcnt vmcnt(8)
  v_xor_b32 v248, 0, v242
  ds_read_b128 v[160:163], v248 offset:0
  v_xor_b32 v249, 16, v242
  ds_read_b128 v[164:167], v249 offset:0
  v_xor_b32 v250, 64, v242
  ds_read_b128 v[168:171], v250 offset:0
  v_xor_b32 v251, 80, v242
  ds_read_b128 v[172:175], v251 offset:0
  s_waitcnt lgkmcnt(6)
  v_mfma_f32_32x32x16_bf16 v[48:63], v[16:19], v[128:131], v[48:63]
  ds_read_b64_tr_b16 v[32:33], v2 offset:18432
  ds_read_b64_tr_b16 v[34:35], v2 offset:19456
  s_waitcnt lgkmcnt(6)
  v_mfma_f32_32x32x16_bf16 v[64:79], v[20:23], v[128:131], v[64:79]
  ds_read_b64_tr_b16 v[36:37], v3 offset:18432
  ds_read_b64_tr_b16 v[38:39], v3 offset:19456
  s_waitcnt lgkmcnt(6)
  v_mfma_f32_32x32x16_bf16 v[80:95], v[24:27], v[128:131], v[80:95]
  ds_read_b64_tr_b16 v[40:41], v4 offset:18432
  ds_read_b64_tr_b16 v[42:43], v4 offset:19456
  s_waitcnt lgkmcnt(6)
  v_mfma_f32_32x32x16_bf16 v[96:111], v[28:31], v[128:131], v[96:111]
  ds_read_b64_tr_b16 v[44:45], v5 offset:18432
  ds_read_b64_tr_b16 v[46:47], v5 offset:19456
  s_waitcnt lgkmcnt(6)
  v_mfma_f32_32x32x16_bf16 v[48:63], v[32:35], v[132:135], v[48:63]
  ds_read_b64_tr_b16 v[16:17], v2 offset:24576
  ds_read_b64_tr_b16 v[18:19], v2 offset:25600
  s_waitcnt lgkmcnt(6)
  v_mfma_f32_32x32x16_bf16 v[64:79], v[36:39], v[132:135], v[64:79]
  ds_read_b64_tr_b16 v[20:21], v3 offset:24576
  ds_read_b64_tr_b16 v[22:23], v3 offset:25600
  s_waitcnt lgkmcnt(6)
  v_mfma_f32_32x32x16_bf16 v[80:95], v[40:43], v[132:135], v[80:95]
  ds_read_b64_tr_b16 v[24:25], v4 offset:24576
  ds_read_b64_tr_b16 v[26:27], v4 offset:25600
  s_waitcnt lgkmcnt(6)
  v_mfma_f32_32x32x16_bf16 v[96:111], v[44:47], v[132:135], v[96:111]
  ds_read_b64_tr_b16 v[28:29], v5 offset:24576
  ds_read_b64_tr_b16 v[30:31], v5 offset:25600
  s_barrier
  s_add_u32 m0, s58, 65536
  s_mul_i32 s57, s52, 256
  s_add_u32 s57, s57, s53
  buffer_load_dwordx4 v10, s[12:15], s57 offen lds
  s_add_u32 m0, s58, 66560
  s_mul_i32 s57, s52, 260
  s_add_u32 s57, s57, s53
  buffer_load_dwordx4 v10, s[12:15], s57 offen lds
  s_add_u32 m0, s58, 67584
  s_mul_i32 s57, s52, 264
  s_add_u32 s57, s57, s53
  buffer_load_dwordx4 v10, s[12:15], s57 offen lds
  s_add_u32 m0, s58, 68608
  s_mul_i32 s57, s52, 268
  s_add_u32 s57, s57, s53
  buffer_load_dwordx4 v10, s[12:15], s57 offen lds
  s_waitcnt lgkmcnt(6)
  v_mfma_f32_32x32x16_bf16 v[48:63], v[16:19], v[136:139], v[48:63]
  ds_read_b64_tr_b16 v[32:33], v2 offset:26624
  ds_read_b64_tr_b16 v[34:35], v2 offset:27648
  s_waitcnt lgkmcnt(6)
  v_mfma_f32_32x32x16_bf16 v[64:79], v[20:23], v[136:139], v[64:79]
  ds_read_b64_tr_b16 v[36:37], v3 offset:26624
  ds_read_b64_tr_b16 v[38:39], v3 offset:27648
  s_waitcnt lgkmcnt(6)
  v_mfma_f32_32x32x16_bf16 v[80:95], v[24:27], v[136:139], v[80:95]
  ds_read_b64_tr_b16 v[40:41], v4 offset:26624
  ds_read_b64_tr_b16 v[42:43], v4 offset:27648
  s_waitcnt lgkmcnt(6)
  v_mfma_f32_32x32x16_bf16 v[96:111], v[28:31], v[136:139], v[96:111]
  ds_read_b64_tr_b16 v[44:45], v5 offset:26624
  ds_read_b64_tr_b16 v[46:47], v5 offset:27648
  s_waitcnt lgkmcnt(6)
  v_mfma_f32_32x32x16_bf16 v[48:63], v[32:35], v[140:143], v[48:63]
  ds_read_b64_tr_b16 v[16:17], v2 offset:32768
  ds_read_b64_tr_b16 v[18:19], v2 offset:33792
  s_waitcnt lgkmcnt(6)
  v_mfma_f32_32x32x16_bf16 v[64:79], v[36:39], v[140:143], v[64:79]
  ds_read_b64_tr_b16 v[20:21], v3 offset:32768
  ds_read_b64_tr_b16 v[22:23], v3 offset:33792
  s_waitcnt lgkmcnt(6)
  v_mfma_f32_32x32x16_bf16 v[80:95], v[40:43], v[140:143], v[80:95]
  ds_read_b64_tr_b16 v[24:25], v4 offset:32768
  ds_read_b64_tr_b16 v[26:27], v4 offset:33792
  s_waitcnt lgkmcnt(6)
  v_mfma_f32_32x32x16_bf16 v[96:111], v[44:47], v[140:143], v[96:111]
  ds_read_b64_tr_b16 v[28:29], v5 offset:32768
  ds_read_b64_tr_b16 v[30:31], v5 offset:33792
  s_barrier
  v_xor_b32 v248, 0, v240
  s_add_u32 m0, s66, 0
  s_movk_i32 s67, 768
  buffer_load_dwordx4 v248, s[8:11], s67 offen lds
  v_xor_b32 v249, 64, v240
  s_add_u32 m0, s66, 1024
  s_movk_i32 s67, 8960
  buffer_load_dwordx4 v249, s[8:11], s67 offen lds
  v_xor_b32 v250, 0, v240
  s_add_u32 m0, s66, 2048
  s_movk_i32 s67, 17152
  buffer_load_dwordx4 v250, s[8:11], s67 offen lds
  v_xor_b32 v251, 64, v240
  s_add_u32 m0, s66, 3072
  s_movk_i32 s67, 25344
  buffer_load_dwordx4 v251, s[8:11], s67 offen lds
  s_waitcnt lgkmcnt(6)
  v_mfma_f32_32x32x16_bf16 v[48:63], v[16:19], v[144:147], v[48:63]
  ds_read_b64_tr_b16 v[32:33], v2 offset:34816
  ds_read_b64_tr_b16 v[34:35], v2 offset:35840
  s_waitcnt lgkmcnt(6)
  v_mfma_f32_32x32x16_bf16 v[64:79], v[20:23], v[144:147], v[64:79]
  ds_read_b64_tr_b16 v[36:37], v3 offset:34816
  ds_read_b64_tr_b16 v[38:39], v3 offset:35840
  s_waitcnt lgkmcnt(6)
  v_mfma_f32_32x32x16_bf16 v[80:95], v[24:27], v[144:147], v[80:95]
  ds_read_b64_tr_b16 v[40:41], v4 offset:34816
  ds_read_b64_tr_b16 v[42:43], v4 offset:35840
  s_waitcnt lgkmcnt(6)
  v_mfma_f32_32x32x16_bf16 v[96:111], v[28:31], v[144:147], v[96:111]
  ds_read_b64_tr_b16 v[44:45], v5 offset:34816
  ds_read_b64_tr_b16 v[46:47], v5 offset:35840
  s_waitcnt vmcnt(12)
  v_xor_b32 v248, 0, v242
  ds_read_b128 v[176:179], v248 offset:32768
  v_xor_b32 v249, 16, v242
  ds_read_b128 v[180:183], v249 offset:32768
  v_xor_b32 v250, 64, v242
  ds_read_b128 v[184:187], v250 offset:32768
  v_xor_b32 v251, 80, v242
  ds_read_b128 v[188:191], v251 offset:32768
  s_waitcnt lgkmcnt(6)
  v_mfma_f32_32x32x16_bf16 v[48:63], v[32:35], v[148:151], v[48:63]
  ds_read_b64_tr_b16 v[16:17], v2 offset:40960
  ds_read_b64_tr_b16 v[18:19], v2 offset:41984
  s_waitcnt lgkmcnt(6)
  v_mfma_f32_32x32x16_bf16 v[64:79], v[36:39], v[148:151], v[64:79]
  ds_read_b64_tr_b16 v[20:21], v3 offset:40960
  ds_read_b64_tr_b16 v[22:23], v3 offset:41984
  s_waitcnt lgkmcnt(6)
  v_mfma_f32_32x32x16_bf16 v[80:95], v[40:43], v[148:151], v[80:95]
  ds_read_b64_tr_b16 v[24:25], v4 offset:40960
  ds_read_b64_tr_b16 v[26:27], v4 offset:41984
  s_waitcnt lgkmcnt(6)
  v_mfma_f32_32x32x16_bf16 v[96:111], v[44:47], v[148:151], v[96:111]
  ds_read_b64_tr_b16 v[28:29], v5 offset:40960
  ds_read_b64_tr_b16 v[30:31], v5 offset:41984
  s_waitcnt lgkmcnt(6)
  v_mfma_f32_32x32x16_bf16 v[48:63], v[16:19], v[152:155], v[48:63]
  ds_read_b64_tr_b16 v[32:33], v2 offset:43008
  ds_read_b64_tr_b16 v[34:35], v2 offset:44032
  s_waitcnt lgkmcnt(6)
  v_mfma_f32_32x32x16_bf16 v[64:79], v[20:23], v[152:155], v[64:79]
  ds_read_b64_tr_b16 v[36:37], v3 offset:43008
  ds_read_b64_tr_b16 v[38:39], v3 offset:44032
  s_waitcnt lgkmcnt(6)
  v_mfma_f32_32x32x16_bf16 v[80:95], v[24:27], v[152:155], v[80:95]
  ds_read_b64_tr_b16 v[40:41], v4 offset:43008
  ds_read_b64_tr_b16 v[42:43], v4 offset:44032
  s_waitcnt lgkmcnt(6)
  v_mfma_f32_32x32x16_bf16 v[96:111], v[28:31], v[152:155], v[96:111]
  ds_read_b64_tr_b16 v[44:45], v5 offset:43008
  ds_read_b64_tr_b16 v[46:47], v5 offset:44032
  s_waitcnt vmcnt(8)
  v_xor_b32 v248, 0, v243
  ds_read_b128 v[192:195], v248 offset:0
  v_xor_b32 v249, 16, v243
  ds_read_b128 v[196:199], v249 offset:0
  v_xor_b32 v250, 64, v243
  ds_read_b128 v[200:203], v250 offset:0
  v_xor_b32 v251, 80, v243
  ds_read_b128 v[204:207], v251 offset:0
  s_waitcnt lgkmcnt(6)
  v_mfma_f32_32x32x16_bf16 v[48:63], v[32:35], v[156:159], v[48:63]
  ds_read_b64_tr_b16 v[16:17], v2 offset:49152
  ds_read_b64_tr_b16 v[18:19], v2 offset:50176
  s_waitcnt lgkmcnt(6)
  v_mfma_f32_32x32x16_bf16 v[64:79], v[36:39], v[156:159], v[64:79]
  ds_read_b64_tr_b16 v[20:21], v3 offset:49152
  ds_read_b64_tr_b16 v[22:23], v3 offset:50176
  s_waitcnt lgkmcnt(6)
  v_mfma_f32_32x32x16_bf16 v[80:95], v[40:43], v[156:159], v[80:95]
  ds_read_b64_tr_b16 v[24:25], v4 offset:49152
  ds_read_b64_tr_b16 v[26:27], v4 offset:50176
  s_waitcnt lgkmcnt(6)
  v_mfma_f32_32x32x16_bf16 v[96:111], v[44:47], v[156:159], v[96:111]
  ds_read_b64_tr_b16 v[28:29], v5 offset:49152
  ds_read_b64_tr_b16 v[30:31], v5 offset:50176
  s_waitcnt lgkmcnt(6)
  v_mfma_f32_32x32x16_bf16 v[48:63], v[16:19], v[160:163], v[48:63]
  ds_read_b64_tr_b16 v[32:33], v2 offset:51200
  ds_read_b64_tr_b16 v[34:35], v2 offset:52224
  s_waitcnt lgkmcnt(6)
  v_mfma_f32_32x32x16_bf16 v[64:79], v[20:23], v[160:163], v[64:79]
  ds_read_b64_tr_b16 v[36:37], v3 offset:51200
  ds_read_b64_tr_b16 v[38:39], v3 offset:52224
  s_waitcnt lgkmcnt(6)
  v_mfma_f32_32x32x16_bf16 v[80:95], v[24:27], v[160:163], v[80:95]
  ds_read_b64_tr_b16 v[40:41], v4 offset:51200
  ds_read_b64_tr_b16 v[42:43], v4 offset:52224
  s_waitcnt lgkmcnt(6)
  v_mfma_f32_32x32x16_bf16 v[96:111], v[28:31], v[160:163], v[96:111]
  ds_read_b64_tr_b16 v[44:45], v5 offset:51200
  ds_read_b64_tr_b16 v[46:47], v5 offset:52224
  s_waitcnt lgkmcnt(6)
  v_mfma_f32_32x32x16_bf16 v[48:63], v[32:35], v[164:167], v[48:63]
  ds_read_b64_tr_b16 v[16:17], v2 offset:57344
  ds_read_b64_tr_b16 v[18:19], v2 offset:58368
  s_waitcnt lgkmcnt(6)
  v_mfma_f32_32x32x16_bf16 v[64:79], v[36:39], v[164:167], v[64:79]
  ds_read_b64_tr_b16 v[20:21], v3 offset:57344
  ds_read_b64_tr_b16 v[22:23], v3 offset:58368
  s_waitcnt lgkmcnt(6)
  v_mfma_f32_32x32x16_bf16 v[80:95], v[40:43], v[164:167], v[80:95]
  ds_read_b64_tr_b16 v[24:25], v4 offset:57344
  ds_read_b64_tr_b16 v[26:27], v4 offset:58368
  s_waitcnt lgkmcnt(6)
  v_mfma_f32_32x32x16_bf16 v[96:111], v[44:47], v[164:167], v[96:111]
  ds_read_b64_tr_b16 v[28:29], v5 offset:57344
  ds_read_b64_tr_b16 v[30:31], v5 offset:58368
  s_waitcnt vmcnt(4)
  s_barrier
  v_xor_b32 v248, 0, v240
  s_add_u32 m0, s66, 131072
  s_movk_i32 s67, 896
  buffer_load_dwordx4 v248, s[8:11], s67 offen lds
  v_xor_b32 v249, 64, v240
  s_add_u32 m0, s66, 132096
  s_movk_i32 s67, 9088
  buffer_load_dwordx4 v249, s[8:11], s67 offen lds
  v_xor_b32 v250, 0, v240
  s_add_u32 m0, s66, 133120
  s_movk_i32 s67, 17280
  buffer_load_dwordx4 v250, s[8:11], s67 offen lds
  v_xor_b32 v251, 64, v240
  s_add_u32 m0, s66, 134144
  s_movk_i32 s67, 25472
  buffer_load_dwordx4 v251, s[8:11], s67 offen lds
  s_add_u32 m0, s58, 98304
  s_mul_i32 s57, s52, 384
  s_add_u32 s57, s57, s53
  buffer_load_dwordx4 v10, s[12:15], s57 offen lds
  s_add_u32 m0, s58, 99328
  s_mul_i32 s57, s52, 388
  s_add_u32 s57, s57, s53
  buffer_load_dwordx4 v10, s[12:15], s57 offen lds
  s_add_u32 m0, s58, 100352
  s_mul_i32 s57, s52, 392
  s_add_u32 s57, s57, s53
  buffer_load_dwordx4 v10, s[12:15], s57 offen lds
  s_add_u32 m0, s58, 101376
  s_mul_i32 s57, s52, 396
  s_add_u32 s57, s57, s53
  buffer_load_dwordx4 v10, s[12:15], s57 offen lds
  s_waitcnt lgkmcnt(6)
  v_mfma_f32_32x32x16_bf16 v[48:63], v[16:19], v[168:171], v[48:63]
  ds_read_b64_tr_b16 v[32:33], v2 offset:59392
  ds_read_b64_tr_b16 v[34:35], v2 offset:60416
  s_waitcnt lgkmcnt(6)
  v_mfma_f32_32x32x16_bf16 v[64:79], v[20:23], v[168:171], v[64:79]
  ds_read_b64_tr_b16 v[36:37], v3 offset:59392
  ds_read_b64_tr_b16 v[38:39], v3 offset:60416
  s_waitcnt lgkmcnt(6)
  v_mfma_f32_32x32x16_bf16 v[80:95], v[24:27], v[168:171], v[80:95]
  ds_read_b64_tr_b16 v[40:41], v4 offset:59392
  ds_read_b64_tr_b16 v[42:43], v4 offset:60416
  s_waitcnt lgkmcnt(6)
  v_mfma_f32_32x32x16_bf16 v[96:111], v[28:31], v[168:171], v[96:111]
  ds_read_b64_tr_b16 v[44:45], v5 offset:59392
  ds_read_b64_tr_b16 v[46:47], v5 offset:60416
  s_waitcnt lgkmcnt(6)
  v_mfma_f32_32x32x16_bf16 v[48:63], v[32:35], v[172:175], v[48:63]
  ds_read_b64_tr_b16 v[16:17], v6 offset:0
  ds_read_b64_tr_b16 v[18:19], v6 offset:1024
  s_waitcnt lgkmcnt(6)
  v_mfma_f32_32x32x16_bf16 v[64:79], v[36:39], v[172:175], v[64:79]
  ds_read_b64_tr_b16 v[20:21], v7 offset:0
  ds_read_b64_tr_b16 v[22:23], v7 offset:1024
  s_waitcnt lgkmcnt(6)
  v_mfma_f32_32x32x16_bf16 v[80:95], v[40:43], v[172:175], v[80:95]
  ds_read_b64_tr_b16 v[24:25], v8 offset:0
  ds_read_b64_tr_b16 v[26:27], v8 offset:1024
  s_waitcnt lgkmcnt(6)
  v_mfma_f32_32x32x16_bf16 v[96:111], v[44:47], v[172:175], v[96:111]
  ds_read_b64_tr_b16 v[28:29], v9 offset:0
  ds_read_b64_tr_b16 v[30:31], v9 offset:1024
  s_barrier
  s_add_u32 m0, s58, 32768
  s_mul_i32 s57, s54, 128
  s_add_u32 s57, s57, s55
  buffer_load_dwordx4 v11, s[48:51], s57 offen lds
  s_add_u32 m0, s58, 33792
  s_mul_i32 s57, s54, 132
  s_add_u32 s57, s57, s55
  buffer_load_dwordx4 v11, s[48:51], s57 offen lds
  s_add_u32 m0, s58, 34816
  s_mul_i32 s57, s54, 136
  s_add_u32 s57, s57, s55
  buffer_load_dwordx4 v11, s[48:51], s57 offen lds
  s_add_u32 m0, s58, 35840
  s_mul_i32 s57, s54, 140
  s_add_u32 s57, s57, s55
  buffer_load_dwordx4 v11, s[48:51], s57 offen lds
  s_waitcnt lgkmcnt(6)
  v_mfma_f32_32x32x16_bf16 v[48:63], v[16:19], v[176:179], v[48:63]
  ds_read_b64_tr_b16 v[32:33], v6 offset:2048
  ds_read_b64_tr_b16 v[34:35], v6 offset:3072
  s_waitcnt lgkmcnt(6)
  v_mfma_f32_32x32x16_bf16 v[64:79], v[20:23], v[176:179], v[64:79]
  ds_read_b64_tr_b16 v[36:37], v7 offset:2048
  ds_read_b64_tr_b16 v[38:39], v7 offset:3072
  s_waitcnt lgkmcnt(6)
  v_mfma_f32_32x32x16_bf16 v[80:95], v[24:27], v[176:179], v[80:95]
  ds_read_b64_tr_b16 v[40:41], v8 offset:2048
  ds_read_b64_tr_b16 v[42:43], v8 offset:3072
  s_waitcnt lgkmcnt(6)
  v_mfma_f32_32x32x16_bf16 v[96:111], v[28:31], v[176:179], v[96:111]
  ds_read_b64_tr_b16 v[44:45], v9 offset:2048
  ds_read_b64_tr_b16 v[46:47], v9 offset:3072
  s_waitcnt vmcnt(12)
  v_xor_b32 v248, 0, v241
  ds_read_b128 v[208:211], v248 offset:0
  v_xor_b32 v249, 16, v241
  ds_read_b128 v[212:215], v249 offset:0
  v_xor_b32 v250, 64, v241
  ds_read_b128 v[216:219], v250 offset:0
  v_xor_b32 v251, 80, v241
  ds_read_b128 v[220:223], v251 offset:0
  s_waitcnt lgkmcnt(6)
  v_mfma_f32_32x32x16_bf16 v[48:63], v[32:35], v[180:183], v[48:63]
  ds_read_b64_tr_b16 v[16:17], v6 offset:8192
  ds_read_b64_tr_b16 v[18:19], v6 offset:9216
  s_waitcnt lgkmcnt(6)
  v_mfma_f32_32x32x16_bf16 v[64:79], v[36:39], v[180:183], v[64:79]
  ds_read_b64_tr_b16 v[20:21], v7 offset:8192
  ds_read_b64_tr_b16 v[22:23], v7 offset:9216
  s_waitcnt lgkmcnt(6)
  v_mfma_f32_32x32x16_bf16 v[80:95], v[40:43], v[180:183], v[80:95]
  ds_read_b64_tr_b16 v[24:25], v8 offset:8192
  ds_read_b64_tr_b16 v[26:27], v8 offset:9216
  s_waitcnt lgkmcnt(6)
  v_mfma_f32_32x32x16_bf16 v[96:111], v[44:47], v[180:183], v[96:111]
  ds_read_b64_tr_b16 v[28:29], v9 offset:8192
  ds_read_b64_tr_b16 v[30:31], v9 offset:9216
  s_waitcnt lgkmcnt(6)
  v_mfma_f32_32x32x16_bf16 v[48:63], v[16:19], v[184:187], v[48:63]
  ds_read_b64_tr_b16 v[32:33], v6 offset:10240
  ds_read_b64_tr_b16 v[34:35], v6 offset:11264
  s_waitcnt lgkmcnt(6)
  v_mfma_f32_32x32x16_bf16 v[64:79], v[20:23], v[184:187], v[64:79]
  ds_read_b64_tr_b16 v[36:37], v7 offset:10240
  ds_read_b64_tr_b16 v[38:39], v7 offset:11264
  s_waitcnt lgkmcnt(6)
  v_mfma_f32_32x32x16_bf16 v[80:95], v[24:27], v[184:187], v[80:95]
  ds_read_b64_tr_b16 v[40:41], v8 offset:10240
  ds_read_b64_tr_b16 v[42:43], v8 offset:11264
  s_waitcnt lgkmcnt(6)
  v_mfma_f32_32x32x16_bf16 v[96:111], v[28:31], v[184:187], v[96:111]
  ds_read_b64_tr_b16 v[44:45], v9 offset:10240
  ds_read_b64_tr_b16 v[46:47], v9 offset:11264
  s_waitcnt vmcnt(8)
  v_xor_b32 v248, 0, v243
  ds_read_b128 v[224:227], v248 offset:0
  v_xor_b32 v249, 16, v243
  ds_read_b128 v[228:231], v249 offset:0
  v_xor_b32 v250, 64, v243
  ds_read_b128 v[232:235], v250 offset:0
  v_xor_b32 v251, 80, v243
  ds_read_b128 v[236:239], v251 offset:0
  s_waitcnt lgkmcnt(6)
  v_mfma_f32_32x32x16_bf16 v[48:63], v[32:35], v[188:191], v[48:63]
  ds_read_b64_tr_b16 v[16:17], v6 offset:16384
  ds_read_b64_tr_b16 v[18:19], v6 offset:17408
  s_waitcnt lgkmcnt(6)
  v_mfma_f32_32x32x16_bf16 v[64:79], v[36:39], v[188:191], v[64:79]
  ds_read_b64_tr_b16 v[20:21], v7 offset:16384
  ds_read_b64_tr_b16 v[22:23], v7 offset:17408
  s_waitcnt lgkmcnt(6)
  v_mfma_f32_32x32x16_bf16 v[80:95], v[40:43], v[188:191], v[80:95]
  ds_read_b64_tr_b16 v[24:25], v8 offset:16384
  ds_read_b64_tr_b16 v[26:27], v8 offset:17408
  s_waitcnt lgkmcnt(6)
  v_mfma_f32_32x32x16_bf16 v[96:111], v[44:47], v[188:191], v[96:111]
  ds_read_b64_tr_b16 v[28:29], v9 offset:16384
  ds_read_b64_tr_b16 v[30:31], v9 offset:17408
  s_waitcnt lgkmcnt(6)
  v_mfma_f32_32x32x16_bf16 v[48:63], v[16:19], v[192:195], v[48:63]
  ds_read_b64_tr_b16 v[32:33], v6 offset:18432
  ds_read_b64_tr_b16 v[34:35], v6 offset:19456
  s_waitcnt lgkmcnt(6)
  v_mfma_f32_32x32x16_bf16 v[64:79], v[20:23], v[192:195], v[64:79]
  ds_read_b64_tr_b16 v[36:37], v7 offset:18432
  ds_read_b64_tr_b16 v[38:39], v7 offset:19456
  s_waitcnt lgkmcnt(6)
  v_mfma_f32_32x32x16_bf16 v[80:95], v[24:27], v[192:195], v[80:95]
  ds_read_b64_tr_b16 v[40:41], v8 offset:18432
  ds_read_b64_tr_b16 v[42:43], v8 offset:19456
  s_waitcnt lgkmcnt(6)
  v_mfma_f32_32x32x16_bf16 v[96:111], v[28:31], v[192:195], v[96:111]
  ds_read_b64_tr_b16 v[44:45], v9 offset:18432
  ds_read_b64_tr_b16 v[46:47], v9 offset:19456
  s_waitcnt lgkmcnt(6)
  v_mfma_f32_32x32x16_bf16 v[48:63], v[32:35], v[196:199], v[48:63]
  ds_read_b64_tr_b16 v[16:17], v6 offset:24576
  ds_read_b64_tr_b16 v[18:19], v6 offset:25600
  s_waitcnt lgkmcnt(6)
  v_mfma_f32_32x32x16_bf16 v[64:79], v[36:39], v[196:199], v[64:79]
  ds_read_b64_tr_b16 v[20:21], v7 offset:24576
  ds_read_b64_tr_b16 v[22:23], v7 offset:25600
  s_waitcnt lgkmcnt(6)
  v_mfma_f32_32x32x16_bf16 v[80:95], v[40:43], v[196:199], v[80:95]
  ds_read_b64_tr_b16 v[24:25], v8 offset:24576
  ds_read_b64_tr_b16 v[26:27], v8 offset:25600
  s_waitcnt lgkmcnt(6)
  v_mfma_f32_32x32x16_bf16 v[96:111], v[44:47], v[196:199], v[96:111]
  ds_read_b64_tr_b16 v[28:29], v9 offset:24576
  ds_read_b64_tr_b16 v[30:31], v9 offset:25600
  s_waitcnt vmcnt(4)
  s_barrier
  s_add_u32 m0, s58, 0
  s_mul_i32 s57, s54, 0
  s_add_u32 s57, s57, s55
  buffer_load_dwordx4 v11, s[48:51], s57 offen lds
  s_add_u32 m0, s58, 1024
  s_mul_i32 s57, s54, 4
  s_add_u32 s57, s57, s55
  buffer_load_dwordx4 v11, s[48:51], s57 offen lds
  s_add_u32 m0, s58, 2048
  s_mul_i32 s57, s54, 8
  s_add_u32 s57, s57, s55
  buffer_load_dwordx4 v11, s[48:51], s57 offen lds
  s_add_u32 m0, s58, 3072
  s_mul_i32 s57, s54, 12
  s_add_u32 s57, s57, s55
  buffer_load_dwordx4 v11, s[48:51], s57 offen lds
  s_waitcnt lgkmcnt(6)
  v_mfma_f32_32x32x16_bf16 v[48:63], v[16:19], v[200:203], v[48:63]
  ds_read_b64_tr_b16 v[32:33], v6 offset:26624
  ds_read_b64_tr_b16 v[34:35], v6 offset:27648
  s_waitcnt lgkmcnt(6)
  v_mfma_f32_32x32x16_bf16 v[64:79], v[20:23], v[200:203], v[64:79]
  ds_read_b64_tr_b16 v[36:37], v7 offset:26624
  ds_read_b64_tr_b16 v[38:39], v7 offset:27648
  s_waitcnt lgkmcnt(6)
  v_mfma_f32_32x32x16_bf16 v[80:95], v[24:27], v[200:203], v[80:95]
  ds_read_b64_tr_b16 v[40:41], v8 offset:26624
  ds_read_b64_tr_b16 v[42:43], v8 offset:27648
  s_waitcnt lgkmcnt(6)
  v_mfma_f32_32x32x16_bf16 v[96:111], v[28:31], v[200:203], v[96:111]
  ds_read_b64_tr_b16 v[44:45], v9 offset:26624
  ds_read_b64_tr_b16 v[46:47], v9 offset:27648
  s_waitcnt lgkmcnt(6)
  v_mfma_f32_32x32x16_bf16 v[48:63], v[32:35], v[204:207], v[48:63]
  ds_read_b64_tr_b16 v[16:17], v6 offset:32768
  ds_read_b64_tr_b16 v[18:19], v6 offset:33792
  s_waitcnt lgkmcnt(6)
  v_mfma_f32_32x32x16_bf16 v[64:79], v[36:39], v[204:207], v[64:79]
  ds_read_b64_tr_b16 v[20:21], v7 offset:32768
  ds_read_b64_tr_b16 v[22:23], v7 offset:33792
  s_waitcnt lgkmcnt(6)
  v_mfma_f32_32x32x16_bf16 v[80:95], v[40:43], v[204:207], v[80:95]
  ds_read_b64_tr_b16 v[24:25], v8 offset:32768
  ds_read_b64_tr_b16 v[26:27], v8 offset:33792
  s_waitcnt lgkmcnt(6)
  v_mfma_f32_32x32x16_bf16 v[96:111], v[44:47], v[204:207], v[96:111]
  ds_read_b64_tr_b16 v[28:29], v9 offset:32768
  ds_read_b64_tr_b16 v[30:31], v9 offset:33792
  s_barrier
  s_add_u32 m0, s58, 65536
  s_mul_i32 s57, s54, 256
  s_add_u32 s57, s57, s55
  buffer_load_dwordx4 v11, s[48:51], s57 offen lds
  s_add_u32 m0, s58, 66560
  s_mul_i32 s57, s54, 260
  s_add_u32 s57, s57, s55
  buffer_load_dwordx4 v11, s[48:51], s57 offen lds
  s_add_u32 m0, s58, 67584
  s_mul_i32 s57, s54, 264
  s_add_u32 s57, s57, s55
  buffer_load_dwordx4 v11, s[48:51], s57 offen lds
  s_add_u32 m0, s58, 68608
  s_mul_i32 s57, s54, 268
  s_add_u32 s57, s57, s55
  buffer_load_dwordx4 v11, s[48:51], s57 offen lds
  s_waitcnt lgkmcnt(6)
  v_mfma_f32_32x32x16_bf16 v[48:63], v[16:19], v[208:211], v[48:63]
  ds_read_b64_tr_b16 v[32:33], v6 offset:34816
  ds_read_b64_tr_b16 v[34:35], v6 offset:35840
  s_waitcnt lgkmcnt(6)
  v_mfma_f32_32x32x16_bf16 v[64:79], v[20:23], v[208:211], v[64:79]
  ds_read_b64_tr_b16 v[36:37], v7 offset:34816
  ds_read_b64_tr_b16 v[38:39], v7 offset:35840
  s_waitcnt lgkmcnt(6)
  v_mfma_f32_32x32x16_bf16 v[80:95], v[24:27], v[208:211], v[80:95]
  ds_read_b64_tr_b16 v[40:41], v8 offset:34816
  ds_read_b64_tr_b16 v[42:43], v8 offset:35840
  s_waitcnt lgkmcnt(6)
  v_mfma_f32_32x32x16_bf16 v[96:111], v[28:31], v[208:211], v[96:111]
  ds_read_b64_tr_b16 v[44:45], v9 offset:34816
  ds_read_b64_tr_b16 v[46:47], v9 offset:35840
  s_waitcnt lgkmcnt(6)
  v_mfma_f32_32x32x16_bf16 v[48:63], v[32:35], v[212:215], v[48:63]
  ds_read_b64_tr_b16 v[16:17], v6 offset:40960
  ds_read_b64_tr_b16 v[18:19], v6 offset:41984
  s_waitcnt lgkmcnt(6)
  v_mfma_f32_32x32x16_bf16 v[64:79], v[36:39], v[212:215], v[64:79]
  ds_read_b64_tr_b16 v[20:21], v7 offset:40960
  ds_read_b64_tr_b16 v[22:23], v7 offset:41984
  s_waitcnt lgkmcnt(6)
  v_mfma_f32_32x32x16_bf16 v[80:95], v[40:43], v[212:215], v[80:95]
  ds_read_b64_tr_b16 v[24:25], v8 offset:40960
  ds_read_b64_tr_b16 v[26:27], v8 offset:41984
  s_waitcnt lgkmcnt(6)
  v_mfma_f32_32x32x16_bf16 v[96:111], v[44:47], v[212:215], v[96:111]
  ds_read_b64_tr_b16 v[28:29], v9 offset:40960
  ds_read_b64_tr_b16 v[30:31], v9 offset:41984
  s_waitcnt lgkmcnt(6)
  v_mfma_f32_32x32x16_bf16 v[48:63], v[16:19], v[216:219], v[48:63]
  ds_read_b64_tr_b16 v[32:33], v6 offset:43008
  ds_read_b64_tr_b16 v[34:35], v6 offset:44032
  s_waitcnt lgkmcnt(6)
  v_mfma_f32_32x32x16_bf16 v[64:79], v[20:23], v[216:219], v[64:79]
  ds_read_b64_tr_b16 v[36:37], v7 offset:43008
  ds_read_b64_tr_b16 v[38:39], v7 offset:44032
  s_waitcnt lgkmcnt(6)
  v_mfma_f32_32x32x16_bf16 v[80:95], v[24:27], v[216:219], v[80:95]
  ds_read_b64_tr_b16 v[40:41], v8 offset:43008
  ds_read_b64_tr_b16 v[42:43], v8 offset:44032
  s_waitcnt lgkmcnt(6)
  v_mfma_f32_32x32x16_bf16 v[96:111], v[28:31], v[216:219], v[96:111]
  ds_read_b64_tr_b16 v[44:45], v9 offset:43008
  ds_read_b64_tr_b16 v[46:47], v9 offset:44032
  s_waitcnt lgkmcnt(6)
  v_mfma_f32_32x32x16_bf16 v[48:63], v[32:35], v[220:223], v[48:63]
  ds_read_b64_tr_b16 v[16:17], v6 offset:49152
  ds_read_b64_tr_b16 v[18:19], v6 offset:50176
  s_waitcnt lgkmcnt(6)
  v_mfma_f32_32x32x16_bf16 v[64:79], v[36:39], v[220:223], v[64:79]
  ds_read_b64_tr_b16 v[20:21], v7 offset:49152
  ds_read_b64_tr_b16 v[22:23], v7 offset:50176
  s_waitcnt lgkmcnt(6)
  v_mfma_f32_32x32x16_bf16 v[80:95], v[40:43], v[220:223], v[80:95]
  ds_read_b64_tr_b16 v[24:25], v8 offset:49152
  ds_read_b64_tr_b16 v[26:27], v8 offset:50176
  s_waitcnt lgkmcnt(6)
  v_mfma_f32_32x32x16_bf16 v[96:111], v[44:47], v[220:223], v[96:111]
  ds_read_b64_tr_b16 v[28:29], v9 offset:49152
  ds_read_b64_tr_b16 v[30:31], v9 offset:50176
  s_waitcnt lgkmcnt(6)
  v_mfma_f32_32x32x16_bf16 v[48:63], v[16:19], v[224:227], v[48:63]
  ds_read_b64_tr_b16 v[32:33], v6 offset:51200
  ds_read_b64_tr_b16 v[34:35], v6 offset:52224
  s_waitcnt lgkmcnt(6)
  v_mfma_f32_32x32x16_bf16 v[64:79], v[20:23], v[224:227], v[64:79]
  ds_read_b64_tr_b16 v[36:37], v7 offset:51200
  ds_read_b64_tr_b16 v[38:39], v7 offset:52224
  s_waitcnt lgkmcnt(6)
  v_mfma_f32_32x32x16_bf16 v[80:95], v[24:27], v[224:227], v[80:95]
  ds_read_b64_tr_b16 v[40:41], v8 offset:51200
  ds_read_b64_tr_b16 v[42:43], v8 offset:52224
  s_waitcnt lgkmcnt(6)
  v_mfma_f32_32x32x16_bf16 v[96:111], v[28:31], v[224:227], v[96:111]
  ds_read_b64_tr_b16 v[44:45], v9 offset:51200
  ds_read_b64_tr_b16 v[46:47], v9 offset:52224
  s_waitcnt lgkmcnt(6)
  v_mfma_f32_32x32x16_bf16 v[48:63], v[32:35], v[228:231], v[48:63]
  ds_read_b64_tr_b16 v[16:17], v6 offset:57344
  ds_read_b64_tr_b16 v[18:19], v6 offset:58368
  s_waitcnt lgkmcnt(6)
  v_mfma_f32_32x32x16_bf16 v[64:79], v[36:39], v[228:231], v[64:79]
  ds_read_b64_tr_b16 v[20:21], v7 offset:57344
  ds_read_b64_tr_b16 v[22:23], v7 offset:58368
  s_waitcnt lgkmcnt(6)
  v_mfma_f32_32x32x16_bf16 v[80:95], v[40:43], v[228:231], v[80:95]
  ds_read_b64_tr_b16 v[24:25], v8 offset:57344
  ds_read_b64_tr_b16 v[26:27], v8 offset:58368
  s_waitcnt lgkmcnt(6)
  v_mfma_f32_32x32x16_bf16 v[96:111], v[44:47], v[228:231], v[96:111]
  ds_read_b64_tr_b16 v[28:29], v9 offset:57344
  ds_read_b64_tr_b16 v[30:31], v9 offset:58368
  s_waitcnt lgkmcnt(6)
  v_mfma_f32_32x32x16_bf16 v[48:63], v[16:19], v[232:235], v[48:63]
  ds_read_b64_tr_b16 v[32:33], v6 offset:59392
  ds_read_b64_tr_b16 v[34:35], v6 offset:60416
  s_waitcnt lgkmcnt(6)
  v_mfma_f32_32x32x16_bf16 v[64:79], v[20:23], v[232:235], v[64:79]
  ds_read_b64_tr_b16 v[36:37], v7 offset:59392
  ds_read_b64_tr_b16 v[38:39], v7 offset:60416
  s_waitcnt lgkmcnt(6)
  v_mfma_f32_32x32x16_bf16 v[80:95], v[24:27], v[232:235], v[80:95]
  ds_read_b64_tr_b16 v[40:41], v8 offset:59392
  ds_read_b64_tr_b16 v[42:43], v8 offset:60416
  s_waitcnt lgkmcnt(6)
  v_mfma_f32_32x32x16_bf16 v[96:111], v[28:31], v[232:235], v[96:111]
  ds_read_b64_tr_b16 v[44:45], v9 offset:59392
  ds_read_b64_tr_b16 v[46:47], v9 offset:60416
  s_waitcnt vmcnt(4)
  s_barrier
  s_waitcnt lgkmcnt(6)
  v_mfma_f32_32x32x16_bf16 v[48:63], v[32:35], v[236:239], v[48:63]
  ds_read_b64_tr_b16 v[16:17], v2 offset:0
  ds_read_b64_tr_b16 v[18:19], v2 offset:1024
  s_waitcnt lgkmcnt(6)
  v_mfma_f32_32x32x16_bf16 v[64:79], v[36:39], v[236:239], v[64:79]
  ds_read_b64_tr_b16 v[20:21], v2 offset:2048
  ds_read_b64_tr_b16 v[22:23], v2 offset:3072
  s_waitcnt lgkmcnt(6)
  v_mfma_f32_32x32x16_bf16 v[80:95], v[40:43], v[236:239], v[80:95]
  ds_read_b64_tr_b16 v[24:25], v2 offset:8192
  ds_read_b64_tr_b16 v[26:27], v2 offset:9216
  s_waitcnt lgkmcnt(6)
  v_mfma_f32_32x32x16_bf16 v[96:111], v[44:47], v[236:239], v[96:111]
  ds_read_b64_tr_b16 v[28:29], v2 offset:10240
  ds_read_b64_tr_b16 v[30:31], v2 offset:11264
  s_mov_b32 s12, s48
  s_mov_b32 s13, s49
  s_mov_b32 s14, s50
  s_mov_b32 s52, s54
  s_mov_b32 s53, s55
  v_mov_b32 v10, v11
  s_mov_b32 s90, s56
  s_add_u32 s91, s56, 4096
  s_mov_b32 s48, s32
  s_mov_b32 s49, s33
  s_mov_b32 s50, 0x400000
  s_mov_b32 s54, 8192
  s_mov_b32 s55, s61
  v_mul_lo_u32 v11, v13, s54
  v_add_u32 v11, v11, v14
  s_add_u32 s56, s64, 0x1000000
  s_waitcnt vmcnt(4)
  s_barrier
  v_cvt_pk_bf16_f32 v48, v48, v49
  v_cvt_pk_bf16_f32 v49, v50, v51
  v_cvt_pk_bf16_f32 v50, v52, v53
  v_cvt_pk_bf16_f32 v51, v54, v55
  buffer_store_dwordx4 v[48:51], v12, s[16:19], s90 offen offset:0 sc1
  v_cvt_pk_bf16_f32 v56, v56, v57
  v_cvt_pk_bf16_f32 v57, v58, v59
  v_cvt_pk_bf16_f32 v58, v60, v61
  v_cvt_pk_bf16_f32 v59, v62, v63
  buffer_store_dwordx4 v[56:59], v12, s[16:19], s90 offen offset:1024 sc1
  s_nop 1
  s_waitcnt lgkmcnt(6)
  v_mfma_f32_32x32x16_bf16 v[48:63], v[16:19], v[112:115], 0
  ds_read_b64_tr_b16 v[32:33], v3 offset:0
  ds_read_b64_tr_b16 v[34:35], v3 offset:1024
  s_waitcnt lgkmcnt(6)
  v_mfma_f32_32x32x16_bf16 v[48:63], v[20:23], v[116:119], v[48:63]
  ds_read_b64_tr_b16 v[36:37], v3 offset:2048
  ds_read_b64_tr_b16 v[38:39], v3 offset:3072
  s_waitcnt lgkmcnt(6)
  v_mfma_f32_32x32x16_bf16 v[48:63], v[24:27], v[120:123], v[48:63]
  ds_read_b64_tr_b16 v[40:41], v3 offset:8192
  ds_read_b64_tr_b16 v[42:43], v3 offset:9216
  s_waitcnt lgkmcnt(6)
  v_mfma_f32_32x32x16_bf16 v[48:63], v[28:31], v[124:127], v[48:63]
  ds_read_b64_tr_b16 v[44:45], v3 offset:10240
  ds_read_b64_tr_b16 v[46:47], v3 offset:11264
  v_cvt_pk_bf16_f32 v64, v64, v65
  v_cvt_pk_bf16_f32 v65, v66, v67
  v_cvt_pk_bf16_f32 v66, v68, v69
  v_cvt_pk_bf16_f32 v67, v70, v71
  buffer_store_dwordx4 v[64:67], v12, s[16:19], s90 offen offset:2048 sc1
  v_cvt_pk_bf16_f32 v72, v72, v73
  v_cvt_pk_bf16_f32 v73, v74, v75
  v_cvt_pk_bf16_f32 v74, v76, v77
  v_cvt_pk_bf16_f32 v75, v78, v79
  buffer_store_dwordx4 v[72:75], v12, s[16:19], s90 offen offset:3072 sc1
  s_nop 1
  s_waitcnt lgkmcnt(6)
  v_mfma_f32_32x32x16_bf16 v[64:79], v[32:35], v[112:115], 0
  ds_read_b64_tr_b16 v[16:17], v4 offset:0
  ds_read_b64_tr_b16 v[18:19], v4 offset:1024
  s_add_u32 m0, s58, 98304
  s_mul_i32 s57, s52, 384
  s_add_u32 s57, s57, s53
  buffer_load_dwordx4 v10, s[12:15], s57 offen lds
  s_waitcnt lgkmcnt(6)
  v_mfma_f32_32x32x16_bf16 v[64:79], v[36:39], v[116:119], v[64:79]
  ds_read_b64_tr_b16 v[20:21], v4 offset:2048
  ds_read_b64_tr_b16 v[22:23], v4 offset:3072
  s_waitcnt lgkmcnt(6)
  v_mfma_f32_32x32x16_bf16 v[64:79], v[40:43], v[120:123], v[64:79]
  ds_read_b64_tr_b16 v[24:25], v4 offset:8192
  ds_read_b64_tr_b16 v[26:27], v4 offset:9216
  s_waitcnt lgkmcnt(6)
  v_mfma_f32_32x32x16_bf16 v[64:79], v[44:47], v[124:127], v[64:79]
  ds_read_b64_tr_b16 v[28:29], v4 offset:10240
  ds_read_b64_tr_b16 v[30:31], v4 offset:11264
  v_cvt_pk_bf16_f32 v80, v80, v81
  v_cvt_pk_bf16_f32 v81, v82, v83
  v_cvt_pk_bf16_f32 v82, v84, v85
  v_cvt_pk_bf16_f32 v83, v86, v87
  buffer_store_dwordx4 v[80:83], v12, s[16:19], s91 offen offset:0 sc1
  v_cvt_pk_bf16_f32 v88, v88, v89
  v_cvt_pk_bf16_f32 v89, v90, v91
  v_cvt_pk_bf16_f32 v90, v92, v93
  v_cvt_pk_bf16_f32 v91, v94, v95
  buffer_store_dwordx4 v[88:91], v12, s[16:19], s91 offen offset:1024 sc1
  s_nop 1
  s_waitcnt lgkmcnt(6)
  v_mfma_f32_32x32x16_bf16 v[80:95], v[16:19], v[112:115], 0
  ds_read_b64_tr_b16 v[32:33], v5 offset:0
  ds_read_b64_tr_b16 v[34:35], v5 offset:1024
  s_waitcnt lgkmcnt(6)
  v_mfma_f32_32x32x16_bf16 v[80:95], v[20:23], v[116:119], v[80:95]
  ds_read_b64_tr_b16 v[36:37], v5 offset:2048
  ds_read_b64_tr_b16 v[38:39], v5 offset:3072
  s_waitcnt lgkmcnt(6)
  v_mfma_f32_32x32x16_bf16 v[80:95], v[24:27], v[120:123], v[80:95]
  ds_read_b64_tr_b16 v[40:41], v5 offset:8192
  ds_read_b64_tr_b16 v[42:43], v5 offset:9216
  s_waitcnt lgkmcnt(6)
  v_mfma_f32_32x32x16_bf16 v[80:95], v[28:31], v[124:127], v[80:95]
  ds_read_b64_tr_b16 v[44:45], v5 offset:10240
  ds_read_b64_tr_b16 v[46:47], v5 offset:11264
  v_cvt_pk_bf16_f32 v96, v96, v97
  v_cvt_pk_bf16_f32 v97, v98, v99
  v_cvt_pk_bf16_f32 v98, v100, v101
  v_cvt_pk_bf16_f32 v99, v102, v103
  buffer_store_dwordx4 v[96:99], v12, s[16:19], s91 offen offset:2048 sc1
  v_cvt_pk_bf16_f32 v104, v104, v105
  v_cvt_pk_bf16_f32 v105, v106, v107
  v_cvt_pk_bf16_f32 v106, v108, v109
  v_cvt_pk_bf16_f32 v107, v110, v111
  buffer_store_dwordx4 v[104:107], v12, s[16:19], s91 offen offset:3072 sc1
  s_nop 1
  s_waitcnt lgkmcnt(6)
  v_mfma_f32_32x32x16_bf16 v[96:111], v[32:35], v[112:115], 0
  ds_read_b64_tr_b16 v[16:17], v2 offset:16384
  ds_read_b64_tr_b16 v[18:19], v2 offset:17408
  s_add_u32 m0, s58, 99328
  s_mul_i32 s57, s52, 388
  s_add_u32 s57, s57, s53
  buffer_load_dwordx4 v10, s[12:15], s57 offen lds
  s_waitcnt lgkmcnt(6)
  v_mfma_f32_32x32x16_bf16 v[96:111], v[36:39], v[116:119], v[96:111]
  ds_read_b64_tr_b16 v[20:21], v3 offset:16384
  ds_read_b64_tr_b16 v[22:23], v3 offset:17408
  s_waitcnt lgkmcnt(6)
  v_mfma_f32_32x32x16_bf16 v[96:111], v[40:43], v[120:123], v[96:111]
  ds_read_b64_tr_b16 v[24:25], v4 offset:16384
  ds_read_b64_tr_b16 v[26:27], v4 offset:17408
  s_waitcnt lgkmcnt(6)
  v_mfma_f32_32x32x16_bf16 v[96:111], v[44:47], v[124:127], v[96:111]
  ds_read_b64_tr_b16 v[28:29], v5 offset:16384
  ds_read_b64_tr_b16 v[30:31], v5 offset:17408
  s_waitcnt lgkmcnt(6)
  v_mfma_f32_32x32x16_bf16 v[48:63], v[16:19], v[128:131], v[48:63]
  ds_read_b64_tr_b16 v[32:33], v2 offset:18432
  ds_read_b64_tr_b16 v[34:35], v2 offset:19456
  s_waitcnt lgkmcnt(6)
  v_mfma_f32_32x32x16_bf16 v[64:79], v[20:23], v[128:131], v[64:79]
  ds_read_b64_tr_b16 v[36:37], v3 offset:18432
  ds_read_b64_tr_b16 v[38:39], v3 offset:19456
  s_waitcnt lgkmcnt(6)
  v_mfma_f32_32x32x16_bf16 v[80:95], v[24:27], v[128:131], v[80:95]
  ds_read_b64_tr_b16 v[40:41], v4 offset:18432
  ds_read_b64_tr_b16 v[42:43], v4 offset:19456
  s_waitcnt lgkmcnt(6)
  v_mfma_f32_32x32x16_bf16 v[96:111], v[28:31], v[128:131], v[96:111]
  ds_read_b64_tr_b16 v[44:45], v5 offset:18432
  ds_read_b64_tr_b16 v[46:47], v5 offset:19456
  s_waitcnt lgkmcnt(6)
  v_mfma_f32_32x32x16_bf16 v[48:63], v[32:35], v[132:135], v[48:63]
  ds_read_b64_tr_b16 v[16:17], v2 offset:24576
  ds_read_b64_tr_b16 v[18:19], v2 offset:25600
  s_add_u32 m0, s58, 100352
  s_mul_i32 s57, s52, 392
  s_add_u32 s57, s57, s53
  buffer_load_dwordx4 v10, s[12:15], s57 offen lds
  s_waitcnt lgkmcnt(6)
  v_mfma_f32_32x32x16_bf16 v[64:79], v[36:39], v[132:135], v[64:79]
  ds_read_b64_tr_b16 v[20:21], v3 offset:24576
  ds_read_b64_tr_b16 v[22:23], v3 offset:25600
  s_waitcnt lgkmcnt(6)
  v_mfma_f32_32x32x16_bf16 v[80:95], v[40:43], v[132:135], v[80:95]
  ds_read_b64_tr_b16 v[24:25], v4 offset:24576
  ds_read_b64_tr_b16 v[26:27], v4 offset:25600
  s_waitcnt lgkmcnt(6)
  v_mfma_f32_32x32x16_bf16 v[96:111], v[44:47], v[132:135], v[96:111]
  ds_read_b64_tr_b16 v[28:29], v5 offset:24576
  ds_read_b64_tr_b16 v[30:31], v5 offset:25600
  s_waitcnt lgkmcnt(6)
  v_mfma_f32_32x32x16_bf16 v[48:63], v[16:19], v[136:139], v[48:63]
  ds_read_b64_tr_b16 v[32:33], v2 offset:26624
  ds_read_b64_tr_b16 v[34:35], v2 offset:27648
  s_waitcnt lgkmcnt(6)
  v_mfma_f32_32x32x16_bf16 v[64:79], v[20:23], v[136:139], v[64:79]
  ds_read_b64_tr_b16 v[36:37], v3 offset:26624
  ds_read_b64_tr_b16 v[38:39], v3 offset:27648
  s_waitcnt lgkmcnt(6)
  v_mfma_f32_32x32x16_bf16 v[80:95], v[24:27], v[136:139], v[80:95]
  ds_read_b64_tr_b16 v[40:41], v4 offset:26624
  ds_read_b64_tr_b16 v[42:43], v4 offset:27648
  s_waitcnt lgkmcnt(6)
  v_mfma_f32_32x32x16_bf16 v[96:111], v[28:31], v[136:139], v[96:111]
  ds_read_b64_tr_b16 v[44:45], v5 offset:26624
  ds_read_b64_tr_b16 v[46:47], v5 offset:27648
  s_waitcnt lgkmcnt(6)
  v_mfma_f32_32x32x16_bf16 v[48:63], v[32:35], v[140:143], v[48:63]
  ds_read_b64_tr_b16 v[16:17], v2 offset:32768
  ds_read_b64_tr_b16 v[18:19], v2 offset:33792
  s_add_u32 m0, s58, 101376
  s_mul_i32 s57, s52, 396
  s_add_u32 s57, s57, s53
  buffer_load_dwordx4 v10, s[12:15], s57 offen lds
  s_waitcnt lgkmcnt(6)
  v_mfma_f32_32x32x16_bf16 v[64:79], v[36:39], v[140:143], v[64:79]
  ds_read_b64_tr_b16 v[20:21], v3 offset:32768
  ds_read_b64_tr_b16 v[22:23], v3 offset:33792
  s_waitcnt lgkmcnt(6)
  v_mfma_f32_32x32x16_bf16 v[80:95], v[40:43], v[140:143], v[80:95]
  ds_read_b64_tr_b16 v[24:25], v4 offset:32768
  ds_read_b64_tr_b16 v[26:27], v4 offset:33792
  s_waitcnt lgkmcnt(6)
  v_mfma_f32_32x32x16_bf16 v[96:111], v[44:47], v[140:143], v[96:111]
  ds_read_b64_tr_b16 v[28:29], v5 offset:32768
  ds_read_b64_tr_b16 v[30:31], v5 offset:33792
  s_waitcnt vmcnt(12)
  s_barrier
  s_waitcnt lgkmcnt(6)
  v_mfma_f32_32x32x16_bf16 v[48:63], v[16:19], v[144:147], v[48:63]
  ds_read_b64_tr_b16 v[32:33], v2 offset:34816
  ds_read_b64_tr_b16 v[34:35], v2 offset:35840
  s_waitcnt lgkmcnt(6)
  v_mfma_f32_32x32x16_bf16 v[64:79], v[20:23], v[144:147], v[64:79]
  ds_read_b64_tr_b16 v[36:37], v3 offset:34816
  ds_read_b64_tr_b16 v[38:39], v3 offset:35840
  s_waitcnt lgkmcnt(6)
  v_mfma_f32_32x32x16_bf16 v[80:95], v[24:27], v[144:147], v[80:95]
  ds_read_b64_tr_b16 v[40:41], v4 offset:34816
  ds_read_b64_tr_b16 v[42:43], v4 offset:35840
  s_waitcnt lgkmcnt(6)
  v_mfma_f32_32x32x16_bf16 v[96:111], v[28:31], v[144:147], v[96:111]
  ds_read_b64_tr_b16 v[44:45], v5 offset:34816
  ds_read_b64_tr_b16 v[46:47], v5 offset:35840
  s_waitcnt lgkmcnt(6)
  v_mfma_f32_32x32x16_bf16 v[48:63], v[32:35], v[148:151], v[48:63]
  ds_read_b64_tr_b16 v[16:17], v2 offset:40960
  ds_read_b64_tr_b16 v[18:19], v2 offset:41984
  s_add_u32 m0, s58, 0
  s_mul_i32 s57, s54, 0
  s_add_u32 s57, s57, s55
  buffer_load_dwordx4 v11, s[48:51], s57 offen lds
  s_waitcnt lgkmcnt(6)
  v_mfma_f32_32x32x16_bf16 v[64:79], v[36:39], v[148:151], v[64:79]
  ds_read_b64_tr_b16 v[20:21], v3 offset:40960
  ds_read_b64_tr_b16 v[22:23], v3 offset:41984
  s_waitcnt lgkmcnt(6)
  v_mfma_f32_32x32x16_bf16 v[80:95], v[40:43], v[148:151], v[80:95]
  ds_read_b64_tr_b16 v[24:25], v4 offset:40960
  ds_read_b64_tr_b16 v[26:27], v4 offset:41984
  s_waitcnt lgkmcnt(6)
  v_mfma_f32_32x32x16_bf16 v[96:111], v[44:47], v[148:151], v[96:111]
  ds_read_b64_tr_b16 v[28:29], v5 offset:40960
  ds_read_b64_tr_b16 v[30:31], v5 offset:41984
  s_waitcnt lgkmcnt(6)
  v_mfma_f32_32x32x16_bf16 v[48:63], v[16:19], v[152:155], v[48:63]
  ds_read_b64_tr_b16 v[32:33], v2 offset:43008
  ds_read_b64_tr_b16 v[34:35], v2 offset:44032
  s_waitcnt lgkmcnt(6)
  v_mfma_f32_32x32x16_bf16 v[64:79], v[20:23], v[152:155], v[64:79]
  ds_read_b64_tr_b16 v[36:37], v3 offset:43008
  ds_read_b64_tr_b16 v[38:39], v3 offset:44032
  s_waitcnt lgkmcnt(6)
  v_mfma_f32_32x32x16_bf16 v[80:95], v[24:27], v[152:155], v[80:95]
  ds_read_b64_tr_b16 v[40:41], v4 offset:43008
  ds_read_b64_tr_b16 v[42:43], v4 offset:44032
  s_waitcnt lgkmcnt(6)
  v_mfma_f32_32x32x16_bf16 v[96:111], v[28:31], v[152:155], v[96:111]
  ds_read_b64_tr_b16 v[44:45], v5 offset:43008
  ds_read_b64_tr_b16 v[46:47], v5 offset:44032
  s_waitcnt lgkmcnt(6)
  v_mfma_f32_32x32x16_bf16 v[48:63], v[32:35], v[156:159], v[48:63]
  ds_read_b64_tr_b16 v[16:17], v2 offset:49152
  ds_read_b64_tr_b16 v[18:19], v2 offset:50176
  s_add_u32 m0, s58, 1024
  s_mul_i32 s57, s54, 4
  s_add_u32 s57, s57, s55
  buffer_load_dwordx4 v11, s[48:51], s57 offen lds
  s_waitcnt lgkmcnt(6)
  v_mfma_f32_32x32x16_bf16 v[64:79], v[36:39], v[156:159], v[64:79]
  ds_read_b64_tr_b16 v[20:21], v3 offset:49152
  ds_read_b64_tr_b16 v[22:23], v3 offset:50176
  s_waitcnt lgkmcnt(6)
  v_mfma_f32_32x32x16_bf16 v[80:95], v[40:43], v[156:159], v[80:95]
  ds_read_b64_tr_b16 v[24:25], v4 offset:49152
  ds_read_b64_tr_b16 v[26:27], v4 offset:50176
  s_waitcnt lgkmcnt(6)
  v_mfma_f32_32x32x16_bf16 v[96:111], v[44:47], v[156:159], v[96:111]
  ds_read_b64_tr_b16 v[28:29], v5 offset:49152
  ds_read_b64_tr_b16 v[30:31], v5 offset:50176
  s_waitcnt lgkmcnt(6)
  v_mfma_f32_32x32x16_bf16 v[48:63], v[16:19], v[160:163], v[48:63]
  ds_read_b64_tr_b16 v[32:33], v2 offset:51200
  ds_read_b64_tr_b16 v[34:35], v2 offset:52224
  s_waitcnt lgkmcnt(6)
  v_mfma_f32_32x32x16_bf16 v[64:79], v[20:23], v[160:163], v[64:79]
  ds_read_b64_tr_b16 v[36:37], v3 offset:51200
  ds_read_b64_tr_b16 v[38:39], v3 offset:52224
  s_waitcnt lgkmcnt(6)
  v_mfma_f32_32x32x16_bf16 v[80:95], v[24:27], v[160:163], v[80:95]
  ds_read_b64_tr_b16 v[40:41], v4 offset:51200
  ds_read_b64_tr_b16 v[42:43], v4 offset:52224
  s_waitcnt lgkmcnt(6)
  v_mfma_f32_32x32x16_bf16 v[96:111], v[28:31], v[160:163], v[96:111]
  ds_read_b64_tr_b16 v[44:45], v5 offset:51200
  ds_read_b64_tr_b16 v[46:47], v5 offset:52224
  s_waitcnt lgkmcnt(6)
  v_mfma_f32_32x32x16_bf16 v[48:63], v[32:35], v[164:167], v[48:63]
  ds_read_b64_tr_b16 v[16:17], v2 offset:57344
  ds_read_b64_tr_b16 v[18:19], v2 offset:58368
  s_add_u32 m0, s58, 2048
  s_mul_i32 s57, s54, 8
  s_add_u32 s57, s57, s55
  buffer_load_dwordx4 v11, s[48:51], s57 offen lds
  s_waitcnt lgkmcnt(6)
  v_mfma_f32_32x32x16_bf16 v[64:79], v[36:39], v[164:167], v[64:79]
  ds_read_b64_tr_b16 v[20:21], v3 offset:57344
  ds_read_b64_tr_b16 v[22:23], v3 offset:58368
  s_waitcnt lgkmcnt(6)
  v_mfma_f32_32x32x16_bf16 v[80:95], v[40:43], v[164:167], v[80:95]
  ds_read_b64_tr_b16 v[24:25], v4 offset:57344
  ds_read_b64_tr_b16 v[26:27], v4 offset:58368
  s_waitcnt lgkmcnt(6)
  v_mfma_f32_32x32x16_bf16 v[96:111], v[44:47], v[164:167], v[96:111]
  ds_read_b64_tr_b16 v[28:29], v5 offset:57344
  ds_read_b64_tr_b16 v[30:31], v5 offset:58368
  s_waitcnt lgkmcnt(6)
  v_mfma_f32_32x32x16_bf16 v[48:63], v[16:19], v[168:171], v[48:63]
  ds_read_b64_tr_b16 v[32:33], v2 offset:59392
  ds_read_b64_tr_b16 v[34:35], v2 offset:60416
  s_waitcnt lgkmcnt(6)
  v_mfma_f32_32x32x16_bf16 v[64:79], v[20:23], v[168:171], v[64:79]
  ds_read_b64_tr_b16 v[36:37], v3 offset:59392
  ds_read_b64_tr_b16 v[38:39], v3 offset:60416
  s_waitcnt lgkmcnt(6)
  v_mfma_f32_32x32x16_bf16 v[80:95], v[24:27], v[168:171], v[80:95]
  ds_read_b64_tr_b16 v[40:41], v4 offset:59392
  ds_read_b64_tr_b16 v[42:43], v4 offset:60416
  s_waitcnt lgkmcnt(6)
  v_mfma_f32_32x32x16_bf16 v[96:111], v[28:31], v[168:171], v[96:111]
  ds_read_b64_tr_b16 v[44:45], v5 offset:59392
  ds_read_b64_tr_b16 v[46:47], v5 offset:60416
  s_waitcnt lgkmcnt(6)
  v_mfma_f32_32x32x16_bf16 v[48:63], v[32:35], v[172:175], v[48:63]
  ds_read_b64_tr_b16 v[16:17], v6 offset:0
  ds_read_b64_tr_b16 v[18:19], v6 offset:1024
  s_add_u32 m0, s58, 3072
  s_mul_i32 s57, s54, 12
  s_add_u32 s57, s57, s55
  buffer_load_dwordx4 v11, s[48:51], s57 offen lds
  s_waitcnt lgkmcnt(6)
  v_mfma_f32_32x32x16_bf16 v[64:79], v[36:39], v[172:175], v[64:79]
  ds_read_b64_tr_b16 v[20:21], v7 offset:0
  ds_read_b64_tr_b16 v[22:23], v7 offset:1024
  s_waitcnt lgkmcnt(6)
  v_mfma_f32_32x32x16_bf16 v[80:95], v[40:43], v[172:175], v[80:95]
  ds_read_b64_tr_b16 v[24:25], v8 offset:0
  ds_read_b64_tr_b16 v[26:27], v8 offset:1024
  s_waitcnt lgkmcnt(6)
  v_mfma_f32_32x32x16_bf16 v[96:111], v[44:47], v[172:175], v[96:111]
  ds_read_b64_tr_b16 v[28:29], v9 offset:0
  ds_read_b64_tr_b16 v[30:31], v9 offset:1024
  s_waitcnt vmcnt(4)
  s_barrier
  s_waitcnt lgkmcnt(6)
  v_mfma_f32_32x32x16_bf16 v[48:63], v[16:19], v[176:179], v[48:63]
  ds_read_b64_tr_b16 v[32:33], v6 offset:2048
  ds_read_b64_tr_b16 v[34:35], v6 offset:3072
  s_waitcnt lgkmcnt(6)
  v_mfma_f32_32x32x16_bf16 v[64:79], v[20:23], v[176:179], v[64:79]
  ds_read_b64_tr_b16 v[36:37], v7 offset:2048
  ds_read_b64_tr_b16 v[38:39], v7 offset:3072
  s_waitcnt lgkmcnt(6)
  v_mfma_f32_32x32x16_bf16 v[80:95], v[24:27], v[176:179], v[80:95]
  ds_read_b64_tr_b16 v[40:41], v8 offset:2048
  ds_read_b64_tr_b16 v[42:43], v8 offset:3072
  s_waitcnt lgkmcnt(6)
  v_mfma_f32_32x32x16_bf16 v[96:111], v[28:31], v[176:179], v[96:111]
  ds_read_b64_tr_b16 v[44:45], v9 offset:2048
  ds_read_b64_tr_b16 v[46:47], v9 offset:3072
  s_waitcnt lgkmcnt(6)
  v_mfma_f32_32x32x16_bf16 v[48:63], v[32:35], v[180:183], v[48:63]
  ds_read_b64_tr_b16 v[16:17], v6 offset:8192
  ds_read_b64_tr_b16 v[18:19], v6 offset:9216
  s_add_u32 m0, s58, 32768
  s_mul_i32 s57, s54, 128
  s_add_u32 s57, s57, s55
  buffer_load_dwordx4 v11, s[48:51], s57 offen lds
  s_waitcnt lgkmcnt(6)
  v_mfma_f32_32x32x16_bf16 v[64:79], v[36:39], v[180:183], v[64:79]
  ds_read_b64_tr_b16 v[20:21], v7 offset:8192
  ds_read_b64_tr_b16 v[22:23], v7 offset:9216
  s_waitcnt lgkmcnt(6)
  v_mfma_f32_32x32x16_bf16 v[80:95], v[40:43], v[180:183], v[80:95]
  ds_read_b64_tr_b16 v[24:25], v8 offset:8192
  ds_read_b64_tr_b16 v[26:27], v8 offset:9216
  s_waitcnt lgkmcnt(6)
  v_mfma_f32_32x32x16_bf16 v[96:111], v[44:47], v[180:183], v[96:111]
  ds_read_b64_tr_b16 v[28:29], v9 offset:8192
  ds_read_b64_tr_b16 v[30:31], v9 offset:9216
  s_waitcnt lgkmcnt(6)
  v_mfma_f32_32x32x16_bf16 v[48:63], v[16:19], v[184:187], v[48:63]
  ds_read_b64_tr_b16 v[32:33], v6 offset:10240
  ds_read_b64_tr_b16 v[34:35], v6 offset:11264
  s_waitcnt lgkmcnt(6)
  v_mfma_f32_32x32x16_bf16 v[64:79], v[20:23], v[184:187], v[64:79]
  ds_read_b64_tr_b16 v[36:37], v7 offset:10240
  ds_read_b64_tr_b16 v[38:39], v7 offset:11264
  s_waitcnt lgkmcnt(6)
  v_mfma_f32_32x32x16_bf16 v[80:95], v[24:27], v[184:187], v[80:95]
  ds_read_b64_tr_b16 v[40:41], v8 offset:10240
  ds_read_b64_tr_b16 v[42:43], v8 offset:11264
  s_waitcnt lgkmcnt(6)
  v_mfma_f32_32x32x16_bf16 v[96:111], v[28:31], v[184:187], v[96:111]
  ds_read_b64_tr_b16 v[44:45], v9 offset:10240
  ds_read_b64_tr_b16 v[46:47], v9 offset:11264
  s_waitcnt lgkmcnt(6)
  v_mfma_f32_32x32x16_bf16 v[48:63], v[32:35], v[188:191], v[48:63]
  ds_read_b64_tr_b16 v[16:17], v6 offset:16384
  ds_read_b64_tr_b16 v[18:19], v6 offset:17408
  s_add_u32 m0, s58, 33792
  s_mul_i32 s57, s54, 132
  s_add_u32 s57, s57, s55
  buffer_load_dwordx4 v11, s[48:51], s57 offen lds
  s_waitcnt lgkmcnt(6)
  v_mfma_f32_32x32x16_bf16 v[64:79], v[36:39], v[188:191], v[64:79]
  ds_read_b64_tr_b16 v[20:21], v7 offset:16384
  ds_read_b64_tr_b16 v[22:23], v7 offset:17408
  s_waitcnt lgkmcnt(6)
  v_mfma_f32_32x32x16_bf16 v[80:95], v[40:43], v[188:191], v[80:95]
  ds_read_b64_tr_b16 v[24:25], v8 offset:16384
  ds_read_b64_tr_b16 v[26:27], v8 offset:17408
  s_waitcnt lgkmcnt(6)
  v_mfma_f32_32x32x16_bf16 v[96:111], v[44:47], v[188:191], v[96:111]
  ds_read_b64_tr_b16 v[28:29], v9 offset:16384
  ds_read_b64_tr_b16 v[30:31], v9 offset:17408
  s_waitcnt lgkmcnt(6)
  v_mfma_f32_32x32x16_bf16 v[48:63], v[16:19], v[192:195], v[48:63]
  ds_read_b64_tr_b16 v[32:33], v6 offset:18432
  ds_read_b64_tr_b16 v[34:35], v6 offset:19456
  s_waitcnt lgkmcnt(6)
  v_mfma_f32_32x32x16_bf16 v[64:79], v[20:23], v[192:195], v[64:79]
  ds_read_b64_tr_b16 v[36:37], v7 offset:18432
  ds_read_b64_tr_b16 v[38:39], v7 offset:19456
  s_waitcnt lgkmcnt(6)
  v_mfma_f32_32x32x16_bf16 v[80:95], v[24:27], v[192:195], v[80:95]
  ds_read_b64_tr_b16 v[40:41], v8 offset:18432
  ds_read_b64_tr_b16 v[42:43], v8 offset:19456
  s_waitcnt lgkmcnt(6)
  v_mfma_f32_32x32x16_bf16 v[96:111], v[28:31], v[192:195], v[96:111]
  ds_read_b64_tr_b16 v[44:45], v9 offset:18432
  ds_read_b64_tr_b16 v[46:47], v9 offset:19456
  s_waitcnt lgkmcnt(6)
  v_mfma_f32_32x32x16_bf16 v[48:63], v[32:35], v[196:199], v[48:63]
  ds_read_b64_tr_b16 v[16:17], v6 offset:24576
  ds_read_b64_tr_b16 v[18:19], v6 offset:25600
  s_add_u32 m0, s58, 34816
  s_mul_i32 s57, s54, 136
  s_add_u32 s57, s57, s55
  buffer_load_dwordx4 v11, s[48:51], s57 offen lds
  s_waitcnt lgkmcnt(6)
  v_mfma_f32_32x32x16_bf16 v[64:79], v[36:39], v[196:199], v[64:79]
  ds_read_b64_tr_b16 v[20:21], v7 offset:24576
  ds_read_b64_tr_b16 v[22:23], v7 offset:25600
  s_waitcnt lgkmcnt(6)
  v_mfma_f32_32x32x16_bf16 v[80:95], v[40:43], v[196:199], v[80:95]
  ds_read_b64_tr_b16 v[24:25], v8 offset:24576
  ds_read_b64_tr_b16 v[26:27], v8 offset:25600
  s_waitcnt lgkmcnt(6)
  v_mfma_f32_32x32x16_bf16 v[96:111], v[44:47], v[196:199], v[96:111]
  ds_read_b64_tr_b16 v[28:29], v9 offset:24576
  ds_read_b64_tr_b16 v[30:31], v9 offset:25600
  s_waitcnt lgkmcnt(6)
  v_mfma_f32_32x32x16_bf16 v[48:63], v[16:19], v[200:203], v[48:63]
  ds_read_b64_tr_b16 v[32:33], v6 offset:26624
  ds_read_b64_tr_b16 v[34:35], v6 offset:27648
  s_waitcnt lgkmcnt(6)
  v_mfma_f32_32x32x16_bf16 v[64:79], v[20:23], v[200:203], v[64:79]
  ds_read_b64_tr_b16 v[36:37], v7 offset:26624
  ds_read_b64_tr_b16 v[38:39], v7 offset:27648
  s_waitcnt lgkmcnt(6)
  v_mfma_f32_32x32x16_bf16 v[80:95], v[24:27], v[200:203], v[80:95]
  ds_read_b64_tr_b16 v[40:41], v8 offset:26624
  ds_read_b64_tr_b16 v[42:43], v8 offset:27648
  s_waitcnt lgkmcnt(6)
  v_mfma_f32_32x32x16_bf16 v[96:111], v[28:31], v[200:203], v[96:111]
  ds_read_b64_tr_b16 v[44:45], v9 offset:26624
  ds_read_b64_tr_b16 v[46:47], v9 offset:27648
  s_waitcnt lgkmcnt(6)
  v_mfma_f32_32x32x16_bf16 v[48:63], v[32:35], v[204:207], v[48:63]
  ds_read_b64_tr_b16 v[16:17], v6 offset:32768
  ds_read_b64_tr_b16 v[18:19], v6 offset:33792
  s_add_u32 m0, s58, 35840
  s_mul_i32 s57, s54, 140
  s_add_u32 s57, s57, s55
  buffer_load_dwordx4 v11, s[48:51], s57 offen lds
  s_waitcnt lgkmcnt(6)
  v_mfma_f32_32x32x16_bf16 v[64:79], v[36:39], v[204:207], v[64:79]
  ds_read_b64_tr_b16 v[20:21], v7 offset:32768
  ds_read_b64_tr_b16 v[22:23], v7 offset:33792
  s_waitcnt lgkmcnt(6)
  v_mfma_f32_32x32x16_bf16 v[80:95], v[40:43], v[204:207], v[80:95]
  ds_read_b64_tr_b16 v[24:25], v8 offset:32768
  ds_read_b64_tr_b16 v[26:27], v8 offset:33792
  s_waitcnt lgkmcnt(6)
  v_mfma_f32_32x32x16_bf16 v[96:111], v[44:47], v[204:207], v[96:111]
  ds_read_b64_tr_b16 v[28:29], v9 offset:32768
  ds_read_b64_tr_b16 v[30:31], v9 offset:33792
  s_waitcnt vmcnt(4)
  s_barrier
  s_waitcnt lgkmcnt(6)
  v_mfma_f32_32x32x16_bf16 v[48:63], v[16:19], v[208:211], v[48:63]
  ds_read_b64_tr_b16 v[32:33], v6 offset:34816
  ds_read_b64_tr_b16 v[34:35], v6 offset:35840
  s_waitcnt lgkmcnt(6)
  v_mfma_f32_32x32x16_bf16 v[64:79], v[20:23], v[208:211], v[64:79]
  ds_read_b64_tr_b16 v[36:37], v7 offset:34816
  ds_read_b64_tr_b16 v[38:39], v7 offset:35840
  s_waitcnt lgkmcnt(6)
  v_mfma_f32_32x32x16_bf16 v[80:95], v[24:27], v[208:211], v[80:95]
  ds_read_b64_tr_b16 v[40:41], v8 offset:34816
  ds_read_b64_tr_b16 v[42:43], v8 offset:35840
  s_waitcnt lgkmcnt(6)
  v_mfma_f32_32x32x16_bf16 v[96:111], v[28:31], v[208:211], v[96:111]
  ds_read_b64_tr_b16 v[44:45], v9 offset:34816
  ds_read_b64_tr_b16 v[46:47], v9 offset:35840
  s_waitcnt lgkmcnt(6)
  v_mfma_f32_32x32x16_bf16 v[48:63], v[32:35], v[212:215], v[48:63]
  ds_read_b64_tr_b16 v[16:17], v6 offset:40960
  ds_read_b64_tr_b16 v[18:19], v6 offset:41984
  s_add_u32 m0, s58, 65536
  s_mul_i32 s57, s54, 256
  s_add_u32 s57, s57, s55
  buffer_load_dwordx4 v11, s[48:51], s57 offen lds
  s_waitcnt lgkmcnt(6)
  v_mfma_f32_32x32x16_bf16 v[64:79], v[36:39], v[212:215], v[64:79]
  ds_read_b64_tr_b16 v[20:21], v7 offset:40960
  ds_read_b64_tr_b16 v[22:23], v7 offset:41984
  s_waitcnt lgkmcnt(6)
  v_mfma_f32_32x32x16_bf16 v[80:95], v[40:43], v[212:215], v[80:95]
  ds_read_b64_tr_b16 v[24:25], v8 offset:40960
  ds_read_b64_tr_b16 v[26:27], v8 offset:41984
  s_waitcnt lgkmcnt(6)
  v_mfma_f32_32x32x16_bf16 v[96:111], v[44:47], v[212:215], v[96:111]
  ds_read_b64_tr_b16 v[28:29], v9 offset:40960
  ds_read_b64_tr_b16 v[30:31], v9 offset:41984
  s_waitcnt lgkmcnt(6)
  v_mfma_f32_32x32x16_bf16 v[48:63], v[16:19], v[216:219], v[48:63]
  ds_read_b64_tr_b16 v[32:33], v6 offset:43008
  ds_read_b64_tr_b16 v[34:35], v6 offset:44032
  s_waitcnt lgkmcnt(6)
  v_mfma_f32_32x32x16_bf16 v[64:79], v[20:23], v[216:219], v[64:79]
  ds_read_b64_tr_b16 v[36:37], v7 offset:43008
  ds_read_b64_tr_b16 v[38:39], v7 offset:44032
  s_waitcnt lgkmcnt(6)
  v_mfma_f32_32x32x16_bf16 v[80:95], v[24:27], v[216:219], v[80:95]
  ds_read_b64_tr_b16 v[40:41], v8 offset:43008
  ds_read_b64_tr_b16 v[42:43], v8 offset:44032
  s_waitcnt lgkmcnt(6)
  v_mfma_f32_32x32x16_bf16 v[96:111], v[28:31], v[216:219], v[96:111]
  ds_read_b64_tr_b16 v[44:45], v9 offset:43008
  ds_read_b64_tr_b16 v[46:47], v9 offset:44032
  s_waitcnt lgkmcnt(6)
  v_mfma_f32_32x32x16_bf16 v[48:63], v[32:35], v[220:223], v[48:63]
  ds_read_b64_tr_b16 v[16:17], v6 offset:49152
  ds_read_b64_tr_b16 v[18:19], v6 offset:50176
  s_add_u32 m0, s58, 66560
  s_mul_i32 s57, s54, 260
  s_add_u32 s57, s57, s55
  buffer_load_dwordx4 v11, s[48:51], s57 offen lds
  s_waitcnt lgkmcnt(6)
  v_mfma_f32_32x32x16_bf16 v[64:79], v[36:39], v[220:223], v[64:79]
  ds_read_b64_tr_b16 v[20:21], v7 offset:49152
  ds_read_b64_tr_b16 v[22:23], v7 offset:50176
  s_waitcnt lgkmcnt(6)
  v_mfma_f32_32x32x16_bf16 v[80:95], v[40:43], v[220:223], v[80:95]
  ds_read_b64_tr_b16 v[24:25], v8 offset:49152
  ds_read_b64_tr_b16 v[26:27], v8 offset:50176
  s_waitcnt lgkmcnt(6)
  v_mfma_f32_32x32x16_bf16 v[96:111], v[44:47], v[220:223], v[96:111]
  ds_read_b64_tr_b16 v[28:29], v9 offset:49152
  ds_read_b64_tr_b16 v[30:31], v9 offset:50176
  s_waitcnt lgkmcnt(6)
  v_mfma_f32_32x32x16_bf16 v[48:63], v[16:19], v[224:227], v[48:63]
  ds_read_b64_tr_b16 v[32:33], v6 offset:51200
  ds_read_b64_tr_b16 v[34:35], v6 offset:52224
  s_waitcnt lgkmcnt(6)
  v_mfma_f32_32x32x16_bf16 v[64:79], v[20:23], v[224:227], v[64:79]
  ds_read_b64_tr_b16 v[36:37], v7 offset:51200
  ds_read_b64_tr_b16 v[38:39], v7 offset:52224
  s_waitcnt lgkmcnt(6)
  v_mfma_f32_32x32x16_bf16 v[80:95], v[24:27], v[224:227], v[80:95]
  ds_read_b64_tr_b16 v[40:41], v8 offset:51200
  ds_read_b64_tr_b16 v[42:43], v8 offset:52224
  s_waitcnt lgkmcnt(6)
  v_mfma_f32_32x32x16_bf16 v[96:111], v[28:31], v[224:227], v[96:111]
  ds_read_b64_tr_b16 v[44:45], v9 offset:51200
  ds_read_b64_tr_b16 v[46:47], v9 offset:52224
  s_waitcnt lgkmcnt(6)
  v_mfma_f32_32x32x16_bf16 v[48:63], v[32:35], v[228:231], v[48:63]
  ds_read_b64_tr_b16 v[16:17], v6 offset:57344
  ds_read_b64_tr_b16 v[18:19], v6 offset:58368
  s_add_u32 m0, s58, 67584
  s_mul_i32 s57, s54, 264
  s_add_u32 s57, s57, s55
  buffer_load_dwordx4 v11, s[48:51], s57 offen lds
  s_waitcnt lgkmcnt(6)
  v_mfma_f32_32x32x16_bf16 v[64:79], v[36:39], v[228:231], v[64:79]
  ds_read_b64_tr_b16 v[20:21], v7 offset:57344
  ds_read_b64_tr_b16 v[22:23], v7 offset:58368
  s_waitcnt lgkmcnt(6)
  v_mfma_f32_32x32x16_bf16 v[80:95], v[40:43], v[228:231], v[80:95]
  ds_read_b64_tr_b16 v[24:25], v8 offset:57344
  ds_read_b64_tr_b16 v[26:27], v8 offset:58368
  s_waitcnt lgkmcnt(6)
  v_mfma_f32_32x32x16_bf16 v[96:111], v[44:47], v[228:231], v[96:111]
  ds_read_b64_tr_b16 v[28:29], v9 offset:57344
  ds_read_b64_tr_b16 v[30:31], v9 offset:58368
  s_waitcnt lgkmcnt(6)
  v_mfma_f32_32x32x16_bf16 v[48:63], v[16:19], v[232:235], v[48:63]
  ds_read_b64_tr_b16 v[32:33], v6 offset:59392
  ds_read_b64_tr_b16 v[34:35], v6 offset:60416
  s_waitcnt lgkmcnt(6)
  v_mfma_f32_32x32x16_bf16 v[64:79], v[20:23], v[232:235], v[64:79]
  ds_read_b64_tr_b16 v[36:37], v7 offset:59392
  ds_read_b64_tr_b16 v[38:39], v7 offset:60416
  s_waitcnt lgkmcnt(6)
  v_mfma_f32_32x32x16_bf16 v[80:95], v[24:27], v[232:235], v[80:95]
  ds_read_b64_tr_b16 v[40:41], v8 offset:59392
  ds_read_b64_tr_b16 v[42:43], v8 offset:60416
  s_waitcnt lgkmcnt(6)
  v_mfma_f32_32x32x16_bf16 v[96:111], v[28:31], v[232:235], v[96:111]
  ds_read_b64_tr_b16 v[44:45], v9 offset:59392
  ds_read_b64_tr_b16 v[46:47], v9 offset:60416
  s_waitcnt lgkmcnt(6)
  v_mfma_f32_32x32x16_bf16 v[48:63], v[32:35], v[236:239], v[48:63]
  ds_read_b64_tr_b16 v[16:17], v2 offset:0
  ds_read_b64_tr_b16 v[18:19], v2 offset:1024
  s_add_u32 m0, s58, 68608
  s_mul_i32 s57, s54, 268
  s_add_u32 s57, s57, s55
  buffer_load_dwordx4 v11, s[48:51], s57 offen lds
  s_waitcnt lgkmcnt(6)
  v_mfma_f32_32x32x16_bf16 v[64:79], v[36:39], v[236:239], v[64:79]
  ds_read_b64_tr_b16 v[20:21], v2 offset:2048
  ds_read_b64_tr_b16 v[22:23], v2 offset:3072
  s_waitcnt lgkmcnt(6)
  v_mfma_f32_32x32x16_bf16 v[80:95], v[40:43], v[236:239], v[80:95]
  ds_read_b64_tr_b16 v[24:25], v2 offset:8192
  ds_read_b64_tr_b16 v[26:27], v2 offset:9216
  s_waitcnt lgkmcnt(6)
  v_mfma_f32_32x32x16_bf16 v[96:111], v[44:47], v[236:239], v[96:111]
  ds_read_b64_tr_b16 v[28:29], v2 offset:10240
  ds_read_b64_tr_b16 v[30:31], v2 offset:11264
  s_mov_b32 s12, s48
  s_mov_b32 s13, s49
  s_mov_b32 s14, s50
  s_mov_b32 s52, s54
  s_mov_b32 s53, s55
  v_mov_b32 v10, v11
  s_mov_b32 s90, s56
  s_add_u32 s91, s56, 4096
  s_mov_b32 s48, s32
  s_mov_b32 s49, s33
  s_mov_b32 s50, 0x400000
  s_mov_b32 s54, 8192
  s_mov_b32 s55, s62
  v_mul_lo_u32 v11, v13, s54
  v_add_u32 v11, v11, v14
  s_add_u32 s56, s63, 0x2000000
  s_waitcnt vmcnt(4)
  s_barrier
  v_cvt_pk_bf16_f32 v48, v48, v49
  v_cvt_pk_bf16_f32 v49, v50, v51
  v_cvt_pk_bf16_f32 v50, v52, v53
  v_cvt_pk_bf16_f32 v51, v54, v55
  buffer_store_dwordx4 v[48:51], v12, s[16:19], s90 offen offset:0 sc1
  v_cvt_pk_bf16_f32 v56, v56, v57
  v_cvt_pk_bf16_f32 v57, v58, v59
  v_cvt_pk_bf16_f32 v58, v60, v61
  v_cvt_pk_bf16_f32 v59, v62, v63
  buffer_store_dwordx4 v[56:59], v12, s[16:19], s90 offen offset:1024 sc1
  s_nop 1
  s_waitcnt lgkmcnt(6)
  v_mfma_f32_32x32x16_bf16 v[48:63], v[112:115], v[16:19], 0
  ds_read_b64_tr_b16 v[32:33], v3 offset:0
  ds_read_b64_tr_b16 v[34:35], v3 offset:1024
  s_waitcnt lgkmcnt(6)
  v_mfma_f32_32x32x16_bf16 v[48:63], v[116:119], v[20:23], v[48:63]
  ds_read_b64_tr_b16 v[36:37], v3 offset:2048
  ds_read_b64_tr_b16 v[38:39], v3 offset:3072
  s_waitcnt lgkmcnt(6)
  v_mfma_f32_32x32x16_bf16 v[48:63], v[120:123], v[24:27], v[48:63]
  ds_read_b64_tr_b16 v[40:41], v3 offset:8192
  ds_read_b64_tr_b16 v[42:43], v3 offset:9216
  s_waitcnt lgkmcnt(6)
  v_mfma_f32_32x32x16_bf16 v[48:63], v[124:127], v[28:31], v[48:63]
  ds_read_b64_tr_b16 v[44:45], v3 offset:10240
  ds_read_b64_tr_b16 v[46:47], v3 offset:11264
  v_cvt_pk_bf16_f32 v64, v64, v65
  v_cvt_pk_bf16_f32 v65, v66, v67
  v_cvt_pk_bf16_f32 v66, v68, v69
  v_cvt_pk_bf16_f32 v67, v70, v71
  buffer_store_dwordx4 v[64:67], v12, s[16:19], s90 offen offset:2048 sc1
  v_cvt_pk_bf16_f32 v72, v72, v73
  v_cvt_pk_bf16_f32 v73, v74, v75
  v_cvt_pk_bf16_f32 v74, v76, v77
  v_cvt_pk_bf16_f32 v75, v78, v79
  buffer_store_dwordx4 v[72:75], v12, s[16:19], s90 offen offset:3072 sc1
  s_nop 1
  s_waitcnt lgkmcnt(6)
  v_mfma_f32_32x32x16_bf16 v[64:79], v[112:115], v[32:35], 0
  ds_read_b64_tr_b16 v[16:17], v4 offset:0
  ds_read_b64_tr_b16 v[18:19], v4 offset:1024
  s_add_u32 m0, s58, 98304
  s_mul_i32 s57, s52, 384
  s_add_u32 s57, s57, s53
  buffer_load_dwordx4 v10, s[12:15], s57 offen lds
  s_waitcnt lgkmcnt(6)
  v_mfma_f32_32x32x16_bf16 v[64:79], v[116:119], v[36:39], v[64:79]
  ds_read_b64_tr_b16 v[20:21], v4 offset:2048
  ds_read_b64_tr_b16 v[22:23], v4 offset:3072
  s_waitcnt lgkmcnt(6)
  v_mfma_f32_32x32x16_bf16 v[64:79], v[120:123], v[40:43], v[64:79]
  ds_read_b64_tr_b16 v[24:25], v4 offset:8192
  ds_read_b64_tr_b16 v[26:27], v4 offset:9216
  s_waitcnt lgkmcnt(6)
  v_mfma_f32_32x32x16_bf16 v[64:79], v[124:127], v[44:47], v[64:79]
  ds_read_b64_tr_b16 v[28:29], v4 offset:10240
  ds_read_b64_tr_b16 v[30:31], v4 offset:11264
  v_cvt_pk_bf16_f32 v80, v80, v81
  v_cvt_pk_bf16_f32 v81, v82, v83
  v_cvt_pk_bf16_f32 v82, v84, v85
  v_cvt_pk_bf16_f32 v83, v86, v87
  buffer_store_dwordx4 v[80:83], v12, s[16:19], s91 offen offset:0 sc1
  v_cvt_pk_bf16_f32 v88, v88, v89
  v_cvt_pk_bf16_f32 v89, v90, v91
  v_cvt_pk_bf16_f32 v90, v92, v93
  v_cvt_pk_bf16_f32 v91, v94, v95
  buffer_store_dwordx4 v[88:91], v12, s[16:19], s91 offen offset:1024 sc1
  s_nop 1
  s_waitcnt lgkmcnt(6)
  v_mfma_f32_32x32x16_bf16 v[80:95], v[112:115], v[16:19], 0
  ds_read_b64_tr_b16 v[32:33], v5 offset:0
  ds_read_b64_tr_b16 v[34:35], v5 offset:1024
  s_waitcnt lgkmcnt(6)
  v_mfma_f32_32x32x16_bf16 v[80:95], v[116:119], v[20:23], v[80:95]
  ds_read_b64_tr_b16 v[36:37], v5 offset:2048
  ds_read_b64_tr_b16 v[38:39], v5 offset:3072
  s_waitcnt lgkmcnt(6)
  v_mfma_f32_32x32x16_bf16 v[80:95], v[120:123], v[24:27], v[80:95]
  ds_read_b64_tr_b16 v[40:41], v5 offset:8192
  ds_read_b64_tr_b16 v[42:43], v5 offset:9216
  s_waitcnt lgkmcnt(6)
  v_mfma_f32_32x32x16_bf16 v[80:95], v[124:127], v[28:31], v[80:95]
  ds_read_b64_tr_b16 v[44:45], v5 offset:10240
  ds_read_b64_tr_b16 v[46:47], v5 offset:11264
  v_cvt_pk_bf16_f32 v96, v96, v97
  v_cvt_pk_bf16_f32 v97, v98, v99
  v_cvt_pk_bf16_f32 v98, v100, v101
  v_cvt_pk_bf16_f32 v99, v102, v103
  buffer_store_dwordx4 v[96:99], v12, s[16:19], s91 offen offset:2048 sc1
  v_cvt_pk_bf16_f32 v104, v104, v105
  v_cvt_pk_bf16_f32 v105, v106, v107
  v_cvt_pk_bf16_f32 v106, v108, v109
  v_cvt_pk_bf16_f32 v107, v110, v111
  buffer_store_dwordx4 v[104:107], v12, s[16:19], s91 offen offset:3072 sc1
  s_nop 1
  s_waitcnt lgkmcnt(6)
  v_mfma_f32_32x32x16_bf16 v[96:111], v[112:115], v[32:35], 0
  ds_read_b64_tr_b16 v[16:17], v2 offset:16384
  ds_read_b64_tr_b16 v[18:19], v2 offset:17408
  s_add_u32 m0, s58, 99328
  s_mul_i32 s57, s52, 388
  s_add_u32 s57, s57, s53
  buffer_load_dwordx4 v10, s[12:15], s57 offen lds
  s_waitcnt lgkmcnt(6)
  v_mfma_f32_32x32x16_bf16 v[96:111], v[116:119], v[36:39], v[96:111]
  ds_read_b64_tr_b16 v[20:21], v3 offset:16384
  ds_read_b64_tr_b16 v[22:23], v3 offset:17408
  s_waitcnt lgkmcnt(6)
  v_mfma_f32_32x32x16_bf16 v[96:111], v[120:123], v[40:43], v[96:111]
  ds_read_b64_tr_b16 v[24:25], v4 offset:16384
  ds_read_b64_tr_b16 v[26:27], v4 offset:17408
  s_waitcnt lgkmcnt(6)
  v_mfma_f32_32x32x16_bf16 v[96:111], v[124:127], v[44:47], v[96:111]
  ds_read_b64_tr_b16 v[28:29], v5 offset:16384
  ds_read_b64_tr_b16 v[30:31], v5 offset:17408
  s_waitcnt lgkmcnt(6)
  v_mfma_f32_32x32x16_bf16 v[48:63], v[128:131], v[16:19], v[48:63]
  ds_read_b64_tr_b16 v[32:33], v2 offset:18432
  ds_read_b64_tr_b16 v[34:35], v2 offset:19456
  s_waitcnt lgkmcnt(6)
  v_mfma_f32_32x32x16_bf16 v[64:79], v[128:131], v[20:23], v[64:79]
  ds_read_b64_tr_b16 v[36:37], v3 offset:18432
  ds_read_b64_tr_b16 v[38:39], v3 offset:19456
  s_waitcnt lgkmcnt(6)
  v_mfma_f32_32x32x16_bf16 v[80:95], v[128:131], v[24:27], v[80:95]
  ds_read_b64_tr_b16 v[40:41], v4 offset:18432
  ds_read_b64_tr_b16 v[42:43], v4 offset:19456
  s_waitcnt lgkmcnt(6)
  v_mfma_f32_32x32x16_bf16 v[96:111], v[128:131], v[28:31], v[96:111]
  ds_read_b64_tr_b16 v[44:45], v5 offset:18432
  ds_read_b64_tr_b16 v[46:47], v5 offset:19456
  s_waitcnt lgkmcnt(6)
  v_mfma_f32_32x32x16_bf16 v[48:63], v[132:135], v[32:35], v[48:63]
  ds_read_b64_tr_b16 v[16:17], v2 offset:24576
  ds_read_b64_tr_b16 v[18:19], v2 offset:25600
  s_add_u32 m0, s58, 100352
  s_mul_i32 s57, s52, 392
  s_add_u32 s57, s57, s53
  buffer_load_dwordx4 v10, s[12:15], s57 offen lds
  s_waitcnt lgkmcnt(6)
  v_mfma_f32_32x32x16_bf16 v[64:79], v[132:135], v[36:39], v[64:79]
  ds_read_b64_tr_b16 v[20:21], v3 offset:24576
  ds_read_b64_tr_b16 v[22:23], v3 offset:25600
  s_waitcnt lgkmcnt(6)
  v_mfma_f32_32x32x16_bf16 v[80:95], v[132:135], v[40:43], v[80:95]
  ds_read_b64_tr_b16 v[24:25], v4 offset:24576
  ds_read_b64_tr_b16 v[26:27], v4 offset:25600
  s_waitcnt lgkmcnt(6)
  v_mfma_f32_32x32x16_bf16 v[96:111], v[132:135], v[44:47], v[96:111]
  ds_read_b64_tr_b16 v[28:29], v5 offset:24576
  ds_read_b64_tr_b16 v[30:31], v5 offset:25600
  s_waitcnt lgkmcnt(6)
  v_mfma_f32_32x32x16_bf16 v[48:63], v[136:139], v[16:19], v[48:63]
  ds_read_b64_tr_b16 v[32:33], v2 offset:26624
  ds_read_b64_tr_b16 v[34:35], v2 offset:27648
  s_waitcnt lgkmcnt(6)
  v_mfma_f32_32x32x16_bf16 v[64:79], v[136:139], v[20:23], v[64:79]
  ds_read_b64_tr_b16 v[36:37], v3 offset:26624
  ds_read_b64_tr_b16 v[38:39], v3 offset:27648
  s_waitcnt lgkmcnt(6)
  v_mfma_f32_32x32x16_bf16 v[80:95], v[136:139], v[24:27], v[80:95]
  ds_read_b64_tr_b16 v[40:41], v4 offset:26624
  ds_read_b64_tr_b16 v[42:43], v4 offset:27648
  s_waitcnt lgkmcnt(6)
  v_mfma_f32_32x32x16_bf16 v[96:111], v[136:139], v[28:31], v[96:111]
  ds_read_b64_tr_b16 v[44:45], v5 offset:26624
  ds_read_b64_tr_b16 v[46:47], v5 offset:27648
  s_waitcnt lgkmcnt(6)
  v_mfma_f32_32x32x16_bf16 v[48:63], v[140:143], v[32:35], v[48:63]
  ds_read_b64_tr_b16 v[16:17], v2 offset:32768
  ds_read_b64_tr_b16 v[18:19], v2 offset:33792
  s_add_u32 m0, s58, 101376
  s_mul_i32 s57, s52, 396
  s_add_u32 s57, s57, s53
  buffer_load_dwordx4 v10, s[12:15], s57 offen lds
  s_waitcnt lgkmcnt(6)
  v_mfma_f32_32x32x16_bf16 v[64:79], v[140:143], v[36:39], v[64:79]
  ds_read_b64_tr_b16 v[20:21], v3 offset:32768
  ds_read_b64_tr_b16 v[22:23], v3 offset:33792
  s_waitcnt lgkmcnt(6)
  v_mfma_f32_32x32x16_bf16 v[80:95], v[140:143], v[40:43], v[80:95]
  ds_read_b64_tr_b16 v[24:25], v4 offset:32768
  ds_read_b64_tr_b16 v[26:27], v4 offset:33792
  s_waitcnt lgkmcnt(6)
  v_mfma_f32_32x32x16_bf16 v[96:111], v[140:143], v[44:47], v[96:111]
  ds_read_b64_tr_b16 v[28:29], v5 offset:32768
  ds_read_b64_tr_b16 v[30:31], v5 offset:33792
  s_waitcnt vmcnt(12)
  s_barrier
  s_waitcnt lgkmcnt(6)
  v_mfma_f32_32x32x16_bf16 v[48:63], v[144:147], v[16:19], v[48:63]
  ds_read_b64_tr_b16 v[32:33], v2 offset:34816
  ds_read_b64_tr_b16 v[34:35], v2 offset:35840
  s_waitcnt lgkmcnt(6)
  v_mfma_f32_32x32x16_bf16 v[64:79], v[144:147], v[20:23], v[64:79]
  ds_read_b64_tr_b16 v[36:37], v3 offset:34816
  ds_read_b64_tr_b16 v[38:39], v3 offset:35840
  s_waitcnt lgkmcnt(6)
  v_mfma_f32_32x32x16_bf16 v[80:95], v[144:147], v[24:27], v[80:95]
  ds_read_b64_tr_b16 v[40:41], v4 offset:34816
  ds_read_b64_tr_b16 v[42:43], v4 offset:35840
  s_waitcnt lgkmcnt(6)
  v_mfma_f32_32x32x16_bf16 v[96:111], v[144:147], v[28:31], v[96:111]
  ds_read_b64_tr_b16 v[44:45], v5 offset:34816
  ds_read_b64_tr_b16 v[46:47], v5 offset:35840
  s_waitcnt lgkmcnt(6)
  v_mfma_f32_32x32x16_bf16 v[48:63], v[148:151], v[32:35], v[48:63]
  ds_read_b64_tr_b16 v[16:17], v2 offset:40960
  ds_read_b64_tr_b16 v[18:19], v2 offset:41984
  s_add_u32 m0, s58, 0
  s_mul_i32 s57, s54, 0
  s_add_u32 s57, s57, s55
  buffer_load_dwordx4 v11, s[48:51], s57 offen lds
  s_waitcnt lgkmcnt(6)
  v_mfma_f32_32x32x16_bf16 v[64:79], v[148:151], v[36:39], v[64:79]
  ds_read_b64_tr_b16 v[20:21], v3 offset:40960
  ds_read_b64_tr_b16 v[22:23], v3 offset:41984
  s_waitcnt lgkmcnt(6)
  v_mfma_f32_32x32x16_bf16 v[80:95], v[148:151], v[40:43], v[80:95]
  ds_read_b64_tr_b16 v[24:25], v4 offset:40960
  ds_read_b64_tr_b16 v[26:27], v4 offset:41984
  s_waitcnt lgkmcnt(6)
  v_mfma_f32_32x32x16_bf16 v[96:111], v[148:151], v[44:47], v[96:111]
  ds_read_b64_tr_b16 v[28:29], v5 offset:40960
  ds_read_b64_tr_b16 v[30:31], v5 offset:41984
  s_waitcnt lgkmcnt(6)
  v_mfma_f32_32x32x16_bf16 v[48:63], v[152:155], v[16:19], v[48:63]
  ds_read_b64_tr_b16 v[32:33], v2 offset:43008
  ds_read_b64_tr_b16 v[34:35], v2 offset:44032
  s_waitcnt lgkmcnt(6)
  v_mfma_f32_32x32x16_bf16 v[64:79], v[152:155], v[20:23], v[64:79]
  ds_read_b64_tr_b16 v[36:37], v3 offset:43008
  ds_read_b64_tr_b16 v[38:39], v3 offset:44032
  s_waitcnt lgkmcnt(6)
  v_mfma_f32_32x32x16_bf16 v[80:95], v[152:155], v[24:27], v[80:95]
  ds_read_b64_tr_b16 v[40:41], v4 offset:43008
  ds_read_b64_tr_b16 v[42:43], v4 offset:44032
  s_waitcnt lgkmcnt(6)
  v_mfma_f32_32x32x16_bf16 v[96:111], v[152:155], v[28:31], v[96:111]
  ds_read_b64_tr_b16 v[44:45], v5 offset:43008
  ds_read_b64_tr_b16 v[46:47], v5 offset:44032
  s_waitcnt lgkmcnt(6)
  v_mfma_f32_32x32x16_bf16 v[48:63], v[156:159], v[32:35], v[48:63]
  ds_read_b64_tr_b16 v[16:17], v2 offset:49152
  ds_read_b64_tr_b16 v[18:19], v2 offset:50176
  s_add_u32 m0, s58, 1024
  s_mul_i32 s57, s54, 4
  s_add_u32 s57, s57, s55
  buffer_load_dwordx4 v11, s[48:51], s57 offen lds
  s_waitcnt lgkmcnt(6)
  v_mfma_f32_32x32x16_bf16 v[64:79], v[156:159], v[36:39], v[64:79]
  ds_read_b64_tr_b16 v[20:21], v3 offset:49152
  ds_read_b64_tr_b16 v[22:23], v3 offset:50176
  s_waitcnt lgkmcnt(6)
  v_mfma_f32_32x32x16_bf16 v[80:95], v[156:159], v[40:43], v[80:95]
  ds_read_b64_tr_b16 v[24:25], v4 offset:49152
  ds_read_b64_tr_b16 v[26:27], v4 offset:50176
  s_waitcnt lgkmcnt(6)
  v_mfma_f32_32x32x16_bf16 v[96:111], v[156:159], v[44:47], v[96:111]
  ds_read_b64_tr_b16 v[28:29], v5 offset:49152
  ds_read_b64_tr_b16 v[30:31], v5 offset:50176
  s_waitcnt lgkmcnt(6)
  v_mfma_f32_32x32x16_bf16 v[48:63], v[160:163], v[16:19], v[48:63]
  ds_read_b64_tr_b16 v[32:33], v2 offset:51200
  ds_read_b64_tr_b16 v[34:35], v2 offset:52224
  s_waitcnt lgkmcnt(6)
  v_mfma_f32_32x32x16_bf16 v[64:79], v[160:163], v[20:23], v[64:79]
  ds_read_b64_tr_b16 v[36:37], v3 offset:51200
  ds_read_b64_tr_b16 v[38:39], v3 offset:52224
  s_waitcnt lgkmcnt(6)
  v_mfma_f32_32x32x16_bf16 v[80:95], v[160:163], v[24:27], v[80:95]
  ds_read_b64_tr_b16 v[40:41], v4 offset:51200
  ds_read_b64_tr_b16 v[42:43], v4 offset:52224
  s_waitcnt lgkmcnt(6)
  v_mfma_f32_32x32x16_bf16 v[96:111], v[160:163], v[28:31], v[96:111]
  ds_read_b64_tr_b16 v[44:45], v5 offset:51200
  ds_read_b64_tr_b16 v[46:47], v5 offset:52224
  s_waitcnt lgkmcnt(6)
  v_mfma_f32_32x32x16_bf16 v[48:63], v[164:167], v[32:35], v[48:63]
  ds_read_b64_tr_b16 v[16:17], v2 offset:57344
  ds_read_b64_tr_b16 v[18:19], v2 offset:58368
  s_add_u32 m0, s58, 2048
  s_mul_i32 s57, s54, 8
  s_add_u32 s57, s57, s55
  buffer_load_dwordx4 v11, s[48:51], s57 offen lds
  s_waitcnt lgkmcnt(6)
  v_mfma_f32_32x32x16_bf16 v[64:79], v[164:167], v[36:39], v[64:79]
  ds_read_b64_tr_b16 v[20:21], v3 offset:57344
  ds_read_b64_tr_b16 v[22:23], v3 offset:58368
  s_waitcnt lgkmcnt(6)
  v_mfma_f32_32x32x16_bf16 v[80:95], v[164:167], v[40:43], v[80:95]
  ds_read_b64_tr_b16 v[24:25], v4 offset:57344
  ds_read_b64_tr_b16 v[26:27], v4 offset:58368
  s_waitcnt lgkmcnt(6)
  v_mfma_f32_32x32x16_bf16 v[96:111], v[164:167], v[44:47], v[96:111]
  ds_read_b64_tr_b16 v[28:29], v5 offset:57344
  ds_read_b64_tr_b16 v[30:31], v5 offset:58368
  s_waitcnt lgkmcnt(6)
  v_mfma_f32_32x32x16_bf16 v[48:63], v[168:171], v[16:19], v[48:63]
  ds_read_b64_tr_b16 v[32:33], v2 offset:59392
  ds_read_b64_tr_b16 v[34:35], v2 offset:60416
  s_waitcnt lgkmcnt(6)
  v_mfma_f32_32x32x16_bf16 v[64:79], v[168:171], v[20:23], v[64:79]
  ds_read_b64_tr_b16 v[36:37], v3 offset:59392
  ds_read_b64_tr_b16 v[38:39], v3 offset:60416
  s_waitcnt lgkmcnt(6)
  v_mfma_f32_32x32x16_bf16 v[80:95], v[168:171], v[24:27], v[80:95]
  ds_read_b64_tr_b16 v[40:41], v4 offset:59392
  ds_read_b64_tr_b16 v[42:43], v4 offset:60416
  s_waitcnt lgkmcnt(6)
  v_mfma_f32_32x32x16_bf16 v[96:111], v[168:171], v[28:31], v[96:111]
  ds_read_b64_tr_b16 v[44:45], v5 offset:59392
  ds_read_b64_tr_b16 v[46:47], v5 offset:60416
  s_waitcnt lgkmcnt(6)
  v_mfma_f32_32x32x16_bf16 v[48:63], v[172:175], v[32:35], v[48:63]
  ds_read_b64_tr_b16 v[16:17], v6 offset:0
  ds_read_b64_tr_b16 v[18:19], v6 offset:1024
  s_add_u32 m0, s58, 3072
  s_mul_i32 s57, s54, 12
  s_add_u32 s57, s57, s55
  buffer_load_dwordx4 v11, s[48:51], s57 offen lds
  s_waitcnt lgkmcnt(6)
  v_mfma_f32_32x32x16_bf16 v[64:79], v[172:175], v[36:39], v[64:79]
  ds_read_b64_tr_b16 v[20:21], v7 offset:0
  ds_read_b64_tr_b16 v[22:23], v7 offset:1024
  s_waitcnt lgkmcnt(6)
  v_mfma_f32_32x32x16_bf16 v[80:95], v[172:175], v[40:43], v[80:95]
  ds_read_b64_tr_b16 v[24:25], v8 offset:0
  ds_read_b64_tr_b16 v[26:27], v8 offset:1024
  s_waitcnt lgkmcnt(6)
  v_mfma_f32_32x32x16_bf16 v[96:111], v[172:175], v[44:47], v[96:111]
  ds_read_b64_tr_b16 v[28:29], v9 offset:0
  ds_read_b64_tr_b16 v[30:31], v9 offset:1024
  s_waitcnt vmcnt(4)
  s_barrier
  s_waitcnt lgkmcnt(6)
  v_mfma_f32_32x32x16_bf16 v[48:63], v[176:179], v[16:19], v[48:63]
  ds_read_b64_tr_b16 v[32:33], v6 offset:2048
  ds_read_b64_tr_b16 v[34:35], v6 offset:3072
  s_waitcnt lgkmcnt(6)
  v_mfma_f32_32x32x16_bf16 v[64:79], v[176:179], v[20:23], v[64:79]
  ds_read_b64_tr_b16 v[36:37], v7 offset:2048
  ds_read_b64_tr_b16 v[38:39], v7 offset:3072
  s_waitcnt lgkmcnt(6)
  v_mfma_f32_32x32x16_bf16 v[80:95], v[176:179], v[24:27], v[80:95]
  ds_read_b64_tr_b16 v[40:41], v8 offset:2048
  ds_read_b64_tr_b16 v[42:43], v8 offset:3072
  s_waitcnt lgkmcnt(6)
  v_mfma_f32_32x32x16_bf16 v[96:111], v[176:179], v[28:31], v[96:111]
  ds_read_b64_tr_b16 v[44:45], v9 offset:2048
  ds_read_b64_tr_b16 v[46:47], v9 offset:3072
  s_waitcnt lgkmcnt(6)
  v_mfma_f32_32x32x16_bf16 v[48:63], v[180:183], v[32:35], v[48:63]
  ds_read_b64_tr_b16 v[16:17], v6 offset:8192
  ds_read_b64_tr_b16 v[18:19], v6 offset:9216
  s_add_u32 m0, s58, 32768
  s_mul_i32 s57, s54, 128
  s_add_u32 s57, s57, s55
  buffer_load_dwordx4 v11, s[48:51], s57 offen lds
  s_waitcnt lgkmcnt(6)
  v_mfma_f32_32x32x16_bf16 v[64:79], v[180:183], v[36:39], v[64:79]
  ds_read_b64_tr_b16 v[20:21], v7 offset:8192
  ds_read_b64_tr_b16 v[22:23], v7 offset:9216
  s_waitcnt lgkmcnt(6)
  v_mfma_f32_32x32x16_bf16 v[80:95], v[180:183], v[40:43], v[80:95]
  ds_read_b64_tr_b16 v[24:25], v8 offset:8192
  ds_read_b64_tr_b16 v[26:27], v8 offset:9216
  s_waitcnt lgkmcnt(6)
  v_mfma_f32_32x32x16_bf16 v[96:111], v[180:183], v[44:47], v[96:111]
  ds_read_b64_tr_b16 v[28:29], v9 offset:8192
  ds_read_b64_tr_b16 v[30:31], v9 offset:9216
  s_waitcnt lgkmcnt(6)
  v_mfma_f32_32x32x16_bf16 v[48:63], v[184:187], v[16:19], v[48:63]
  ds_read_b64_tr_b16 v[32:33], v6 offset:10240
  ds_read_b64_tr_b16 v[34:35], v6 offset:11264
  s_waitcnt lgkmcnt(6)
  v_mfma_f32_32x32x16_bf16 v[64:79], v[184:187], v[20:23], v[64:79]
  ds_read_b64_tr_b16 v[36:37], v7 offset:10240
  ds_read_b64_tr_b16 v[38:39], v7 offset:11264
  s_waitcnt lgkmcnt(6)
  v_mfma_f32_32x32x16_bf16 v[80:95], v[184:187], v[24:27], v[80:95]
  ds_read_b64_tr_b16 v[40:41], v8 offset:10240
  ds_read_b64_tr_b16 v[42:43], v8 offset:11264
  s_waitcnt lgkmcnt(6)
  v_mfma_f32_32x32x16_bf16 v[96:111], v[184:187], v[28:31], v[96:111]
  ds_read_b64_tr_b16 v[44:45], v9 offset:10240
  ds_read_b64_tr_b16 v[46:47], v9 offset:11264
  s_waitcnt lgkmcnt(6)
  v_mfma_f32_32x32x16_bf16 v[48:63], v[188:191], v[32:35], v[48:63]
  ds_read_b64_tr_b16 v[16:17], v6 offset:16384
  ds_read_b64_tr_b16 v[18:19], v6 offset:17408
  s_add_u32 m0, s58, 33792
  s_mul_i32 s57, s54, 132
  s_add_u32 s57, s57, s55
  buffer_load_dwordx4 v11, s[48:51], s57 offen lds
  s_waitcnt lgkmcnt(6)
  v_mfma_f32_32x32x16_bf16 v[64:79], v[188:191], v[36:39], v[64:79]
  ds_read_b64_tr_b16 v[20:21], v7 offset:16384
  ds_read_b64_tr_b16 v[22:23], v7 offset:17408
  s_waitcnt lgkmcnt(6)
  v_mfma_f32_32x32x16_bf16 v[80:95], v[188:191], v[40:43], v[80:95]
  ds_read_b64_tr_b16 v[24:25], v8 offset:16384
  ds_read_b64_tr_b16 v[26:27], v8 offset:17408
  s_waitcnt lgkmcnt(6)
  v_mfma_f32_32x32x16_bf16 v[96:111], v[188:191], v[44:47], v[96:111]
  ds_read_b64_tr_b16 v[28:29], v9 offset:16384
  ds_read_b64_tr_b16 v[30:31], v9 offset:17408
  s_waitcnt lgkmcnt(6)
  v_mfma_f32_32x32x16_bf16 v[48:63], v[192:195], v[16:19], v[48:63]
  ds_read_b64_tr_b16 v[32:33], v6 offset:18432
  ds_read_b64_tr_b16 v[34:35], v6 offset:19456
  s_waitcnt lgkmcnt(6)
  v_mfma_f32_32x32x16_bf16 v[64:79], v[192:195], v[20:23], v[64:79]
  ds_read_b64_tr_b16 v[36:37], v7 offset:18432
  ds_read_b64_tr_b16 v[38:39], v7 offset:19456
  s_waitcnt lgkmcnt(6)
  v_mfma_f32_32x32x16_bf16 v[80:95], v[192:195], v[24:27], v[80:95]
  ds_read_b64_tr_b16 v[40:41], v8 offset:18432
  ds_read_b64_tr_b16 v[42:43], v8 offset:19456
  s_waitcnt lgkmcnt(6)
  v_mfma_f32_32x32x16_bf16 v[96:111], v[192:195], v[28:31], v[96:111]
  ds_read_b64_tr_b16 v[44:45], v9 offset:18432
  ds_read_b64_tr_b16 v[46:47], v9 offset:19456
  s_waitcnt lgkmcnt(6)
  v_mfma_f32_32x32x16_bf16 v[48:63], v[196:199], v[32:35], v[48:63]
  ds_read_b64_tr_b16 v[16:17], v6 offset:24576
  ds_read_b64_tr_b16 v[18:19], v6 offset:25600
  s_add_u32 m0, s58, 34816
  s_mul_i32 s57, s54, 136
  s_add_u32 s57, s57, s55
  buffer_load_dwordx4 v11, s[48:51], s57 offen lds
  s_waitcnt lgkmcnt(6)
  v_mfma_f32_32x32x16_bf16 v[64:79], v[196:199], v[36:39], v[64:79]
  ds_read_b64_tr_b16 v[20:21], v7 offset:24576
  ds_read_b64_tr_b16 v[22:23], v7 offset:25600
  s_waitcnt lgkmcnt(6)
  v_mfma_f32_32x32x16_bf16 v[80:95], v[196:199], v[40:43], v[80:95]
  ds_read_b64_tr_b16 v[24:25], v8 offset:24576
  ds_read_b64_tr_b16 v[26:27], v8 offset:25600
  s_waitcnt lgkmcnt(6)
  v_mfma_f32_32x32x16_bf16 v[96:111], v[196:199], v[44:47], v[96:111]
  ds_read_b64_tr_b16 v[28:29], v9 offset:24576
  ds_read_b64_tr_b16 v[30:31], v9 offset:25600
  s_waitcnt lgkmcnt(6)
  v_mfma_f32_32x32x16_bf16 v[48:63], v[200:203], v[16:19], v[48:63]
  ds_read_b64_tr_b16 v[32:33], v6 offset:26624
  ds_read_b64_tr_b16 v[34:35], v6 offset:27648
  s_waitcnt lgkmcnt(6)
  v_mfma_f32_32x32x16_bf16 v[64:79], v[200:203], v[20:23], v[64:79]
  ds_read_b64_tr_b16 v[36:37], v7 offset:26624
  ds_read_b64_tr_b16 v[38:39], v7 offset:27648
  s_waitcnt lgkmcnt(6)
  v_mfma_f32_32x32x16_bf16 v[80:95], v[200:203], v[24:27], v[80:95]
  ds_read_b64_tr_b16 v[40:41], v8 offset:26624
  ds_read_b64_tr_b16 v[42:43], v8 offset:27648
  s_waitcnt lgkmcnt(6)
  v_mfma_f32_32x32x16_bf16 v[96:111], v[200:203], v[28:31], v[96:111]
  ds_read_b64_tr_b16 v[44:45], v9 offset:26624
  ds_read_b64_tr_b16 v[46:47], v9 offset:27648
  s_waitcnt lgkmcnt(6)
  v_mfma_f32_32x32x16_bf16 v[48:63], v[204:207], v[32:35], v[48:63]
  ds_read_b64_tr_b16 v[16:17], v6 offset:32768
  ds_read_b64_tr_b16 v[18:19], v6 offset:33792
  s_add_u32 m0, s58, 35840
  s_mul_i32 s57, s54, 140
  s_add_u32 s57, s57, s55
  buffer_load_dwordx4 v11, s[48:51], s57 offen lds
  s_waitcnt lgkmcnt(6)
  v_mfma_f32_32x32x16_bf16 v[64:79], v[204:207], v[36:39], v[64:79]
  ds_read_b64_tr_b16 v[20:21], v7 offset:32768
  ds_read_b64_tr_b16 v[22:23], v7 offset:33792
  s_waitcnt lgkmcnt(6)
  v_mfma_f32_32x32x16_bf16 v[80:95], v[204:207], v[40:43], v[80:95]
  ds_read_b64_tr_b16 v[24:25], v8 offset:32768
  ds_read_b64_tr_b16 v[26:27], v8 offset:33792
  s_waitcnt lgkmcnt(6)
  v_mfma_f32_32x32x16_bf16 v[96:111], v[204:207], v[44:47], v[96:111]
  ds_read_b64_tr_b16 v[28:29], v9 offset:32768
  ds_read_b64_tr_b16 v[30:31], v9 offset:33792
  s_waitcnt vmcnt(4)
  s_barrier
  s_waitcnt lgkmcnt(6)
  v_mfma_f32_32x32x16_bf16 v[48:63], v[208:211], v[16:19], v[48:63]
  ds_read_b64_tr_b16 v[32:33], v6 offset:34816
  ds_read_b64_tr_b16 v[34:35], v6 offset:35840
  s_waitcnt lgkmcnt(6)
  v_mfma_f32_32x32x16_bf16 v[64:79], v[208:211], v[20:23], v[64:79]
  ds_read_b64_tr_b16 v[36:37], v7 offset:34816
  ds_read_b64_tr_b16 v[38:39], v7 offset:35840
  s_waitcnt lgkmcnt(6)
  v_mfma_f32_32x32x16_bf16 v[80:95], v[208:211], v[24:27], v[80:95]
  ds_read_b64_tr_b16 v[40:41], v8 offset:34816
  ds_read_b64_tr_b16 v[42:43], v8 offset:35840
  s_waitcnt lgkmcnt(6)
  v_mfma_f32_32x32x16_bf16 v[96:111], v[208:211], v[28:31], v[96:111]
  ds_read_b64_tr_b16 v[44:45], v9 offset:34816
  ds_read_b64_tr_b16 v[46:47], v9 offset:35840
  s_waitcnt lgkmcnt(6)
  v_mfma_f32_32x32x16_bf16 v[48:63], v[212:215], v[32:35], v[48:63]
  ds_read_b64_tr_b16 v[16:17], v6 offset:40960
  ds_read_b64_tr_b16 v[18:19], v6 offset:41984
  s_add_u32 m0, s58, 65536
  s_mul_i32 s57, s54, 256
  s_add_u32 s57, s57, s55
  buffer_load_dwordx4 v11, s[48:51], s57 offen lds
  s_waitcnt lgkmcnt(6)
  v_mfma_f32_32x32x16_bf16 v[64:79], v[212:215], v[36:39], v[64:79]
  ds_read_b64_tr_b16 v[20:21], v7 offset:40960
  ds_read_b64_tr_b16 v[22:23], v7 offset:41984
  s_waitcnt lgkmcnt(6)
  v_mfma_f32_32x32x16_bf16 v[80:95], v[212:215], v[40:43], v[80:95]
  ds_read_b64_tr_b16 v[24:25], v8 offset:40960
  ds_read_b64_tr_b16 v[26:27], v8 offset:41984
  s_waitcnt lgkmcnt(6)
  v_mfma_f32_32x32x16_bf16 v[96:111], v[212:215], v[44:47], v[96:111]
  ds_read_b64_tr_b16 v[28:29], v9 offset:40960
  ds_read_b64_tr_b16 v[30:31], v9 offset:41984
  s_waitcnt lgkmcnt(6)
  v_mfma_f32_32x32x16_bf16 v[48:63], v[216:219], v[16:19], v[48:63]
  ds_read_b64_tr_b16 v[32:33], v6 offset:43008
  ds_read_b64_tr_b16 v[34:35], v6 offset:44032
  s_waitcnt lgkmcnt(6)
  v_mfma_f32_32x32x16_bf16 v[64:79], v[216:219], v[20:23], v[64:79]
  ds_read_b64_tr_b16 v[36:37], v7 offset:43008
  ds_read_b64_tr_b16 v[38:39], v7 offset:44032
  s_waitcnt lgkmcnt(6)
  v_mfma_f32_32x32x16_bf16 v[80:95], v[216:219], v[24:27], v[80:95]
  ds_read_b64_tr_b16 v[40:41], v8 offset:43008
  ds_read_b64_tr_b16 v[42:43], v8 offset:44032
  s_waitcnt lgkmcnt(6)
  v_mfma_f32_32x32x16_bf16 v[96:111], v[216:219], v[28:31], v[96:111]
  ds_read_b64_tr_b16 v[44:45], v9 offset:43008
  ds_read_b64_tr_b16 v[46:47], v9 offset:44032
  s_waitcnt lgkmcnt(6)
  v_mfma_f32_32x32x16_bf16 v[48:63], v[220:223], v[32:35], v[48:63]
  ds_read_b64_tr_b16 v[16:17], v6 offset:49152
  ds_read_b64_tr_b16 v[18:19], v6 offset:50176
  s_add_u32 m0, s58, 66560
  s_mul_i32 s57, s54, 260
  s_add_u32 s57, s57, s55
  buffer_load_dwordx4 v11, s[48:51], s57 offen lds
  s_waitcnt lgkmcnt(6)
  v_mfma_f32_32x32x16_bf16 v[64:79], v[220:223], v[36:39], v[64:79]
  ds_read_b64_tr_b16 v[20:21], v7 offset:49152
  ds_read_b64_tr_b16 v[22:23], v7 offset:50176
  s_waitcnt lgkmcnt(6)
  v_mfma_f32_32x32x16_bf16 v[80:95], v[220:223], v[40:43], v[80:95]
  ds_read_b64_tr_b16 v[24:25], v8 offset:49152
  ds_read_b64_tr_b16 v[26:27], v8 offset:50176
  s_waitcnt lgkmcnt(6)
  v_mfma_f32_32x32x16_bf16 v[96:111], v[220:223], v[44:47], v[96:111]
  ds_read_b64_tr_b16 v[28:29], v9 offset:49152
  ds_read_b64_tr_b16 v[30:31], v9 offset:50176
  s_waitcnt lgkmcnt(6)
  v_mfma_f32_32x32x16_bf16 v[48:63], v[224:227], v[16:19], v[48:63]
  ds_read_b64_tr_b16 v[32:33], v6 offset:51200
  ds_read_b64_tr_b16 v[34:35], v6 offset:52224
  s_waitcnt lgkmcnt(6)
  v_mfma_f32_32x32x16_bf16 v[64:79], v[224:227], v[20:23], v[64:79]
  ds_read_b64_tr_b16 v[36:37], v7 offset:51200
  ds_read_b64_tr_b16 v[38:39], v7 offset:52224
  s_waitcnt lgkmcnt(6)
  v_mfma_f32_32x32x16_bf16 v[80:95], v[224:227], v[24:27], v[80:95]
  ds_read_b64_tr_b16 v[40:41], v8 offset:51200
  ds_read_b64_tr_b16 v[42:43], v8 offset:52224
  s_waitcnt lgkmcnt(6)
  v_mfma_f32_32x32x16_bf16 v[96:111], v[224:227], v[28:31], v[96:111]
  ds_read_b64_tr_b16 v[44:45], v9 offset:51200
  ds_read_b64_tr_b16 v[46:47], v9 offset:52224
  s_waitcnt lgkmcnt(6)
  v_mfma_f32_32x32x16_bf16 v[48:63], v[228:231], v[32:35], v[48:63]
  ds_read_b64_tr_b16 v[16:17], v6 offset:57344
  ds_read_b64_tr_b16 v[18:19], v6 offset:58368
  s_add_u32 m0, s58, 67584
  s_mul_i32 s57, s54, 264
  s_add_u32 s57, s57, s55
  buffer_load_dwordx4 v11, s[48:51], s57 offen lds
  s_waitcnt lgkmcnt(6)
  v_mfma_f32_32x32x16_bf16 v[64:79], v[228:231], v[36:39], v[64:79]
  ds_read_b64_tr_b16 v[20:21], v7 offset:57344
  ds_read_b64_tr_b16 v[22:23], v7 offset:58368
  s_waitcnt lgkmcnt(6)
  v_mfma_f32_32x32x16_bf16 v[80:95], v[228:231], v[40:43], v[80:95]
  ds_read_b64_tr_b16 v[24:25], v8 offset:57344
  ds_read_b64_tr_b16 v[26:27], v8 offset:58368
  s_waitcnt lgkmcnt(6)
  v_mfma_f32_32x32x16_bf16 v[96:111], v[228:231], v[44:47], v[96:111]
  ds_read_b64_tr_b16 v[28:29], v9 offset:57344
  ds_read_b64_tr_b16 v[30:31], v9 offset:58368
  s_waitcnt lgkmcnt(6)
  v_mfma_f32_32x32x16_bf16 v[48:63], v[232:235], v[16:19], v[48:63]
  ds_read_b64_tr_b16 v[32:33], v6 offset:59392
  ds_read_b64_tr_b16 v[34:35], v6 offset:60416
  s_waitcnt lgkmcnt(6)
  v_mfma_f32_32x32x16_bf16 v[64:79], v[232:235], v[20:23], v[64:79]
  ds_read_b64_tr_b16 v[36:37], v7 offset:59392
  ds_read_b64_tr_b16 v[38:39], v7 offset:60416
  s_waitcnt lgkmcnt(6)
  v_mfma_f32_32x32x16_bf16 v[80:95], v[232:235], v[24:27], v[80:95]
  ds_read_b64_tr_b16 v[40:41], v8 offset:59392
  ds_read_b64_tr_b16 v[42:43], v8 offset:60416
  s_waitcnt lgkmcnt(6)
  v_mfma_f32_32x32x16_bf16 v[96:111], v[232:235], v[28:31], v[96:111]
  ds_read_b64_tr_b16 v[44:45], v9 offset:59392
  ds_read_b64_tr_b16 v[46:47], v9 offset:60416
  s_waitcnt lgkmcnt(6)
  v_mfma_f32_32x32x16_bf16 v[48:63], v[236:239], v[32:35], v[48:63]
  ds_read_b64_tr_b16 v[16:17], v2 offset:0
  ds_read_b64_tr_b16 v[18:19], v2 offset:1024
  s_add_u32 m0, s58, 68608
  s_mul_i32 s57, s54, 268
  s_add_u32 s57, s57, s55
  buffer_load_dwordx4 v11, s[48:51], s57 offen lds
  s_waitcnt lgkmcnt(6)
  v_mfma_f32_32x32x16_bf16 v[64:79], v[236:239], v[36:39], v[64:79]
  ds_read_b64_tr_b16 v[20:21], v2 offset:2048
  ds_read_b64_tr_b16 v[22:23], v2 offset:3072
  s_waitcnt lgkmcnt(6)
  v_mfma_f32_32x32x16_bf16 v[80:95], v[236:239], v[40:43], v[80:95]
  ds_read_b64_tr_b16 v[24:25], v2 offset:8192
  ds_read_b64_tr_b16 v[26:27], v2 offset:9216
  s_waitcnt lgkmcnt(6)
  v_mfma_f32_32x32x16_bf16 v[96:111], v[236:239], v[44:47], v[96:111]
  ds_read_b64_tr_b16 v[28:29], v2 offset:10240
  ds_read_b64_tr_b16 v[30:31], v2 offset:11264
  s_mov_b32 s12, s48
  s_mov_b32 s13, s49
  s_mov_b32 s14, s50
  s_mov_b32 s52, s54
  s_mov_b32 s53, s55
  v_mov_b32 v10, v11
  s_mov_b32 s90, s56
  s_add_u32 s91, s56, 4096
  s_mov_b32 s66, 0
  s_mov_b32 s48, s38
  s_mov_b32 s49, s39
  s_mov_b32 s50, s66
  s_mov_b32 s54, 3584
  s_mov_b32 s55, s46
  v_mul_lo_u32 v11, v13, s54
  v_add_u32 v11, v11, v14
  s_add_u32 s56, s64, 0x2000000
  s_waitcnt vmcnt(4)
  s_barrier
  v_cvt_pk_bf16_f32 v48, v48, v49
  v_cvt_pk_bf16_f32 v49, v50, v51
  v_cvt_pk_bf16_f32 v50, v52, v53
  v_cvt_pk_bf16_f32 v51, v54, v55
  buffer_store_dwordx4 v[48:51], v12, s[16:19], s90 offen offset:0 sc1
  v_cvt_pk_bf16_f32 v56, v56, v57
  v_cvt_pk_bf16_f32 v57, v58, v59
  v_cvt_pk_bf16_f32 v58, v60, v61
  v_cvt_pk_bf16_f32 v59, v62, v63
  buffer_store_dwordx4 v[56:59], v12, s[16:19], s90 offen offset:1024 sc1
  s_nop 1
  s_waitcnt lgkmcnt(6)
  v_mfma_f32_32x32x16_bf16 v[48:63], v[112:115], v[16:19], 0
  ds_read_b64_tr_b16 v[32:33], v3 offset:0
  ds_read_b64_tr_b16 v[34:35], v3 offset:1024
  s_waitcnt lgkmcnt(6)
  v_mfma_f32_32x32x16_bf16 v[48:63], v[116:119], v[20:23], v[48:63]
  ds_read_b64_tr_b16 v[36:37], v3 offset:2048
  ds_read_b64_tr_b16 v[38:39], v3 offset:3072
  s_waitcnt lgkmcnt(6)
  v_mfma_f32_32x32x16_bf16 v[48:63], v[120:123], v[24:27], v[48:63]
  ds_read_b64_tr_b16 v[40:41], v3 offset:8192
  ds_read_b64_tr_b16 v[42:43], v3 offset:9216
  s_waitcnt lgkmcnt(6)
  v_mfma_f32_32x32x16_bf16 v[48:63], v[124:127], v[28:31], v[48:63]
  ds_read_b64_tr_b16 v[44:45], v3 offset:10240
  ds_read_b64_tr_b16 v[46:47], v3 offset:11264
  v_cvt_pk_bf16_f32 v64, v64, v65
  v_cvt_pk_bf16_f32 v65, v66, v67
  v_cvt_pk_bf16_f32 v66, v68, v69
  v_cvt_pk_bf16_f32 v67, v70, v71
  buffer_store_dwordx4 v[64:67], v12, s[16:19], s90 offen offset:2048 sc1
  v_cvt_pk_bf16_f32 v72, v72, v73
  v_cvt_pk_bf16_f32 v73, v74, v75
  v_cvt_pk_bf16_f32 v74, v76, v77
  v_cvt_pk_bf16_f32 v75, v78, v79
  buffer_store_dwordx4 v[72:75], v12, s[16:19], s90 offen offset:3072 sc1
  s_nop 1
  s_waitcnt lgkmcnt(6)
  v_mfma_f32_32x32x16_bf16 v[64:79], v[112:115], v[32:35], 0
  ds_read_b64_tr_b16 v[16:17], v4 offset:0
  ds_read_b64_tr_b16 v[18:19], v4 offset:1024
  s_add_u32 m0, s58, 98304
  s_mul_i32 s57, s52, 384
  s_add_u32 s57, s57, s53
  buffer_load_dwordx4 v10, s[12:15], s57 offen lds
  s_waitcnt lgkmcnt(6)
  v_mfma_f32_32x32x16_bf16 v[64:79], v[116:119], v[36:39], v[64:79]
  ds_read_b64_tr_b16 v[20:21], v4 offset:2048
  ds_read_b64_tr_b16 v[22:23], v4 offset:3072
  s_waitcnt lgkmcnt(6)
  v_mfma_f32_32x32x16_bf16 v[64:79], v[120:123], v[40:43], v[64:79]
  ds_read_b64_tr_b16 v[24:25], v4 offset:8192
  ds_read_b64_tr_b16 v[26:27], v4 offset:9216
  s_waitcnt lgkmcnt(6)
  v_mfma_f32_32x32x16_bf16 v[64:79], v[124:127], v[44:47], v[64:79]
  ds_read_b64_tr_b16 v[28:29], v4 offset:10240
  ds_read_b64_tr_b16 v[30:31], v4 offset:11264
  v_cvt_pk_bf16_f32 v80, v80, v81
  v_cvt_pk_bf16_f32 v81, v82, v83
  v_cvt_pk_bf16_f32 v82, v84, v85
  v_cvt_pk_bf16_f32 v83, v86, v87
  buffer_store_dwordx4 v[80:83], v12, s[16:19], s91 offen offset:0 sc1
  v_cvt_pk_bf16_f32 v88, v88, v89
  v_cvt_pk_bf16_f32 v89, v90, v91
  v_cvt_pk_bf16_f32 v90, v92, v93
  v_cvt_pk_bf16_f32 v91, v94, v95
  buffer_store_dwordx4 v[88:91], v12, s[16:19], s91 offen offset:1024 sc1
  s_nop 1
  s_waitcnt lgkmcnt(6)
  v_mfma_f32_32x32x16_bf16 v[80:95], v[112:115], v[16:19], 0
  ds_read_b64_tr_b16 v[32:33], v5 offset:0
  ds_read_b64_tr_b16 v[34:35], v5 offset:1024
  s_waitcnt lgkmcnt(6)
  v_mfma_f32_32x32x16_bf16 v[80:95], v[116:119], v[20:23], v[80:95]
  ds_read_b64_tr_b16 v[36:37], v5 offset:2048
  ds_read_b64_tr_b16 v[38:39], v5 offset:3072
  s_waitcnt lgkmcnt(6)
  v_mfma_f32_32x32x16_bf16 v[80:95], v[120:123], v[24:27], v[80:95]
  ds_read_b64_tr_b16 v[40:41], v5 offset:8192
  ds_read_b64_tr_b16 v[42:43], v5 offset:9216
  s_waitcnt lgkmcnt(6)
  v_mfma_f32_32x32x16_bf16 v[80:95], v[124:127], v[28:31], v[80:95]
  ds_read_b64_tr_b16 v[44:45], v5 offset:10240
  ds_read_b64_tr_b16 v[46:47], v5 offset:11264
  v_cvt_pk_bf16_f32 v96, v96, v97
  v_cvt_pk_bf16_f32 v97, v98, v99
  v_cvt_pk_bf16_f32 v98, v100, v101
  v_cvt_pk_bf16_f32 v99, v102, v103
  buffer_store_dwordx4 v[96:99], v12, s[16:19], s91 offen offset:2048 sc1
  v_cvt_pk_bf16_f32 v104, v104, v105
  v_cvt_pk_bf16_f32 v105, v106, v107
  v_cvt_pk_bf16_f32 v106, v108, v109
  v_cvt_pk_bf16_f32 v107, v110, v111
  buffer_store_dwordx4 v[104:107], v12, s[16:19], s91 offen offset:3072 sc1
  s_nop 1
  s_waitcnt lgkmcnt(6)
  v_mfma_f32_32x32x16_bf16 v[96:111], v[112:115], v[32:35], 0
  ds_read_b64_tr_b16 v[16:17], v2 offset:16384
  ds_read_b64_tr_b16 v[18:19], v2 offset:17408
  s_add_u32 m0, s58, 99328
  s_mul_i32 s57, s52, 388
  s_add_u32 s57, s57, s53
  buffer_load_dwordx4 v10, s[12:15], s57 offen lds
  s_waitcnt lgkmcnt(6)
  v_mfma_f32_32x32x16_bf16 v[96:111], v[116:119], v[36:39], v[96:111]
  ds_read_b64_tr_b16 v[20:21], v3 offset:16384
  ds_read_b64_tr_b16 v[22:23], v3 offset:17408
  s_waitcnt lgkmcnt(6)
  v_mfma_f32_32x32x16_bf16 v[96:111], v[120:123], v[40:43], v[96:111]
  ds_read_b64_tr_b16 v[24:25], v4 offset:16384
  ds_read_b64_tr_b16 v[26:27], v4 offset:17408
  s_waitcnt lgkmcnt(6)
  v_mfma_f32_32x32x16_bf16 v[96:111], v[124:127], v[44:47], v[96:111]
  ds_read_b64_tr_b16 v[28:29], v5 offset:16384
  ds_read_b64_tr_b16 v[30:31], v5 offset:17408
  s_waitcnt lgkmcnt(6)
  v_mfma_f32_32x32x16_bf16 v[48:63], v[128:131], v[16:19], v[48:63]
  ds_read_b64_tr_b16 v[32:33], v2 offset:18432
  ds_read_b64_tr_b16 v[34:35], v2 offset:19456
  s_waitcnt lgkmcnt(6)
  v_mfma_f32_32x32x16_bf16 v[64:79], v[128:131], v[20:23], v[64:79]
  ds_read_b64_tr_b16 v[36:37], v3 offset:18432
  ds_read_b64_tr_b16 v[38:39], v3 offset:19456
  s_waitcnt lgkmcnt(6)
  v_mfma_f32_32x32x16_bf16 v[80:95], v[128:131], v[24:27], v[80:95]
  ds_read_b64_tr_b16 v[40:41], v4 offset:18432
  ds_read_b64_tr_b16 v[42:43], v4 offset:19456
  s_waitcnt lgkmcnt(6)
  v_mfma_f32_32x32x16_bf16 v[96:111], v[128:131], v[28:31], v[96:111]
  ds_read_b64_tr_b16 v[44:45], v5 offset:18432
  ds_read_b64_tr_b16 v[46:47], v5 offset:19456
  s_waitcnt lgkmcnt(6)
  v_mfma_f32_32x32x16_bf16 v[48:63], v[132:135], v[32:35], v[48:63]
  ds_read_b64_tr_b16 v[16:17], v2 offset:24576
  ds_read_b64_tr_b16 v[18:19], v2 offset:25600
  s_add_u32 m0, s58, 100352
  s_mul_i32 s57, s52, 392
  s_add_u32 s57, s57, s53
  buffer_load_dwordx4 v10, s[12:15], s57 offen lds
  s_waitcnt lgkmcnt(6)
  v_mfma_f32_32x32x16_bf16 v[64:79], v[132:135], v[36:39], v[64:79]
  ds_read_b64_tr_b16 v[20:21], v3 offset:24576
  ds_read_b64_tr_b16 v[22:23], v3 offset:25600
  s_waitcnt lgkmcnt(6)
  v_mfma_f32_32x32x16_bf16 v[80:95], v[132:135], v[40:43], v[80:95]
  ds_read_b64_tr_b16 v[24:25], v4 offset:24576
  ds_read_b64_tr_b16 v[26:27], v4 offset:25600
  s_waitcnt lgkmcnt(6)
  v_mfma_f32_32x32x16_bf16 v[96:111], v[132:135], v[44:47], v[96:111]
  ds_read_b64_tr_b16 v[28:29], v5 offset:24576
  ds_read_b64_tr_b16 v[30:31], v5 offset:25600
  s_waitcnt lgkmcnt(6)
  v_mfma_f32_32x32x16_bf16 v[48:63], v[136:139], v[16:19], v[48:63]
  ds_read_b64_tr_b16 v[32:33], v2 offset:26624
  ds_read_b64_tr_b16 v[34:35], v2 offset:27648
  s_waitcnt lgkmcnt(6)
  v_mfma_f32_32x32x16_bf16 v[64:79], v[136:139], v[20:23], v[64:79]
  ds_read_b64_tr_b16 v[36:37], v3 offset:26624
  ds_read_b64_tr_b16 v[38:39], v3 offset:27648
  s_waitcnt lgkmcnt(6)
  v_mfma_f32_32x32x16_bf16 v[80:95], v[136:139], v[24:27], v[80:95]
  ds_read_b64_tr_b16 v[40:41], v4 offset:26624
  ds_read_b64_tr_b16 v[42:43], v4 offset:27648
  s_waitcnt lgkmcnt(6)
  v_mfma_f32_32x32x16_bf16 v[96:111], v[136:139], v[28:31], v[96:111]
  ds_read_b64_tr_b16 v[44:45], v5 offset:26624
  ds_read_b64_tr_b16 v[46:47], v5 offset:27648
  s_waitcnt lgkmcnt(6)
  v_mfma_f32_32x32x16_bf16 v[48:63], v[140:143], v[32:35], v[48:63]
  ds_read_b64_tr_b16 v[16:17], v2 offset:32768
  ds_read_b64_tr_b16 v[18:19], v2 offset:33792
  s_add_u32 m0, s58, 101376
  s_mul_i32 s57, s52, 396
  s_add_u32 s57, s57, s53
  buffer_load_dwordx4 v10, s[12:15], s57 offen lds
  s_waitcnt lgkmcnt(6)
  v_mfma_f32_32x32x16_bf16 v[64:79], v[140:143], v[36:39], v[64:79]
  ds_read_b64_tr_b16 v[20:21], v3 offset:32768
  ds_read_b64_tr_b16 v[22:23], v3 offset:33792
  s_waitcnt lgkmcnt(6)
  v_mfma_f32_32x32x16_bf16 v[80:95], v[140:143], v[40:43], v[80:95]
  ds_read_b64_tr_b16 v[24:25], v4 offset:32768
  ds_read_b64_tr_b16 v[26:27], v4 offset:33792
  s_lshl_b32 s88, s2, 3
  s_add_u32 s88, s88, s6
  v_lshlrev_b32 v255, 6, v1
  s_cmp_lt_u32 s88, 1024
  s_cselect_b32 s84, s34, s42
  s_cselect_b32 s85, s35, s43
  s_cselect_b32 s86, s7, 0x1c0000
  s_mov_b32 s87, 0x20000
  s_and_b32 s89, s88, 1023
  s_lshl_b32 s89, s89, 12
  buffer_load_dword v254, v255, s[84:87], s89 offen
  s_waitcnt lgkmcnt(6)
  v_mfma_f32_32x32x16_bf16 v[96:111], v[140:143], v[44:47], v[96:111]
  ds_read_b64_tr_b16 v[28:29], v5 offset:32768
  ds_read_b64_tr_b16 v[30:31], v5 offset:33792
  s_waitcnt vmcnt(13)
  s_barrier
  s_waitcnt lgkmcnt(6)
  v_mfma_f32_32x32x16_bf16 v[48:63], v[144:147], v[16:19], v[48:63]
  ds_read_b64_tr_b16 v[32:33], v2 offset:34816
  ds_read_b64_tr_b16 v[34:35], v2 offset:35840
  s_waitcnt lgkmcnt(6)
  v_mfma_f32_32x32x16_bf16 v[64:79], v[144:147], v[20:23], v[64:79]
  ds_read_b64_tr_b16 v[36:37], v3 offset:34816
  ds_read_b64_tr_b16 v[38:39], v3 offset:35840
  s_waitcnt lgkmcnt(6)
  v_mfma_f32_32x32x16_bf16 v[80:95], v[144:147], v[24:27], v[80:95]
  ds_read_b64_tr_b16 v[40:41], v4 offset:34816
  ds_read_b64_tr_b16 v[42:43], v4 offset:35840
  s_waitcnt lgkmcnt(6)
  v_mfma_f32_32x32x16_bf16 v[96:111], v[144:147], v[28:31], v[96:111]
  ds_read_b64_tr_b16 v[44:45], v5 offset:34816
  ds_read_b64_tr_b16 v[46:47], v5 offset:35840
  s_waitcnt lgkmcnt(6)
  v_mfma_f32_32x32x16_bf16 v[48:63], v[148:151], v[32:35], v[48:63]
  ds_read_b64_tr_b16 v[16:17], v2 offset:40960
  ds_read_b64_tr_b16 v[18:19], v2 offset:41984
  s_add_u32 m0, s58, 0
  s_mul_i32 s57, s54, 0
  s_add_u32 s57, s57, s55
  buffer_load_dwordx4 v11, s[48:51], s57 offen lds
  s_waitcnt lgkmcnt(6)
  v_mfma_f32_32x32x16_bf16 v[64:79], v[148:151], v[36:39], v[64:79]
  ds_read_b64_tr_b16 v[20:21], v3 offset:40960
  ds_read_b64_tr_b16 v[22:23], v3 offset:41984
  s_waitcnt lgkmcnt(6)
  v_mfma_f32_32x32x16_bf16 v[80:95], v[148:151], v[40:43], v[80:95]
  ds_read_b64_tr_b16 v[24:25], v4 offset:40960
  ds_read_b64_tr_b16 v[26:27], v4 offset:41984
  s_waitcnt lgkmcnt(6)
  v_mfma_f32_32x32x16_bf16 v[96:111], v[148:151], v[44:47], v[96:111]
  ds_read_b64_tr_b16 v[28:29], v5 offset:40960
  ds_read_b64_tr_b16 v[30:31], v5 offset:41984
  s_waitcnt lgkmcnt(6)
  v_mfma_f32_32x32x16_bf16 v[48:63], v[152:155], v[16:19], v[48:63]
  ds_read_b64_tr_b16 v[32:33], v2 offset:43008
  ds_read_b64_tr_b16 v[34:35], v2 offset:44032
  s_waitcnt lgkmcnt(6)
  v_mfma_f32_32x32x16_bf16 v[64:79], v[152:155], v[20:23], v[64:79]
  ds_read_b64_tr_b16 v[36:37], v3 offset:43008
  ds_read_b64_tr_b16 v[38:39], v3 offset:44032
  s_waitcnt lgkmcnt(6)
  v_mfma_f32_32x32x16_bf16 v[80:95], v[152:155], v[24:27], v[80:95]
  ds_read_b64_tr_b16 v[40:41], v4 offset:43008
  ds_read_b64_tr_b16 v[42:43], v4 offset:44032
  s_waitcnt lgkmcnt(6)
  v_mfma_f32_32x32x16_bf16 v[96:111], v[152:155], v[28:31], v[96:111]
  ds_read_b64_tr_b16 v[44:45], v5 offset:43008
  ds_read_b64_tr_b16 v[46:47], v5 offset:44032
  s_waitcnt lgkmcnt(6)
  v_mfma_f32_32x32x16_bf16 v[48:63], v[156:159], v[32:35], v[48:63]
  ds_read_b64_tr_b16 v[16:17], v2 offset:49152
  ds_read_b64_tr_b16 v[18:19], v2 offset:50176
  s_add_u32 m0, s58, 1024
  s_mul_i32 s57, s54, 4
  s_add_u32 s57, s57, s55
  buffer_load_dwordx4 v11, s[48:51], s57 offen lds
  s_waitcnt lgkmcnt(6)
  v_mfma_f32_32x32x16_bf16 v[64:79], v[156:159], v[36:39], v[64:79]
  ds_read_b64_tr_b16 v[20:21], v3 offset:49152
  ds_read_b64_tr_b16 v[22:23], v3 offset:50176
  s_waitcnt lgkmcnt(6)
  v_mfma_f32_32x32x16_bf16 v[80:95], v[156:159], v[40:43], v[80:95]
  ds_read_b64_tr_b16 v[24:25], v4 offset:49152
  ds_read_b64_tr_b16 v[26:27], v4 offset:50176
  s_waitcnt lgkmcnt(6)
  v_mfma_f32_32x32x16_bf16 v[96:111], v[156:159], v[44:47], v[96:111]
  ds_read_b64_tr_b16 v[28:29], v5 offset:49152
  ds_read_b64_tr_b16 v[30:31], v5 offset:50176
  s_waitcnt lgkmcnt(6)
  v_mfma_f32_32x32x16_bf16 v[48:63], v[160:163], v[16:19], v[48:63]
  ds_read_b64_tr_b16 v[32:33], v2 offset:51200
  ds_read_b64_tr_b16 v[34:35], v2 offset:52224
  s_waitcnt lgkmcnt(6)
  v_mfma_f32_32x32x16_bf16 v[64:79], v[160:163], v[20:23], v[64:79]
  ds_read_b64_tr_b16 v[36:37], v3 offset:51200
  ds_read_b64_tr_b16 v[38:39], v3 offset:52224
  s_waitcnt lgkmcnt(6)
  v_mfma_f32_32x32x16_bf16 v[80:95], v[160:163], v[24:27], v[80:95]
  ds_read_b64_tr_b16 v[40:41], v4 offset:51200
  ds_read_b64_tr_b16 v[42:43], v4 offset:52224
  s_waitcnt lgkmcnt(6)
  v_mfma_f32_32x32x16_bf16 v[96:111], v[160:163], v[28:31], v[96:111]
  ds_read_b64_tr_b16 v[44:45], v5 offset:51200
  ds_read_b64_tr_b16 v[46:47], v5 offset:52224
  s_waitcnt lgkmcnt(6)
  v_mfma_f32_32x32x16_bf16 v[48:63], v[164:167], v[32:35], v[48:63]
  ds_read_b64_tr_b16 v[16:17], v2 offset:57344
  ds_read_b64_tr_b16 v[18:19], v2 offset:58368
  s_add_u32 m0, s58, 2048
  s_mul_i32 s57, s54, 8
  s_add_u32 s57, s57, s55
  buffer_load_dwordx4 v11, s[48:51], s57 offen lds
  s_waitcnt lgkmcnt(6)
  v_mfma_f32_32x32x16_bf16 v[64:79], v[164:167], v[36:39], v[64:79]
  ds_read_b64_tr_b16 v[20:21], v3 offset:57344
  ds_read_b64_tr_b16 v[22:23], v3 offset:58368
  s_waitcnt lgkmcnt(6)
  v_mfma_f32_32x32x16_bf16 v[80:95], v[164:167], v[40:43], v[80:95]
  ds_read_b64_tr_b16 v[24:25], v4 offset:57344
  ds_read_b64_tr_b16 v[26:27], v4 offset:58368
  s_waitcnt lgkmcnt(6)
  v_mfma_f32_32x32x16_bf16 v[96:111], v[164:167], v[44:47], v[96:111]
  ds_read_b64_tr_b16 v[28:29], v5 offset:57344
  ds_read_b64_tr_b16 v[30:31], v5 offset:58368
  s_waitcnt lgkmcnt(6)
  v_mfma_f32_32x32x16_bf16 v[48:63], v[168:171], v[16:19], v[48:63]
  ds_read_b64_tr_b16 v[32:33], v2 offset:59392
  ds_read_b64_tr_b16 v[34:35], v2 offset:60416
  s_waitcnt lgkmcnt(6)
  v_mfma_f32_32x32x16_bf16 v[64:79], v[168:171], v[20:23], v[64:79]
  ds_read_b64_tr_b16 v[36:37], v3 offset:59392
  ds_read_b64_tr_b16 v[38:39], v3 offset:60416
  s_waitcnt lgkmcnt(6)
  v_mfma_f32_32x32x16_bf16 v[80:95], v[168:171], v[24:27], v[80:95]
  ds_read_b64_tr_b16 v[40:41], v4 offset:59392
  ds_read_b64_tr_b16 v[42:43], v4 offset:60416
  s_waitcnt lgkmcnt(6)
  v_mfma_f32_32x32x16_bf16 v[96:111], v[168:171], v[28:31], v[96:111]
  ds_read_b64_tr_b16 v[44:45], v5 offset:59392
  ds_read_b64_tr_b16 v[46:47], v5 offset:60416
  s_waitcnt lgkmcnt(6)
  v_mfma_f32_32x32x16_bf16 v[48:63], v[172:175], v[32:35], v[48:63]
  ds_read_b64_tr_b16 v[16:17], v6 offset:0
  ds_read_b64_tr_b16 v[18:19], v6 offset:1024
  s_add_u32 m0, s58, 3072
  s_mul_i32 s57, s54, 12
  s_add_u32 s57, s57, s55
  buffer_load_dwordx4 v11, s[48:51], s57 offen lds
  s_waitcnt lgkmcnt(6)
  v_mfma_f32_32x32x16_bf16 v[64:79], v[172:175], v[36:39], v[64:79]
  ds_read_b64_tr_b16 v[20:21], v7 offset:0
  ds_read_b64_tr_b16 v[22:23], v7 offset:1024
  s_waitcnt lgkmcnt(6)
  v_mfma_f32_32x32x16_bf16 v[80:95], v[172:175], v[40:43], v[80:95]
  ds_read_b64_tr_b16 v[24:25], v8 offset:0
  ds_read_b64_tr_b16 v[26:27], v8 offset:1024
  s_waitcnt lgkmcnt(6)
  v_mfma_f32_32x32x16_bf16 v[96:111], v[172:175], v[44:47], v[96:111]
  ds_read_b64_tr_b16 v[28:29], v9 offset:0
  ds_read_b64_tr_b16 v[30:31], v9 offset:1024
  s_waitcnt vmcnt(5)
  s_barrier
  s_waitcnt lgkmcnt(6)
  v_mfma_f32_32x32x16_bf16 v[48:63], v[176:179], v[16:19], v[48:63]
  ds_read_b64_tr_b16 v[32:33], v6 offset:2048
  ds_read_b64_tr_b16 v[34:35], v6 offset:3072
  s_waitcnt lgkmcnt(6)
  v_mfma_f32_32x32x16_bf16 v[64:79], v[176:179], v[20:23], v[64:79]
  ds_read_b64_tr_b16 v[36:37], v7 offset:2048
  ds_read_b64_tr_b16 v[38:39], v7 offset:3072
  s_waitcnt lgkmcnt(6)
  v_mfma_f32_32x32x16_bf16 v[80:95], v[176:179], v[24:27], v[80:95]
  ds_read_b64_tr_b16 v[40:41], v8 offset:2048
  ds_read_b64_tr_b16 v[42:43], v8 offset:3072
  s_waitcnt lgkmcnt(6)
  v_mfma_f32_32x32x16_bf16 v[96:111], v[176:179], v[28:31], v[96:111]
  ds_read_b64_tr_b16 v[44:45], v9 offset:2048
  ds_read_b64_tr_b16 v[46:47], v9 offset:3072
  s_waitcnt lgkmcnt(6)
  v_mfma_f32_32x32x16_bf16 v[48:63], v[180:183], v[32:35], v[48:63]
  ds_read_b64_tr_b16 v[16:17], v6 offset:8192
  ds_read_b64_tr_b16 v[18:19], v6 offset:9216
  s_add_u32 m0, s58, 32768
  s_mul_i32 s57, s54, 128
  s_add_u32 s57, s57, s55
  buffer_load_dwordx4 v11, s[48:51], s57 offen lds
  s_waitcnt lgkmcnt(6)
  v_mfma_f32_32x32x16_bf16 v[64:79], v[180:183], v[36:39], v[64:79]
  ds_read_b64_tr_b16 v[20:21], v7 offset:8192
  ds_read_b64_tr_b16 v[22:23], v7 offset:9216
  s_waitcnt lgkmcnt(6)
  v_mfma_f32_32x32x16_bf16 v[80:95], v[180:183], v[40:43], v[80:95]
  ds_read_b64_tr_b16 v[24:25], v8 offset:8192
  ds_read_b64_tr_b16 v[26:27], v8 offset:9216
  s_waitcnt lgkmcnt(6)
  v_mfma_f32_32x32x16_bf16 v[96:111], v[180:183], v[44:47], v[96:111]
  ds_read_b64_tr_b16 v[28:29], v9 offset:8192
  ds_read_b64_tr_b16 v[30:31], v9 offset:9216
  s_waitcnt lgkmcnt(6)
  v_mfma_f32_32x32x16_bf16 v[48:63], v[184:187], v[16:19], v[48:63]
  ds_read_b64_tr_b16 v[32:33], v6 offset:10240
  ds_read_b64_tr_b16 v[34:35], v6 offset:11264
  s_waitcnt lgkmcnt(6)
  v_mfma_f32_32x32x16_bf16 v[64:79], v[184:187], v[20:23], v[64:79]
  ds_read_b64_tr_b16 v[36:37], v7 offset:10240
  ds_read_b64_tr_b16 v[38:39], v7 offset:11264
  s_waitcnt lgkmcnt(6)
  v_mfma_f32_32x32x16_bf16 v[80:95], v[184:187], v[24:27], v[80:95]
  ds_read_b64_tr_b16 v[40:41], v8 offset:10240
  ds_read_b64_tr_b16 v[42:43], v8 offset:11264
  s_waitcnt lgkmcnt(6)
  v_mfma_f32_32x32x16_bf16 v[96:111], v[184:187], v[28:31], v[96:111]
  ds_read_b64_tr_b16 v[44:45], v9 offset:10240
  ds_read_b64_tr_b16 v[46:47], v9 offset:11264
  s_waitcnt lgkmcnt(6)
  v_mfma_f32_32x32x16_bf16 v[48:63], v[188:191], v[32:35], v[48:63]
  ds_read_b64_tr_b16 v[16:17], v6 offset:16384
  ds_read_b64_tr_b16 v[18:19], v6 offset:17408
  s_add_u32 m0, s58, 33792
  s_mul_i32 s57, s54, 132
  s_add_u32 s57, s57, s55
  buffer_load_dwordx4 v11, s[48:51], s57 offen lds
  s_waitcnt lgkmcnt(6)
  v_mfma_f32_32x32x16_bf16 v[64:79], v[188:191], v[36:39], v[64:79]
  ds_read_b64_tr_b16 v[20:21], v7 offset:16384
  ds_read_b64_tr_b16 v[22:23], v7 offset:17408
  s_waitcnt lgkmcnt(6)
  v_mfma_f32_32x32x16_bf16 v[80:95], v[188:191], v[40:43], v[80:95]
  ds_read_b64_tr_b16 v[24:25], v8 offset:16384
  ds_read_b64_tr_b16 v[26:27], v8 offset:17408
  s_waitcnt lgkmcnt(6)
  v_mfma_f32_32x32x16_bf16 v[96:111], v[188:191], v[44:47], v[96:111]
  ds_read_b64_tr_b16 v[28:29], v9 offset:16384
  ds_read_b64_tr_b16 v[30:31], v9 offset:17408
  s_waitcnt lgkmcnt(6)
  v_mfma_f32_32x32x16_bf16 v[48:63], v[192:195], v[16:19], v[48:63]
  ds_read_b64_tr_b16 v[32:33], v6 offset:18432
  ds_read_b64_tr_b16 v[34:35], v6 offset:19456
  s_waitcnt lgkmcnt(6)
  v_mfma_f32_32x32x16_bf16 v[64:79], v[192:195], v[20:23], v[64:79]
  ds_read_b64_tr_b16 v[36:37], v7 offset:18432
  ds_read_b64_tr_b16 v[38:39], v7 offset:19456
  s_waitcnt lgkmcnt(6)
  v_mfma_f32_32x32x16_bf16 v[80:95], v[192:195], v[24:27], v[80:95]
  ds_read_b64_tr_b16 v[40:41], v8 offset:18432
  ds_read_b64_tr_b16 v[42:43], v8 offset:19456
  s_waitcnt lgkmcnt(6)
  v_mfma_f32_32x32x16_bf16 v[96:111], v[192:195], v[28:31], v[96:111]
  ds_read_b64_tr_b16 v[44:45], v9 offset:18432
  ds_read_b64_tr_b16 v[46:47], v9 offset:19456
  s_waitcnt lgkmcnt(6)
  v_mfma_f32_32x32x16_bf16 v[48:63], v[196:199], v[32:35], v[48:63]
  ds_read_b64_tr_b16 v[16:17], v6 offset:24576
  ds_read_b64_tr_b16 v[18:19], v6 offset:25600
  s_add_u32 m0, s58, 34816
  s_mul_i32 s57, s54, 136
  s_add_u32 s57, s57, s55
  buffer_load_dwordx4 v11, s[48:51], s57 offen lds
  s_waitcnt lgkmcnt(6)
  v_mfma_f32_32x32x16_bf16 v[64:79], v[196:199], v[36:39], v[64:79]
  ds_read_b64_tr_b16 v[20:21], v7 offset:24576
  ds_read_b64_tr_b16 v[22:23], v7 offset:25600
  s_waitcnt lgkmcnt(6)
  v_mfma_f32_32x32x16_bf16 v[80:95], v[196:199], v[40:43], v[80:95]
  ds_read_b64_tr_b16 v[24:25], v8 offset:24576
  ds_read_b64_tr_b16 v[26:27], v8 offset:25600
  s_waitcnt lgkmcnt(6)
  v_mfma_f32_32x32x16_bf16 v[96:111], v[196:199], v[44:47], v[96:111]
  ds_read_b64_tr_b16 v[28:29], v9 offset:24576
  ds_read_b64_tr_b16 v[30:31], v9 offset:25600
  s_waitcnt lgkmcnt(6)
  v_mfma_f32_32x32x16_bf16 v[48:63], v[200:203], v[16:19], v[48:63]
  ds_read_b64_tr_b16 v[32:33], v6 offset:26624
  ds_read_b64_tr_b16 v[34:35], v6 offset:27648
  s_waitcnt lgkmcnt(6)
  v_mfma_f32_32x32x16_bf16 v[64:79], v[200:203], v[20:23], v[64:79]
  ds_read_b64_tr_b16 v[36:37], v7 offset:26624
  ds_read_b64_tr_b16 v[38:39], v7 offset:27648
  s_waitcnt lgkmcnt(6)
  v_mfma_f32_32x32x16_bf16 v[80:95], v[200:203], v[24:27], v[80:95]
  ds_read_b64_tr_b16 v[40:41], v8 offset:26624
  ds_read_b64_tr_b16 v[42:43], v8 offset:27648
  s_waitcnt lgkmcnt(6)
  v_mfma_f32_32x32x16_bf16 v[96:111], v[200:203], v[28:31], v[96:111]
  ds_read_b64_tr_b16 v[44:45], v9 offset:26624
  ds_read_b64_tr_b16 v[46:47], v9 offset:27648
  s_waitcnt lgkmcnt(6)
  v_mfma_f32_32x32x16_bf16 v[48:63], v[204:207], v[32:35], v[48:63]
  ds_read_b64_tr_b16 v[16:17], v6 offset:32768
  ds_read_b64_tr_b16 v[18:19], v6 offset:33792
  s_add_u32 m0, s58, 35840
  s_mul_i32 s57, s54, 140
  s_add_u32 s57, s57, s55
  buffer_load_dwordx4 v11, s[48:51], s57 offen lds
  s_waitcnt lgkmcnt(6)
  v_mfma_f32_32x32x16_bf16 v[64:79], v[204:207], v[36:39], v[64:79]
  ds_read_b64_tr_b16 v[20:21], v6 offset:34816
  ds_read_b64_tr_b16 v[22:23], v6 offset:35840
  s_waitcnt lgkmcnt(6)
  v_mfma_f32_32x32x16_bf16 v[80:95], v[204:207], v[40:43], v[80:95]
  ds_read_b64_tr_b16 v[24:25], v6 offset:40960
  ds_read_b64_tr_b16 v[26:27], v6 offset:41984
  s_waitcnt lgkmcnt(6)
  v_mfma_f32_32x32x16_bf16 v[96:111], v[204:207], v[44:47], v[96:111]
  ds_read_b64_tr_b16 v[28:29], v6 offset:43008
  ds_read_b64_tr_b16 v[30:31], v6 offset:44032
  s_waitcnt vmcnt(4)
  s_barrier
  s_mov_b32 s90, s56
  s_add_u32 s91, s56, 4096
  s_waitcnt lgkmcnt(6)
  v_mfma_f32_32x32x16_bf16 v[48:63], v[208:211], v[16:19], v[48:63]
  ds_read_b64_tr_b16 v[32:33], v6 offset:49152
  ds_read_b64_tr_b16 v[34:35], v6 offset:50176
  s_waitcnt lgkmcnt(6)
  v_mfma_f32_32x32x16_bf16 v[48:63], v[212:215], v[20:23], v[48:63]
  ds_read_b64_tr_b16 v[36:37], v6 offset:51200
  ds_read_b64_tr_b16 v[38:39], v6 offset:52224
  s_waitcnt lgkmcnt(6)
  v_mfma_f32_32x32x16_bf16 v[48:63], v[216:219], v[24:27], v[48:63]
  ds_read_b64_tr_b16 v[40:41], v6 offset:57344
  ds_read_b64_tr_b16 v[42:43], v6 offset:58368
  s_waitcnt lgkmcnt(6)
  v_mfma_f32_32x32x16_bf16 v[48:63], v[220:223], v[28:31], v[48:63]
  ds_read_b64_tr_b16 v[44:45], v6 offset:59392
  ds_read_b64_tr_b16 v[46:47], v6 offset:60416
  s_waitcnt lgkmcnt(6)
  v_mfma_f32_32x32x16_bf16 v[48:63], v[224:227], v[32:35], v[48:63]
  ds_read_b64_tr_b16 v[16:17], v7 offset:32768
  ds_read_b64_tr_b16 v[18:19], v7 offset:33792
  s_add_u32 m0, s58, 65536
  s_mul_i32 s57, s54, 256
  s_add_u32 s57, s57, s55
  buffer_load_dwordx4 v11, s[48:51], s57 offen lds
  s_waitcnt lgkmcnt(6)
  v_mfma_f32_32x32x16_bf16 v[48:63], v[228:231], v[36:39], v[48:63]
  ds_read_b64_tr_b16 v[20:21], v7 offset:34816
  ds_read_b64_tr_b16 v[22:23], v7 offset:35840
  s_waitcnt lgkmcnt(6)
  v_mfma_f32_32x32x16_bf16 v[48:63], v[232:235], v[40:43], v[48:63]
  ds_read_b64_tr_b16 v[24:25], v7 offset:40960
  ds_read_b64_tr_b16 v[26:27], v7 offset:41984
  s_waitcnt lgkmcnt(6)
  v_mfma_f32_32x32x16_bf16 v[48:63], v[236:239], v[44:47], v[48:63]
  ds_read_b64_tr_b16 v[28:29], v7 offset:43008
  ds_read_b64_tr_b16 v[30:31], v7 offset:44032
  s_waitcnt lgkmcnt(6)
  v_mfma_f32_32x32x16_bf16 v[64:79], v[208:211], v[16:19], v[64:79]
  ds_read_b64_tr_b16 v[32:33], v7 offset:49152
  ds_read_b64_tr_b16 v[34:35], v7 offset:50176
  s_waitcnt lgkmcnt(6)
  v_mfma_f32_32x32x16_bf16 v[64:79], v[212:215], v[20:23], v[64:79]
  ds_read_b64_tr_b16 v[36:37], v7 offset:51200
  ds_read_b64_tr_b16 v[38:39], v7 offset:52224
  s_waitcnt lgkmcnt(6)
  v_mfma_f32_32x32x16_bf16 v[64:79], v[216:219], v[24:27], v[64:79]
  ds_read_b64_tr_b16 v[40:41], v7 offset:57344
  ds_read_b64_tr_b16 v[42:43], v7 offset:58368
  s_waitcnt lgkmcnt(6)
  v_mfma_f32_32x32x16_bf16 v[64:79], v[220:223], v[28:31], v[64:79]
  ds_read_b64_tr_b16 v[44:45], v7 offset:59392
  ds_read_b64_tr_b16 v[46:47], v7 offset:60416
  v_cvt_pk_bf16_f32 v48, v48, v49
  v_cvt_pk_bf16_f32 v49, v50, v51
  v_cvt_pk_bf16_f32 v50, v52, v53
  v_cvt_pk_bf16_f32 v51, v54, v55
  buffer_store_dwordx4 v[48:51], v12, s[16:19], s90 offen offset:0 sc1
  v_cvt_pk_bf16_f32 v56, v56, v57
  v_cvt_pk_bf16_f32 v57, v58, v59
  v_cvt_pk_bf16_f32 v58, v60, v61
  v_cvt_pk_bf16_f32 v59, v62, v63
  buffer_store_dwordx4 v[56:59], v12, s[16:19], s90 offen offset:1024 sc1
  s_nop 1
  s_waitcnt lgkmcnt(6)
  v_mfma_f32_32x32x16_bf16 v[64:79], v[224:227], v[32:35], v[64:79]
  ds_read_b64_tr_b16 v[16:17], v8 offset:32768
  ds_read_b64_tr_b16 v[18:19], v8 offset:33792
  s_add_u32 m0, s58, 66560
  s_mul_i32 s57, s54, 260
  s_add_u32 s57, s57, s55
  buffer_load_dwordx4 v11, s[48:51], s57 offen lds
  s_waitcnt lgkmcnt(6)
  v_mfma_f32_32x32x16_bf16 v[64:79], v[228:231], v[36:39], v[64:79]
  ds_read_b64_tr_b16 v[20:21], v8 offset:34816
  ds_read_b64_tr_b16 v[22:23], v8 offset:35840
  s_waitcnt lgkmcnt(6)
  v_mfma_f32_32x32x16_bf16 v[64:79], v[232:235], v[40:43], v[64:79]
  ds_read_b64_tr_b16 v[24:25], v8 offset:40960
  ds_read_b64_tr_b16 v[26:27], v8 offset:41984
  s_waitcnt lgkmcnt(6)
  v_mfma_f32_32x32x16_bf16 v[64:79], v[236:239], v[44:47], v[64:79]
  ds_read_b64_tr_b16 v[28:29], v8 offset:43008
  ds_read_b64_tr_b16 v[30:31], v8 offset:44032
  s_waitcnt lgkmcnt(6)
  v_mfma_f32_32x32x16_bf16 v[80:95], v[208:211], v[16:19], v[80:95]
  ds_read_b64_tr_b16 v[32:33], v8 offset:49152
  ds_read_b64_tr_b16 v[34:35], v8 offset:50176
  s_waitcnt lgkmcnt(6)
  v_mfma_f32_32x32x16_bf16 v[80:95], v[212:215], v[20:23], v[80:95]
  ds_read_b64_tr_b16 v[36:37], v8 offset:51200
  ds_read_b64_tr_b16 v[38:39], v8 offset:52224
  s_waitcnt lgkmcnt(6)
  v_mfma_f32_32x32x16_bf16 v[80:95], v[216:219], v[24:27], v[80:95]
  ds_read_b64_tr_b16 v[40:41], v8 offset:57344
  ds_read_b64_tr_b16 v[42:43], v8 offset:58368
  s_waitcnt lgkmcnt(6)
  v_mfma_f32_32x32x16_bf16 v[80:95], v[220:223], v[28:31], v[80:95]
  ds_read_b64_tr_b16 v[44:45], v8 offset:59392
  ds_read_b64_tr_b16 v[46:47], v8 offset:60416
  v_cvt_pk_bf16_f32 v64, v64, v65
  v_cvt_pk_bf16_f32 v65, v66, v67
  v_cvt_pk_bf16_f32 v66, v68, v69
  v_cvt_pk_bf16_f32 v67, v70, v71
  buffer_store_dwordx4 v[64:67], v12, s[16:19], s90 offen offset:2048 sc1
  v_cvt_pk_bf16_f32 v72, v72, v73
  v_cvt_pk_bf16_f32 v73, v74, v75
  v_cvt_pk_bf16_f32 v74, v76, v77
  v_cvt_pk_bf16_f32 v75, v78, v79
  buffer_store_dwordx4 v[72:75], v12, s[16:19], s90 offen offset:3072 sc1
  s_nop 1
  s_waitcnt lgkmcnt(6)
  v_mfma_f32_32x32x16_bf16 v[80:95], v[224:227], v[32:35], v[80:95]
  ds_read_b64_tr_b16 v[16:17], v9 offset:32768
  ds_read_b64_tr_b16 v[18:19], v9 offset:33792
  s_add_u32 m0, s58, 67584
  s_mul_i32 s57, s54, 264
  s_add_u32 s57, s57, s55
  buffer_load_dwordx4 v11, s[48:51], s57 offen lds
  s_waitcnt lgkmcnt(6)
  v_mfma_f32_32x32x16_bf16 v[80:95], v[228:231], v[36:39], v[80:95]
  ds_read_b64_tr_b16 v[20:21], v9 offset:34816
  ds_read_b64_tr_b16 v[22:23], v9 offset:35840
  s_waitcnt lgkmcnt(6)
  v_mfma_f32_32x32x16_bf16 v[80:95], v[232:235], v[40:43], v[80:95]
  ds_read_b64_tr_b16 v[24:25], v9 offset:40960
  ds_read_b64_tr_b16 v[26:27], v9 offset:41984
  s_waitcnt lgkmcnt(6)
  v_mfma_f32_32x32x16_bf16 v[80:95], v[236:239], v[44:47], v[80:95]
  ds_read_b64_tr_b16 v[28:29], v9 offset:43008
  ds_read_b64_tr_b16 v[30:31], v9 offset:44032
  s_waitcnt lgkmcnt(6)
  v_mfma_f32_32x32x16_bf16 v[96:111], v[208:211], v[16:19], v[96:111]
  ds_read_b64_tr_b16 v[32:33], v9 offset:49152
  ds_read_b64_tr_b16 v[34:35], v9 offset:50176
  s_waitcnt lgkmcnt(6)
  v_mfma_f32_32x32x16_bf16 v[96:111], v[212:215], v[20:23], v[96:111]
  ds_read_b64_tr_b16 v[36:37], v9 offset:51200
  ds_read_b64_tr_b16 v[38:39], v9 offset:52224
  s_waitcnt lgkmcnt(6)
  v_mfma_f32_32x32x16_bf16 v[96:111], v[216:219], v[24:27], v[96:111]
  ds_read_b64_tr_b16 v[40:41], v9 offset:57344
  ds_read_b64_tr_b16 v[42:43], v9 offset:58368
  s_waitcnt lgkmcnt(6)
  v_mfma_f32_32x32x16_bf16 v[96:111], v[220:223], v[28:31], v[96:111]
  ds_read_b64_tr_b16 v[44:45], v9 offset:59392
  ds_read_b64_tr_b16 v[46:47], v9 offset:60416
  v_cvt_pk_bf16_f32 v80, v80, v81
  v_cvt_pk_bf16_f32 v81, v82, v83
  v_cvt_pk_bf16_f32 v82, v84, v85
  v_cvt_pk_bf16_f32 v83, v86, v87
  buffer_store_dwordx4 v[80:83], v12, s[16:19], s91 offen offset:0 sc1
  v_cvt_pk_bf16_f32 v88, v88, v89
  v_cvt_pk_bf16_f32 v89, v90, v91
  v_cvt_pk_bf16_f32 v90, v92, v93
  v_cvt_pk_bf16_f32 v91, v94, v95
  buffer_store_dwordx4 v[88:91], v12, s[16:19], s91 offen offset:1024 sc1
  s_nop 1
  s_waitcnt lgkmcnt(6)
  v_mfma_f32_32x32x16_bf16 v[96:111], v[224:227], v[32:35], v[96:111]
  ds_read_b64_tr_b16 v[16:17], v2 offset:0
  ds_read_b64_tr_b16 v[18:19], v2 offset:1024
  s_add_u32 m0, s58, 68608
  s_mul_i32 s57, s54, 268
  s_add_u32 s57, s57, s55
  buffer_load_dwordx4 v11, s[48:51], s57 offen lds
  s_waitcnt lgkmcnt(6)
  v_mfma_f32_32x32x16_bf16 v[96:111], v[228:231], v[36:39], v[96:111]
  ds_read_b64_tr_b16 v[20:21], v3 offset:0
  ds_read_b64_tr_b16 v[22:23], v3 offset:1024
  s_waitcnt lgkmcnt(6)
  v_mfma_f32_32x32x16_bf16 v[96:111], v[232:235], v[40:43], v[96:111]
  ds_read_b64_tr_b16 v[24:25], v4 offset:0
  ds_read_b64_tr_b16 v[26:27], v4 offset:1024
  s_waitcnt lgkmcnt(6)
  v_mfma_f32_32x32x16_bf16 v[96:111], v[236:239], v[44:47], v[96:111]
  ds_read_b64_tr_b16 v[28:29], v5 offset:0
  ds_read_b64_tr_b16 v[30:31], v5 offset:1024
  s_nop 15
  v_cvt_pk_bf16_f32 v96, v96, v97
  v_cvt_pk_bf16_f32 v97, v98, v99
  v_cvt_pk_bf16_f32 v98, v100, v101
  v_cvt_pk_bf16_f32 v99, v102, v103
  buffer_store_dwordx4 v[96:99], v12, s[16:19], s91 offen offset:2048 sc1
  v_cvt_pk_bf16_f32 v104, v104, v105
  v_cvt_pk_bf16_f32 v105, v106, v107
  v_cvt_pk_bf16_f32 v106, v108, v109
  v_cvt_pk_bf16_f32 v107, v110, v111
  buffer_store_dwordx4 v[104:107], v12, s[16:19], s91 offen offset:3072 sc1
  s_nop 1
  s_mov_b32 s12, s48
  s_mov_b32 s13, s49
  s_mov_b32 s14, s50
  s_mov_b32 s52, s54
  s_mov_b32 s53, s55
  v_mov_b32 v10, v11
proj_end:
  s_cmp_ge_u32 s2, 96
  s_cbranch_scc1 gb_noinit
  s_load_dwordx2 s[8:9], s[0:1], 104
  s_mov_b32 s10, 0x10000000
  s_mov_b32 s11, 0x20000
  s_lshl_b32 s12, s2, 12
  s_add_u32 s12, s12, 0x6400000
  v_mov_b32 v1, 0
  v_mov_b32 v2, 0
  s_waitcnt lgkmcnt(0)
  buffer_store_dword v1, v2, s[8:11], s12 offen sc0 sc1
gb_noinit:
  s_waitcnt vmcnt(0) lgkmcnt(0)
  s_barrier
  v_lshrrev_b32 v1, 6, v0
  s_nop 0
  v_readfirstlane_b32 s6, v1
  s_cmp_lg_u32 s6, 0
  s_cbranch_scc1 gb_wait0
  s_load_dwordx2 s[8:9], s[0:1], 96
  s_load_dwordx2 s[24:25], s[0:1], 104
  s_mov_b32 s10, 256
  s_mov_b32 s11, 0x20000
  s_mov_b32 s26, 0x10000000
  s_mov_b32 s27, 0x20000
  s_mov_b64 exec, 1
  v_mov_b32 v1, 1
  v_mov_b32 v2, 0
  s_waitcnt lgkmcnt(0)
  s_and_b32 s12, s2, 15
  v_mov_b32 v3, 1
  v_mov_b32 v4, 0
  s_lshl_b32 s12, s12, 2
  s_add_u32 s12, s12, 128
  buffer_atomic_add v3, v4, s[8:11], s12 offen sc0 sc1
  s_waitcnt vmcnt(0)
  v_readfirstlane_b32 s13, v3
  s_cmp_lg_u32 s13, 15
  s_cbranch_scc1 gb_nr0
  buffer_atomic_add v1, v2, s[8:11], 0 offen sc1
gb_nr0:
  s_mov_b32 s12, 0
gb_loop0:
  buffer_load_dword v3, v2, s[8:11], 0 offen sc1
  s_waitcnt vmcnt(0)
  v_readfirstlane_b32 s13, v3
  s_cmp_ge_u32 s13, 16
  s_cbranch_scc1 gb_done0
  s_add_u32 s12, s12, 1
  s_cmp_gt_u32 s12, 40000
  s_cbranch_scc1 gb_done0
  s_sleep 8
  s_branch gb_loop0
gb_done0:
  s_mov_b64 exec, -1
  s_waitcnt lgkmcnt(0)
gb_wait0:
  s_barrier
attn_kernel:
  s_load_dwordx2 s[8:9], s[0:1], 104
  v_lshrrev_b32 v1, 6, v0
  s_nop 0
  v_readfirstlane_b32 s6, v1
  v_and_b32 v1, 63, v0
  s_lshr_b32 s22, s6, 2
  s_and_b32 s23, s6, 3
  s_and_b32 s3, s2, 7
  s_lshl_b32 s3, s3, 2
  s_lshr_b32 s4, s2, 3
  s_and_b32 s4, s4, 3
  s_add_u32 s3, s3, s4
  s_lshr_b32 s4, s2, 5
  s_sub_u32 s5, 15, s4
  s_mov_b32 s24, 0
  s_mov_b32 s77, 1000000
  s_mov_b32 s10, 0x10000000
  s_mov_b32 s11, 0x20000
  s_lshl_b32 s12, s3, 19
  v_lshlrev_b32 v2, 4, v1
  s_lshl_b32 s13, s23, 11
  s_lshl_b32 s25, s22, 13
  s_add_u32 s25, s25, s13
  v_add_u32 v3, s25, v2
  s_lshl_b32 s26, s22, 14
  v_add_u32 v4, s26, v2
  s_add_u32 s27, s26, s13
  v_and_b32 v12, 31, v1
  v_lshrrev_b32 v13, 5, v1
  v_lshlrev_b32 v13, 2, v13
  v_sub_u32 v12, v12, v13
  v_cmp_le_i32 s[36:37], 0, v12
  v_cmp_le_i32 s[38:39], 1, v12
  v_cmp_le_i32 s[40:41], 2, v12
  v_cmp_le_i32 s[42:43], 3, v12
  v_cmp_le_i32 s[44:45], 8, v12
  v_cmp_le_i32 s[46:47], 9, v12
  v_cmp_le_i32 s[48:49], 10, v12
  v_cmp_le_i32 s[50:51], 11, v12
  v_cmp_le_i32 s[52:53], 16, v12
  v_cmp_le_i32 s[54:55], 17, v12
  v_cmp_le_i32 s[56:57], 18, v12
  v_cmp_le_i32 s[58:59], 19, v12
  v_cmp_le_i32 s[60:61], 24, v12
  v_cmp_le_i32 s[62:63], 25, v12
  v_cmp_le_i32 s[64:65], 26, v12
  v_cmp_le_i32 s[66:67], 27, v12
  v_mov_b32 v5, 0xf149f2ca
  s_waitcnt lgkmcnt(0)
  s_lshl_b32 s15, s5, 2
  s_add_u32 s15, s15, s23
  s_lshl_b32 s15, s15, 13
  s_add_u32 s15, s15, s12
  buffer_load_dwordx4 v[16:19], v2, s[8:11], s15 offen offset:0
  buffer_load_dwordx4 v[20:23], v2, s[8:11], s15 offen offset:1024
  buffer_load_dwordx4 v[24:27], v2, s[8:11], s15 offen offset:2048
  buffer_load_dwordx4 v[28:31], v2, s[8:11], s15 offen offset:3072
  s_add_u32 s15, s15, 4096
  buffer_load_dwordx4 v[32:35], v2, s[8:11], s15 offen offset:0
  buffer_load_dwordx4 v[36:39], v2, s[8:11], s15 offen offset:1024
  buffer_load_dwordx4 v[40:43], v2, s[8:11], s15 offen offset:2048
  buffer_load_dwordx4 v[44:47], v2, s[8:11], s15 offen offset:3072
  s_add_u32 s15, s15, 4096
  s_add_u32 s16, s12, 0x1000000
  s_add_u32 s17, s12, 0x2000000
  s_mov_b32 s28, 98304
  s_mov_b32 s78, 0
  s_mov_b32 s79, -1
  s_add_u32 m0, s27, s28
  s_cmp_eq_u32 s78, s79
  s_cselect_b32 s16, s80, s16
  s_cselect_b32 s17, s81, s17
  s_add_u32 s78, s78, 1
  buffer_load_dwordx4 v3, s[8:11], s16 offen offset:0 lds
  buffer_load_dwordx4 v3, s[8:11], s16 offen offset:1024 lds
  s_add_u32 m0, m0, 8192
  s_add_u32 s16, s16, 16384
  buffer_load_dwordx4 v3, s[8:11], s17 offen offset:0 lds
  buffer_load_dwordx4 v3, s[8:11], s17 offen offset:1024 lds
  s_add_u32 s17, s17, 16384
  s_add_u32 s28, s28, 32768
  s_cmp_ge_u32 s28, 163840
  s_cselect_b32 s28, 0, s28
  s_add_u32 m0, s27, s28
  s_cmp_eq_u32 s78, s79
  s_cselect_b32 s16, s80, s16
  s_cselect_b32 s17, s81, s17
  s_add_u32 s78, s78, 1
  buffer_load_dwordx4 v3, s[8:11], s16 offen offset:0 lds
  buffer_load_dwordx4 v3, s[8:11], s16 offen offset:1024 lds
  s_add_u32 m0, m0, 8192
  s_add_u32 s16, s16, 16384
  buffer_load_dwordx4 v3, s[8:11], s17 offen offset:0 lds
  buffer_load_dwordx4 v3, s[8:11], s17 offen offset:1024 lds
  s_add_u32 s17, s17, 16384
  s_add_u32 s28, s28, 32768
  s_cmp_ge_u32 s28, 163840
  s_cselect_b32 s28, 0, s28
  s_add_u32 m0, s27, s28
  s_cmp_eq_u32 s78, s79
  s_cselect_b32 s16, s80, s16
  s_cselect_b32 s17, s81, s17
  s_add_u32 s78, s78, 1
  buffer_load_dwordx4 v3, s[8:11], s16 offen offset:0 lds
  buffer_load_dwordx4 v3, s[8:11], s16 offen offset:1024 lds
  s_add_u32 m0, m0, 8192
  s_add_u32 s16, s16, 16384
  buffer_load_dwordx4 v3, s[8:11], s17 offen offset:0 lds
  buffer_load_dwordx4 v3, s[8:11], s17 offen offset:1024 lds
  s_add_u32 s17, s17, 16384
  s_add_u32 s28, s28, 32768
  s_cmp_ge_u32 s28, 163840
  s_cselect_b32 s28, 0, s28
  s_add_u32 m0, s27, s28
  s_cmp_eq_u32 s78, s79
  s_cselect_b32 s16, s80, s16
  s_cselect_b32 s17, s81, s17
  s_add_u32 s78, s78, 1
  buffer_load_dwordx4 v3, s[8:11], s16 offen offset:0 lds
  buffer_load_dwordx4 v3, s[8:11], s16 offen offset:1024 lds
  s_add_u32 m0, m0, 8192
  s_add_u32 s16, s16, 16384
  buffer_load_dwordx4 v3, s[8:11], s17 offen offset:0 lds
  buffer_load_dwordx4 v3, s[8:11], s17 offen offset:1024 lds
  s_add_u32 s17, s17, 16384
  s_add_u32 s28, s28, 32768
  s_cmp_ge_u32 s28, 163840
  s_cselect_b32 s28, 0, s28
  s_mov_b32 s32, 98304
  s_add_u32 s80, s12, 0x1000000
  s_add_u32 s81, s12, 0x2000000
  s_lshl_b32 s82, s4, 2
  s_add_u32 s82, s82, s23
  s_lshl_b32 s82, s82, 13
  s_add_u32 s82, s82, s12
  s_add_u32 s83, s82, 4096
attn_tile:
  s_lshl_b32 s14, s5, 2
  s_add_u32 s14, s14, s23
  s_mov_b32 s30, s14
  s_lshl_b32 s79, s5, 1
  s_add_u32 s79, s79, 2
  s_mov_b32 s33, s32
  v_add_u32 v6, s32, v4
  v_add_u32 v7, s32, v4
  v_mov_b32 v8, 0
  s_mov_b32 s34, 0xbf800000
  s_mov_b32 s35, 0xff7fffff
  v_mov_b32 v216, 0
  v_mov_b32 v217, 0
  v_mov_b32 v218, 0
  v_mov_b32 v219, 0
  v_mov_b32 v220, 0
  v_mov_b32 v221, 0
  v_mov_b32 v222, 0
  v_mov_b32 v223, 0
  v_mov_b32 v224, 0
  v_mov_b32 v225, 0
  v_mov_b32 v226, 0
  v_mov_b32 v227, 0
  v_mov_b32 v228, 0
  v_mov_b32 v229, 0
  v_mov_b32 v230, 0
  v_mov_b32 v231, 0
  v_mov_b32 v9, 0
  v_mov_b32 v48, 0
  v_mov_b32 v49, 0
  v_mov_b32 v50, 0
  v_mov_b32 v51, 0
  v_mov_b32 v52, 0
  v_mov_b32 v53, 0
  v_mov_b32 v54, 0
  v_mov_b32 v55, 0
  v_mov_b32 v56, 0
  v_mov_b32 v57, 0
  v_mov_b32 v58, 0
  v_mov_b32 v59, 0
  v_mov_b32 v60, 0
  v_mov_b32 v61, 0
  v_mov_b32 v62, 0
  v_mov_b32 v63, 0
  v_mov_b32 v64, 0
  v_mov_b32 v65, 0
  v_mov_b32 v66, 0
  v_mov_b32 v67, 0
  v_mov_b32 v68, 0
  v_mov_b32 v69, 0
  v_mov_b32 v70, 0
  v_mov_b32 v71, 0
  v_mov_b32 v72, 0
  v_mov_b32 v73, 0
  v_mov_b32 v74, 0
  v_mov_b32 v75, 0
  v_mov_b32 v76, 0
  v_mov_b32 v77, 0
  v_mov_b32 v78, 0
  v_mov_b32 v79, 0
  v_mov_b32 v80, 0
  v_mov_b32 v81, 0
  v_mov_b32 v82, 0
  v_mov_b32 v83, 0
  v_mov_b32 v84, 0
  v_mov_b32 v85, 0
  v_mov_b32 v86, 0
  v_mov_b32 v87, 0
  v_mov_b32 v88, 0
  v_mov_b32 v89, 0
  v_mov_b32 v90, 0
  v_mov_b32 v91, 0
  v_mov_b32 v92, 0
  v_mov_b32 v93, 0
  v_mov_b32 v94, 0
  v_mov_b32 v95, 0
  v_mov_b32 v96, 0
  v_mov_b32 v97, 0
  v_mov_b32 v98, 0
  v_mov_b32 v99, 0
  v_mov_b32 v100, 0
  v_mov_b32 v101, 0
  v_mov_b32 v102, 0
  v_mov_b32 v103, 0
  v_mov_b32 v104, 0
  v_mov_b32 v105, 0
  v_mov_b32 v106, 0
  v_mov_b32 v107, 0
  v_mov_b32 v108, 0
  v_mov_b32 v109, 0
  v_mov_b32 v110, 0
  v_mov_b32 v111, 0
  s_lshl_b32 s19, s5, 1
  s_mov_b32 s18, 0
  s_waitcnt vmcnt(8)
  s_cmp_eq_u32 s24, 0
  s_cbranch_scc1 attn_w2
  s_waitcnt vmcnt(4)
attn_w2:
  s_barrier
  ds_read_b128 v[152:155], v7 offset:0
  ds_read_b128 v[156:159], v7 offset:1024
  ds_read_b128 v[160:163], v7 offset:2048
  ds_read_b128 v[164:167], v7 offset:3072
  ds_read_b128 v[168:171], v7 offset:4096
  ds_read_b128 v[172:175], v7 offset:5120
  ds_read_b128 v[176:179], v7 offset:6144
  ds_read_b128 v[180:183], v7 offset:7168
  s_add_u32 s33, s33, 32768
  s_cmp_ge_u32 s33, 163840
  s_cselect_b32 s33, 0, s33
  v_add_u32 v7, s33, v4
  s_cmp_eq_u32 s24, 0
  s_cbranch_scc1 attn_w3
  s_mov_b32 s78, 2
  s_add_u32 m0, s27, s28
  s_cmp_eq_u32 s78, s79
  s_cselect_b32 s16, s80, s16
  s_cselect_b32 s17, s81, s17
  s_add_u32 s78, s78, 1
  buffer_load_dwordx4 v3, s[8:11], s16 offen offset:0 lds
  buffer_load_dwordx4 v3, s[8:11], s16 offen offset:1024 lds
  s_add_u32 m0, m0, 8192
  s_add_u32 s16, s16, 16384
  buffer_load_dwordx4 v3, s[8:11], s17 offen offset:0 lds
  buffer_load_dwordx4 v3, s[8:11], s17 offen offset:1024 lds
  s_add_u32 s17, s17, 16384
  s_add_u32 s28, s28, 32768
  s_cmp_ge_u32 s28, 163840
  s_cselect_b32 s28, 0, s28
  s_add_u32 m0, s27, s28
  s_cmp_eq_u32 s78, s79
  s_cselect_b32 s16, s80, s16
  s_cselect_b32 s17, s81, s17
  s_add_u32 s78, s78, 1
  buffer_load_dwordx4 v3, s[8:11], s16 offen offset:0 lds
  buffer_load_dwordx4 v3, s[8:11], s16 offen offset:1024 lds
  s_add_u32 m0, m0, 8192
  s_add_u32 s16, s16, 16384
  buffer_load_dwordx4 v3, s[8:11], s17 offen offset:0 lds
  buffer_load_dwordx4 v3, s[8:11], s17 offen offset:1024 lds
  s_add_u32 s17, s17, 16384
  s_add_u32 s28, s28, 32768
  s_cmp_ge_u32 s28, 163840
  s_cselect_b32 s28, 0, s28
attn_w3:
  s_waitcnt lgkmcnt(0)
  v_mfma_f32_32x32x16_bf16 v[112:127], v[152:155], v[16:19], v[216:231]
  v_mfma_f32_32x32x16_bf16 v[112:127], v[156:159], v[20:23], v[112:127]
  v_mfma_f32_32x32x16_bf16 v[112:127], v[160:163], v[24:27], v[112:127]
  v_mfma_f32_32x32x16_bf16 v[112:127], v[164:167], v[28:31], v[112:127]
  v_mfma_f32_32x32x16_bf16 v[112:127], v[168:171], v[32:35], v[112:127]
  v_mfma_f32_32x32x16_bf16 v[112:127], v[172:175], v[36:39], v[112:127]
  v_mfma_f32_32x32x16_bf16 v[112:127], v[176:179], v[40:43], v[112:127]
  v_mfma_f32_32x32x16_bf16 v[112:127], v[180:183], v[44:47], v[112:127]
  ds_read_b128 v[152:155], v7 offset:0
  ds_read_b128 v[156:159], v7 offset:1024
  ds_read_b128 v[160:163], v7 offset:2048
  ds_read_b128 v[164:167], v7 offset:3072
  ds_read_b128 v[168:171], v7 offset:4096
  ds_read_b128 v[172:175], v7 offset:5120
  ds_read_b128 v[176:179], v7 offset:6144
  ds_read_b128 v[180:183], v7 offset:7168
  s_add_u32 s33, s33, 32768
  s_cmp_ge_u32 s33, 163840
  s_cselect_b32 s33, 0, s33
  v_add_u32 v7, s33, v4
  s_nop 7
  s_cmp_lg_u32 s5, 0
  s_cbranch_scc1 attn_im_nomask
  s_lshl_b32 s29, s18, 1
  s_add_u32 s29, s29, s22
  s_cmp_lt_u32 s29, s30
  s_cbranch_scc1 attn_im_nomask
  s_cmp_eq_u32 s29, s30
  s_cbranch_scc1 attn_im_tri
  v_mov_b32 v112, v5
  v_mov_b32 v113, v5
  v_mov_b32 v114, v5
  v_mov_b32 v115, v5
  v_mov_b32 v116, v5
  v_mov_b32 v117, v5
  v_mov_b32 v118, v5
  v_mov_b32 v119, v5
  v_mov_b32 v120, v5
  v_mov_b32 v121, v5
  v_mov_b32 v122, v5
  v_mov_b32 v123, v5
  v_mov_b32 v124, v5
  v_mov_b32 v125, v5
  v_mov_b32 v126, v5
  v_mov_b32 v127, v5
  s_branch attn_im_nomask
attn_im_tri:
  v_cndmask_b32 v112, v5, v112, s[36:37]
  v_cndmask_b32 v113, v5, v113, s[38:39]
  v_cndmask_b32 v114, v5, v114, s[40:41]
  v_cndmask_b32 v115, v5, v115, s[42:43]
  v_cndmask_b32 v116, v5, v116, s[44:45]
  v_cndmask_b32 v117, v5, v117, s[46:47]
  v_cndmask_b32 v118, v5, v118, s[48:49]
  v_cndmask_b32 v119, v5, v119, s[50:51]
  v_cndmask_b32 v120, v5, v120, s[52:53]
  v_cndmask_b32 v121, v5, v121, s[54:55]
  v_cndmask_b32 v122, v5, v122, s[56:57]
  v_cndmask_b32 v123, v5, v123, s[58:59]
  v_cndmask_b32 v124, v5, v124, s[60:61]
  v_cndmask_b32 v125, v5, v125, s[62:63]
  v_cndmask_b32 v126, v5, v126, s[64:65]
  v_cndmask_b32 v127, v5, v127, s[66:67]
attn_im_nomask:
  v_max3_f32 v10, v112, v113, v114
  v_max3_f32 v11, v115, v116, v117
  v_max3_f32 v10, v10, v118, v119
  v_max3_f32 v11, v11, v120, v121
  v_max3_f32 v10, v10, v122, v123
  v_max3_f32 v11, v11, v124, v125
  v_max3_f32 v10, v10, v126, v127
  v_max_f32 v10, v10, v11
  v_mov_b32 v11, v10
  s_nop 1
  v_permlane32_swap_b32 v10, v11
  s_nop 0
  v_max_f32 v10, v10, v11
  s_mov_b32 s34, 0x53800000
  s_mov_b32 s35, 0
  v_mov_b32 v8, v10
  v_sub_f32 v112, v112, v10
  v_sub_f32 v113, v113, v10
  v_sub_f32 v114, v114, v10
  v_sub_f32 v115, v115, v10
  v_sub_f32 v116, v116, v10
  v_sub_f32 v117, v117, v10
  v_sub_f32 v118, v118, v10
  v_sub_f32 v119, v119, v10
  v_sub_f32 v120, v120, v10
  v_sub_f32 v121, v121, v10
  v_sub_f32 v122, v122, v10
  v_sub_f32 v123, v123, v10
  v_sub_f32 v124, v124, v10
  v_sub_f32 v125, v125, v10
  v_sub_f32 v126, v126, v10
  v_sub_f32 v127, v127, v10
  v_sub_f32 v216, 0, v10
  v_sub_f32 v217, 0, v10
  v_sub_f32 v218, 0, v10
  v_sub_f32 v219, 0, v10
  v_sub_f32 v220, 0, v10
  v_sub_f32 v221, 0, v10
  v_sub_f32 v222, 0, v10
  v_sub_f32 v223, 0, v10
  v_sub_f32 v224, 0, v10
  v_sub_f32 v225, 0, v10
  v_sub_f32 v226, 0, v10
  v_sub_f32 v227, 0, v10
  v_sub_f32 v228, 0, v10
  v_sub_f32 v229, 0, v10
  v_sub_f32 v230, 0, v10
  v_sub_f32 v231, 0, v10
  s_cmp_eq_u32 s22, 1
  s_cbranch_scc1 attn_g1
  s_cmp_eq_u32 s5, 0
  s_cbranch_scc1 attn_diag0
attn_loop0:
  s_waitcnt vmcnt(4) lgkmcnt(0)
  s_barrier
  s_waitcnt lgkmcnt(0)
  v_mfma_f32_32x32x16_bf16 v[128:143], v[152:155], v[16:19], v[216:231]
  v_exp_f32 v232, v112
  v_exp_f32 v233, v113
  v_exp_f32 v234, v114
  ds_read_b128 v[184:187], v6 offset:8192
  v_exp_f32 v235, v115
  v_cvt_pk_bf16_f32 v144, v232, v233
  v_mfma_f32_32x32x16_bf16 v[128:143], v[156:159], v[20:23], v[128:143]
  v_add_f32 v13, v232, v233
  ds_read_b128 v[188:191], v6 offset:9216
  v_exp_f32 v236, v116
  v_exp_f32 v237, v117
  v_cvt_pk_bf16_f32 v145, v234, v235
  ds_read_b128 v[192:195], v6 offset:10240
  v_mfma_f32_32x32x16_bf16 v[128:143], v[160:163], v[24:27], v[128:143]
  v_add_f32 v14, v234, v235
  v_exp_f32 v238, v118
  v_exp_f32 v239, v119
  ds_read_b128 v[196:199], v6 offset:11264
  v_cvt_pk_bf16_f32 v146, v236, v237
  v_add_f32 v13, v13, v236
  v_add_f32 v14, v14, v237
  v_mfma_f32_32x32x16_bf16 v[128:143], v[164:167], v[28:31], v[128:143]
  ds_read_b128 v[200:203], v6 offset:12288
  v_exp_f32 v240, v120
  v_exp_f32 v241, v121
  v_cvt_pk_bf16_f32 v147, v238, v239
  ds_read_b128 v[204:207], v6 offset:13312
  v_add_f32 v13, v13, v238
  v_mfma_f32_32x32x16_bf16 v[128:143], v[168:171], v[32:35], v[128:143]
  v_add_f32 v14, v14, v239
  v_exp_f32 v242, v122
  ds_read_b128 v[208:211], v6 offset:14336
  v_exp_f32 v243, v123
  v_cvt_pk_bf16_f32 v148, v240, v241
  v_add_f32 v13, v13, v240
  v_mfma_f32_32x32x16_bf16 v[128:143], v[172:175], v[36:39], v[128:143]
  ds_read_b128 v[212:215], v6 offset:15360
  v_add_f32 v14, v14, v241
  v_exp_f32 v244, v124
  v_exp_f32 v245, v125
  s_add_u32 s32, s32, 32768
  v_cvt_pk_bf16_f32 v149, v242, v243
  v_add_f32 v13, v13, v242
  v_mfma_f32_32x32x16_bf16 v[128:143], v[176:179], v[40:43], v[128:143]
  v_add_f32 v14, v14, v243
  s_cmp_ge_u32 s32, 163840
  v_exp_f32 v246, v126
  v_exp_f32 v247, v127
  v_cvt_pk_bf16_f32 v150, v244, v245
  s_cselect_b32 s32, 0, s32
  v_mfma_f32_32x32x16_bf16 v[128:143], v[180:183], v[44:47], v[128:143]
  v_add_f32 v13, v13, v244
  v_add_f32 v14, v14, v245
  v_add_f32 v13, v13, v14
  v_add_u32 v6, s32, v4
  v_cvt_pk_bf16_f32 v151, v246, v247
  v_add_f32 v14, v246, v247
  v_add_f32 v13, v13, v14
  v_cmp_lt_f32 vcc, s34, v13
  s_nop 1
  s_cbranch_vccnz attn_it1_rs
attn_it1_nors:
  v_add_f32 v9, v9, v13
  s_add_u32 s18, s18, 1
  s_waitcnt lgkmcnt(0)
  s_nop 0
  v_mfma_f32_32x32x16_bf16 v[48:63], v[184:187], v[144:147], v[48:63]
  ds_read_b128 v[152:155], v7 offset:0
  ds_read_b128 v[156:159], v7 offset:1024
  ds_read_b128 v[160:163], v7 offset:2048
  v_mfma_f32_32x32x16_bf16 v[64:79], v[192:195], v[144:147], v[64:79]
  ds_read_b128 v[164:167], v7 offset:3072
  ds_read_b128 v[168:171], v7 offset:4096
  s_add_u32 m0, s27, s28
  s_cmp_eq_u32 s78, s79
  s_cselect_b32 s16, s80, s16
  s_cselect_b32 s17, s81, s17
  s_add_u32 s78, s78, 1
  buffer_load_dwordx4 v3, s[8:11], s16 offen offset:0 lds
  v_mfma_f32_32x32x16_bf16 v[80:95], v[200:203], v[144:147], v[80:95]
  ds_read_b128 v[172:175], v7 offset:5120
  ds_read_b128 v[176:179], v7 offset:6144
  ds_read_b128 v[180:183], v7 offset:7168
  v_mfma_f32_32x32x16_bf16 v[96:111], v[208:211], v[144:147], v[96:111]
  s_add_u32 s33, s33, 32768
  s_cmp_ge_u32 s33, 163840
  s_cselect_b32 s33, 0, s33
  v_add_u32 v7, s33, v4
  buffer_load_dwordx4 v3, s[8:11], s16 offen offset:1024 lds
  v_mfma_f32_32x32x16_bf16 v[48:63], v[188:191], v[148:151], v[48:63]
  s_add_u32 m0, m0, 8192
  s_add_u32 s16, s16, 16384
  v_mfma_f32_32x32x16_bf16 v[64:79], v[196:199], v[148:151], v[64:79]
  buffer_load_dwordx4 v3, s[8:11], s17 offen offset:0 lds
  v_mfma_f32_32x32x16_bf16 v[80:95], v[204:207], v[148:151], v[80:95]
  buffer_load_dwordx4 v3, s[8:11], s17 offen offset:1024 lds
  v_mfma_f32_32x32x16_bf16 v[96:111], v[212:215], v[148:151], v[96:111]
  s_add_u32 s17, s17, 16384
  s_add_u32 s28, s28, 32768
  s_cmp_ge_u32 s28, 163840
  s_cselect_b32 s28, 0, s28
  s_waitcnt vmcnt(4) lgkmcnt(0)
  s_barrier
  s_waitcnt lgkmcnt(0)
  v_mfma_f32_32x32x16_bf16 v[112:127], v[152:155], v[16:19], v[216:231]
  v_exp_f32 v232, v128
  v_exp_f32 v233, v129
  v_exp_f32 v234, v130
  ds_read_b128 v[184:187], v6 offset:8192
  v_exp_f32 v235, v131
  v_cvt_pk_bf16_f32 v144, v232, v233
  v_mfma_f32_32x32x16_bf16 v[112:127], v[156:159], v[20:23], v[112:127]
  v_add_f32 v13, v232, v233
  ds_read_b128 v[188:191], v6 offset:9216
  v_exp_f32 v236, v132
  v_exp_f32 v237, v133
  v_cvt_pk_bf16_f32 v145, v234, v235
  ds_read_b128 v[192:195], v6 offset:10240
  v_mfma_f32_32x32x16_bf16 v[112:127], v[160:163], v[24:27], v[112:127]
  v_add_f32 v14, v234, v235
  v_exp_f32 v238, v134
  v_exp_f32 v239, v135
  ds_read_b128 v[196:199], v6 offset:11264
  v_cvt_pk_bf16_f32 v146, v236, v237
  v_add_f32 v13, v13, v236
  v_add_f32 v14, v14, v237
  v_mfma_f32_32x32x16_bf16 v[112:127], v[164:167], v[28:31], v[112:127]
  ds_read_b128 v[200:203], v6 offset:12288
  v_exp_f32 v240, v136
  v_exp_f32 v241, v137
  v_cvt_pk_bf16_f32 v147, v238, v239
  ds_read_b128 v[204:207], v6 offset:13312
  v_add_f32 v13, v13, v238
  v_mfma_f32_32x32x16_bf16 v[112:127], v[168:171], v[32:35], v[112:127]
  v_add_f32 v14, v14, v239
  v_exp_f32 v242, v138
  ds_read_b128 v[208:211], v6 offset:14336
  v_exp_f32 v243, v139
  v_cvt_pk_bf16_f32 v148, v240, v241
  v_add_f32 v13, v13, v240
  v_mfma_f32_32x32x16_bf16 v[112:127], v[172:175], v[36:39], v[112:127]
  ds_read_b128 v[212:215], v6 offset:15360
  v_add_f32 v14, v14, v241
  v_exp_f32 v244, v140
  v_exp_f32 v245, v141
  s_add_u32 s32, s32, 32768
  v_cvt_pk_bf16_f32 v149, v242, v243
  v_add_f32 v13, v13, v242
  v_mfma_f32_32x32x16_bf16 v[112:127], v[176:179], v[40:43], v[112:127]
  v_add_f32 v14, v14, v243
  s_cmp_ge_u32 s32, 163840
  v_exp_f32 v246, v142
  v_exp_f32 v247, v143
  v_cvt_pk_bf16_f32 v150, v244, v245
  s_cselect_b32 s32, 0, s32
  v_mfma_f32_32x32x16_bf16 v[112:127], v[180:183], v[44:47], v[112:127]
  v_add_f32 v13, v13, v244
  v_add_f32 v14, v14, v245
  v_add_f32 v13, v13, v14
  v_add_u32 v6, s32, v4
  v_cvt_pk_bf16_f32 v151, v246, v247
  v_add_f32 v14, v246, v247
  v_add_f32 v13, v13, v14
  v_cmp_lt_f32 vcc, s34, v13
  s_nop 1
  s_cbranch_vccnz attn_it2_rs
attn_it2_nors:
  v_add_f32 v9, v9, v13
  s_add_u32 s18, s18, 1
  s_waitcnt lgkmcnt(0)
  s_nop 0
  v_mfma_f32_32x32x16_bf16 v[48:63], v[184:187], v[144:147], v[48:63]
  ds_read_b128 v[152:155], v7 offset:0
  ds_read_b128 v[156:159], v7 offset:1024
  ds_read_b128 v[160:163], v7 offset:2048
  v_mfma_f32_32x32x16_bf16 v[64:79], v[192:195], v[144:147], v[64:79]
  ds_read_b128 v[164:167], v7 offset:3072
  ds_read_b128 v[168:171], v7 offset:4096
  s_add_u32 m0, s27, s28
  s_cmp_eq_u32 s78, s79
  s_cselect_b32 s16, s80, s16
  s_cselect_b32 s17, s81, s17
  s_add_u32 s78, s78, 1
  buffer_load_dwordx4 v3, s[8:11], s16 offen offset:0 lds
  v_mfma_f32_32x32x16_bf16 v[80:95], v[200:203], v[144:147], v[80:95]
  ds_read_b128 v[172:175], v7 offset:5120
  ds_read_b128 v[176:179], v7 offset:6144
  ds_read_b128 v[180:183], v7 offset:7168
  v_mfma_f32_32x32x16_bf16 v[96:111], v[208:211], v[144:147], v[96:111]
  s_add_u32 s33, s33, 32768
  s_cmp_ge_u32 s33, 163840
  s_cselect_b32 s33, 0, s33
  v_add_u32 v7, s33, v4
  buffer_load_dwordx4 v3, s[8:11], s16 offen offset:1024 lds
  v_mfma_f32_32x32x16_bf16 v[48:63], v[188:191], v[148:151], v[48:63]
  s_add_u32 m0, m0, 8192
  s_add_u32 s16, s16, 16384
  v_mfma_f32_32x32x16_bf16 v[64:79], v[196:199], v[148:151], v[64:79]
  buffer_load_dwordx4 v3, s[8:11], s17 offen offset:0 lds
  v_mfma_f32_32x32x16_bf16 v[80:95], v[204:207], v[148:151], v[80:95]
  buffer_load_dwordx4 v3, s[8:11], s17 offen offset:1024 lds
  v_mfma_f32_32x32x16_bf16 v[96:111], v[212:215], v[148:151], v[96:111]
  s_add_u32 s17, s17, 16384
  s_add_u32 s28, s28, 32768
  s_cmp_ge_u32 s28, 163840
  s_cselect_b32 s28, 0, s28
  s_cmp_lt_u32 s18, s19
  s_cbranch_scc1 attn_loop0
attn_diag0:
  s_waitcnt vmcnt(4) lgkmcnt(0)
  s_barrier
  s_waitcnt lgkmcnt(0)
  s_lshl_b32 s29, s18, 1
  s_add_u32 s29, s29, s22
  s_cmp_lt_u32 s29, s30
  s_cbranch_scc1 attn_it3_nomask
  s_cmp_eq_u32 s29, s30
  s_cbranch_scc1 attn_it3_tri
  v_mov_b32 v112, v5
  v_mov_b32 v113, v5
  v_mov_b32 v114, v5
  v_mov_b32 v115, v5
  v_mov_b32 v116, v5
  v_mov_b32 v117, v5
  v_mov_b32 v118, v5
  v_mov_b32 v119, v5
  v_mov_b32 v120, v5
  v_mov_b32 v121, v5
  v_mov_b32 v122, v5
  v_mov_b32 v123, v5
  v_mov_b32 v124, v5
  v_mov_b32 v125, v5
  v_mov_b32 v126, v5
  v_mov_b32 v127, v5
  s_branch attn_it3_nomask
attn_it3_tri:
  v_cndmask_b32 v112, v5, v112, s[36:37]
  v_cndmask_b32 v113, v5, v113, s[38:39]
  v_cndmask_b32 v114, v5, v114, s[40:41]
  v_cndmask_b32 v115, v5, v115, s[42:43]
  v_cndmask_b32 v116, v5, v116, s[44:45]
  v_cndmask_b32 v117, v5, v117, s[46:47]
  v_cndmask_b32 v118, v5, v118, s[48:49]
  v_cndmask_b32 v119, v5, v119, s[50:51]
  v_cndmask_b32 v120, v5, v120, s[52:53]
  v_cndmask_b32 v121, v5, v121, s[54:55]
  v_cndmask_b32 v122, v5, v122, s[56:57]
  v_cndmask_b32 v123, v5, v123, s[58:59]
  v_cndmask_b32 v124, v5, v124, s[60:61]
  v_cndmask_b32 v125, v5, v125, s[62:63]
  v_cndmask_b32 v126, v5, v126, s[64:65]
  v_cndmask_b32 v127, v5, v127, s[66:67]
attn_it3_nomask:
  v_mfma_f32_32x32x16_bf16 v[128:143], v[152:155], v[16:19], v[216:231]
  v_exp_f32 v232, v112
  v_exp_f32 v233, v113
  v_exp_f32 v234, v114
  ds_read_b128 v[184:187], v6 offset:8192
  v_exp_f32 v235, v115
  v_cvt_pk_bf16_f32 v144, v232, v233
  v_mfma_f32_32x32x16_bf16 v[128:143], v[156:159], v[20:23], v[128:143]
  v_add_f32 v13, v232, v233
  ds_read_b128 v[188:191], v6 offset:9216
  v_exp_f32 v236, v116
  v_exp_f32 v237, v117
  v_cvt_pk_bf16_f32 v145, v234, v235
  ds_read_b128 v[192:195], v6 offset:10240
  v_mfma_f32_32x32x16_bf16 v[128:143], v[160:163], v[24:27], v[128:143]
  v_add_f32 v14, v234, v235
  v_exp_f32 v238, v118
  v_exp_f32 v239, v119
  ds_read_b128 v[196:199], v6 offset:11264
  v_cvt_pk_bf16_f32 v146, v236, v237
  v_add_f32 v13, v13, v236
  v_add_f32 v14, v14, v237
  v_mfma_f32_32x32x16_bf16 v[128:143], v[164:167], v[28:31], v[128:143]
  ds_read_b128 v[200:203], v6 offset:12288
  v_exp_f32 v240, v120
  v_exp_f32 v241, v121
  v_cvt_pk_bf16_f32 v147, v238, v239
  ds_read_b128 v[204:207], v6 offset:13312
  v_add_f32 v13, v13, v238
  v_mfma_f32_32x32x16_bf16 v[128:143], v[168:171], v[32:35], v[128:143]
  v_add_f32 v14, v14, v239
  v_exp_f32 v242, v122
  ds_read_b128 v[208:211], v6 offset:14336
  v_exp_f32 v243, v123
  v_cvt_pk_bf16_f32 v148, v240, v241
  v_add_f32 v13, v13, v240
  v_mfma_f32_32x32x16_bf16 v[128:143], v[172:175], v[36:39], v[128:143]
  ds_read_b128 v[212:215], v6 offset:15360
  v_add_f32 v14, v14, v241
  v_exp_f32 v244, v124
  v_exp_f32 v245, v125
  s_add_u32 s32, s32, 32768
  v_cvt_pk_bf16_f32 v149, v242, v243
  v_add_f32 v13, v13, v242
  v_mfma_f32_32x32x16_bf16 v[128:143], v[176:179], v[40:43], v[128:143]
  v_add_f32 v14, v14, v243
  s_cmp_ge_u32 s32, 163840
  v_exp_f32 v246, v126
  v_exp_f32 v247, v127
  v_cvt_pk_bf16_f32 v150, v244, v245
  s_cselect_b32 s32, 0, s32
  v_mfma_f32_32x32x16_bf16 v[128:143], v[180:183], v[44:47], v[128:143]
  v_add_f32 v13, v13, v244
  v_add_f32 v14, v14, v245
  v_add_f32 v13, v13, v14
  v_add_u32 v6, s32, v4
  v_cvt_pk_bf16_f32 v151, v246, v247
  v_add_f32 v14, v246, v247
  v_add_f32 v13, v13, v14
  v_cmp_lt_f32 vcc, s34, v13
  s_nop 1
  s_cbranch_vccnz attn_it3_rs
attn_it3_nors:
  v_add_f32 v9, v9, v13
  s_add_u32 s18, s18, 1
  s_waitcnt lgkmcnt(0)
  s_nop 0
  v_mfma_f32_32x32x16_bf16 v[48:63], v[184:187], v[144:147], v[48:63]
  v_mfma_f32_32x32x16_bf16 v[64:79], v[192:195], v[144:147], v[64:79]
  buffer_load_dwordx4 v[16:19], v2, s[8:11], s82 offen offset:0
  v_mfma_f32_32x32x16_bf16 v[80:95], v[200:203], v[144:147], v[80:95]
  v_mfma_f32_32x32x16_bf16 v[96:111], v[208:211], v[144:147], v[96:111]
  buffer_load_dwordx4 v[20:23], v2, s[8:11], s82 offen offset:1024
  v_mfma_f32_32x32x16_bf16 v[48:63], v[188:191], v[148:151], v[48:63]
  v_mfma_f32_32x32x16_bf16 v[64:79], v[196:199], v[148:151], v[64:79]
  buffer_load_dwordx4 v[24:27], v2, s[8:11], s82 offen offset:2048
  v_mfma_f32_32x32x16_bf16 v[80:95], v[204:207], v[148:151], v[80:95]
  v_mfma_f32_32x32x16_bf16 v[96:111], v[212:215], v[148:151], v[96:111]
  buffer_load_dwordx4 v[28:31], v2, s[8:11], s82 offen offset:3072
  s_waitcnt vmcnt(4) lgkmcnt(0)
  s_barrier
  s_waitcnt lgkmcnt(0)
  s_lshl_b32 s29, s18, 1
  s_add_u32 s29, s29, s22
  s_cmp_lt_u32 s29, s30
  s_cbranch_scc1 attn_it4_nomask
  s_cmp_eq_u32 s29, s30
  s_cbranch_scc1 attn_it4_tri
  v_mov_b32 v128, v5
  v_mov_b32 v129, v5
  v_mov_b32 v130, v5
  v_mov_b32 v131, v5
  v_mov_b32 v132, v5
  v_mov_b32 v133, v5
  v_mov_b32 v134, v5
  v_mov_b32 v135, v5
  v_mov_b32 v136, v5
  v_mov_b32 v137, v5
  v_mov_b32 v138, v5
  v_mov_b32 v139, v5
  v_mov_b32 v140, v5
  v_mov_b32 v141, v5
  v_mov_b32 v142, v5
  v_mov_b32 v143, v5
  s_branch attn_it4_nomask
attn_it4_tri:
  v_cndmask_b32 v128, v5, v128, s[36:37]
  v_cndmask_b32 v129, v5, v129, s[38:39]
  v_cndmask_b32 v130, v5, v130, s[40:41]
  v_cndmask_b32 v131, v5, v131, s[42:43]
  v_cndmask_b32 v132, v5, v132, s[44:45]
  v_cndmask_b32 v133, v5, v133, s[46:47]
  v_cndmask_b32 v134, v5, v134, s[48:49]
  v_cndmask_b32 v135, v5, v135, s[50:51]
  v_cndmask_b32 v136, v5, v136, s[52:53]
  v_cndmask_b32 v137, v5, v137, s[54:55]
  v_cndmask_b32 v138, v5, v138, s[56:57]
  v_cndmask_b32 v139, v5, v139, s[58:59]
  v_cndmask_b32 v140, v5, v140, s[60:61]
  v_cndmask_b32 v141, v5, v141, s[62:63]
  v_cndmask_b32 v142, v5, v142, s[64:65]
  v_cndmask_b32 v143, v5, v143, s[66:67]
attn_it4_nomask:
  v_exp_f32 v232, v128
  v_exp_f32 v233, v129
  v_exp_f32 v234, v130
  ds_read_b128 v[184:187], v6 offset:8192
  v_exp_f32 v235, v131
  v_cvt_pk_bf16_f32 v144, v232, v233
  v_add_f32 v13, v232, v233
  ds_read_b128 v[188:191], v6 offset:9216
  v_exp_f32 v236, v132
  v_exp_f32 v237, v133
  v_cvt_pk_bf16_f32 v145, v234, v235
  ds_read_b128 v[192:195], v6 offset:10240
  v_add_f32 v14, v234, v235
  v_exp_f32 v238, v134
  v_exp_f32 v239, v135
  ds_read_b128 v[196:199], v6 offset:11264
  v_cvt_pk_bf16_f32 v146, v236, v237
  v_add_f32 v13, v13, v236
  v_add_f32 v14, v14, v237
  ds_read_b128 v[200:203], v6 offset:12288
  v_exp_f32 v240, v136
  v_exp_f32 v241, v137
  v_cvt_pk_bf16_f32 v147, v238, v239
  ds_read_b128 v[204:207], v6 offset:13312
  v_add_f32 v13, v13, v238
  v_add_f32 v14, v14, v239
  v_exp_f32 v242, v138
  ds_read_b128 v[208:211], v6 offset:14336
  v_exp_f32 v243, v139
  v_cvt_pk_bf16_f32 v148, v240, v241
  v_add_f32 v13, v13, v240
  ds_read_b128 v[212:215], v6 offset:15360
  v_add_f32 v14, v14, v241
  v_exp_f32 v244, v140
  v_exp_f32 v245, v141
  s_add_u32 s32, s32, 32768
  v_cvt_pk_bf16_f32 v149, v242, v243
  v_add_f32 v13, v13, v242
  v_add_f32 v14, v14, v243
  s_cmp_ge_u32 s32, 163840
  v_exp_f32 v246, v142
  v_exp_f32 v247, v143
  v_cvt_pk_bf16_f32 v150, v244, v245
  s_cselect_b32 s32, 0, s32
  v_add_f32 v13, v13, v244
  v_add_f32 v14, v14, v245
  v_add_f32 v13, v13, v14
  v_add_u32 v6, s32, v4
  v_cvt_pk_bf16_f32 v151, v246, v247
  v_add_f32 v14, v246, v247
  v_add_f32 v13, v13, v14
  v_cmp_lt_f32 vcc, s34, v13
  s_nop 1
  s_cbranch_vccnz attn_it4_rs
attn_it4_nors:
  v_add_f32 v9, v9, v13
  s_add_u32 s18, s18, 1
  s_waitcnt lgkmcnt(0)
  s_nop 0
  v_mfma_f32_32x32x16_bf16 v[48:63], v[184:187], v[144:147], v[48:63]
  v_mfma_f32_32x32x16_bf16 v[64:79], v[192:195], v[144:147], v[64:79]
  buffer_load_dwordx4 v[32:35], v2, s[8:11], s83 offen offset:0
  v_mfma_f32_32x32x16_bf16 v[80:95], v[200:203], v[144:147], v[80:95]
  v_mfma_f32_32x32x16_bf16 v[96:111], v[208:211], v[144:147], v[96:111]
  buffer_load_dwordx4 v[36:39], v2, s[8:11], s83 offen offset:1024
  v_mfma_f32_32x32x16_bf16 v[48:63], v[188:191], v[148:151], v[48:63]
  v_mfma_f32_32x32x16_bf16 v[64:79], v[196:199], v[148:151], v[64:79]
  buffer_load_dwordx4 v[40:43], v2, s[8:11], s83 offen offset:2048
  v_mfma_f32_32x32x16_bf16 v[80:95], v[204:207], v[148:151], v[80:95]
  v_mfma_f32_32x32x16_bf16 v[96:111], v[212:215], v[148:151], v[96:111]
  buffer_load_dwordx4 v[44:47], v2, s[8:11], s83 offen offset:3072
  s_branch attn_merge
attn_g1:
  s_waitcnt vmcnt(4) lgkmcnt(0)
  s_barrier
  s_waitcnt lgkmcnt(0)
  s_cmp_eq_u32 s5, 0
  s_cbranch_scc1 attn_diag1a
  s_add_u32 m0, s27, s28
  s_cmp_eq_u32 s78, s79
  s_cselect_b32 s16, s80, s16
  s_cselect_b32 s17, s81, s17
  s_add_u32 s78, s78, 1
  buffer_load_dwordx4 v3, s[8:11], s16 offen offset:0 lds
  buffer_load_dwordx4 v3, s[8:11], s16 offen offset:1024 lds
  s_add_u32 m0, m0, 8192
  s_add_u32 s16, s16, 16384
  buffer_load_dwordx4 v3, s[8:11], s17 offen offset:0 lds
  buffer_load_dwordx4 v3, s[8:11], s17 offen offset:1024 lds
  s_add_u32 s17, s17, 16384
  s_add_u32 s28, s28, 32768
  s_cmp_ge_u32 s28, 163840
  s_cselect_b32 s28, 0, s28
  v_mfma_f32_32x32x16_bf16 v[128:143], v[152:155], v[16:19], v[216:231]
  v_exp_f32 v232, v112
  v_exp_f32 v233, v113
  v_exp_f32 v234, v114
  ds_read_b128 v[184:187], v6 offset:8192
  v_exp_f32 v235, v115
  v_cvt_pk_bf16_f32 v144, v232, v233
  v_mfma_f32_32x32x16_bf16 v[128:143], v[156:159], v[20:23], v[128:143]
  v_add_f32 v13, v232, v233
  ds_read_b128 v[188:191], v6 offset:9216
  v_exp_f32 v236, v116
  v_exp_f32 v237, v117
  v_cvt_pk_bf16_f32 v145, v234, v235
  ds_read_b128 v[192:195], v6 offset:10240
  v_mfma_f32_32x32x16_bf16 v[128:143], v[160:163], v[24:27], v[128:143]
  v_add_f32 v14, v234, v235
  v_exp_f32 v238, v118
  v_exp_f32 v239, v119
  ds_read_b128 v[196:199], v6 offset:11264
  v_cvt_pk_bf16_f32 v146, v236, v237
  v_add_f32 v13, v13, v236
  v_add_f32 v14, v14, v237
  v_mfma_f32_32x32x16_bf16 v[128:143], v[164:167], v[28:31], v[128:143]
  ds_read_b128 v[200:203], v6 offset:12288
  v_exp_f32 v240, v120
  v_exp_f32 v241, v121
  v_cvt_pk_bf16_f32 v147, v238, v239
  ds_read_b128 v[204:207], v6 offset:13312
  v_add_f32 v13, v13, v238
  v_mfma_f32_32x32x16_bf16 v[128:143], v[168:171], v[32:35], v[128:143]
  v_add_f32 v14, v14, v239
  v_exp_f32 v242, v122
  ds_read_b128 v[208:211], v6 offset:14336
  v_exp_f32 v243, v123
  v_cvt_pk_bf16_f32 v148, v240, v241
  v_add_f32 v13, v13, v240
  v_mfma_f32_32x32x16_bf16 v[128:143], v[172:175], v[36:39], v[128:143]
  ds_read_b128 v[212:215], v6 offset:15360
  v_add_f32 v14, v14, v241
  v_exp_f32 v244, v124
  v_exp_f32 v245, v125
  s_add_u32 s32, s32, 32768
  v_cvt_pk_bf16_f32 v149, v242, v243
  v_add_f32 v13, v13, v242
  v_mfma_f32_32x32x16_bf16 v[128:143], v[176:179], v[40:43], v[128:143]
  v_add_f32 v14, v14, v243
  s_cmp_ge_u32 s32, 163840
  v_exp_f32 v246, v126
  v_exp_f32 v247, v127
  v_cvt_pk_bf16_f32 v150, v244, v245
  s_cselect_b32 s32, 0, s32
  v_mfma_f32_32x32x16_bf16 v[128:143], v[180:183], v[44:47], v[128:143]
  v_add_f32 v13, v13, v244
  v_add_f32 v14, v14, v245
  v_add_f32 v13, v13, v14
  v_add_u32 v6, s32, v4
  v_cvt_pk_bf16_f32 v151, v246, v247
  v_add_f32 v14, v246, v247
  v_add_f32 v13, v13, v14
  v_cmp_lt_f32 vcc, s34, v13
  s_nop 1
  s_cbranch_vccnz attn_it5_rs
attn_it5_nors:
  v_add_f32 v9, v9, v13
  s_add_u32 s18, s18, 1
attn_loop1:
  s_waitcnt vmcnt(4) lgkmcnt(0)
  s_barrier
  s_waitcnt lgkmcnt(0)
  s_nop 0
  v_mfma_f32_32x32x16_bf16 v[48:63], v[184:187], v[144:147], v[48:63]
  ds_read_b128 v[152:155], v7 offset:0
  ds_read_b128 v[156:159], v7 offset:1024
  ds_read_b128 v[160:163], v7 offset:2048
  v_mfma_f32_32x32x16_bf16 v[64:79], v[192:195], v[144:147], v[64:79]
  ds_read_b128 v[164:167], v7 offset:3072
  ds_read_b128 v[168:171], v7 offset:4096
  s_add_u32 m0, s27, s28
  s_cmp_eq_u32 s78, s79
  s_cselect_b32 s16, s80, s16
  s_cselect_b32 s17, s81, s17
  s_add_u32 s78, s78, 1
  buffer_load_dwordx4 v3, s[8:11], s16 offen offset:0 lds
  v_mfma_f32_32x32x16_bf16 v[80:95], v[200:203], v[144:147], v[80:95]
  ds_read_b128 v[172:175], v7 offset:5120
  ds_read_b128 v[176:179], v7 offset:6144
  ds_read_b128 v[180:183], v7 offset:7168
  v_mfma_f32_32x32x16_bf16 v[96:111], v[208:211], v[144:147], v[96:111]
  s_add_u32 s33, s33, 32768
  s_cmp_ge_u32 s33, 163840
  s_cselect_b32 s33, 0, s33
  v_add_u32 v7, s33, v4
  buffer_load_dwordx4 v3, s[8:11], s16 offen offset:1024 lds
  v_mfma_f32_32x32x16_bf16 v[48:63], v[188:191], v[148:151], v[48:63]
  s_add_u32 m0, m0, 8192
  s_add_u32 s16, s16, 16384
  v_mfma_f32_32x32x16_bf16 v[64:79], v[196:199], v[148:151], v[64:79]
  buffer_load_dwordx4 v3, s[8:11], s17 offen offset:0 lds
  v_mfma_f32_32x32x16_bf16 v[80:95], v[204:207], v[148:151], v[80:95]
  buffer_load_dwordx4 v3, s[8:11], s17 offen offset:1024 lds
  v_mfma_f32_32x32x16_bf16 v[96:111], v[212:215], v[148:151], v[96:111]
  s_add_u32 s17, s17, 16384
  s_add_u32 s28, s28, 32768
  s_cmp_ge_u32 s28, 163840
  s_cselect_b32 s28, 0, s28
  s_waitcnt lgkmcnt(0)
  v_mfma_f32_32x32x16_bf16 v[112:127], v[152:155], v[16:19], v[216:231]
  v_exp_f32 v232, v128
  v_exp_f32 v233, v129
  v_exp_f32 v234, v130
  ds_read_b128 v[184:187], v6 offset:8192
  v_exp_f32 v235, v131
  v_cvt_pk_bf16_f32 v144, v232, v233
  v_mfma_f32_32x32x16_bf16 v[112:127], v[156:159], v[20:23], v[112:127]
  v_add_f32 v13, v232, v233
  ds_read_b128 v[188:191], v6 offset:9216
  v_exp_f32 v236, v132
  v_exp_f32 v237, v133
  v_cvt_pk_bf16_f32 v145, v234, v235
  ds_read_b128 v[192:195], v6 offset:10240
  v_mfma_f32_32x32x16_bf16 v[112:127], v[160:163], v[24:27], v[112:127]
  v_add_f32 v14, v234, v235
  v_exp_f32 v238, v134
  v_exp_f32 v239, v135
  ds_read_b128 v[196:199], v6 offset:11264
  v_cvt_pk_bf16_f32 v146, v236, v237
  v_add_f32 v13, v13, v236
  v_add_f32 v14, v14, v237
  v_mfma_f32_32x32x16_bf16 v[112:127], v[164:167], v[28:31], v[112:127]
  ds_read_b128 v[200:203], v6 offset:12288
  v_exp_f32 v240, v136
  v_exp_f32 v241, v137
  v_cvt_pk_bf16_f32 v147, v238, v239
  ds_read_b128 v[204:207], v6 offset:13312
  v_add_f32 v13, v13, v238
  v_mfma_f32_32x32x16_bf16 v[112:127], v[168:171], v[32:35], v[112:127]
  v_add_f32 v14, v14, v239
  v_exp_f32 v242, v138
  ds_read_b128 v[208:211], v6 offset:14336
  v_exp_f32 v243, v139
  v_cvt_pk_bf16_f32 v148, v240, v241
  v_add_f32 v13, v13, v240
  v_mfma_f32_32x32x16_bf16 v[112:127], v[172:175], v[36:39], v[112:127]
  ds_read_b128 v[212:215], v6 offset:15360
  v_add_f32 v14, v14, v241
  v_exp_f32 v244, v140
  v_exp_f32 v245, v141
  s_add_u32 s32, s32, 32768
  v_cvt_pk_bf16_f32 v149, v242, v243
  v_add_f32 v13, v13, v242
  v_mfma_f32_32x32x16_bf16 v[112:127], v[176:179], v[40:43], v[112:127]
  v_add_f32 v14, v14, v243
  s_cmp_ge_u32 s32, 163840
  v_exp_f32 v246, v142
  v_exp_f32 v247, v143
  v_cvt_pk_bf16_f32 v150, v244, v245
  s_cselect_b32 s32, 0, s32
  v_mfma_f32_32x32x16_bf16 v[112:127], v[180:183], v[44:47], v[112:127]
  v_add_f32 v13, v13, v244
  v_add_f32 v14, v14, v245
  v_add_f32 v13, v13, v14
  v_add_u32 v6, s32, v4
  v_cvt_pk_bf16_f32 v151, v246, v247
  v_add_f32 v14, v246, v247
  v_add_f32 v13, v13, v14
  v_cmp_lt_f32 vcc, s34, v13
  s_nop 1
  s_cbranch_vccnz attn_it6_rs
attn_it6_nors:
  v_add_f32 v9, v9, v13
  s_add_u32 s18, s18, 1
  s_cmp_ge_u32 s18, s19
  s_cbranch_scc1 attn_diag1
  s_waitcnt vmcnt(4) lgkmcnt(0)
  s_barrier
  s_waitcnt lgkmcnt(0)
  s_nop 0
  v_mfma_f32_32x32x16_bf16 v[48:63], v[184:187], v[144:147], v[48:63]
  ds_read_b128 v[152:155], v7 offset:0
  ds_read_b128 v[156:159], v7 offset:1024
  ds_read_b128 v[160:163], v7 offset:2048
  v_mfma_f32_32x32x16_bf16 v[64:79], v[192:195], v[144:147], v[64:79]
  ds_read_b128 v[164:167], v7 offset:3072
  ds_read_b128 v[168:171], v7 offset:4096
  s_add_u32 m0, s27, s28
  s_cmp_eq_u32 s78, s79
  s_cselect_b32 s16, s80, s16
  s_cselect_b32 s17, s81, s17
  s_add_u32 s78, s78, 1
  buffer_load_dwordx4 v3, s[8:11], s16 offen offset:0 lds
  v_mfma_f32_32x32x16_bf16 v[80:95], v[200:203], v[144:147], v[80:95]
  ds_read_b128 v[172:175], v7 offset:5120
  ds_read_b128 v[176:179], v7 offset:6144
  ds_read_b128 v[180:183], v7 offset:7168
  v_mfma_f32_32x32x16_bf16 v[96:111], v[208:211], v[144:147], v[96:111]
  s_add_u32 s33, s33, 32768
  s_cmp_ge_u32 s33, 163840
  s_cselect_b32 s33, 0, s33
  v_add_u32 v7, s33, v4
  buffer_load_dwordx4 v3, s[8:11], s16 offen offset:1024 lds
  v_mfma_f32_32x32x16_bf16 v[48:63], v[188:191], v[148:151], v[48:63]
  s_add_u32 m0, m0, 8192
  s_add_u32 s16, s16, 16384
  v_mfma_f32_32x32x16_bf16 v[64:79], v[196:199], v[148:151], v[64:79]
  buffer_load_dwordx4 v3, s[8:11], s17 offen offset:0 lds
  v_mfma_f32_32x32x16_bf16 v[80:95], v[204:207], v[148:151], v[80:95]
  buffer_load_dwordx4 v3, s[8:11], s17 offen offset:1024 lds
  v_mfma_f32_32x32x16_bf16 v[96:111], v[212:215], v[148:151], v[96:111]
  s_add_u32 s17, s17, 16384
  s_add_u32 s28, s28, 32768
  s_cmp_ge_u32 s28, 163840
  s_cselect_b32 s28, 0, s28
  s_waitcnt lgkmcnt(0)
  v_mfma_f32_32x32x16_bf16 v[128:143], v[152:155], v[16:19], v[216:231]
  v_exp_f32 v232, v112
  v_exp_f32 v233, v113
  v_exp_f32 v234, v114
  ds_read_b128 v[184:187], v6 offset:8192
  v_exp_f32 v235, v115
  v_cvt_pk_bf16_f32 v144, v232, v233
  v_mfma_f32_32x32x16_bf16 v[128:143], v[156:159], v[20:23], v[128:143]
  v_add_f32 v13, v232, v233
  ds_read_b128 v[188:191], v6 offset:9216
  v_exp_f32 v236, v116
  v_exp_f32 v237, v117
  v_cvt_pk_bf16_f32 v145, v234, v235
  ds_read_b128 v[192:195], v6 offset:10240
  v_mfma_f32_32x32x16_bf16 v[128:143], v[160:163], v[24:27], v[128:143]
  v_add_f32 v14, v234, v235
  v_exp_f32 v238, v118
  v_exp_f32 v239, v119
  ds_read_b128 v[196:199], v6 offset:11264
  v_cvt_pk_bf16_f32 v146, v236, v237
  v_add_f32 v13, v13, v236
  v_add_f32 v14, v14, v237
  v_mfma_f32_32x32x16_bf16 v[128:143], v[164:167], v[28:31], v[128:143]
  ds_read_b128 v[200:203], v6 offset:12288
  v_exp_f32 v240, v120
  v_exp_f32 v241, v121
  v_cvt_pk_bf16_f32 v147, v238, v239
  ds_read_b128 v[204:207], v6 offset:13312
  v_add_f32 v13, v13, v238
  v_mfma_f32_32x32x16_bf16 v[128:143], v[168:171], v[32:35], v[128:143]
  v_add_f32 v14, v14, v239
  v_exp_f32 v242, v122
  ds_read_b128 v[208:211], v6 offset:14336
  v_exp_f32 v243, v123
  v_cvt_pk_bf16_f32 v148, v240, v241
  v_add_f32 v13, v13, v240
  v_mfma_f32_32x32x16_bf16 v[128:143], v[172:175], v[36:39], v[128:143]
  ds_read_b128 v[212:215], v6 offset:15360
  v_add_f32 v14, v14, v241
  v_exp_f32 v244, v124
  v_exp_f32 v245, v125
  s_add_u32 s32, s32, 32768
  v_cvt_pk_bf16_f32 v149, v242, v243
  v_add_f32 v13, v13, v242
  v_mfma_f32_32x32x16_bf16 v[128:143], v[176:179], v[40:43], v[128:143]
  v_add_f32 v14, v14, v243
  s_cmp_ge_u32 s32, 163840
  v_exp_f32 v246, v126
  v_exp_f32 v247, v127
  v_cvt_pk_bf16_f32 v150, v244, v245
  s_cselect_b32 s32, 0, s32
  v_mfma_f32_32x32x16_bf16 v[128:143], v[180:183], v[44:47], v[128:143]
  v_add_f32 v13, v13, v244
  v_add_f32 v14, v14, v245
  v_add_f32 v13, v13, v14
  v_add_u32 v6, s32, v4
  v_cvt_pk_bf16_f32 v151, v246, v247
  v_add_f32 v14, v246, v247
  v_add_f32 v13, v13, v14
  v_cmp_lt_f32 vcc, s34, v13
  s_nop 1
  s_cbranch_vccnz attn_it7_rs
attn_it7_nors:
  v_add_f32 v9, v9, v13
  s_add_u32 s18, s18, 1
  s_branch attn_loop1
attn_diag1:
  s_waitcnt vmcnt(4) lgkmcnt(0)
  s_barrier
  s_waitcnt lgkmcnt(0)
  s_nop 0
  v_mfma_f32_32x32x16_bf16 v[48:63], v[184:187], v[144:147], v[48:63]
  ds_read_b128 v[152:155], v7 offset:0
  v_mfma_f32_32x32x16_bf16 v[64:79], v[192:195], v[144:147], v[64:79]
  ds_read_b128 v[156:159], v7 offset:1024
  ds_read_b128 v[160:163], v7 offset:2048
  v_mfma_f32_32x32x16_bf16 v[80:95], v[200:203], v[144:147], v[80:95]
  ds_read_b128 v[164:167], v7 offset:3072
  v_mfma_f32_32x32x16_bf16 v[96:111], v[208:211], v[144:147], v[96:111]
  ds_read_b128 v[168:171], v7 offset:4096
  ds_read_b128 v[172:175], v7 offset:5120
  v_mfma_f32_32x32x16_bf16 v[48:63], v[188:191], v[148:151], v[48:63]
  ds_read_b128 v[176:179], v7 offset:6144
  v_mfma_f32_32x32x16_bf16 v[64:79], v[196:199], v[148:151], v[64:79]
  ds_read_b128 v[180:183], v7 offset:7168
  s_add_u32 s33, s33, 32768
  v_mfma_f32_32x32x16_bf16 v[80:95], v[204:207], v[148:151], v[80:95]
  s_cmp_ge_u32 s33, 163840
  v_mfma_f32_32x32x16_bf16 v[96:111], v[212:215], v[148:151], v[96:111]
  s_cselect_b32 s33, 0, s33
  v_add_u32 v7, s33, v4
  s_waitcnt lgkmcnt(0)
attn_diag1a:
  s_lshl_b32 s29, s18, 1
  s_add_u32 s29, s29, s22
  s_cmp_lt_u32 s29, s30
  s_cbranch_scc1 attn_it8_nomask
  s_cmp_eq_u32 s29, s30
  s_cbranch_scc1 attn_it8_tri
  v_mov_b32 v112, v5
  v_mov_b32 v113, v5
  v_mov_b32 v114, v5
  v_mov_b32 v115, v5
  v_mov_b32 v116, v5
  v_mov_b32 v117, v5
  v_mov_b32 v118, v5
  v_mov_b32 v119, v5
  v_mov_b32 v120, v5
  v_mov_b32 v121, v5
  v_mov_b32 v122, v5
  v_mov_b32 v123, v5
  v_mov_b32 v124, v5
  v_mov_b32 v125, v5
  v_mov_b32 v126, v5
  v_mov_b32 v127, v5
  s_branch attn_it8_nomask
attn_it8_tri:
  v_cndmask_b32 v112, v5, v112, s[36:37]
  v_cndmask_b32 v113, v5, v113, s[38:39]
  v_cndmask_b32 v114, v5, v114, s[40:41]
  v_cndmask_b32 v115, v5, v115, s[42:43]
  v_cndmask_b32 v116, v5, v116, s[44:45]
  v_cndmask_b32 v117, v5, v117, s[46:47]
  v_cndmask_b32 v118, v5, v118, s[48:49]
  v_cndmask_b32 v119, v5, v119, s[50:51]
  v_cndmask_b32 v120, v5, v120, s[52:53]
  v_cndmask_b32 v121, v5, v121, s[54:55]
  v_cndmask_b32 v122, v5, v122, s[56:57]
  v_cndmask_b32 v123, v5, v123, s[58:59]
  v_cndmask_b32 v124, v5, v124, s[60:61]
  v_cndmask_b32 v125, v5, v125, s[62:63]
  v_cndmask_b32 v126, v5, v126, s[64:65]
  v_cndmask_b32 v127, v5, v127, s[66:67]
attn_it8_nomask:
  v_mfma_f32_32x32x16_bf16 v[128:143], v[152:155], v[16:19], v[216:231]
  v_exp_f32 v232, v112
  v_exp_f32 v233, v113
  v_exp_f32 v234, v114
  ds_read_b128 v[184:187], v6 offset:8192
  v_exp_f32 v235, v115
  v_cvt_pk_bf16_f32 v144, v232, v233
  v_mfma_f32_32x32x16_bf16 v[128:143], v[156:159], v[20:23], v[128:143]
  v_add_f32 v13, v232, v233
  ds_read_b128 v[188:191], v6 offset:9216
  v_exp_f32 v236, v116
  v_exp_f32 v237, v117
  v_cvt_pk_bf16_f32 v145, v234, v235
  ds_read_b128 v[192:195], v6 offset:10240
  v_mfma_f32_32x32x16_bf16 v[128:143], v[160:163], v[24:27], v[128:143]
  v_add_f32 v14, v234, v235
  v_exp_f32 v238, v118
  v_exp_f32 v239, v119
  ds_read_b128 v[196:199], v6 offset:11264
  v_cvt_pk_bf16_f32 v146, v236, v237
  v_add_f32 v13, v13, v236
  v_add_f32 v14, v14, v237
  v_mfma_f32_32x32x16_bf16 v[128:143], v[164:167], v[28:31], v[128:143]
  ds_read_b128 v[200:203], v6 offset:12288
  v_exp_f32 v240, v120
  v_exp_f32 v241, v121
  v_cvt_pk_bf16_f32 v147, v238, v239
  ds_read_b128 v[204:207], v6 offset:13312
  v_add_f32 v13, v13, v238
  v_mfma_f32_32x32x16_bf16 v[128:143], v[168:171], v[32:35], v[128:143]
  v_add_f32 v14, v14, v239
  v_exp_f32 v242, v122
  ds_read_b128 v[208:211], v6 offset:14336
  v_exp_f32 v243, v123
  v_cvt_pk_bf16_f32 v148, v240, v241
  v_add_f32 v13, v13, v240
  v_mfma_f32_32x32x16_bf16 v[128:143], v[172:175], v[36:39], v[128:143]
  ds_read_b128 v[212:215], v6 offset:15360
  v_add_f32 v14, v14, v241
  v_exp_f32 v244, v124
  v_exp_f32 v245, v125
  s_add_u32 s32, s32, 32768
  v_cvt_pk_bf16_f32 v149, v242, v243
  v_add_f32 v13, v13, v242
  v_mfma_f32_32x32x16_bf16 v[128:143], v[176:179], v[40:43], v[128:143]
  v_add_f32 v14, v14, v243
  s_cmp_ge_u32 s32, 163840
  v_exp_f32 v246, v126
  v_exp_f32 v247, v127
  v_cvt_pk_bf16_f32 v150, v244, v245
  s_cselect_b32 s32, 0, s32
  v_mfma_f32_32x32x16_bf16 v[128:143], v[180:183], v[44:47], v[128:143]
  v_add_f32 v13, v13, v244
  v_add_f32 v14, v14, v245
  v_add_f32 v13, v13, v14
  v_add_u32 v6, s32, v4
  v_cvt_pk_bf16_f32 v151, v246, v247
  v_add_f32 v14, v246, v247
  v_add_f32 v13, v13, v14
  v_cmp_lt_f32 vcc, s34, v13
  s_nop 1
  s_cbranch_vccnz attn_it8_rs
attn_it8_nors:
  v_add_f32 v9, v9, v13
  s_add_u32 s18, s18, 1
  s_waitcnt vmcnt(4) lgkmcnt(0)
  s_barrier
  s_waitcnt lgkmcnt(0)
  s_nop 0
  v_mfma_f32_32x32x16_bf16 v[48:63], v[184:187], v[144:147], v[48:63]
  v_mfma_f32_32x32x16_bf16 v[64:79], v[192:195], v[144:147], v[64:79]
  buffer_load_dwordx4 v[16:19], v2, s[8:11], s82 offen offset:0
  v_mfma_f32_32x32x16_bf16 v[80:95], v[200:203], v[144:147], v[80:95]
  v_mfma_f32_32x32x16_bf16 v[96:111], v[208:211], v[144:147], v[96:111]
  buffer_load_dwordx4 v[20:23], v2, s[8:11], s82 offen offset:1024
  v_mfma_f32_32x32x16_bf16 v[48:63], v[188:191], v[148:151], v[48:63]
  v_mfma_f32_32x32x16_bf16 v[64:79], v[196:199], v[148:151], v[64:79]
  buffer_load_dwordx4 v[24:27], v2, s[8:11], s82 offen offset:2048
  v_mfma_f32_32x32x16_bf16 v[80:95], v[204:207], v[148:151], v[80:95]
  v_mfma_f32_32x32x16_bf16 v[96:111], v[212:215], v[148:151], v[96:111]
  buffer_load_dwordx4 v[28:31], v2, s[8:11], s82 offen offset:3072
  s_lshl_b32 s29, s18, 1
  s_add_u32 s29, s29, s22
  s_cmp_lt_u32 s29, s30
  s_cbranch_scc1 attn_it9_nomask
  s_cmp_eq_u32 s29, s30
  s_cbranch_scc1 attn_it9_tri
  v_mov_b32 v128, v5
  v_mov_b32 v129, v5
  v_mov_b32 v130, v5
  v_mov_b32 v131, v5
  v_mov_b32 v132, v5
  v_mov_b32 v133, v5
  v_mov_b32 v134, v5
  v_mov_b32 v135, v5
  v_mov_b32 v136, v5
  v_mov_b32 v137, v5
  v_mov_b32 v138, v5
  v_mov_b32 v139, v5
  v_mov_b32 v140, v5
  v_mov_b32 v141, v5
  v_mov_b32 v142, v5
  v_mov_b32 v143, v5
  s_branch attn_it9_nomask
attn_it9_tri:
  v_cndmask_b32 v128, v5, v128, s[36:37]
  v_cndmask_b32 v129, v5, v129, s[38:39]
  v_cndmask_b32 v130, v5, v130, s[40:41]
  v_cndmask_b32 v131, v5, v131, s[42:43]
  v_cndmask_b32 v132, v5, v132, s[44:45]
  v_cndmask_b32 v133, v5, v133, s[46:47]
  v_cndmask_b32 v134, v5, v134, s[48:49]
  v_cndmask_b32 v135, v5, v135, s[50:51]
  v_cndmask_b32 v136, v5, v136, s[52:53]
  v_cndmask_b32 v137, v5, v137, s[54:55]
  v_cndmask_b32 v138, v5, v138, s[56:57]
  v_cndmask_b32 v139, v5, v139, s[58:59]
  v_cndmask_b32 v140, v5, v140, s[60:61]
  v_cndmask_b32 v141, v5, v141, s[62:63]
  v_cndmask_b32 v142, v5, v142, s[64:65]
  v_cndmask_b32 v143, v5, v143, s[66:67]
attn_it9_nomask:
  v_exp_f32 v232, v128
  v_exp_f32 v233, v129
  v_exp_f32 v234, v130
  ds_read_b128 v[184:187], v6 offset:8192
  v_exp_f32 v235, v131
  v_cvt_pk_bf16_f32 v144, v232, v233
  v_add_f32 v13, v232, v233
  ds_read_b128 v[188:191], v6 offset:9216
  v_exp_f32 v236, v132
  v_exp_f32 v237, v133
  v_cvt_pk_bf16_f32 v145, v234, v235
  ds_read_b128 v[192:195], v6 offset:10240
  v_add_f32 v14, v234, v235
  v_exp_f32 v238, v134
  v_exp_f32 v239, v135
  ds_read_b128 v[196:199], v6 offset:11264
  v_cvt_pk_bf16_f32 v146, v236, v237
  v_add_f32 v13, v13, v236
  v_add_f32 v14, v14, v237
  ds_read_b128 v[200:203], v6 offset:12288
  v_exp_f32 v240, v136
  v_exp_f32 v241, v137
  v_cvt_pk_bf16_f32 v147, v238, v239
  ds_read_b128 v[204:207], v6 offset:13312
  v_add_f32 v13, v13, v238
  v_add_f32 v14, v14, v239
  v_exp_f32 v242, v138
  ds_read_b128 v[208:211], v6 offset:14336
  v_exp_f32 v243, v139
  v_cvt_pk_bf16_f32 v148, v240, v241
  v_add_f32 v13, v13, v240
  ds_read_b128 v[212:215], v6 offset:15360
  v_add_f32 v14, v14, v241
  v_exp_f32 v244, v140
  v_exp_f32 v245, v141
  s_add_u32 s32, s32, 32768
  v_cvt_pk_bf16_f32 v149, v242, v243
  v_add_f32 v13, v13, v242
  v_add_f32 v14, v14, v243
  s_cmp_ge_u32 s32, 163840
  v_exp_f32 v246, v142
  v_exp_f32 v247, v143
  v_cvt_pk_bf16_f32 v150, v244, v245
  s_cselect_b32 s32, 0, s32
  v_add_f32 v13, v13, v244
  v_add_f32 v14, v14, v245
  v_add_f32 v13, v13, v14
  v_add_u32 v6, s32, v4
  v_cvt_pk_bf16_f32 v151, v246, v247
  v_add_f32 v14, v246, v247
  v_add_f32 v13, v13, v14
  v_cmp_lt_f32 vcc, s34, v13
  s_nop 1
  s_cbranch_vccnz attn_it9_rs
attn_it9_nors:
  v_add_f32 v9, v9, v13
  s_add_u32 s18, s18, 1
  s_waitcnt lgkmcnt(0)
  s_nop 0
  v_mfma_f32_32x32x16_bf16 v[48:63], v[184:187], v[144:147], v[48:63]
  v_mfma_f32_32x32x16_bf16 v[64:79], v[192:195], v[144:147], v[64:79]
  buffer_load_dwordx4 v[32:35], v2, s[8:11], s83 offen offset:0
  v_mfma_f32_32x32x16_bf16 v[80:95], v[200:203], v[144:147], v[80:95]
  v_mfma_f32_32x32x16_bf16 v[96:111], v[208:211], v[144:147], v[96:111]
  buffer_load_dwordx4 v[36:39], v2, s[8:11], s83 offen offset:1024
  v_mfma_f32_32x32x16_bf16 v[48:63], v[188:191], v[148:151], v[48:63]
  v_mfma_f32_32x32x16_bf16 v[64:79], v[196:199], v[148:151], v[64:79]
  buffer_load_dwordx4 v[40:43], v2, s[8:11], s83 offen offset:2048
  v_mfma_f32_32x32x16_bf16 v[80:95], v[204:207], v[148:151], v[80:95]
  v_mfma_f32_32x32x16_bf16 v[96:111], v[212:215], v[148:151], v[96:111]
  buffer_load_dwordx4 v[44:47], v2, s[8:11], s83 offen offset:3072
attn_merge:
  s_mul_i32 s29, s6, 11
  s_lshr_b32 s29, s29, 5
  s_mul_i32 s84, s29, 3
  s_sub_u32 s84, s6, s84
  s_lshl_b32 s29, s29, 15
  s_add_u32 s29, s29, s28
  s_sub_u32 s85, s29, 163840
  s_cmp_ge_u32 s29, 163840
  s_cselect_b32 s29, s85, s29
  s_mul_i32 s84, s84, 9216
  s_add_u32 s29, s29, s84
  v_add_u32 v12, s29, v2
  s_xor_b32 s31, s6, 4
  s_mul_i32 s29, s31, 11
  s_lshr_b32 s29, s29, 5
  s_mul_i32 s84, s29, 3
  s_sub_u32 s84, s31, s84
  s_lshl_b32 s29, s29, 15
  s_add_u32 s29, s29, s28
  s_sub_u32 s85, s29, 163840
  s_cmp_ge_u32 s29, 163840
  s_cselect_b32 s29, s85, s29
  s_mul_i32 s84, s84, 9216
  s_add_u32 s29, s29, s84
  v_add_u32 v13, s29, v2
  s_waitcnt lgkmcnt(0)
  s_barrier
  s_nop 3
  s_cmp_eq_u32 s22, 1
  s_cbranch_scc1 attn_mg1
  ds_write_b128 v12, v[80:83] offset:0
  ds_write_b128 v12, v[84:87] offset:1024
  ds_write_b128 v12, v[88:91] offset:2048
  ds_write_b128 v12, v[92:95] offset:3072
  ds_write_b128 v12, v[96:99] offset:4096
  ds_write_b128 v12, v[100:103] offset:5120
  ds_write_b128 v12, v[104:107] offset:6144
  ds_write_b128 v12, v[108:111] offset:7168
  ds_write_b64 v12, v[8:9] offset:8192
  s_waitcnt lgkmcnt(0)
  s_barrier
  ds_read_b64 v[14:15], v13 offset:8192
  ds_read_b128 v[152:155], v13 offset:0
  ds_read_b128 v[156:159], v13 offset:1024
  ds_read_b128 v[160:163], v13 offset:2048
  ds_read_b128 v[164:167], v13 offset:3072
  ds_read_b128 v[168:171], v13 offset:4096
  ds_read_b128 v[172:175], v13 offset:5120
  ds_read_b128 v[176:179], v13 offset:6144
  ds_read_b128 v[180:183], v13 offset:7168
  s_waitcnt lgkmcnt(8)
  v_max_f32 v10, v8, v14
  v_sub_f32 v11, v8, v10
  v_sub_f32 v10, v14, v10
  v_exp_f32 v11, v11
  v_exp_f32 v10, v10
  s_nop 0
  v_mul_f32 v9, v9, v11
  v_fma_f32 v9, v15, v10, v9
  v_mov_b32 v14, v9
  s_nop 1
  v_permlane32_swap_b32 v9, v14
  s_nop 0
  v_add_f32 v14, v14, v9
  v_rcp_f32 v14, v14
  s_nop 0
  v_mul_f32 v11, v11, v14
  v_mul_f32 v10, v10, v14
  s_mul_i32 s20, s14, 376832
  s_lshl_b32 s21, s3, 13
  s_add_u32 s20, s20, s21
  s_add_u32 s20, s20, 0x3100000
  s_waitcnt lgkmcnt(0)
  v_mul_f32 v152, v152, v10
  v_fma_f32 v152, v48, v11, v152
  v_mul_f32 v153, v153, v10
  v_fma_f32 v153, v49, v11, v153
  v_mul_f32 v154, v154, v10
  v_fma_f32 v154, v50, v11, v154
  v_mul_f32 v155, v155, v10
  v_fma_f32 v155, v51, v11, v155
  v_mul_f32 v156, v156, v10
  v_fma_f32 v156, v52, v11, v156
  v_mul_f32 v157, v157, v10
  v_fma_f32 v157, v53, v11, v157
  v_mul_f32 v158, v158, v10
  v_fma_f32 v158, v54, v11, v158
  v_mul_f32 v159, v159, v10
  v_fma_f32 v159, v55, v11, v159
  v_mul_f32 v160, v160, v10
  v_fma_f32 v160, v56, v11, v160
  v_mul_f32 v161, v161, v10
  v_fma_f32 v161, v57, v11, v161
  v_mul_f32 v162, v162, v10
  v_fma_f32 v162, v58, v11, v162
  v_mul_f32 v163, v163, v10
  v_fma_f32 v163, v59, v11, v163
  v_mul_f32 v164, v164, v10
  v_fma_f32 v164, v60, v11, v164
  v_mul_f32 v165, v165, v10
  v_fma_f32 v165, v61, v11, v165
  v_mul_f32 v166, v166, v10
  v_fma_f32 v166, v62, v11, v166
  v_mul_f32 v167, v167, v10
  v_fma_f32 v167, v63, v11, v167
  v_mul_f32 v168, v168, v10
  v_fma_f32 v168, v64, v11, v168
  v_mul_f32 v169, v169, v10
  v_fma_f32 v169, v65, v11, v169
  v_mul_f32 v170, v170, v10
  v_fma_f32 v170, v66, v11, v170
  v_mul_f32 v171, v171, v10
  v_fma_f32 v171, v67, v11, v171
  v_mul_f32 v172, v172, v10
  v_fma_f32 v172, v68, v11, v172
  v_mul_f32 v173, v173, v10
  v_fma_f32 v173, v69, v11, v173
  v_mul_f32 v174, v174, v10
  v_fma_f32 v174, v70, v11, v174
  v_mul_f32 v175, v175, v10
  v_fma_f32 v175, v71, v11, v175
  v_mul_f32 v176, v176, v10
  v_fma_f32 v176, v72, v11, v176
  v_mul_f32 v177, v177, v10
  v_fma_f32 v177, v73, v11, v177
  v_mul_f32 v178, v178, v10
  v_fma_f32 v178, v74, v11, v178
  v_mul_f32 v179, v179, v10
  v_fma_f32 v179, v75, v11, v179
  v_mul_f32 v180, v180, v10
  v_fma_f32 v180, v76, v11, v180
  v_mul_f32 v181, v181, v10
  v_fma_f32 v181, v77, v11, v181
  v_mul_f32 v182, v182, v10
  v_fma_f32 v182, v78, v11, v182
  v_mul_f32 v183, v183, v10
  v_fma_f32 v183, v79, v11, v183
  v_cvt_pk_bf16_f32 v184, v152, v153
  v_cvt_pk_bf16_f32 v185, v154, v155
  v_cvt_pk_bf16_f32 v186, v156, v157
  v_cvt_pk_bf16_f32 v187, v158, v159
  buffer_store_dwordx4 v[184:187], v2, s[8:11], s20 offen offset:0 sc1
  v_cvt_pk_bf16_f32 v188, v160, v161
  v_cvt_pk_bf16_f32 v189, v162, v163
  v_cvt_pk_bf16_f32 v190, v164, v165
  v_cvt_pk_bf16_f32 v191, v166, v167
  buffer_store_dwordx4 v[188:191], v2, s[8:11], s20 offen offset:1024 sc1
  v_cvt_pk_bf16_f32 v192, v168, v169
  v_cvt_pk_bf16_f32 v193, v170, v171
  v_cvt_pk_bf16_f32 v194, v172, v173
  v_cvt_pk_bf16_f32 v195, v174, v175
  buffer_store_dwordx4 v[192:195], v2, s[8:11], s20 offen offset:2048 sc1
  v_cvt_pk_bf16_f32 v196, v176, v177
  v_cvt_pk_bf16_f32 v197, v178, v179
  v_cvt_pk_bf16_f32 v198, v180, v181
  v_cvt_pk_bf16_f32 v199, v182, v183
  buffer_store_dwordx4 v[196:199], v2, s[8:11], s20 offen offset:3072 sc1
  s_branch attn_mgdone
attn_mg1:
  ds_write_b128 v12, v[48:51] offset:0
  ds_write_b128 v12, v[52:55] offset:1024
  ds_write_b128 v12, v[56:59] offset:2048
  ds_write_b128 v12, v[60:63] offset:3072
  ds_write_b128 v12, v[64:67] offset:4096
  ds_write_b128 v12, v[68:71] offset:5120
  ds_write_b128 v12, v[72:75] offset:6144
  ds_write_b128 v12, v[76:79] offset:7168
  ds_write_b64 v12, v[8:9] offset:8192
  s_waitcnt lgkmcnt(0)
  s_barrier
  ds_read_b64 v[14:15], v13 offset:8192
  ds_read_b128 v[152:155], v13 offset:0
  ds_read_b128 v[156:159], v13 offset:1024
  ds_read_b128 v[160:163], v13 offset:2048
  ds_read_b128 v[164:167], v13 offset:3072
  ds_read_b128 v[168:171], v13 offset:4096
  ds_read_b128 v[172:175], v13 offset:5120
  ds_read_b128 v[176:179], v13 offset:6144
  ds_read_b128 v[180:183], v13 offset:7168
  s_waitcnt lgkmcnt(8)
  v_max_f32 v10, v8, v14
  v_sub_f32 v11, v8, v10
  v_sub_f32 v10, v14, v10
  v_exp_f32 v11, v11
  v_exp_f32 v10, v10
  s_nop 0
  v_mul_f32 v9, v9, v11
  v_fma_f32 v9, v15, v10, v9
  v_mov_b32 v14, v9
  s_nop 1
  v_permlane32_swap_b32 v9, v14
  s_nop 0
  v_add_f32 v14, v14, v9
  v_rcp_f32 v14, v14
  s_nop 0
  v_mul_f32 v11, v11, v14
  v_mul_f32 v10, v10, v14
  s_mul_i32 s20, s14, 376832
  s_lshl_b32 s21, s3, 13
  s_add_u32 s20, s20, s21
  s_add_u32 s20, s20, 0x3101000
  s_waitcnt lgkmcnt(0)
  v_mul_f32 v152, v152, v10
  v_fma_f32 v152, v80, v11, v152
  v_mul_f32 v153, v153, v10
  v_fma_f32 v153, v81, v11, v153
  v_mul_f32 v154, v154, v10
  v_fma_f32 v154, v82, v11, v154
  v_mul_f32 v155, v155, v10
  v_fma_f32 v155, v83, v11, v155
  v_mul_f32 v156, v156, v10
  v_fma_f32 v156, v84, v11, v156
  v_mul_f32 v157, v157, v10
  v_fma_f32 v157, v85, v11, v157
  v_mul_f32 v158, v158, v10
  v_fma_f32 v158, v86, v11, v158
  v_mul_f32 v159, v159, v10
  v_fma_f32 v159, v87, v11, v159
  v_mul_f32 v160, v160, v10
  v_fma_f32 v160, v88, v11, v160
  v_mul_f32 v161, v161, v10
  v_fma_f32 v161, v89, v11, v161
  v_mul_f32 v162, v162, v10
  v_fma_f32 v162, v90, v11, v162
  v_mul_f32 v163, v163, v10
  v_fma_f32 v163, v91, v11, v163
  v_mul_f32 v164, v164, v10
  v_fma_f32 v164, v92, v11, v164
  v_mul_f32 v165, v165, v10
  v_fma_f32 v165, v93, v11, v165
  v_mul_f32 v166, v166, v10
  v_fma_f32 v166, v94, v11, v166
  v_mul_f32 v167, v167, v10
  v_fma_f32 v167, v95, v11, v167
  v_mul_f32 v168, v168, v10
  v_fma_f32 v168, v96, v11, v168
  v_mul_f32 v169, v169, v10
  v_fma_f32 v169, v97, v11, v169
  v_mul_f32 v170, v170, v10
  v_fma_f32 v170, v98, v11, v170
  v_mul_f32 v171, v171, v10
  v_fma_f32 v171, v99, v11, v171
  v_mul_f32 v172, v172, v10
  v_fma_f32 v172, v100, v11, v172
  v_mul_f32 v173, v173, v10
  v_fma_f32 v173, v101, v11, v173
  v_mul_f32 v174, v174, v10
  v_fma_f32 v174, v102, v11, v174
  v_mul_f32 v175, v175, v10
  v_fma_f32 v175, v103, v11, v175
  v_mul_f32 v176, v176, v10
  v_fma_f32 v176, v104, v11, v176
  v_mul_f32 v177, v177, v10
  v_fma_f32 v177, v105, v11, v177
  v_mul_f32 v178, v178, v10
  v_fma_f32 v178, v106, v11, v178
  v_mul_f32 v179, v179, v10
  v_fma_f32 v179, v107, v11, v179
  v_mul_f32 v180, v180, v10
  v_fma_f32 v180, v108, v11, v180
  v_mul_f32 v181, v181, v10
  v_fma_f32 v181, v109, v11, v181
  v_mul_f32 v182, v182, v10
  v_fma_f32 v182, v110, v11, v182
  v_mul_f32 v183, v183, v10
  v_fma_f32 v183, v111, v11, v183
  v_cvt_pk_bf16_f32 v184, v152, v153
  v_cvt_pk_bf16_f32 v185, v154, v155
  v_cvt_pk_bf16_f32 v186, v156, v157
  v_cvt_pk_bf16_f32 v187, v158, v159
  buffer_store_dwordx4 v[184:187], v2, s[8:11], s20 offen offset:0 sc1
  v_cvt_pk_bf16_f32 v188, v160, v161
  v_cvt_pk_bf16_f32 v189, v162, v163
  v_cvt_pk_bf16_f32 v190, v164, v165
  v_cvt_pk_bf16_f32 v191, v166, v167
  buffer_store_dwordx4 v[188:191], v2, s[8:11], s20 offen offset:1024 sc1
  v_cvt_pk_bf16_f32 v192, v168, v169
  v_cvt_pk_bf16_f32 v193, v170, v171
  v_cvt_pk_bf16_f32 v194, v172, v173
  v_cvt_pk_bf16_f32 v195, v174, v175
  buffer_store_dwordx4 v[192:195], v2, s[8:11], s20 offen offset:2048 sc1
  v_cvt_pk_bf16_f32 v196, v176, v177
  v_cvt_pk_bf16_f32 v197, v178, v179
  v_cvt_pk_bf16_f32 v198, v180, v181
  v_cvt_pk_bf16_f32 v199, v182, v183
  buffer_store_dwordx4 v[196:199], v2, s[8:11], s20 offen offset:3072 sc1
attn_mgdone:
  s_cmp_eq_u32 s24, 1
  s_cbranch_scc1 attn_fin
  s_mov_b32 s24, 1
  s_mov_b32 s5, s4
  s_mov_b32 s80, 0x10000000
  s_mov_b32 s81, 0x10000000
  s_mov_b32 s82, 0x10000000
  s_mov_b32 s83, 0x10000000
  s_branch attn_tile
attn_fin:
attn_end:
  s_branch attn_after
attn_it1_rs:
  v_max3_f32 v10, v112, v113, v114
  v_max3_f32 v11, v115, v116, v117
  v_max3_f32 v10, v10, v118, v119
  v_max3_f32 v11, v11, v120, v121
  v_max3_f32 v10, v10, v122, v123
  v_max3_f32 v11, v11, v124, v125
  v_max3_f32 v10, v10, v126, v127
  v_max_f32 v10, v10, v11
  v_mov_b32 v11, v10
  s_nop 1
  v_permlane32_swap_b32 v10, v11
  s_nop 0
  v_max3_f32 v10, v10, v11, s35
  v_exp_f32 v11, -v10
  v_add_f32 v8, v8, v10
  v_min_f32 v11, 0x7149f2ca, v11
  s_mov_b32 s34, 0x53800000
  s_mov_b32 s35, 0
  v_mul_f32 v9, v9, v11
  v_mul_f32 v48, v48, v11
  v_mul_f32 v49, v49, v11
  v_mul_f32 v50, v50, v11
  v_mul_f32 v51, v51, v11
  v_mul_f32 v52, v52, v11
  v_mul_f32 v53, v53, v11
  v_mul_f32 v54, v54, v11
  v_mul_f32 v55, v55, v11
  v_mul_f32 v56, v56, v11
  v_mul_f32 v57, v57, v11
  v_mul_f32 v58, v58, v11
  v_mul_f32 v59, v59, v11
  v_mul_f32 v60, v60, v11
  v_mul_f32 v61, v61, v11
  v_mul_f32 v62, v62, v11
  v_mul_f32 v63, v63, v11
  v_mul_f32 v64, v64, v11
  v_mul_f32 v65, v65, v11
  v_mul_f32 v66, v66, v11
  v_mul_f32 v67, v67, v11
  v_mul_f32 v68, v68, v11
  v_mul_f32 v69, v69, v11
  v_mul_f32 v70, v70, v11
  v_mul_f32 v71, v71, v11
  v_mul_f32 v72, v72, v11
  v_mul_f32 v73, v73, v11
  v_mul_f32 v74, v74, v11
  v_mul_f32 v75, v75, v11
  v_mul_f32 v76, v76, v11
  v_mul_f32 v77, v77, v11
  v_mul_f32 v78, v78, v11
  v_mul_f32 v79, v79, v11
  v_mul_f32 v80, v80, v11
  v_mul_f32 v81, v81, v11
  v_mul_f32 v82, v82, v11
  v_mul_f32 v83, v83, v11
  v_mul_f32 v84, v84, v11
  v_mul_f32 v85, v85, v11
  v_mul_f32 v86, v86, v11
  v_mul_f32 v87, v87, v11
  v_mul_f32 v88, v88, v11
  v_mul_f32 v89, v89, v11
  v_mul_f32 v90, v90, v11
  v_mul_f32 v91, v91, v11
  v_mul_f32 v92, v92, v11
  v_mul_f32 v93, v93, v11
  v_mul_f32 v94, v94, v11
  v_mul_f32 v95, v95, v11
  v_mul_f32 v96, v96, v11
  v_mul_f32 v97, v97, v11
  v_mul_f32 v98, v98, v11
  v_mul_f32 v99, v99, v11
  v_mul_f32 v100, v100, v11
  v_mul_f32 v101, v101, v11
  v_mul_f32 v102, v102, v11
  v_mul_f32 v103, v103, v11
  v_mul_f32 v104, v104, v11
  v_mul_f32 v105, v105, v11
  v_mul_f32 v106, v106, v11
  v_mul_f32 v107, v107, v11
  v_mul_f32 v108, v108, v11
  v_mul_f32 v109, v109, v11
  v_mul_f32 v110, v110, v11
  v_mul_f32 v111, v111, v11
  v_sub_f32 v112, v112, v10
  v_sub_f32 v113, v113, v10
  v_sub_f32 v114, v114, v10
  v_sub_f32 v115, v115, v10
  v_sub_f32 v116, v116, v10
  v_sub_f32 v117, v117, v10
  v_sub_f32 v118, v118, v10
  v_sub_f32 v119, v119, v10
  v_sub_f32 v120, v120, v10
  v_sub_f32 v121, v121, v10
  v_sub_f32 v122, v122, v10
  v_sub_f32 v123, v123, v10
  v_sub_f32 v124, v124, v10
  v_sub_f32 v125, v125, v10
  v_sub_f32 v126, v126, v10
  v_sub_f32 v127, v127, v10
  v_exp_f32 v232, v112
  v_exp_f32 v233, v113
  v_exp_f32 v234, v114
  v_exp_f32 v235, v115
  v_cvt_pk_bf16_f32 v144, v232, v233
  v_add_f32 v13, v232, v233
  v_exp_f32 v236, v116
  v_exp_f32 v237, v117
  v_cvt_pk_bf16_f32 v145, v234, v235
  v_add_f32 v14, v234, v235
  v_exp_f32 v238, v118
  v_exp_f32 v239, v119
  v_cvt_pk_bf16_f32 v146, v236, v237
  v_add_f32 v13, v13, v236
  v_add_f32 v14, v14, v237
  v_exp_f32 v240, v120
  v_exp_f32 v241, v121
  v_cvt_pk_bf16_f32 v147, v238, v239
  v_add_f32 v13, v13, v238
  v_add_f32 v14, v14, v239
  v_exp_f32 v242, v122
  v_exp_f32 v243, v123
  v_cvt_pk_bf16_f32 v148, v240, v241
  v_add_f32 v13, v13, v240
  v_add_f32 v14, v14, v241
  v_exp_f32 v244, v124
  v_exp_f32 v245, v125
  v_cvt_pk_bf16_f32 v149, v242, v243
  v_add_f32 v13, v13, v242
  v_add_f32 v14, v14, v243
  v_exp_f32 v246, v126
  v_exp_f32 v247, v127
  v_cvt_pk_bf16_f32 v150, v244, v245
  v_add_f32 v13, v13, v244
  v_add_f32 v14, v14, v245
  v_add_f32 v13, v13, v14
  v_cvt_pk_bf16_f32 v151, v246, v247
  v_add_f32 v14, v246, v247
  v_add_f32 v13, v13, v14
  v_sub_f32 v216, v216, v10
  v_sub_f32 v217, v217, v10
  v_sub_f32 v218, v218, v10
  v_sub_f32 v219, v219, v10
  v_sub_f32 v220, v220, v10
  v_sub_f32 v221, v221, v10
  v_sub_f32 v222, v222, v10
  v_sub_f32 v223, v223, v10
  v_sub_f32 v224, v224, v10
  v_sub_f32 v225, v225, v10
  v_sub_f32 v226, v226, v10
  v_sub_f32 v227, v227, v10
  v_sub_f32 v228, v228, v10
  v_sub_f32 v229, v229, v10
  v_sub_f32 v230, v230, v10
  v_sub_f32 v231, v231, v10
  v_sub_f32 v128, v128, v10
  v_sub_f32 v129, v129, v10
  v_sub_f32 v130, v130, v10
  v_sub_f32 v131, v131, v10
  v_sub_f32 v132, v132, v10
  v_sub_f32 v133, v133, v10
  v_sub_f32 v134, v134, v10
  v_sub_f32 v135, v135, v10
  v_sub_f32 v136, v136, v10
  v_sub_f32 v137, v137, v10
  v_sub_f32 v138, v138, v10
  v_sub_f32 v139, v139, v10
  v_sub_f32 v140, v140, v10
  v_sub_f32 v141, v141, v10
  v_sub_f32 v142, v142, v10
  v_sub_f32 v143, v143, v10
  s_branch attn_it1_nors
attn_it2_rs:
  v_max3_f32 v10, v128, v129, v130
  v_max3_f32 v11, v131, v132, v133
  v_max3_f32 v10, v10, v134, v135
  v_max3_f32 v11, v11, v136, v137
  v_max3_f32 v10, v10, v138, v139
  v_max3_f32 v11, v11, v140, v141
  v_max3_f32 v10, v10, v142, v143
  v_max_f32 v10, v10, v11
  v_mov_b32 v11, v10
  s_nop 1
  v_permlane32_swap_b32 v10, v11
  s_nop 0
  v_max3_f32 v10, v10, v11, s35
  v_exp_f32 v11, -v10
  v_add_f32 v8, v8, v10
  v_min_f32 v11, 0x7149f2ca, v11
  s_mov_b32 s34, 0x53800000
  s_mov_b32 s35, 0
  v_mul_f32 v9, v9, v11
  v_mul_f32 v48, v48, v11
  v_mul_f32 v49, v49, v11
  v_mul_f32 v50, v50, v11
  v_mul_f32 v51, v51, v11
  v_mul_f32 v52, v52, v11
  v_mul_f32 v53, v53, v11
  v_mul_f32 v54, v54, v11
  v_mul_f32 v55, v55, v11
  v_mul_f32 v56, v56, v11
  v_mul_f32 v57, v57, v11
  v_mul_f32 v58, v58, v11
  v_mul_f32 v59, v59, v11
  v_mul_f32 v60, v60, v11
  v_mul_f32 v61, v61, v11
  v_mul_f32 v62, v62, v11
  v_mul_f32 v63, v63, v11
  v_mul_f32 v64, v64, v11
  v_mul_f32 v65, v65, v11
  v_mul_f32 v66, v66, v11
  v_mul_f32 v67, v67, v11
  v_mul_f32 v68, v68, v11
  v_mul_f32 v69, v69, v11
  v_mul_f32 v70, v70, v11
  v_mul_f32 v71, v71, v11
  v_mul_f32 v72, v72, v11
  v_mul_f32 v73, v73, v11
  v_mul_f32 v74, v74, v11
  v_mul_f32 v75, v75, v11
  v_mul_f32 v76, v76, v11
  v_mul_f32 v77, v77, v11
  v_mul_f32 v78, v78, v11
  v_mul_f32 v79, v79, v11
  v_mul_f32 v80, v80, v11
  v_mul_f32 v81, v81, v11
  v_mul_f32 v82, v82, v11
  v_mul_f32 v83, v83, v11
  v_mul_f32 v84, v84, v11
  v_mul_f32 v85, v85, v11
  v_mul_f32 v86, v86, v11
  v_mul_f32 v87, v87, v11
  v_mul_f32 v88, v88, v11
  v_mul_f32 v89, v89, v11
  v_mul_f32 v90, v90, v11
  v_mul_f32 v91, v91, v11
  v_mul_f32 v92, v92, v11
  v_mul_f32 v93, v93, v11
  v_mul_f32 v94, v94, v11
  v_mul_f32 v95, v95, v11
  v_mul_f32 v96, v96, v11
  v_mul_f32 v97, v97, v11
  v_mul_f32 v98, v98, v11
  v_mul_f32 v99, v99, v11
  v_mul_f32 v100, v100, v11
  v_mul_f32 v101, v101, v11
  v_mul_f32 v102, v102, v11
  v_mul_f32 v103, v103, v11
  v_mul_f32 v104, v104, v11
  v_mul_f32 v105, v105, v11
  v_mul_f32 v106, v106, v11
  v_mul_f32 v107, v107, v11
  v_mul_f32 v108, v108, v11
  v_mul_f32 v109, v109, v11
  v_mul_f32 v110, v110, v11
  v_mul_f32 v111, v111, v11
  v_sub_f32 v128, v128, v10
  v_sub_f32 v129, v129, v10
  v_sub_f32 v130, v130, v10
  v_sub_f32 v131, v131, v10
  v_sub_f32 v132, v132, v10
  v_sub_f32 v133, v133, v10
  v_sub_f32 v134, v134, v10
  v_sub_f32 v135, v135, v10
  v_sub_f32 v136, v136, v10
  v_sub_f32 v137, v137, v10
  v_sub_f32 v138, v138, v10
  v_sub_f32 v139, v139, v10
  v_sub_f32 v140, v140, v10
  v_sub_f32 v141, v141, v10
  v_sub_f32 v142, v142, v10
  v_sub_f32 v143, v143, v10
  v_exp_f32 v232, v128
  v_exp_f32 v233, v129
  v_exp_f32 v234, v130
  v_exp_f32 v235, v131
  v_cvt_pk_bf16_f32 v144, v232, v233
  v_add_f32 v13, v232, v233
  v_exp_f32 v236, v132
  v_exp_f32 v237, v133
  v_cvt_pk_bf16_f32 v145, v234, v235
  v_add_f32 v14, v234, v235
  v_exp_f32 v238, v134
  v_exp_f32 v239, v135
  v_cvt_pk_bf16_f32 v146, v236, v237
  v_add_f32 v13, v13, v236
  v_add_f32 v14, v14, v237
  v_exp_f32 v240, v136
  v_exp_f32 v241, v137
  v_cvt_pk_bf16_f32 v147, v238, v239
  v_add_f32 v13, v13, v238
  v_add_f32 v14, v14, v239
  v_exp_f32 v242, v138
  v_exp_f32 v243, v139
  v_cvt_pk_bf16_f32 v148, v240, v241
  v_add_f32 v13, v13, v240
  v_add_f32 v14, v14, v241
  v_exp_f32 v244, v140
  v_exp_f32 v245, v141
  v_cvt_pk_bf16_f32 v149, v242, v243
  v_add_f32 v13, v13, v242
  v_add_f32 v14, v14, v243
  v_exp_f32 v246, v142
  v_exp_f32 v247, v143
  v_cvt_pk_bf16_f32 v150, v244, v245
  v_add_f32 v13, v13, v244
  v_add_f32 v14, v14, v245
  v_add_f32 v13, v13, v14
  v_cvt_pk_bf16_f32 v151, v246, v247
  v_add_f32 v14, v246, v247
  v_add_f32 v13, v13, v14
  v_sub_f32 v216, v216, v10
  v_sub_f32 v217, v217, v10
  v_sub_f32 v218, v218, v10
  v_sub_f32 v219, v219, v10
  v_sub_f32 v220, v220, v10
  v_sub_f32 v221, v221, v10
  v_sub_f32 v222, v222, v10
  v_sub_f32 v223, v223, v10
  v_sub_f32 v224, v224, v10
  v_sub_f32 v225, v225, v10
  v_sub_f32 v226, v226, v10
  v_sub_f32 v227, v227, v10
  v_sub_f32 v228, v228, v10
  v_sub_f32 v229, v229, v10
  v_sub_f32 v230, v230, v10
  v_sub_f32 v231, v231, v10
  v_sub_f32 v112, v112, v10
  v_sub_f32 v113, v113, v10
  v_sub_f32 v114, v114, v10
  v_sub_f32 v115, v115, v10
  v_sub_f32 v116, v116, v10
  v_sub_f32 v117, v117, v10
  v_sub_f32 v118, v118, v10
  v_sub_f32 v119, v119, v10
  v_sub_f32 v120, v120, v10
  v_sub_f32 v121, v121, v10
  v_sub_f32 v122, v122, v10
  v_sub_f32 v123, v123, v10
  v_sub_f32 v124, v124, v10
  v_sub_f32 v125, v125, v10
  v_sub_f32 v126, v126, v10
  v_sub_f32 v127, v127, v10
  s_branch attn_it2_nors
attn_it3_rs:
  v_max3_f32 v10, v112, v113, v114
  v_max3_f32 v11, v115, v116, v117
  v_max3_f32 v10, v10, v118, v119
  v_max3_f32 v11, v11, v120, v121
  v_max3_f32 v10, v10, v122, v123
  v_max3_f32 v11, v11, v124, v125
  v_max3_f32 v10, v10, v126, v127
  v_max_f32 v10, v10, v11
  v_mov_b32 v11, v10
  s_nop 1
  v_permlane32_swap_b32 v10, v11
  s_nop 0
  v_max3_f32 v10, v10, v11, s35
  v_exp_f32 v11, -v10
  v_add_f32 v8, v8, v10
  v_min_f32 v11, 0x7149f2ca, v11
  s_mov_b32 s34, 0x53800000
  s_mov_b32 s35, 0
  v_mul_f32 v9, v9, v11
  v_mul_f32 v48, v48, v11
  v_mul_f32 v49, v49, v11
  v_mul_f32 v50, v50, v11
  v_mul_f32 v51, v51, v11
  v_mul_f32 v52, v52, v11
  v_mul_f32 v53, v53, v11
  v_mul_f32 v54, v54, v11
  v_mul_f32 v55, v55, v11
  v_mul_f32 v56, v56, v11
  v_mul_f32 v57, v57, v11
  v_mul_f32 v58, v58, v11
  v_mul_f32 v59, v59, v11
  v_mul_f32 v60, v60, v11
  v_mul_f32 v61, v61, v11
  v_mul_f32 v62, v62, v11
  v_mul_f32 v63, v63, v11
  v_mul_f32 v64, v64, v11
  v_mul_f32 v65, v65, v11
  v_mul_f32 v66, v66, v11
  v_mul_f32 v67, v67, v11
  v_mul_f32 v68, v68, v11
  v_mul_f32 v69, v69, v11
  v_mul_f32 v70, v70, v11
  v_mul_f32 v71, v71, v11
  v_mul_f32 v72, v72, v11
  v_mul_f32 v73, v73, v11
  v_mul_f32 v74, v74, v11
  v_mul_f32 v75, v75, v11
  v_mul_f32 v76, v76, v11
  v_mul_f32 v77, v77, v11
  v_mul_f32 v78, v78, v11
  v_mul_f32 v79, v79, v11
  v_mul_f32 v80, v80, v11
  v_mul_f32 v81, v81, v11
  v_mul_f32 v82, v82, v11
  v_mul_f32 v83, v83, v11
  v_mul_f32 v84, v84, v11
  v_mul_f32 v85, v85, v11
  v_mul_f32 v86, v86, v11
  v_mul_f32 v87, v87, v11
  v_mul_f32 v88, v88, v11
  v_mul_f32 v89, v89, v11
  v_mul_f32 v90, v90, v11
  v_mul_f32 v91, v91, v11
  v_mul_f32 v92, v92, v11
  v_mul_f32 v93, v93, v11
  v_mul_f32 v94, v94, v11
  v_mul_f32 v95, v95, v11
  v_mul_f32 v96, v96, v11
  v_mul_f32 v97, v97, v11
  v_mul_f32 v98, v98, v11
  v_mul_f32 v99, v99, v11
  v_mul_f32 v100, v100, v11
  v_mul_f32 v101, v101, v11
  v_mul_f32 v102, v102, v11
  v_mul_f32 v103, v103, v11
  v_mul_f32 v104, v104, v11
  v_mul_f32 v105, v105, v11
  v_mul_f32 v106, v106, v11
  v_mul_f32 v107, v107, v11
  v_mul_f32 v108, v108, v11
  v_mul_f32 v109, v109, v11
  v_mul_f32 v110, v110, v11
  v_mul_f32 v111, v111, v11
  v_sub_f32 v112, v112, v10
  v_sub_f32 v113, v113, v10
  v_sub_f32 v114, v114, v10
  v_sub_f32 v115, v115, v10
  v_sub_f32 v116, v116, v10
  v_sub_f32 v117, v117, v10
  v_sub_f32 v118, v118, v10
  v_sub_f32 v119, v119, v10
  v_sub_f32 v120, v120, v10
  v_sub_f32 v121, v121, v10
  v_sub_f32 v122, v122, v10
  v_sub_f32 v123, v123, v10
  v_sub_f32 v124, v124, v10
  v_sub_f32 v125, v125, v10
  v_sub_f32 v126, v126, v10
  v_sub_f32 v127, v127, v10
  v_exp_f32 v232, v112
  v_exp_f32 v233, v113
  v_exp_f32 v234, v114
  v_exp_f32 v235, v115
  v_cvt_pk_bf16_f32 v144, v232, v233
  v_add_f32 v13, v232, v233
  v_exp_f32 v236, v116
  v_exp_f32 v237, v117
  v_cvt_pk_bf16_f32 v145, v234, v235
  v_add_f32 v14, v234, v235
  v_exp_f32 v238, v118
  v_exp_f32 v239, v119
  v_cvt_pk_bf16_f32 v146, v236, v237
  v_add_f32 v13, v13, v236
  v_add_f32 v14, v14, v237
  v_exp_f32 v240, v120
  v_exp_f32 v241, v121
  v_cvt_pk_bf16_f32 v147, v238, v239
  v_add_f32 v13, v13, v238
  v_add_f32 v14, v14, v239
  v_exp_f32 v242, v122
  v_exp_f32 v243, v123
  v_cvt_pk_bf16_f32 v148, v240, v241
  v_add_f32 v13, v13, v240
  v_add_f32 v14, v14, v241
  v_exp_f32 v244, v124
  v_exp_f32 v245, v125
  v_cvt_pk_bf16_f32 v149, v242, v243
  v_add_f32 v13, v13, v242
  v_add_f32 v14, v14, v243
  v_exp_f32 v246, v126
  v_exp_f32 v247, v127
  v_cvt_pk_bf16_f32 v150, v244, v245
  v_add_f32 v13, v13, v244
  v_add_f32 v14, v14, v245
  v_add_f32 v13, v13, v14
  v_cvt_pk_bf16_f32 v151, v246, v247
  v_add_f32 v14, v246, v247
  v_add_f32 v13, v13, v14
  v_sub_f32 v216, v216, v10
  v_sub_f32 v217, v217, v10
  v_sub_f32 v218, v218, v10
  v_sub_f32 v219, v219, v10
  v_sub_f32 v220, v220, v10
  v_sub_f32 v221, v221, v10
  v_sub_f32 v222, v222, v10
  v_sub_f32 v223, v223, v10
  v_sub_f32 v224, v224, v10
  v_sub_f32 v225, v225, v10
  v_sub_f32 v226, v226, v10
  v_sub_f32 v227, v227, v10
  v_sub_f32 v228, v228, v10
  v_sub_f32 v229, v229, v10
  v_sub_f32 v230, v230, v10
  v_sub_f32 v231, v231, v10
  v_sub_f32 v128, v128, v10
  v_sub_f32 v129, v129, v10
  v_sub_f32 v130, v130, v10
  v_sub_f32 v131, v131, v10
  v_sub_f32 v132, v132, v10
  v_sub_f32 v133, v133, v10
  v_sub_f32 v134, v134, v10
  v_sub_f32 v135, v135, v10
  v_sub_f32 v136, v136, v10
  v_sub_f32 v137, v137, v10
  v_sub_f32 v138, v138, v10
  v_sub_f32 v139, v139, v10
  v_sub_f32 v140, v140, v10
  v_sub_f32 v141, v141, v10
  v_sub_f32 v142, v142, v10
  v_sub_f32 v143, v143, v10
  s_branch attn_it3_nors
attn_it4_rs:
  v_max3_f32 v10, v128, v129, v130
  v_max3_f32 v11, v131, v132, v133
  v_max3_f32 v10, v10, v134, v135
  v_max3_f32 v11, v11, v136, v137
  v_max3_f32 v10, v10, v138, v139
  v_max3_f32 v11, v11, v140, v141
  v_max3_f32 v10, v10, v142, v143
  v_max_f32 v10, v10, v11
  v_mov_b32 v11, v10
  s_nop 1
  v_permlane32_swap_b32 v10, v11
  s_nop 0
  v_max3_f32 v10, v10, v11, s35
  v_exp_f32 v11, -v10
  v_add_f32 v8, v8, v10
  v_min_f32 v11, 0x7149f2ca, v11
  s_mov_b32 s34, 0x53800000
  s_mov_b32 s35, 0
  v_mul_f32 v9, v9, v11
  v_mul_f32 v48, v48, v11
  v_mul_f32 v49, v49, v11
  v_mul_f32 v50, v50, v11
  v_mul_f32 v51, v51, v11
  v_mul_f32 v52, v52, v11
  v_mul_f32 v53, v53, v11
  v_mul_f32 v54, v54, v11
  v_mul_f32 v55, v55, v11
  v_mul_f32 v56, v56, v11
  v_mul_f32 v57, v57, v11
  v_mul_f32 v58, v58, v11
  v_mul_f32 v59, v59, v11
  v_mul_f32 v60, v60, v11
  v_mul_f32 v61, v61, v11
  v_mul_f32 v62, v62, v11
  v_mul_f32 v63, v63, v11
  v_mul_f32 v64, v64, v11
  v_mul_f32 v65, v65, v11
  v_mul_f32 v66, v66, v11
  v_mul_f32 v67, v67, v11
  v_mul_f32 v68, v68, v11
  v_mul_f32 v69, v69, v11
  v_mul_f32 v70, v70, v11
  v_mul_f32 v71, v71, v11
  v_mul_f32 v72, v72, v11
  v_mul_f32 v73, v73, v11
  v_mul_f32 v74, v74, v11
  v_mul_f32 v75, v75, v11
  v_mul_f32 v76, v76, v11
  v_mul_f32 v77, v77, v11
  v_mul_f32 v78, v78, v11
  v_mul_f32 v79, v79, v11
  v_mul_f32 v80, v80, v11
  v_mul_f32 v81, v81, v11
  v_mul_f32 v82, v82, v11
  v_mul_f32 v83, v83, v11
  v_mul_f32 v84, v84, v11
  v_mul_f32 v85, v85, v11
  v_mul_f32 v86, v86, v11
  v_mul_f32 v87, v87, v11
  v_mul_f32 v88, v88, v11
  v_mul_f32 v89, v89, v11
  v_mul_f32 v90, v90, v11
  v_mul_f32 v91, v91, v11
  v_mul_f32 v92, v92, v11
  v_mul_f32 v93, v93, v11
  v_mul_f32 v94, v94, v11
  v_mul_f32 v95, v95, v11
  v_mul_f32 v96, v96, v11
  v_mul_f32 v97, v97, v11
  v_mul_f32 v98, v98, v11
  v_mul_f32 v99, v99, v11
  v_mul_f32 v100, v100, v11
  v_mul_f32 v101, v101, v11
  v_mul_f32 v102, v102, v11
  v_mul_f32 v103, v103, v11
  v_mul_f32 v104, v104, v11
  v_mul_f32 v105, v105, v11
  v_mul_f32 v106, v106, v11
  v_mul_f32 v107, v107, v11
  v_mul_f32 v108, v108, v11
  v_mul_f32 v109, v109, v11
  v_mul_f32 v110, v110, v11
  v_mul_f32 v111, v111, v11
  v_sub_f32 v128, v128, v10
  v_sub_f32 v129, v129, v10
  v_sub_f32 v130, v130, v10
  v_sub_f32 v131, v131, v10
  v_sub_f32 v132, v132, v10
  v_sub_f32 v133, v133, v10
  v_sub_f32 v134, v134, v10
  v_sub_f32 v135, v135, v10
  v_sub_f32 v136, v136, v10
  v_sub_f32 v137, v137, v10
  v_sub_f32 v138, v138, v10
  v_sub_f32 v139, v139, v10
  v_sub_f32 v140, v140, v10
  v_sub_f32 v141, v141, v10
  v_sub_f32 v142, v142, v10
  v_sub_f32 v143, v143, v10
  v_exp_f32 v232, v128
  v_exp_f32 v233, v129
  v_exp_f32 v234, v130
  v_exp_f32 v235, v131
  v_cvt_pk_bf16_f32 v144, v232, v233
  v_add_f32 v13, v232, v233
  v_exp_f32 v236, v132
  v_exp_f32 v237, v133
  v_cvt_pk_bf16_f32 v145, v234, v235
  v_add_f32 v14, v234, v235
  v_exp_f32 v238, v134
  v_exp_f32 v239, v135
  v_cvt_pk_bf16_f32 v146, v236, v237
  v_add_f32 v13, v13, v236
  v_add_f32 v14, v14, v237
  v_exp_f32 v240, v136
  v_exp_f32 v241, v137
  v_cvt_pk_bf16_f32 v147, v238, v239
  v_add_f32 v13, v13, v238
  v_add_f32 v14, v14, v239
  v_exp_f32 v242, v138
  v_exp_f32 v243, v139
  v_cvt_pk_bf16_f32 v148, v240, v241
  v_add_f32 v13, v13, v240
  v_add_f32 v14, v14, v241
  v_exp_f32 v244, v140
  v_exp_f32 v245, v141
  v_cvt_pk_bf16_f32 v149, v242, v243
  v_add_f32 v13, v13, v242
  v_add_f32 v14, v14, v243
  v_exp_f32 v246, v142
  v_exp_f32 v247, v143
  v_cvt_pk_bf16_f32 v150, v244, v245
  v_add_f32 v13, v13, v244
  v_add_f32 v14, v14, v245
  v_add_f32 v13, v13, v14
  v_cvt_pk_bf16_f32 v151, v246, v247
  v_add_f32 v14, v246, v247
  v_add_f32 v13, v13, v14
  v_sub_f32 v216, v216, v10
  v_sub_f32 v217, v217, v10
  v_sub_f32 v218, v218, v10
  v_sub_f32 v219, v219, v10
  v_sub_f32 v220, v220, v10
  v_sub_f32 v221, v221, v10
  v_sub_f32 v222, v222, v10
  v_sub_f32 v223, v223, v10
  v_sub_f32 v224, v224, v10
  v_sub_f32 v225, v225, v10
  v_sub_f32 v226, v226, v10
  v_sub_f32 v227, v227, v10
  v_sub_f32 v228, v228, v10
  v_sub_f32 v229, v229, v10
  v_sub_f32 v230, v230, v10
  v_sub_f32 v231, v231, v10
  s_branch attn_it4_nors
attn_it5_rs:
  v_max3_f32 v10, v112, v113, v114
  v_max3_f32 v11, v115, v116, v117
  v_max3_f32 v10, v10, v118, v119
  v_max3_f32 v11, v11, v120, v121
  v_max3_f32 v10, v10, v122, v123
  v_max3_f32 v11, v11, v124, v125
  v_max3_f32 v10, v10, v126, v127
  v_max_f32 v10, v10, v11
  v_mov_b32 v11, v10
  s_nop 1
  v_permlane32_swap_b32 v10, v11
  s_nop 0
  v_max3_f32 v10, v10, v11, s35
  v_exp_f32 v11, -v10
  v_add_f32 v8, v8, v10
  v_min_f32 v11, 0x7149f2ca, v11
  s_mov_b32 s34, 0x53800000
  s_mov_b32 s35, 0
  v_mul_f32 v9, v9, v11
  v_mul_f32 v48, v48, v11
  v_mul_f32 v49, v49, v11
  v_mul_f32 v50, v50, v11
  v_mul_f32 v51, v51, v11
  v_mul_f32 v52, v52, v11
  v_mul_f32 v53, v53, v11
  v_mul_f32 v54, v54, v11
  v_mul_f32 v55, v55, v11
  v_mul_f32 v56, v56, v11
  v_mul_f32 v57, v57, v11
  v_mul_f32 v58, v58, v11
  v_mul_f32 v59, v59, v11
  v_mul_f32 v60, v60, v11
  v_mul_f32 v61, v61, v11
  v_mul_f32 v62, v62, v11
  v_mul_f32 v63, v63, v11
  v_mul_f32 v64, v64, v11
  v_mul_f32 v65, v65, v11
  v_mul_f32 v66, v66, v11
  v_mul_f32 v67, v67, v11
  v_mul_f32 v68, v68, v11
  v_mul_f32 v69, v69, v11
  v_mul_f32 v70, v70, v11
  v_mul_f32 v71, v71, v11
  v_mul_f32 v72, v72, v11
  v_mul_f32 v73, v73, v11
  v_mul_f32 v74, v74, v11
  v_mul_f32 v75, v75, v11
  v_mul_f32 v76, v76, v11
  v_mul_f32 v77, v77, v11
  v_mul_f32 v78, v78, v11
  v_mul_f32 v79, v79, v11
  v_mul_f32 v80, v80, v11
  v_mul_f32 v81, v81, v11
  v_mul_f32 v82, v82, v11
  v_mul_f32 v83, v83, v11
  v_mul_f32 v84, v84, v11
  v_mul_f32 v85, v85, v11
  v_mul_f32 v86, v86, v11
  v_mul_f32 v87, v87, v11
  v_mul_f32 v88, v88, v11
  v_mul_f32 v89, v89, v11
  v_mul_f32 v90, v90, v11
  v_mul_f32 v91, v91, v11
  v_mul_f32 v92, v92, v11
  v_mul_f32 v93, v93, v11
  v_mul_f32 v94, v94, v11
  v_mul_f32 v95, v95, v11
  v_mul_f32 v96, v96, v11
  v_mul_f32 v97, v97, v11
  v_mul_f32 v98, v98, v11
  v_mul_f32 v99, v99, v11
  v_mul_f32 v100, v100, v11
  v_mul_f32 v101, v101, v11
  v_mul_f32 v102, v102, v11
  v_mul_f32 v103, v103, v11
  v_mul_f32 v104, v104, v11
  v_mul_f32 v105, v105, v11
  v_mul_f32 v106, v106, v11
  v_mul_f32 v107, v107, v11
  v_mul_f32 v108, v108, v11
  v_mul_f32 v109, v109, v11
  v_mul_f32 v110, v110, v11
  v_mul_f32 v111, v111, v11
  v_sub_f32 v112, v112, v10
  v_sub_f32 v113, v113, v10
  v_sub_f32 v114, v114, v10
  v_sub_f32 v115, v115, v10
  v_sub_f32 v116, v116, v10
  v_sub_f32 v117, v117, v10
  v_sub_f32 v118, v118, v10
  v_sub_f32 v119, v119, v10
  v_sub_f32 v120, v120, v10
  v_sub_f32 v121, v121, v10
  v_sub_f32 v122, v122, v10
  v_sub_f32 v123, v123, v10
  v_sub_f32 v124, v124, v10
  v_sub_f32 v125, v125, v10
  v_sub_f32 v126, v126, v10
  v_sub_f32 v127, v127, v10
  v_exp_f32 v232, v112
  v_exp_f32 v233, v113
  v_exp_f32 v234, v114
  v_exp_f32 v235, v115
  v_cvt_pk_bf16_f32 v144, v232, v233
  v_add_f32 v13, v232, v233
  v_exp_f32 v236, v116
  v_exp_f32 v237, v117
  v_cvt_pk_bf16_f32 v145, v234, v235
  v_add_f32 v14, v234, v235
  v_exp_f32 v238, v118
  v_exp_f32 v239, v119
  v_cvt_pk_bf16_f32 v146, v236, v237
  v_add_f32 v13, v13, v236
  v_add_f32 v14, v14, v237
  v_exp_f32 v240, v120
  v_exp_f32 v241, v121
  v_cvt_pk_bf16_f32 v147, v238, v239
  v_add_f32 v13, v13, v238
  v_add_f32 v14, v14, v239
  v_exp_f32 v242, v122
  v_exp_f32 v243, v123
  v_cvt_pk_bf16_f32 v148, v240, v241
  v_add_f32 v13, v13, v240
  v_add_f32 v14, v14, v241
  v_exp_f32 v244, v124
  v_exp_f32 v245, v125
  v_cvt_pk_bf16_f32 v149, v242, v243
  v_add_f32 v13, v13, v242
  v_add_f32 v14, v14, v243
  v_exp_f32 v246, v126
  v_exp_f32 v247, v127
  v_cvt_pk_bf16_f32 v150, v244, v245
  v_add_f32 v13, v13, v244
  v_add_f32 v14, v14, v245
  v_add_f32 v13, v13, v14
  v_cvt_pk_bf16_f32 v151, v246, v247
  v_add_f32 v14, v246, v247
  v_add_f32 v13, v13, v14
  v_sub_f32 v216, v216, v10
  v_sub_f32 v217, v217, v10
  v_sub_f32 v218, v218, v10
  v_sub_f32 v219, v219, v10
  v_sub_f32 v220, v220, v10
  v_sub_f32 v221, v221, v10
  v_sub_f32 v222, v222, v10
  v_sub_f32 v223, v223, v10
  v_sub_f32 v224, v224, v10
  v_sub_f32 v225, v225, v10
  v_sub_f32 v226, v226, v10
  v_sub_f32 v227, v227, v10
  v_sub_f32 v228, v228, v10
  v_sub_f32 v229, v229, v10
  v_sub_f32 v230, v230, v10
  v_sub_f32 v231, v231, v10
  v_sub_f32 v128, v128, v10
  v_sub_f32 v129, v129, v10
  v_sub_f32 v130, v130, v10
  v_sub_f32 v131, v131, v10
  v_sub_f32 v132, v132, v10
  v_sub_f32 v133, v133, v10
  v_sub_f32 v134, v134, v10
  v_sub_f32 v135, v135, v10
  v_sub_f32 v136, v136, v10
  v_sub_f32 v137, v137, v10
  v_sub_f32 v138, v138, v10
  v_sub_f32 v139, v139, v10
  v_sub_f32 v140, v140, v10
  v_sub_f32 v141, v141, v10
  v_sub_f32 v142, v142, v10
  v_sub_f32 v143, v143, v10
  s_branch attn_it5_nors
attn_it6_rs:
  v_max3_f32 v10, v128, v129, v130
  v_max3_f32 v11, v131, v132, v133
  v_max3_f32 v10, v10, v134, v135
  v_max3_f32 v11, v11, v136, v137
  v_max3_f32 v10, v10, v138, v139
  v_max3_f32 v11, v11, v140, v141
  v_max3_f32 v10, v10, v142, v143
  v_max_f32 v10, v10, v11
  v_mov_b32 v11, v10
  s_nop 1
  v_permlane32_swap_b32 v10, v11
  s_nop 0
  v_max3_f32 v10, v10, v11, s35
  v_exp_f32 v11, -v10
  v_add_f32 v8, v8, v10
  v_min_f32 v11, 0x7149f2ca, v11
  s_mov_b32 s34, 0x53800000
  s_mov_b32 s35, 0
  v_mul_f32 v9, v9, v11
  v_mul_f32 v48, v48, v11
  v_mul_f32 v49, v49, v11
  v_mul_f32 v50, v50, v11
  v_mul_f32 v51, v51, v11
  v_mul_f32 v52, v52, v11
  v_mul_f32 v53, v53, v11
  v_mul_f32 v54, v54, v11
  v_mul_f32 v55, v55, v11
  v_mul_f32 v56, v56, v11
  v_mul_f32 v57, v57, v11
  v_mul_f32 v58, v58, v11
  v_mul_f32 v59, v59, v11
  v_mul_f32 v60, v60, v11
  v_mul_f32 v61, v61, v11
  v_mul_f32 v62, v62, v11
  v_mul_f32 v63, v63, v11
  v_mul_f32 v64, v64, v11
  v_mul_f32 v65, v65, v11
  v_mul_f32 v66, v66, v11
  v_mul_f32 v67, v67, v11
  v_mul_f32 v68, v68, v11
  v_mul_f32 v69, v69, v11
  v_mul_f32 v70, v70, v11
  v_mul_f32 v71, v71, v11
  v_mul_f32 v72, v72, v11
  v_mul_f32 v73, v73, v11
  v_mul_f32 v74, v74, v11
  v_mul_f32 v75, v75, v11
  v_mul_f32 v76, v76, v11
  v_mul_f32 v77, v77, v11
  v_mul_f32 v78, v78, v11
  v_mul_f32 v79, v79, v11
  v_mul_f32 v80, v80, v11
  v_mul_f32 v81, v81, v11
  v_mul_f32 v82, v82, v11
  v_mul_f32 v83, v83, v11
  v_mul_f32 v84, v84, v11
  v_mul_f32 v85, v85, v11
  v_mul_f32 v86, v86, v11
  v_mul_f32 v87, v87, v11
  v_mul_f32 v88, v88, v11
  v_mul_f32 v89, v89, v11
  v_mul_f32 v90, v90, v11
  v_mul_f32 v91, v91, v11
  v_mul_f32 v92, v92, v11
  v_mul_f32 v93, v93, v11
  v_mul_f32 v94, v94, v11
  v_mul_f32 v95, v95, v11
  v_mul_f32 v96, v96, v11
  v_mul_f32 v97, v97, v11
  v_mul_f32 v98, v98, v11
  v_mul_f32 v99, v99, v11
  v_mul_f32 v100, v100, v11
  v_mul_f32 v101, v101, v11
  v_mul_f32 v102, v102, v11
  v_mul_f32 v103, v103, v11
  v_mul_f32 v104, v104, v11
  v_mul_f32 v105, v105, v11
  v_mul_f32 v106, v106, v11
  v_mul_f32 v107, v107, v11
  v_mul_f32 v108, v108, v11
  v_mul_f32 v109, v109, v11
  v_mul_f32 v110, v110, v11
  v_mul_f32 v111, v111, v11
  v_sub_f32 v128, v128, v10
  v_sub_f32 v129, v129, v10
  v_sub_f32 v130, v130, v10
  v_sub_f32 v131, v131, v10
  v_sub_f32 v132, v132, v10
  v_sub_f32 v133, v133, v10
  v_sub_f32 v134, v134, v10
  v_sub_f32 v135, v135, v10
  v_sub_f32 v136, v136, v10
  v_sub_f32 v137, v137, v10
  v_sub_f32 v138, v138, v10
  v_sub_f32 v139, v139, v10
  v_sub_f32 v140, v140, v10
  v_sub_f32 v141, v141, v10
  v_sub_f32 v142, v142, v10
  v_sub_f32 v143, v143, v10
  v_exp_f32 v232, v128
  v_exp_f32 v233, v129
  v_exp_f32 v234, v130
  v_exp_f32 v235, v131
  v_cvt_pk_bf16_f32 v144, v232, v233
  v_add_f32 v13, v232, v233
  v_exp_f32 v236, v132
  v_exp_f32 v237, v133
  v_cvt_pk_bf16_f32 v145, v234, v235
  v_add_f32 v14, v234, v235
  v_exp_f32 v238, v134
  v_exp_f32 v239, v135
  v_cvt_pk_bf16_f32 v146, v236, v237
  v_add_f32 v13, v13, v236
  v_add_f32 v14, v14, v237
  v_exp_f32 v240, v136
  v_exp_f32 v241, v137
  v_cvt_pk_bf16_f32 v147, v238, v239
  v_add_f32 v13, v13, v238
  v_add_f32 v14, v14, v239
  v_exp_f32 v242, v138
  v_exp_f32 v243, v139
  v_cvt_pk_bf16_f32 v148, v240, v241
  v_add_f32 v13, v13, v240
  v_add_f32 v14, v14, v241
  v_exp_f32 v244, v140
  v_exp_f32 v245, v141
  v_cvt_pk_bf16_f32 v149, v242, v243
  v_add_f32 v13, v13, v242
  v_add_f32 v14, v14, v243
  v_exp_f32 v246, v142
  v_exp_f32 v247, v143
  v_cvt_pk_bf16_f32 v150, v244, v245
  v_add_f32 v13, v13, v244
  v_add_f32 v14, v14, v245
  v_add_f32 v13, v13, v14
  v_cvt_pk_bf16_f32 v151, v246, v247
  v_add_f32 v14, v246, v247
  v_add_f32 v13, v13, v14
  v_sub_f32 v216, v216, v10
  v_sub_f32 v217, v217, v10
  v_sub_f32 v218, v218, v10
  v_sub_f32 v219, v219, v10
  v_sub_f32 v220, v220, v10
  v_sub_f32 v221, v221, v10
  v_sub_f32 v222, v222, v10
  v_sub_f32 v223, v223, v10
  v_sub_f32 v224, v224, v10
  v_sub_f32 v225, v225, v10
  v_sub_f32 v226, v226, v10
  v_sub_f32 v227, v227, v10
  v_sub_f32 v228, v228, v10
  v_sub_f32 v229, v229, v10
  v_sub_f32 v230, v230, v10
  v_sub_f32 v231, v231, v10
  v_sub_f32 v112, v112, v10
  v_sub_f32 v113, v113, v10
  v_sub_f32 v114, v114, v10
  v_sub_f32 v115, v115, v10
  v_sub_f32 v116, v116, v10
  v_sub_f32 v117, v117, v10
  v_sub_f32 v118, v118, v10
  v_sub_f32 v119, v119, v10
  v_sub_f32 v120, v120, v10
  v_sub_f32 v121, v121, v10
  v_sub_f32 v122, v122, v10
  v_sub_f32 v123, v123, v10
  v_sub_f32 v124, v124, v10
  v_sub_f32 v125, v125, v10
  v_sub_f32 v126, v126, v10
  v_sub_f32 v127, v127, v10
  s_branch attn_it6_nors
attn_it7_rs:
  v_max3_f32 v10, v112, v113, v114
  v_max3_f32 v11, v115, v116, v117
  v_max3_f32 v10, v10, v118, v119
  v_max3_f32 v11, v11, v120, v121
  v_max3_f32 v10, v10, v122, v123
  v_max3_f32 v11, v11, v124, v125
  v_max3_f32 v10, v10, v126, v127
  v_max_f32 v10, v10, v11
  v_mov_b32 v11, v10
  s_nop 1
  v_permlane32_swap_b32 v10, v11
  s_nop 0
  v_max3_f32 v10, v10, v11, s35
  v_exp_f32 v11, -v10
  v_add_f32 v8, v8, v10
  v_min_f32 v11, 0x7149f2ca, v11
  s_mov_b32 s34, 0x53800000
  s_mov_b32 s35, 0
  v_mul_f32 v9, v9, v11
  v_mul_f32 v48, v48, v11
  v_mul_f32 v49, v49, v11
  v_mul_f32 v50, v50, v11
  v_mul_f32 v51, v51, v11
  v_mul_f32 v52, v52, v11
  v_mul_f32 v53, v53, v11
  v_mul_f32 v54, v54, v11
  v_mul_f32 v55, v55, v11
  v_mul_f32 v56, v56, v11
  v_mul_f32 v57, v57, v11
  v_mul_f32 v58, v58, v11
  v_mul_f32 v59, v59, v11
  v_mul_f32 v60, v60, v11
  v_mul_f32 v61, v61, v11
  v_mul_f32 v62, v62, v11
  v_mul_f32 v63, v63, v11
  v_mul_f32 v64, v64, v11
  v_mul_f32 v65, v65, v11
  v_mul_f32 v66, v66, v11
  v_mul_f32 v67, v67, v11
  v_mul_f32 v68, v68, v11
  v_mul_f32 v69, v69, v11
  v_mul_f32 v70, v70, v11
  v_mul_f32 v71, v71, v11
  v_mul_f32 v72, v72, v11
  v_mul_f32 v73, v73, v11
  v_mul_f32 v74, v74, v11
  v_mul_f32 v75, v75, v11
  v_mul_f32 v76, v76, v11
  v_mul_f32 v77, v77, v11
  v_mul_f32 v78, v78, v11
  v_mul_f32 v79, v79, v11
  v_mul_f32 v80, v80, v11
  v_mul_f32 v81, v81, v11
  v_mul_f32 v82, v82, v11
  v_mul_f32 v83, v83, v11
  v_mul_f32 v84, v84, v11
  v_mul_f32 v85, v85, v11
  v_mul_f32 v86, v86, v11
  v_mul_f32 v87, v87, v11
  v_mul_f32 v88, v88, v11
  v_mul_f32 v89, v89, v11
  v_mul_f32 v90, v90, v11
  v_mul_f32 v91, v91, v11
  v_mul_f32 v92, v92, v11
  v_mul_f32 v93, v93, v11
  v_mul_f32 v94, v94, v11
  v_mul_f32 v95, v95, v11
  v_mul_f32 v96, v96, v11
  v_mul_f32 v97, v97, v11
  v_mul_f32 v98, v98, v11
  v_mul_f32 v99, v99, v11
  v_mul_f32 v100, v100, v11
  v_mul_f32 v101, v101, v11
  v_mul_f32 v102, v102, v11
  v_mul_f32 v103, v103, v11
  v_mul_f32 v104, v104, v11
  v_mul_f32 v105, v105, v11
  v_mul_f32 v106, v106, v11
  v_mul_f32 v107, v107, v11
  v_mul_f32 v108, v108, v11
  v_mul_f32 v109, v109, v11
  v_mul_f32 v110, v110, v11
  v_mul_f32 v111, v111, v11
  v_sub_f32 v112, v112, v10
  v_sub_f32 v113, v113, v10
  v_sub_f32 v114, v114, v10
  v_sub_f32 v115, v115, v10
  v_sub_f32 v116, v116, v10
  v_sub_f32 v117, v117, v10
  v_sub_f32 v118, v118, v10
  v_sub_f32 v119, v119, v10
  v_sub_f32 v120, v120, v10
  v_sub_f32 v121, v121, v10
  v_sub_f32 v122, v122, v10
  v_sub_f32 v123, v123, v10
  v_sub_f32 v124, v124, v10
  v_sub_f32 v125, v125, v10
  v_sub_f32 v126, v126, v10
  v_sub_f32 v127, v127, v10
  v_exp_f32 v232, v112
  v_exp_f32 v233, v113
  v_exp_f32 v234, v114
  v_exp_f32 v235, v115
  v_cvt_pk_bf16_f32 v144, v232, v233
  v_add_f32 v13, v232, v233
  v_exp_f32 v236, v116
  v_exp_f32 v237, v117
  v_cvt_pk_bf16_f32 v145, v234, v235
  v_add_f32 v14, v234, v235
  v_exp_f32 v238, v118
  v_exp_f32 v239, v119
  v_cvt_pk_bf16_f32 v146, v236, v237
  v_add_f32 v13, v13, v236
  v_add_f32 v14, v14, v237
  v_exp_f32 v240, v120
  v_exp_f32 v241, v121
  v_cvt_pk_bf16_f32 v147, v238, v239
  v_add_f32 v13, v13, v238
  v_add_f32 v14, v14, v239
  v_exp_f32 v242, v122
  v_exp_f32 v243, v123
  v_cvt_pk_bf16_f32 v148, v240, v241
  v_add_f32 v13, v13, v240
  v_add_f32 v14, v14, v241
  v_exp_f32 v244, v124
  v_exp_f32 v245, v125
  v_cvt_pk_bf16_f32 v149, v242, v243
  v_add_f32 v13, v13, v242
  v_add_f32 v14, v14, v243
  v_exp_f32 v246, v126
  v_exp_f32 v247, v127
  v_cvt_pk_bf16_f32 v150, v244, v245
  v_add_f32 v13, v13, v244
  v_add_f32 v14, v14, v245
  v_add_f32 v13, v13, v14
  v_cvt_pk_bf16_f32 v151, v246, v247
  v_add_f32 v14, v246, v247
  v_add_f32 v13, v13, v14
  v_sub_f32 v216, v216, v10
  v_sub_f32 v217, v217, v10
  v_sub_f32 v218, v218, v10
  v_sub_f32 v219, v219, v10
  v_sub_f32 v220, v220, v10
  v_sub_f32 v221, v221, v10
  v_sub_f32 v222, v222, v10
  v_sub_f32 v223, v223, v10
  v_sub_f32 v224, v224, v10
  v_sub_f32 v225, v225, v10
  v_sub_f32 v226, v226, v10
  v_sub_f32 v227, v227, v10
  v_sub_f32 v228, v228, v10
  v_sub_f32 v229, v229, v10
  v_sub_f32 v230, v230, v10
  v_sub_f32 v231, v231, v10
  v_sub_f32 v128, v128, v10
  v_sub_f32 v129, v129, v10
  v_sub_f32 v130, v130, v10
  v_sub_f32 v131, v131, v10
  v_sub_f32 v132, v132, v10
  v_sub_f32 v133, v133, v10
  v_sub_f32 v134, v134, v10
  v_sub_f32 v135, v135, v10
  v_sub_f32 v136, v136, v10
  v_sub_f32 v137, v137, v10
  v_sub_f32 v138, v138, v10
  v_sub_f32 v139, v139, v10
  v_sub_f32 v140, v140, v10
  v_sub_f32 v141, v141, v10
  v_sub_f32 v142, v142, v10
  v_sub_f32 v143, v143, v10
  s_branch attn_it7_nors
attn_it8_rs:
  v_max3_f32 v10, v112, v113, v114
  v_max3_f32 v11, v115, v116, v117
  v_max3_f32 v10, v10, v118, v119
  v_max3_f32 v11, v11, v120, v121
  v_max3_f32 v10, v10, v122, v123
  v_max3_f32 v11, v11, v124, v125
  v_max3_f32 v10, v10, v126, v127
  v_max_f32 v10, v10, v11
  v_mov_b32 v11, v10
  s_nop 1
  v_permlane32_swap_b32 v10, v11
  s_nop 0
  v_max3_f32 v10, v10, v11, s35
  v_exp_f32 v11, -v10
  v_add_f32 v8, v8, v10
  v_min_f32 v11, 0x7149f2ca, v11
  s_mov_b32 s34, 0x53800000
  s_mov_b32 s35, 0
  v_mul_f32 v9, v9, v11
  v_mul_f32 v48, v48, v11
  v_mul_f32 v49, v49, v11
  v_mul_f32 v50, v50, v11
  v_mul_f32 v51, v51, v11
  v_mul_f32 v52, v52, v11
  v_mul_f32 v53, v53, v11
  v_mul_f32 v54, v54, v11
  v_mul_f32 v55, v55, v11
  v_mul_f32 v56, v56, v11
  v_mul_f32 v57, v57, v11
  v_mul_f32 v58, v58, v11
  v_mul_f32 v59, v59, v11
  v_mul_f32 v60, v60, v11
  v_mul_f32 v61, v61, v11
  v_mul_f32 v62, v62, v11
  v_mul_f32 v63, v63, v11
  v_mul_f32 v64, v64, v11
  v_mul_f32 v65, v65, v11
  v_mul_f32 v66, v66, v11
  v_mul_f32 v67, v67, v11
  v_mul_f32 v68, v68, v11
  v_mul_f32 v69, v69, v11
  v_mul_f32 v70, v70, v11
  v_mul_f32 v71, v71, v11
  v_mul_f32 v72, v72, v11
  v_mul_f32 v73, v73, v11
  v_mul_f32 v74, v74, v11
  v_mul_f32 v75, v75, v11
  v_mul_f32 v76, v76, v11
  v_mul_f32 v77, v77, v11
  v_mul_f32 v78, v78, v11
  v_mul_f32 v79, v79, v11
  v_mul_f32 v80, v80, v11
  v_mul_f32 v81, v81, v11
  v_mul_f32 v82, v82, v11
  v_mul_f32 v83, v83, v11
  v_mul_f32 v84, v84, v11
  v_mul_f32 v85, v85, v11
  v_mul_f32 v86, v86, v11
  v_mul_f32 v87, v87, v11
  v_mul_f32 v88, v88, v11
  v_mul_f32 v89, v89, v11
  v_mul_f32 v90, v90, v11
  v_mul_f32 v91, v91, v11
  v_mul_f32 v92, v92, v11
  v_mul_f32 v93, v93, v11
  v_mul_f32 v94, v94, v11
  v_mul_f32 v95, v95, v11
  v_mul_f32 v96, v96, v11
  v_mul_f32 v97, v97, v11
  v_mul_f32 v98, v98, v11
  v_mul_f32 v99, v99, v11
  v_mul_f32 v100, v100, v11
  v_mul_f32 v101, v101, v11
  v_mul_f32 v102, v102, v11
  v_mul_f32 v103, v103, v11
  v_mul_f32 v104, v104, v11
  v_mul_f32 v105, v105, v11
  v_mul_f32 v106, v106, v11
  v_mul_f32 v107, v107, v11
  v_mul_f32 v108, v108, v11
  v_mul_f32 v109, v109, v11
  v_mul_f32 v110, v110, v11
  v_mul_f32 v111, v111, v11
  v_sub_f32 v112, v112, v10
  v_sub_f32 v113, v113, v10
  v_sub_f32 v114, v114, v10
  v_sub_f32 v115, v115, v10
  v_sub_f32 v116, v116, v10
  v_sub_f32 v117, v117, v10
  v_sub_f32 v118, v118, v10
  v_sub_f32 v119, v119, v10
  v_sub_f32 v120, v120, v10
  v_sub_f32 v121, v121, v10
  v_sub_f32 v122, v122, v10
  v_sub_f32 v123, v123, v10
  v_sub_f32 v124, v124, v10
  v_sub_f32 v125, v125, v10
  v_sub_f32 v126, v126, v10
  v_sub_f32 v127, v127, v10
  v_exp_f32 v232, v112
  v_exp_f32 v233, v113
  v_exp_f32 v234, v114
  v_exp_f32 v235, v115
  v_cvt_pk_bf16_f32 v144, v232, v233
  v_add_f32 v13, v232, v233
  v_exp_f32 v236, v116
  v_exp_f32 v237, v117
  v_cvt_pk_bf16_f32 v145, v234, v235
  v_add_f32 v14, v234, v235
  v_exp_f32 v238, v118
  v_exp_f32 v239, v119
  v_cvt_pk_bf16_f32 v146, v236, v237
  v_add_f32 v13, v13, v236
  v_add_f32 v14, v14, v237
  v_exp_f32 v240, v120
  v_exp_f32 v241, v121
  v_cvt_pk_bf16_f32 v147, v238, v239
  v_add_f32 v13, v13, v238
  v_add_f32 v14, v14, v239
  v_exp_f32 v242, v122
  v_exp_f32 v243, v123
  v_cvt_pk_bf16_f32 v148, v240, v241
  v_add_f32 v13, v13, v240
  v_add_f32 v14, v14, v241
  v_exp_f32 v244, v124
  v_exp_f32 v245, v125
  v_cvt_pk_bf16_f32 v149, v242, v243
  v_add_f32 v13, v13, v242
  v_add_f32 v14, v14, v243
  v_exp_f32 v246, v126
  v_exp_f32 v247, v127
  v_cvt_pk_bf16_f32 v150, v244, v245
  v_add_f32 v13, v13, v244
  v_add_f32 v14, v14, v245
  v_add_f32 v13, v13, v14
  v_cvt_pk_bf16_f32 v151, v246, v247
  v_add_f32 v14, v246, v247
  v_add_f32 v13, v13, v14
  v_sub_f32 v216, v216, v10
  v_sub_f32 v217, v217, v10
  v_sub_f32 v218, v218, v10
  v_sub_f32 v219, v219, v10
  v_sub_f32 v220, v220, v10
  v_sub_f32 v221, v221, v10
  v_sub_f32 v222, v222, v10
  v_sub_f32 v223, v223, v10
  v_sub_f32 v224, v224, v10
  v_sub_f32 v225, v225, v10
  v_sub_f32 v226, v226, v10
  v_sub_f32 v227, v227, v10
  v_sub_f32 v228, v228, v10
  v_sub_f32 v229, v229, v10
  v_sub_f32 v230, v230, v10
  v_sub_f32 v231, v231, v10
  v_sub_f32 v128, v128, v10
  v_sub_f32 v129, v129, v10
  v_sub_f32 v130, v130, v10
  v_sub_f32 v131, v131, v10
  v_sub_f32 v132, v132, v10
  v_sub_f32 v133, v133, v10
  v_sub_f32 v134, v134, v10
  v_sub_f32 v135, v135, v10
  v_sub_f32 v136, v136, v10
  v_sub_f32 v137, v137, v10
  v_sub_f32 v138, v138, v10
  v_sub_f32 v139, v139, v10
  v_sub_f32 v140, v140, v10
  v_sub_f32 v141, v141, v10
  v_sub_f32 v142, v142, v10
  v_sub_f32 v143, v143, v10
  s_branch attn_it8_nors
attn_it9_rs:
  v_max3_f32 v10, v128, v129, v130
  v_max3_f32 v11, v131, v132, v133
  v_max3_f32 v10, v10, v134, v135
  v_max3_f32 v11, v11, v136, v137
  v_max3_f32 v10, v10, v138, v139
  v_max3_f32 v11, v11, v140, v141
  v_max3_f32 v10, v10, v142, v143
  v_max_f32 v10, v10, v11
  v_mov_b32 v11, v10
  s_nop 1
  v_permlane32_swap_b32 v10, v11
  s_nop 0
  v_max3_f32 v10, v10, v11, s35
  v_exp_f32 v11, -v10
  v_add_f32 v8, v8, v10
  v_min_f32 v11, 0x7149f2ca, v11
  s_mov_b32 s34, 0x53800000
  s_mov_b32 s35, 0
  v_mul_f32 v9, v9, v11
  v_mul_f32 v48, v48, v11
  v_mul_f32 v49, v49, v11
  v_mul_f32 v50, v50, v11
  v_mul_f32 v51, v51, v11
  v_mul_f32 v52, v52, v11
  v_mul_f32 v53, v53, v11
  v_mul_f32 v54, v54, v11
  v_mul_f32 v55, v55, v11
  v_mul_f32 v56, v56, v11
  v_mul_f32 v57, v57, v11
  v_mul_f32 v58, v58, v11
  v_mul_f32 v59, v59, v11
  v_mul_f32 v60, v60, v11
  v_mul_f32 v61, v61, v11
  v_mul_f32 v62, v62, v11
  v_mul_f32 v63, v63, v11
  v_mul_f32 v64, v64, v11
  v_mul_f32 v65, v65, v11
  v_mul_f32 v66, v66, v11
  v_mul_f32 v67, v67, v11
  v_mul_f32 v68, v68, v11
  v_mul_f32 v69, v69, v11
  v_mul_f32 v70, v70, v11
  v_mul_f32 v71, v71, v11
  v_mul_f32 v72, v72, v11
  v_mul_f32 v73, v73, v11
  v_mul_f32 v74, v74, v11
  v_mul_f32 v75, v75, v11
  v_mul_f32 v76, v76, v11
  v_mul_f32 v77, v77, v11
  v_mul_f32 v78, v78, v11
  v_mul_f32 v79, v79, v11
  v_mul_f32 v80, v80, v11
  v_mul_f32 v81, v81, v11
  v_mul_f32 v82, v82, v11
  v_mul_f32 v83, v83, v11
  v_mul_f32 v84, v84, v11
  v_mul_f32 v85, v85, v11
  v_mul_f32 v86, v86, v11
  v_mul_f32 v87, v87, v11
  v_mul_f32 v88, v88, v11
  v_mul_f32 v89, v89, v11
  v_mul_f32 v90, v90, v11
  v_mul_f32 v91, v91, v11
  v_mul_f32 v92, v92, v11
  v_mul_f32 v93, v93, v11
  v_mul_f32 v94, v94, v11
  v_mul_f32 v95, v95, v11
  v_mul_f32 v96, v96, v11
  v_mul_f32 v97, v97, v11
  v_mul_f32 v98, v98, v11
  v_mul_f32 v99, v99, v11
  v_mul_f32 v100, v100, v11
  v_mul_f32 v101, v101, v11
  v_mul_f32 v102, v102, v11
  v_mul_f32 v103, v103, v11
  v_mul_f32 v104, v104, v11
  v_mul_f32 v105, v105, v11
  v_mul_f32 v106, v106, v11
  v_mul_f32 v107, v107, v11
  v_mul_f32 v108, v108, v11
  v_mul_f32 v109, v109, v11
  v_mul_f32 v110, v110, v11
  v_mul_f32 v111, v111, v11
  v_sub_f32 v128, v128, v10
  v_sub_f32 v129, v129, v10
  v_sub_f32 v130, v130, v10
  v_sub_f32 v131, v131, v10
  v_sub_f32 v132, v132, v10
  v_sub_f32 v133, v133, v10
  v_sub_f32 v134, v134, v10
  v_sub_f32 v135, v135, v10
  v_sub_f32 v136, v136, v10
  v_sub_f32 v137, v137, v10
  v_sub_f32 v138, v138, v10
  v_sub_f32 v139, v139, v10
  v_sub_f32 v140, v140, v10
  v_sub_f32 v141, v141, v10
  v_sub_f32 v142, v142, v10
  v_sub_f32 v143, v143, v10
  v_exp_f32 v232, v128
  v_exp_f32 v233, v129
  v_exp_f32 v234, v130
  v_exp_f32 v235, v131
  v_cvt_pk_bf16_f32 v144, v232, v233
  v_add_f32 v13, v232, v233
  v_exp_f32 v236, v132
  v_exp_f32 v237, v133
  v_cvt_pk_bf16_f32 v145, v234, v235
  v_add_f32 v14, v234, v235
  v_exp_f32 v238, v134
  v_exp_f32 v239, v135
  v_cvt_pk_bf16_f32 v146, v236, v237
  v_add_f32 v13, v13, v236
  v_add_f32 v14, v14, v237
  v_exp_f32 v240, v136
  v_exp_f32 v241, v137
  v_cvt_pk_bf16_f32 v147, v238, v239
  v_add_f32 v13, v13, v238
  v_add_f32 v14, v14, v239
  v_exp_f32 v242, v138
  v_exp_f32 v243, v139
  v_cvt_pk_bf16_f32 v148, v240, v241
  v_add_f32 v13, v13, v240
  v_add_f32 v14, v14, v241
  v_exp_f32 v244, v140
  v_exp_f32 v245, v141
  v_cvt_pk_bf16_f32 v149, v242, v243
  v_add_f32 v13, v13, v242
  v_add_f32 v14, v14, v243
  v_exp_f32 v246, v142
  v_exp_f32 v247, v143
  v_cvt_pk_bf16_f32 v150, v244, v245
  v_add_f32 v13, v13, v244
  v_add_f32 v14, v14, v245
  v_add_f32 v13, v13, v14
  v_cvt_pk_bf16_f32 v151, v246, v247
  v_add_f32 v14, v246, v247
  v_add_f32 v13, v13, v14
  v_sub_f32 v216, v216, v10
  v_sub_f32 v217, v217, v10
  v_sub_f32 v218, v218, v10
  v_sub_f32 v219, v219, v10
  v_sub_f32 v220, v220, v10
  v_sub_f32 v221, v221, v10
  v_sub_f32 v222, v222, v10
  v_sub_f32 v223, v223, v10
  v_sub_f32 v224, v224, v10
  v_sub_f32 v225, v225, v10
  v_sub_f32 v226, v226, v10
  v_sub_f32 v227, v227, v10
  v_sub_f32 v228, v228, v10
  v_sub_f32 v229, v229, v10
  v_sub_f32 v230, v230, v10
  v_sub_f32 v231, v231, v10
  s_branch attn_it9_nors
attn_after:
  s_waitcnt vmcnt(4) lgkmcnt(0)
  s_barrier
ogemm_kernel:
  s_load_dwordx2 s[8:9], s[0:1], 104
  s_load_dwordx2 s[24:25], s[0:1], 40
  s_load_dwordx2 s[26:27], s[0:1], 72
  v_lshrrev_b32 v1, 6, v0
  s_nop 0
  v_readfirstlane_b32 s6, v1
  v_and_b32 v1, 63, v0
  s_lshr_b32 s3, s2, 4
  s_and_b32 s4, s2, 1
  s_lshl_b32 s4, s4, 1
  s_bfe_u32 s5, s2, 0x10003
  s_or_b32 s4, s4, s5
  s_bfe_u32 s5, s2, 0x20001
  s_and_b32 s3, s2, 1
  s_lshl_b32 s3, s3, 3
  s_bfe_u32 s4, s2, 0x30003
  s_or_b32 s3, s3, s4
  s_lshr_b32 s4, s2, 6
  s_mov_b32 s10, 0x10000000
  s_mov_b32 s11, 0x20000
  s_mov_b32 s15, 0x20000
  s_lshr_b32 s30, s6, 2
  s_lshr_b32 s31, s6, 1
  s_and_b32 s31, s31, 1
  s_and_b32 s32, s6, 1
  v_lshlrev_b32 v11, 4, v1
  s_lshl_b32 s33, s31, 13
  s_lshl_b32 s34, s30, 12
  s_add_u32 s33, s33, s34
  v_add_u32 v2, s33, v11
  v_add_u32 v3, 0x10000, v2
  v_bfe_u32 v12, v1, 2, 2
  v_lshrrev_b32 v13, 5, v1
  v_lshl_add_u32 v13, v13, 2, v12
  v_lshlrev_b32 v13, 8, v13
  v_bfe_u32 v14, v1, 4, 1
  v_lshl_add_u32 v13, v14, 5, v13
  v_and_b32 v14, 3, v1
  v_lshl_add_u32 v13, v14, 3, v13
  s_movk_i32 s33, 0x4000
  v_add_u32 v13, s33, v13
  v_lshlrev_b32 v12, 6, v12
  s_lshl_b32 s34, s32, 7
  s_add_u32 s35, s34, 0
  v_xor_b32 v14, s35, v12
  v_add_u32 v4, v13, v14
  v_add_u32 v6, 0x10000, v4
  s_add_u32 s35, s34, 64
  v_xor_b32 v14, s35, v12
  v_add_u32 v5, v13, v14
  v_add_u32 v7, 0x10000, v5
  s_lshr_b32 s33, s6, 1
  s_lshl_b32 s34, s3, 2
  s_add_u32 s34, s34, s33
  s_mul_i32 s34, s34, 376832
  s_lshl_b32 s35, s32, 11
  s_add_u32 s34, s34, s35
  s_add_u32 s34, s34, 0x3100000
  v_add_u32 v8, s34, v11
  s_lshl_b32 s36, s6, 11
  v_lshrrev_b32 v12, 4, v1
  v_bfe_u32 v13, v1, 2, 2
  v_xor_b32 v13, v13, v12
  v_lshlrev_b32 v13, 6, v13
  v_and_b32 v14, 3, v1
  v_lshl_add_u32 v13, v14, 4, v13
  s_lshl_b32 s33, s6, 3
  v_add_u32 v12, s33, v12
  v_lshlrev_b32 v12, 10, v12
  v_add_u32 v12, v12, v13
  s_lshl_b32 s33, s4, 8
  v_add_u32 v9, s33, v12
  v_add_u32 v10, 3072, v9
  s_mov_b32 s42, 0x1c0000
  s_mul_i32 s37, s5, 7
  s_add_u32 s37, s37, 64
  s_lshl_b32 s44, s5, 4
  s_mov_b32 s43, 0
  s_waitcnt lgkmcnt(0)
  s_cmp_lt_u32 s37, 64
  s_cselect_b32 s12, s24, s26
  s_cselect_b32 s13, s25, s27
  s_cselect_b32 s14, 0x400000, s42
  s_cselect_b32 s39, 0, 64
  s_sub_u32 s39, s37, s39
  s_lshl_b32 s39, s39, 16
  s_lshl_b32 s40, s37, 12
  s_cmp_lt_u32 s43, 23
  s_cselect_b32 s14, s14, 0
  s_cselect_b32 s40, s40, 0x10000000
  s_add_u32 s37, s37, 1
  s_add_u32 s43, s43, 1
  s_cmp_eq_u32 s43, 7
  s_cselect_b32 s37, s44, s37
  s_add_u32 m0, s36, 0
  s_nop 0
  buffer_load_dwordx4 v8, s[8:11], s40 offen offset:0 lds
  buffer_load_dwordx4 v8, s[8:11], s40 offen offset:1024 lds
  s_add_u32 m0, s36, 16384
  s_nop 0
  buffer_load_dwordx4 v9, s[12:15], s39 offen offset:0 lds
  buffer_load_dwordx4 v10, s[12:15], s39 offen offset:1024 lds
  s_cmp_lt_u32 s37, 64
  s_cselect_b32 s12, s24, s26
  s_cselect_b32 s13, s25, s27
  s_cselect_b32 s14, 0x400000, s42
  s_cselect_b32 s39, 0, 64
  s_sub_u32 s39, s37, s39
  s_lshl_b32 s39, s39, 16
  s_lshl_b32 s40, s37, 12
  s_cmp_lt_u32 s43, 23
  s_cselect_b32 s14, s14, 0
  s_cselect_b32 s40, s40, 0x10000000
  s_add_u32 s37, s37, 1
  s_add_u32 s43, s43, 1
  s_cmp_eq_u32 s43, 7
  s_cselect_b32 s37, s44, s37
  s_add_u32 m0, s36, 32768
  s_nop 0
  buffer_load_dwordx4 v8, s[8:11], s40 offen offset:0 lds
  buffer_load_dwordx4 v8, s[8:11], s40 offen offset:1024 lds
  s_add_u32 m0, s36, 49152
  s_nop 0
  buffer_load_dwordx4 v9, s[12:15], s39 offen offset:0 lds
  buffer_load_dwordx4 v10, s[12:15], s39 offen offset:1024 lds
  s_cmp_lt_u32 s37, 64
  s_cselect_b32 s12, s24, s26
  s_cselect_b32 s13, s25, s27
  s_cselect_b32 s14, 0x400000, s42
  s_cselect_b32 s39, 0, 64
  s_sub_u32 s39, s37, s39
  s_lshl_b32 s39, s39, 16
  s_lshl_b32 s40, s37, 12
  s_cmp_lt_u32 s43, 23
  s_cselect_b32 s14, s14, 0
  s_cselect_b32 s40, s40, 0x10000000
  s_add_u32 s37, s37, 1
  s_add_u32 s43, s43, 1
  s_cmp_eq_u32 s43, 7
  s_cselect_b32 s37, s44, s37
  s_add_u32 m0, s36, 65536
  s_nop 0
  buffer_load_dwordx4 v8, s[8:11], s40 offen offset:0 lds
  buffer_load_dwordx4 v8, s[8:11], s40 offen offset:1024 lds
  s_add_u32 m0, s36, 81920
  s_nop 0
  buffer_load_dwordx4 v9, s[12:15], s39 offen offset:0 lds
  buffer_load_dwordx4 v10, s[12:15], s39 offen offset:1024 lds
  v_mov_b32 v64, 0
  v_mov_b32 v65, 0
  v_mov_b32 v66, 0
  v_mov_b32 v67, 0
  v_mov_b32 v68, 0
  v_mov_b32 v69, 0
  v_mov_b32 v70, 0
  v_mov_b32 v71, 0
  v_mov_b32 v72, 0
  v_mov_b32 v73, 0
  v_mov_b32 v74, 0
  v_mov_b32 v75, 0
  v_mov_b32 v76, 0
  v_mov_b32 v77, 0
  v_mov_b32 v78, 0
  v_mov_b32 v79, 0
  v_mov_b32 v80, 0
  v_mov_b32 v81, 0
  v_mov_b32 v82, 0
  v_mov_b32 v83, 0
  v_mov_b32 v84, 0
  v_mov_b32 v85, 0
  v_mov_b32 v86, 0
  v_mov_b32 v87, 0
  v_mov_b32 v88, 0
  v_mov_b32 v89, 0
  v_mov_b32 v90, 0
  v_mov_b32 v91, 0
  v_mov_b32 v92, 0
  v_mov_b32 v93, 0
  v_mov_b32 v94, 0
  v_mov_b32 v95, 0
  s_lshl_b32 s49, s3, 2
  s_add_u32 s49, s49, s4
  s_lshl_b32 s45, s49, 4
  s_lshl_b32 s46, s5, 2
  s_add_u32 s45, s45, s46
  s_load_dwordx2 s[52:53], s[0:1], 0
  s_load_dwordx2 s[56:57], s[0:1], 80
  s_load_dwordx2 s[60:61], s[0:1], 88
  s_mov_b32 s54, 0x200000
  s_mov_b32 s55, 0x20000
  s_mov_b32 s58, 1024
  s_mov_b32 s59, 0x20000
  s_mov_b32 s62, 0x200000
  s_mov_b32 s63, 0x20000
  s_lshr_b32 s23, s6, 2
  v_and_b32 v246, 255, v0
  s_add_u32 s50, s45, s23
  v_lshlrev_b32 v177, 4, v246
  s_lshr_b32 s51, s6, 1
  s_add_u32 s51, s51, s45
  s_lshr_b32 s64, s51, 4
  s_lshr_b32 s65, s51, 2
  s_and_b32 s65, s65, 3
  s_and_b32 s66, s51, 3
  s_lshr_b32 s16, s64, 2
  s_and_b32 s17, s64, 3
  s_lshr_b32 s18, s65, 1
  s_and_b32 s19, s65, 1
  s_lshr_b32 s28, s66, 1
  s_and_b32 s29, s66, 1
  s_lshl_b32 s20, s16, 2
  s_lshl_b32 s21, s18, 1
  s_add_u32 s20, s20, s21
  s_add_u32 s20, s20, s28
  s_lshl_b32 s20, s20, 15
  s_lshl_b32 s21, s17, 2
  s_lshl_b32 s22, s19, 1
  s_add_u32 s21, s21, s22
  s_add_u32 s21, s21, s29
  s_lshl_b32 s21, s21, 6
  v_and_b32 v178, 31, v246
  v_lshlrev_b32 v178, 10, v178
  s_and_b32 s22, s6, 1
  s_lshl_b32 s22, s22, 5
  s_add_u32 s22, s22, 0
  v_mov_b32 v207, s22
  v_bfe_u32 v196, v246, 5, 1
  v_lshl_add_u32 v207, v196, 3, v207
  v_add_u32 v207, s21, v207
  v_add_u32 v178, v178, v207
  v_add_u32 v206, s20, v178
  s_lshr_b32 s51, s6, 1
  s_add_u32 s51, s51, s45
  s_lshr_b32 s64, s51, 4
  s_lshr_b32 s65, s51, 2
  s_and_b32 s65, s65, 3
  s_and_b32 s66, s51, 3
  s_lshr_b32 s16, s64, 2
  s_and_b32 s17, s64, 3
  s_lshr_b32 s18, s65, 1
  s_and_b32 s19, s65, 1
  s_lshr_b32 s28, s66, 1
  s_and_b32 s29, s66, 1
  s_lshl_b32 s20, s16, 2
  s_lshl_b32 s21, s18, 1
  s_add_u32 s20, s20, s21
  s_add_u32 s20, s20, s28
  s_lshl_b32 s20, s20, 15
  s_lshl_b32 s21, s17, 2
  s_lshl_b32 s22, s19, 1
  s_add_u32 s21, s21, s22
  s_add_u32 s21, s21, s29
  s_lshl_b32 s21, s21, 6
  v_and_b32 v178, 31, v246
  v_lshlrev_b32 v178, 10, v178
  s_and_b32 s22, s6, 1
  s_lshl_b32 s22, s22, 5
  s_add_u32 s22, s22, 16
  v_mov_b32 v239, s22
  v_bfe_u32 v228, v246, 5, 1
  v_lshl_add_u32 v239, v228, 3, v239
  v_add_u32 v239, s21, v239
  v_add_u32 v178, v178, v239
  v_add_u32 v238, s20, v178
  s_waitcnt lgkmcnt(0)
  s_waitcnt vmcnt(12)
  s_barrier
  s_cmp_lg_u32 s6, 0
  s_cbranch_scc1 ogemm_nosig
  s_load_dwordx2 s[80:81], s[0:1], 96
  s_load_dwordx2 s[84:85], s[0:1], 104
  s_mov_b32 s82, 256
  s_mov_b32 s83, 0x20000
  s_mov_b32 s86, 0x10000000
  s_mov_b32 s87, 0x20000
  s_mov_b64 exec, 1
  v_mov_b32 v12, 1
  v_mov_b32 v13, 4
  v_mov_b32 v14, 1
  v_mov_b32 v15, 0
  s_and_b32 s88, s2, 15
  s_lshl_b32 s88, s88, 12
  s_add_u32 s88, s88, 0x6400000
  s_waitcnt lgkmcnt(0)
  buffer_atomic_add v14, v15, s[84:87], s88 offen sc0 sc1
  s_mov_b64 exec, -1
ogemm_nosig:
  s_mov_b32 s41, 0
  s_waitcnt vmcnt(8)
  s_barrier
  ds_read_b128 v[16:19], v2 offset:0
  ds_read_b64_tr_b16 v[20:21], v4 offset:0
  ds_read_b64_tr_b16 v[22:23], v4 offset:2048
  ds_read_b64_tr_b16 v[24:25], v5 offset:0
  ds_read_b64_tr_b16 v[26:27], v5 offset:2048
  ds_read_b128 v[28:31], v2 offset:1024
  ds_read_b64_tr_b16 v[32:33], v4 offset:4096
  ds_read_b64_tr_b16 v[34:35], v4 offset:6144
  ds_read_b64_tr_b16 v[36:37], v5 offset:4096
  ds_read_b64_tr_b16 v[38:39], v5 offset:6144
  s_waitcnt vmcnt(4)
  s_barrier
  s_waitcnt lgkmcnt(7)
  v_mfma_f32_32x32x16_bf16 v[64:79], v[20:23], v[16:19], v[64:79]
  ds_read_b128 v[40:43], v2 offset:2048
  ds_read_b64_tr_b16 v[44:45], v4 offset:8192
  ds_read_b64_tr_b16 v[46:47], v4 offset:10240
  s_cmp_lt_u32 s37, 64
  s_cselect_b32 s12, s24, s26
  s_cselect_b32 s13, s25, s27
  s_cselect_b32 s14, 0x400000, s42
  s_cselect_b32 s39, 0, 64
  s_sub_u32 s39, s37, s39
  s_lshl_b32 s39, s39, 16
  s_lshl_b32 s40, s37, 12
  s_cmp_lt_u32 s43, 23
  s_cselect_b32 s14, s14, 0
  s_cselect_b32 s40, s40, 0x10000000
  s_add_u32 s37, s37, 1
  s_add_u32 s43, s43, 1
  s_cmp_eq_u32 s43, 7
  s_cselect_b32 s37, s44, s37
  s_add_u32 m0, s36, 98304
  s_nop 0
  buffer_load_dwordx4 v8, s[8:11], s40 offen offset:0 lds
  s_waitcnt lgkmcnt(8)
  v_mfma_f32_32x32x16_bf16 v[80:95], v[24:27], v[16:19], v[80:95]
  ds_read_b64_tr_b16 v[48:49], v5 offset:8192
  ds_read_b64_tr_b16 v[50:51], v5 offset:10240
  s_waitcnt lgkmcnt(7)
  v_mfma_f32_32x32x16_bf16 v[64:79], v[32:35], v[28:31], v[64:79]
  ds_read_b128 v[52:55], v2 offset:3072
  ds_read_b64_tr_b16 v[56:57], v4 offset:12288
  ds_read_b64_tr_b16 v[58:59], v4 offset:14336
  buffer_load_dwordx4 v8, s[8:11], s40 offen offset:1024 lds
  s_waitcnt lgkmcnt(8)
  v_mfma_f32_32x32x16_bf16 v[80:95], v[36:39], v[28:31], v[80:95]
  ds_read_b64_tr_b16 v[60:61], v5 offset:12288
  ds_read_b64_tr_b16 v[62:63], v5 offset:14336
  s_waitcnt lgkmcnt(7)
  v_mfma_f32_32x32x16_bf16 v[64:79], v[44:47], v[40:43], v[64:79]
  ds_read_b128 v[16:19], v2 offset:32768
  ds_read_b64_tr_b16 v[20:21], v4 offset:32768
  ds_read_b64_tr_b16 v[22:23], v4 offset:34816
  s_add_u32 m0, s36, 114688
  s_nop 0
  buffer_load_dwordx4 v9, s[12:15], s39 offen offset:0 lds
  s_waitcnt lgkmcnt(8)
  v_mfma_f32_32x32x16_bf16 v[80:95], v[48:51], v[40:43], v[80:95]
  ds_read_b64_tr_b16 v[24:25], v5 offset:32768
  ds_read_b64_tr_b16 v[26:27], v5 offset:34816
  s_waitcnt lgkmcnt(7)
  v_mfma_f32_32x32x16_bf16 v[64:79], v[56:59], v[52:55], v[64:79]
  ds_read_b128 v[28:31], v2 offset:33792
  ds_read_b64_tr_b16 v[32:33], v4 offset:36864
  ds_read_b64_tr_b16 v[34:35], v4 offset:38912
  buffer_load_dwordx4 v10, s[12:15], s39 offen offset:1024 lds
  s_waitcnt lgkmcnt(8)
  v_mfma_f32_32x32x16_bf16 v[80:95], v[60:63], v[52:55], v[80:95]
  ds_read_b64_tr_b16 v[36:37], v5 offset:36864
  ds_read_b64_tr_b16 v[38:39], v5 offset:38912
  s_add_u32 s41, s41, 1
  s_waitcnt vmcnt(4)
  s_barrier
  s_waitcnt lgkmcnt(7)
  v_mfma_f32_32x32x16_bf16 v[64:79], v[20:23], v[16:19], v[64:79]
  ds_read_b128 v[40:43], v2 offset:34816
  ds_read_b64_tr_b16 v[44:45], v4 offset:40960
  ds_read_b64_tr_b16 v[46:47], v4 offset:43008
  s_waitcnt lgkmcnt(8)
  v_mfma_f32_32x32x16_bf16 v[80:95], v[24:27], v[16:19], v[80:95]
  ds_read_b64_tr_b16 v[48:49], v5 offset:40960
  ds_read_b64_tr_b16 v[50:51], v5 offset:43008
  s_waitcnt lgkmcnt(7)
  v_mfma_f32_32x32x16_bf16 v[64:79], v[32:35], v[28:31], v[64:79]
  ds_read_b128 v[52:55], v2 offset:35840
  ds_read_b64_tr_b16 v[56:57], v4 offset:45056
  ds_read_b64_tr_b16 v[58:59], v4 offset:47104
  s_waitcnt lgkmcnt(8)
  v_mfma_f32_32x32x16_bf16 v[80:95], v[36:39], v[28:31], v[80:95]
  ds_read_b64_tr_b16 v[60:61], v5 offset:45056
  ds_read_b64_tr_b16 v[62:63], v5 offset:47104
  s_cmp_lg_u32 s6, 0
  s_cbranch_scc1 ogemm_nosig2
  v_readfirstlane_b32 s89, v14
  s_cmp_lg_u32 s89, 15
  s_cbranch_scc1 gs_nr1
  s_mov_b64 exec, 1
  buffer_atomic_add v12, v13, s[80:83], 0 offen sc1
gs_nr1:
  s_mov_b64 exec, -1
ogemm_nosig2:
  s_waitcnt lgkmcnt(7)
  v_mfma_f32_32x32x16_bf16 v[64:79], v[44:47], v[40:43], v[64:79]
  ds_read_b128 v[16:19], v3 offset:0
  ds_read_b64_tr_b16 v[20:21], v6 offset:0
  ds_read_b64_tr_b16 v[22:23], v6 offset:2048
  s_cmp_lt_u32 s37, 64
  s_cselect_b32 s12, s24, s26
  s_cselect_b32 s13, s25, s27
  s_cselect_b32 s14, 0x400000, s42
  s_cselect_b32 s39, 0, 64
  s_sub_u32 s39, s37, s39
  s_lshl_b32 s39, s39, 16
  s_lshl_b32 s40, s37, 12
  s_cmp_lt_u32 s43, 23
  s_cselect_b32 s14, s14, 0
  s_cselect_b32 s40, s40, 0x10000000
  s_add_u32 s37, s37, 1
  s_add_u32 s43, s43, 1
  s_cmp_eq_u32 s43, 7
  s_cselect_b32 s37, s44, s37
  s_add_u32 m0, s36, 0
  s_nop 0
  buffer_load_dwordx4 v8, s[8:11], s40 offen offset:0 lds
  s_waitcnt lgkmcnt(8)
  v_mfma_f32_32x32x16_bf16 v[80:95], v[48:51], v[40:43], v[80:95]
  ds_read_b64_tr_b16 v[24:25], v7 offset:0
  ds_read_b64_tr_b16 v[26:27], v7 offset:2048
  buffer_load_dwordx4 v8, s[8:11], s40 offen offset:1024 lds
  s_waitcnt lgkmcnt(7)
  v_mfma_f32_32x32x16_bf16 v[64:79], v[56:59], v[52:55], v[64:79]
  ds_read_b128 v[28:31], v3 offset:1024
  ds_read_b64_tr_b16 v[32:33], v6 offset:4096
  ds_read_b64_tr_b16 v[34:35], v6 offset:6144
  s_add_u32 m0, s36, 16384
  s_nop 0
  buffer_load_dwordx4 v9, s[12:15], s39 offen offset:0 lds
  s_waitcnt lgkmcnt(8)
  v_mfma_f32_32x32x16_bf16 v[80:95], v[60:63], v[52:55], v[80:95]
  ds_read_b64_tr_b16 v[36:37], v7 offset:4096
  ds_read_b64_tr_b16 v[38:39], v7 offset:6144
  buffer_load_dwordx4 v10, s[12:15], s39 offen offset:1024 lds
  s_add_u32 s41, s41, 1
  s_waitcnt vmcnt(4)
  s_barrier
  s_waitcnt lgkmcnt(7)
  v_mfma_f32_32x32x16_bf16 v[64:79], v[20:23], v[16:19], v[64:79]
  ds_read_b128 v[40:43], v3 offset:2048
  ds_read_b64_tr_b16 v[44:45], v6 offset:8192
  ds_read_b64_tr_b16 v[46:47], v6 offset:10240
  s_cmp_lt_u32 s37, 64
  s_cselect_b32 s12, s24, s26
  s_cselect_b32 s13, s25, s27
  s_cselect_b32 s14, 0x400000, s42
  s_cselect_b32 s39, 0, 64
  s_sub_u32 s39, s37, s39
  s_lshl_b32 s39, s39, 16
  s_lshl_b32 s40, s37, 12
  s_cmp_lt_u32 s43, 23
  s_cselect_b32 s14, s14, 0
  s_cselect_b32 s40, s40, 0x10000000
  s_add_u32 s37, s37, 1
  s_add_u32 s43, s43, 1
  s_cmp_eq_u32 s43, 7
  s_cselect_b32 s37, s44, s37
  s_add_u32 m0, s36, 32768
  s_nop 0
  buffer_load_dwordx4 v8, s[8:11], s40 offen offset:0 lds
  s_waitcnt lgkmcnt(8)
  v_mfma_f32_32x32x16_bf16 v[80:95], v[24:27], v[16:19], v[80:95]
  ds_read_b64_tr_b16 v[48:49], v7 offset:8192
  ds_read_b64_tr_b16 v[50:51], v7 offset:10240
  s_waitcnt lgkmcnt(7)
  v_mfma_f32_32x32x16_bf16 v[64:79], v[32:35], v[28:31], v[64:79]
  ds_read_b128 v[52:55], v3 offset:3072
  ds_read_b64_tr_b16 v[56:57], v6 offset:12288
  ds_read_b64_tr_b16 v[58:59], v6 offset:14336
  buffer_load_dwordx4 v8, s[8:11], s40 offen offset:1024 lds
  s_waitcnt lgkmcnt(8)
  v_mfma_f32_32x32x16_bf16 v[80:95], v[36:39], v[28:31], v[80:95]
  ds_read_b64_tr_b16 v[60:61], v7 offset:12288
  ds_read_b64_tr_b16 v[62:63], v7 offset:14336
  s_waitcnt lgkmcnt(7)
  v_mfma_f32_32x32x16_bf16 v[64:79], v[44:47], v[40:43], v[64:79]
  ds_read_b128 v[16:19], v3 offset:32768
  ds_read_b64_tr_b16 v[20:21], v6 offset:32768
  ds_read_b64_tr_b16 v[22:23], v6 offset:34816
  s_add_u32 m0, s36, 49152
  s_nop 0
  buffer_load_dwordx4 v9, s[12:15], s39 offen offset:0 lds
  s_waitcnt lgkmcnt(8)
  v_mfma_f32_32x32x16_bf16 v[80:95], v[48:51], v[40:43], v[80:95]
  ds_read_b64_tr_b16 v[24:25], v7 offset:32768
  ds_read_b64_tr_b16 v[26:27], v7 offset:34816
  s_waitcnt lgkmcnt(7)
  v_mfma_f32_32x32x16_bf16 v[64:79], v[56:59], v[52:55], v[64:79]
  ds_read_b128 v[28:31], v3 offset:33792
  ds_read_b64_tr_b16 v[32:33], v6 offset:36864
  ds_read_b64_tr_b16 v[34:35], v6 offset:38912
  buffer_load_dwordx4 v10, s[12:15], s39 offen offset:1024 lds
  s_waitcnt lgkmcnt(8)
  v_mfma_f32_32x32x16_bf16 v[80:95], v[60:63], v[52:55], v[80:95]
  ds_read_b64_tr_b16 v[36:37], v7 offset:36864
  ds_read_b64_tr_b16 v[38:39], v7 offset:38912
  s_add_u32 s41, s41, 1
  s_waitcnt vmcnt(4)
  s_barrier
  s_waitcnt lgkmcnt(7)
  v_mfma_f32_32x32x16_bf16 v[64:79], v[20:23], v[16:19], v[64:79]
  ds_read_b128 v[40:43], v3 offset:34816
  ds_read_b64_tr_b16 v[44:45], v6 offset:40960
  ds_read_b64_tr_b16 v[46:47], v6 offset:43008
  s_cmp_lt_u32 s37, 64
  s_cselect_b32 s12, s24, s26
  s_cselect_b32 s13, s25, s27
  s_cselect_b32 s14, 0x400000, s42
  s_cselect_b32 s39, 0, 64
  s_sub_u32 s39, s37, s39
  s_lshl_b32 s39, s39, 16
  s_lshl_b32 s40, s37, 12
  s_cmp_lt_u32 s43, 23
  s_cselect_b32 s14, s14, 0
  s_cselect_b32 s40, s40, 0x10000000
  s_add_u32 s37, s37, 1
  s_add_u32 s43, s43, 1
  s_cmp_eq_u32 s43, 7
  s_cselect_b32 s37, s44, s37
  s_add_u32 m0, s36, 65536
  s_nop 0
  buffer_load_dwordx4 v8, s[8:11], s40 offen offset:0 lds
  s_waitcnt lgkmcnt(8)
  v_mfma_f32_32x32x16_bf16 v[80:95], v[24:27], v[16:19], v[80:95]
  ds_read_b64_tr_b16 v[48:49], v7 offset:40960
  ds_read_b64_tr_b16 v[50:51], v7 offset:43008
  s_waitcnt lgkmcnt(7)
  v_mfma_f32_32x32x16_bf16 v[64:79], v[32:35], v[28:31], v[64:79]
  ds_read_b128 v[52:55], v3 offset:35840
  ds_read_b64_tr_b16 v[56:57], v6 offset:45056
  ds_read_b64_tr_b16 v[58:59], v6 offset:47104
  buffer_load_dwordx4 v8, s[8:11], s40 offen offset:1024 lds
  s_waitcnt lgkmcnt(8)
  v_mfma_f32_32x32x16_bf16 v[80:95], v[36:39], v[28:31], v[80:95]
  ds_read_b64_tr_b16 v[60:61], v7 offset:45056
  ds_read_b64_tr_b16 v[62:63], v7 offset:47104
  s_waitcnt lgkmcnt(7)
  v_mfma_f32_32x32x16_bf16 v[64:79], v[44:47], v[40:43], v[64:79]
  ds_read_b128 v[16:19], v2 offset:0
  ds_read_b64_tr_b16 v[20:21], v4 offset:0
  ds_read_b64_tr_b16 v[22:23], v4 offset:2048
  s_add_u32 m0, s36, 81920
  s_nop 0
  buffer_load_dwordx4 v9, s[12:15], s39 offen offset:0 lds
  s_waitcnt lgkmcnt(8)
  v_mfma_f32_32x32x16_bf16 v[80:95], v[48:51], v[40:43], v[80:95]
  ds_read_b64_tr_b16 v[24:25], v5 offset:0
  ds_read_b64_tr_b16 v[26:27], v5 offset:2048
  s_waitcnt lgkmcnt(7)
  v_mfma_f32_32x32x16_bf16 v[64:79], v[56:59], v[52:55], v[64:79]
  ds_read_b128 v[28:31], v2 offset:1024
  ds_read_b64_tr_b16 v[32:33], v4 offset:4096
  ds_read_b64_tr_b16 v[34:35], v4 offset:6144
  buffer_load_dwordx4 v10, s[12:15], s39 offen offset:1024 lds
  s_waitcnt lgkmcnt(8)
  v_mfma_f32_32x32x16_bf16 v[80:95], v[60:63], v[52:55], v[80:95]
  ds_read_b64_tr_b16 v[36:37], v5 offset:4096
  ds_read_b64_tr_b16 v[38:39], v5 offset:6144
  s_add_u32 s41, s41, 1
  s_waitcnt vmcnt(4)
  s_barrier
  s_waitcnt lgkmcnt(7)
  v_mfma_f32_32x32x16_bf16 v[64:79], v[20:23], v[16:19], v[64:79]
  ds_read_b128 v[40:43], v2 offset:2048
  ds_read_b64_tr_b16 v[44:45], v4 offset:8192
  ds_read_b64_tr_b16 v[46:47], v4 offset:10240
  s_waitcnt lgkmcnt(8)
  v_mfma_f32_32x32x16_bf16 v[80:95], v[24:27], v[16:19], v[80:95]
  ds_read_b64_tr_b16 v[48:49], v5 offset:8192
  ds_read_b64_tr_b16 v[50:51], v5 offset:10240
  s_waitcnt lgkmcnt(7)
  v_mfma_f32_32x32x16_bf16 v[64:79], v[32:35], v[28:31], v[64:79]
  ds_read_b128 v[52:55], v2 offset:3072
  ds_read_b64_tr_b16 v[56:57], v4 offset:12288
  ds_read_b64_tr_b16 v[58:59], v4 offset:14336
  s_waitcnt lgkmcnt(8)
  v_mfma_f32_32x32x16_bf16 v[80:95], v[36:39], v[28:31], v[80:95]
  ds_read_b64_tr_b16 v[60:61], v5 offset:12288
  ds_read_b64_tr_b16 v[62:63], v5 offset:14336
  buffer_load_dwordx2 v[196:197], v206, s[52:55], 0 offen
  buffer_load_dwordx2 v[198:199], v207, s[56:59], 0 offen
  buffer_load_dwordx2 v[228:229], v238, s[52:55], 0 offen
  buffer_load_dwordx2 v[230:231], v239, s[56:59], 0 offen
  s_cmp_lg_u32 s6, 0
  s_cbranch_scc1 ogemm_nopoll
  s_mov_b64 exec, 1
  v_mov_b32 v13, 4
  s_mov_b32 s88, 0
gp_loop1:
  buffer_load_dword v14, v13, s[80:83], 0 offen sc1
  s_waitcnt vmcnt(0)
  v_readfirstlane_b32 s89, v14
  s_cmp_ge_u32 s89, 16
  s_cbranch_scc1 gp_done1
  s_add_u32 s88, s88, 1
  s_cmp_gt_u32 s88, 40000
  s_cbranch_scc1 gp_done1
  s_sleep 8
  s_branch gp_loop1
gp_done1:
  s_mov_b64 exec, -1
ogemm_nopoll:
  s_barrier
  s_waitcnt lgkmcnt(7)
  v_mfma_f32_32x32x16_bf16 v[64:79], v[44:47], v[40:43], v[64:79]
  ds_read_b128 v[16:19], v2 offset:32768
  ds_read_b64_tr_b16 v[20:21], v4 offset:32768
  ds_read_b64_tr_b16 v[22:23], v4 offset:34816
  s_cmp_lt_u32 s37, 64
  s_cselect_b32 s12, s24, s26
  s_cselect_b32 s13, s25, s27
  s_cselect_b32 s14, 0x400000, s42
  s_cselect_b32 s39, 0, 64
  s_sub_u32 s39, s37, s39
  s_lshl_b32 s39, s39, 16
  s_lshl_b32 s40, s37, 12
  s_cmp_lt_u32 s43, 23
  s_cselect_b32 s14, s14, 0
  s_cselect_b32 s40, s40, 0x10000000
  s_add_u32 s37, s37, 1
  s_add_u32 s43, s43, 1
  s_cmp_eq_u32 s43, 7
  s_cselect_b32 s37, s44, s37
  s_add_u32 m0, s36, 98304
  s_nop 0
  buffer_load_dwordx4 v8, s[8:11], s40 offen offset:0 lds
  s_waitcnt lgkmcnt(8)
  v_mfma_f32_32x32x16_bf16 v[80:95], v[48:51], v[40:43], v[80:95]
  ds_read_b64_tr_b16 v[24:25], v5 offset:32768
  ds_read_b64_tr_b16 v[26:27], v5 offset:34816
  buffer_load_dwordx4 v8, s[8:11], s40 offen offset:1024 lds
  s_waitcnt lgkmcnt(7)
  v_mfma_f32_32x32x16_bf16 v[64:79], v[56:59], v[52:55], v[64:79]
  ds_read_b128 v[28:31], v2 offset:33792
  ds_read_b64_tr_b16 v[32:33], v4 offset:36864
  ds_read_b64_tr_b16 v[34:35], v4 offset:38912
  s_add_u32 m0, s36, 114688
  s_nop 0
  buffer_load_dwordx4 v9, s[12:15], s39 offen offset:0 lds
  s_waitcnt lgkmcnt(8)
  v_mfma_f32_32x32x16_bf16 v[80:95], v[60:63], v[52:55], v[80:95]
  ds_read_b64_tr_b16 v[36:37], v5 offset:36864
  ds_read_b64_tr_b16 v[38:39], v5 offset:38912
  buffer_load_dwordx4 v10, s[12:15], s39 offen offset:1024 lds
  s_add_u32 s41, s41, 1
  s_waitcnt vmcnt(4)
  s_barrier
  s_waitcnt lgkmcnt(7)
  v_mfma_f32_32x32x16_bf16 v[64:79], v[20:23], v[16:19], v[64:79]
  ds_read_b128 v[40:43], v2 offset:34816
  ds_read_b64_tr_b16 v[44:45], v4 offset:40960
  ds_read_b64_tr_b16 v[46:47], v4 offset:43008
  s_cmp_lt_u32 s37, 64
  s_cselect_b32 s12, s24, s26
  s_cselect_b32 s13, s25, s27
  s_cselect_b32 s14, 0x400000, s42
  s_cselect_b32 s39, 0, 64
  s_sub_u32 s39, s37, s39
  s_lshl_b32 s39, s39, 16
  s_lshl_b32 s40, s37, 12
  s_cmp_lt_u32 s43, 23
  s_cselect_b32 s14, s14, 0
  s_cselect_b32 s40, s40, 0x10000000
  s_add_u32 s37, s37, 1
  s_add_u32 s43, s43, 1
  s_cmp_eq_u32 s43, 7
  s_cselect_b32 s37, s44, s37
  s_add_u32 m0, s36, 0
  s_nop 0
  buffer_load_dwordx4 v8, s[8:11], s40 offen offset:0 lds
  s_waitcnt lgkmcnt(8)
  v_mfma_f32_32x32x16_bf16 v[80:95], v[24:27], v[16:19], v[80:95]
  ds_read_b64_tr_b16 v[48:49], v5 offset:40960
  ds_read_b64_tr_b16 v[50:51], v5 offset:43008
  s_waitcnt lgkmcnt(7)
  v_mfma_f32_32x32x16_bf16 v[64:79], v[32:35], v[28:31], v[64:79]
  ds_read_b128 v[52:55], v2 offset:35840
  ds_read_b64_tr_b16 v[56:57], v4 offset:45056
  ds_read_b64_tr_b16 v[58:59], v4 offset:47104
  buffer_load_dwordx4 v8, s[8:11], s40 offen offset:1024 lds
  s_waitcnt lgkmcnt(8)
  v_mfma_f32_32x32x16_bf16 v[80:95], v[36:39], v[28:31], v[80:95]
  ds_read_b64_tr_b16 v[60:61], v5 offset:45056
  ds_read_b64_tr_b16 v[62:63], v5 offset:47104
  s_waitcnt lgkmcnt(7)
  v_mfma_f32_32x32x16_bf16 v[64:79], v[44:47], v[40:43], v[64:79]
  ds_read_b128 v[16:19], v3 offset:0
  ds_read_b64_tr_b16 v[20:21], v6 offset:0
  ds_read_b64_tr_b16 v[22:23], v6 offset:2048
  s_add_u32 m0, s36, 16384
  s_nop 0
  buffer_load_dwordx4 v9, s[12:15], s39 offen offset:0 lds
  s_waitcnt lgkmcnt(8)
  v_mfma_f32_32x32x16_bf16 v[80:95], v[48:51], v[40:43], v[80:95]
  ds_read_b64_tr_b16 v[24:25], v7 offset:0
  ds_read_b64_tr_b16 v[26:27], v7 offset:2048
  s_waitcnt lgkmcnt(7)
  v_mfma_f32_32x32x16_bf16 v[64:79], v[56:59], v[52:55], v[64:79]
  ds_read_b128 v[28:31], v3 offset:1024
  ds_read_b64_tr_b16 v[32:33], v6 offset:4096
  ds_read_b64_tr_b16 v[34:35], v6 offset:6144
  buffer_load_dwordx4 v10, s[12:15], s39 offen offset:1024 lds
  s_waitcnt lgkmcnt(8)
  v_mfma_f32_32x32x16_bf16 v[80:95], v[60:63], v[52:55], v[80:95]
  ds_read_b64_tr_b16 v[36:37], v7 offset:4096
  ds_read_b64_tr_b16 v[38:39], v7 offset:6144
  s_add_u32 s41, s41, 1
  s_waitcnt vmcnt(4)
  s_barrier
  s_waitcnt lgkmcnt(7)
  v_mfma_f32_32x32x16_bf16 v[64:79], v[20:23], v[16:19], v[64:79]
  ds_read_b128 v[40:43], v3 offset:2048
  ds_read_b64_tr_b16 v[44:45], v6 offset:8192
  ds_read_b64_tr_b16 v[46:47], v6 offset:10240
  s_cmp_lt_u32 s37, 64
  s_cselect_b32 s12, s24, s26
  s_cselect_b32 s13, s25, s27
  s_cselect_b32 s14, 0x400000, s42
  s_cselect_b32 s39, 0, 64
  s_sub_u32 s39, s37, s39
  s_lshl_b32 s39, s39, 16
  s_lshl_b32 s40, s37, 12
  s_cmp_lt_u32 s43, 23
  s_cselect_b32 s14, s14, 0
  s_cselect_b32 s40, s40, 0x10000000
  s_add_u32 s37, s37, 1
  s_add_u32 s43, s43, 1
  s_cmp_eq_u32 s43, 7
  s_cselect_b32 s37, s44, s37
  s_add_u32 m0, s36, 32768
  s_nop 0
  buffer_load_dwordx4 v8, s[8:11], s40 offen offset:0 lds
  s_waitcnt lgkmcnt(8)
  v_mfma_f32_32x32x16_bf16 v[80:95], v[24:27], v[16:19], v[80:95]
  ds_read_b64_tr_b16 v[48:49], v7 offset:8192
  ds_read_b64_tr_b16 v[50:51], v7 offset:10240
  s_waitcnt lgkmcnt(7)
  v_mfma_f32_32x32x16_bf16 v[64:79], v[32:35], v[28:31], v[64:79]
  ds_read_b128 v[52:55], v3 offset:3072
  ds_read_b64_tr_b16 v[56:57], v6 offset:12288
  ds_read_b64_tr_b16 v[58:59], v6 offset:14336
  buffer_load_dwordx4 v8, s[8:11], s40 offen offset:1024 lds
  s_waitcnt lgkmcnt(8)
  v_mfma_f32_32x32x16_bf16 v[80:95], v[36:39], v[28:31], v[80:95]
  ds_read_b64_tr_b16 v[60:61], v7 offset:12288
  ds_read_b64_tr_b16 v[62:63], v7 offset:14336
  s_waitcnt lgkmcnt(7)
  v_mfma_f32_32x32x16_bf16 v[64:79], v[44:47], v[40:43], v[64:79]
  ds_read_b128 v[16:19], v3 offset:32768
  ds_read_b64_tr_b16 v[20:21], v6 offset:32768
  ds_read_b64_tr_b16 v[22:23], v6 offset:34816
  s_add_u32 m0, s36, 49152
  s_nop 0
  buffer_load_dwordx4 v9, s[12:15], s39 offen offset:0 lds
  s_waitcnt lgkmcnt(8)
  v_mfma_f32_32x32x16_bf16 v[80:95], v[48:51], v[40:43], v[80:95]
  ds_read_b64_tr_b16 v[24:25], v7 offset:32768
  ds_read_b64_tr_b16 v[26:27], v7 offset:34816
  s_waitcnt lgkmcnt(7)
  v_mfma_f32_32x32x16_bf16 v[64:79], v[56:59], v[52:55], v[64:79]
  ds_read_b128 v[28:31], v3 offset:33792
  ds_read_b64_tr_b16 v[32:33], v6 offset:36864
  ds_read_b64_tr_b16 v[34:35], v6 offset:38912
  buffer_load_dwordx4 v10, s[12:15], s39 offen offset:1024 lds
  s_waitcnt lgkmcnt(8)
  v_mfma_f32_32x32x16_bf16 v[80:95], v[60:63], v[52:55], v[80:95]
  ds_read_b64_tr_b16 v[36:37], v7 offset:36864
  ds_read_b64_tr_b16 v[38:39], v7 offset:38912
  s_add_u32 s41, s41, 1
  s_waitcnt vmcnt(4)
  s_barrier
  s_waitcnt lgkmcnt(7)
  v_mfma_f32_32x32x16_bf16 v[64:79], v[20:23], v[16:19], v[64:79]
  ds_read_b128 v[40:43], v3 offset:34816
  ds_read_b64_tr_b16 v[44:45], v6 offset:40960
  ds_read_b64_tr_b16 v[46:47], v6 offset:43008
  s_cmp_lt_u32 s37, 64
  s_cselect_b32 s12, s24, s26
  s_cselect_b32 s13, s25, s27
  s_cselect_b32 s14, 0x400000, s42
  s_cselect_b32 s39, 0, 64
  s_sub_u32 s39, s37, s39
  s_lshl_b32 s39, s39, 16
  s_lshl_b32 s40, s37, 12
  s_cmp_lt_u32 s43, 23
  s_cselect_b32 s14, s14, 0
  s_cselect_b32 s40, s40, 0x10000000
  s_add_u32 s37, s37, 1
  s_add_u32 s43, s43, 1
  s_cmp_eq_u32 s43, 7
  s_cselect_b32 s37, s44, s37
  s_add_u32 m0, s36, 65536
  s_nop 0
  buffer_load_dwordx4 v8, s[8:11], s40 offen offset:0 lds
  s_waitcnt lgkmcnt(8)
  v_mfma_f32_32x32x16_bf16 v[80:95], v[24:27], v[16:19], v[80:95]
  ds_read_b64_tr_b16 v[48:49], v7 offset:40960
  ds_read_b64_tr_b16 v[50:51], v7 offset:43008
  s_waitcnt lgkmcnt(7)
  v_mfma_f32_32x32x16_bf16 v[64:79], v[32:35], v[28:31], v[64:79]
  ds_read_b128 v[52:55], v3 offset:35840
  ds_read_b64_tr_b16 v[56:57], v6 offset:45056
  ds_read_b64_tr_b16 v[58:59], v6 offset:47104
  buffer_load_dwordx4 v8, s[8:11], s40 offen offset:1024 lds
  s_waitcnt lgkmcnt(8)
  v_mfma_f32_32x32x16_bf16 v[80:95], v[36:39], v[28:31], v[80:95]
  ds_read_b64_tr_b16 v[60:61], v7 offset:45056
  ds_read_b64_tr_b16 v[62:63], v7 offset:47104
  s_waitcnt lgkmcnt(7)
  v_mfma_f32_32x32x16_bf16 v[64:79], v[44:47], v[40:43], v[64:79]
  ds_read_b128 v[16:19], v2 offset:0
  ds_read_b64_tr_b16 v[20:21], v4 offset:0
  ds_read_b64_tr_b16 v[22:23], v4 offset:2048
  s_add_u32 m0, s36, 81920
  s_nop 0
  buffer_load_dwordx4 v9, s[12:15], s39 offen offset:0 lds
  s_waitcnt lgkmcnt(8)
  v_mfma_f32_32x32x16_bf16 v[80:95], v[48:51], v[40:43], v[80:95]
  ds_read_b64_tr_b16 v[24:25], v5 offset:0
  ds_read_b64_tr_b16 v[26:27], v5 offset:2048
  s_waitcnt lgkmcnt(7)
  v_mfma_f32_32x32x16_bf16 v[64:79], v[56:59], v[52:55], v[64:79]
  ds_read_b128 v[28:31], v2 offset:1024
  ds_read_b64_tr_b16 v[32:33], v4 offset:4096
  ds_read_b64_tr_b16 v[34:35], v4 offset:6144
  buffer_load_dwordx4 v10, s[12:15], s39 offen offset:1024 lds
  s_waitcnt lgkmcnt(8)
  v_mfma_f32_32x32x16_bf16 v[80:95], v[60:63], v[52:55], v[80:95]
  ds_read_b64_tr_b16 v[36:37], v5 offset:4096
  ds_read_b64_tr_b16 v[38:39], v5 offset:6144
  s_add_u32 s41, s41, 1
ogemm_loop:
  s_waitcnt vmcnt(4)
  s_barrier
  s_waitcnt lgkmcnt(7)
  v_mfma_f32_32x32x16_bf16 v[64:79], v[20:23], v[16:19], v[64:79]
  ds_read_b128 v[40:43], v2 offset:2048
  ds_read_b64_tr_b16 v[44:45], v4 offset:8192
  ds_read_b64_tr_b16 v[46:47], v4 offset:10240
  s_cmp_lt_u32 s37, 64
  s_cselect_b32 s12, s24, s26
  s_cselect_b32 s13, s25, s27
  s_cselect_b32 s14, 0x400000, s42
  s_cselect_b32 s39, 0, 64
  s_sub_u32 s39, s37, s39
  s_lshl_b32 s39, s39, 16
  s_lshl_b32 s40, s37, 12
  s_cmp_lt_u32 s43, 23
  s_cselect_b32 s14, s14, 0
  s_cselect_b32 s40, s40, 0x10000000
  s_add_u32 s37, s37, 1
  s_add_u32 s43, s43, 1
  s_cmp_eq_u32 s43, 7
  s_cselect_b32 s37, s44, s37
  s_add_u32 m0, s36, 98304
  s_nop 0
  buffer_load_dwordx4 v8, s[8:11], s40 offen offset:0 lds
  s_waitcnt lgkmcnt(8)
  v_mfma_f32_32x32x16_bf16 v[80:95], v[24:27], v[16:19], v[80:95]
  ds_read_b64_tr_b16 v[48:49], v5 offset:8192
  ds_read_b64_tr_b16 v[50:51], v5 offset:10240
  s_waitcnt lgkmcnt(7)
  v_mfma_f32_32x32x16_bf16 v[64:79], v[32:35], v[28:31], v[64:79]
  ds_read_b128 v[52:55], v2 offset:3072
  ds_read_b64_tr_b16 v[56:57], v4 offset:12288
  ds_read_b64_tr_b16 v[58:59], v4 offset:14336
  buffer_load_dwordx4 v8, s[8:11], s40 offen offset:1024 lds
  s_waitcnt lgkmcnt(8)
  v_mfma_f32_32x32x16_bf16 v[80:95], v[36:39], v[28:31], v[80:95]
  ds_read_b64_tr_b16 v[60:61], v5 offset:12288
  ds_read_b64_tr_b16 v[62:63], v5 offset:14336
  s_waitcnt lgkmcnt(7)
  v_mfma_f32_32x32x16_bf16 v[64:79], v[44:47], v[40:43], v[64:79]
  ds_read_b128 v[16:19], v2 offset:32768
  ds_read_b64_tr_b16 v[20:21], v4 offset:32768
  ds_read_b64_tr_b16 v[22:23], v4 offset:34816
  s_add_u32 m0, s36, 114688
  s_nop 0
  buffer_load_dwordx4 v9, s[12:15], s39 offen offset:0 lds
  s_waitcnt lgkmcnt(8)
  v_mfma_f32_32x32x16_bf16 v[80:95], v[48:51], v[40:43], v[80:95]
  ds_read_b64_tr_b16 v[24:25], v5 offset:32768
  ds_read_b64_tr_b16 v[26:27], v5 offset:34816
  s_waitcnt lgkmcnt(7)
  v_mfma_f32_32x32x16_bf16 v[64:79], v[56:59], v[52:55], v[64:79]
  ds_read_b128 v[28:31], v2 offset:33792
  ds_read_b64_tr_b16 v[32:33], v4 offset:36864
  ds_read_b64_tr_b16 v[34:35], v4 offset:38912
  buffer_load_dwordx4 v10, s[12:15], s39 offen offset:1024 lds
  s_waitcnt lgkmcnt(8)
  v_mfma_f32_32x32x16_bf16 v[80:95], v[60:63], v[52:55], v[80:95]
  ds_read_b64_tr_b16 v[36:37], v5 offset:36864
  ds_read_b64_tr_b16 v[38:39], v5 offset:38912
  s_add_u32 s41, s41, 1
  s_cmp_ge_u32 s41, 23
  s_cbranch_scc1 ogemm_done
  s_waitcnt vmcnt(4)
  s_barrier
  s_waitcnt lgkmcnt(7)
  v_mfma_f32_32x32x16_bf16 v[64:79], v[20:23], v[16:19], v[64:79]
  ds_read_b128 v[40:43], v2 offset:34816
  ds_read_b64_tr_b16 v[44:45], v4 offset:40960
  ds_read_b64_tr_b16 v[46:47], v4 offset:43008
  s_cmp_lt_u32 s37, 64
  s_cselect_b32 s12, s24, s26
  s_cselect_b32 s13, s25, s27
  s_cselect_b32 s14, 0x400000, s42
  s_cselect_b32 s39, 0, 64
  s_sub_u32 s39, s37, s39
  s_lshl_b32 s39, s39, 16
  s_lshl_b32 s40, s37, 12
  s_cmp_lt_u32 s43, 23
  s_cselect_b32 s14, s14, 0
  s_cselect_b32 s40, s40, 0x10000000
  s_add_u32 s37, s37, 1
  s_add_u32 s43, s43, 1
  s_cmp_eq_u32 s43, 7
  s_cselect_b32 s37, s44, s37
  s_add_u32 m0, s36, 0
  s_nop 0
  buffer_load_dwordx4 v8, s[8:11], s40 offen offset:0 lds
  s_waitcnt lgkmcnt(8)
  v_mfma_f32_32x32x16_bf16 v[80:95], v[24:27], v[16:19], v[80:95]
  ds_read_b64_tr_b16 v[48:49], v5 offset:40960
  ds_read_b64_tr_b16 v[50:51], v5 offset:43008
  s_waitcnt lgkmcnt(7)
  v_mfma_f32_32x32x16_bf16 v[64:79], v[32:35], v[28:31], v[64:79]
  ds_read_b128 v[52:55], v2 offset:35840
  ds_read_b64_tr_b16 v[56:57], v4 offset:45056
  ds_read_b64_tr_b16 v[58:59], v4 offset:47104
  buffer_load_dwordx4 v8, s[8:11], s40 offen offset:1024 lds
  s_waitcnt lgkmcnt(8)
  v_mfma_f32_32x32x16_bf16 v[80:95], v[36:39], v[28:31], v[80:95]
  ds_read_b64_tr_b16 v[60:61], v5 offset:45056
  ds_read_b64_tr_b16 v[62:63], v5 offset:47104
  s_waitcnt lgkmcnt(7)
  v_mfma_f32_32x32x16_bf16 v[64:79], v[44:47], v[40:43], v[64:79]
  ds_read_b128 v[16:19], v3 offset:0
  ds_read_b64_tr_b16 v[20:21], v6 offset:0
  ds_read_b64_tr_b16 v[22:23], v6 offset:2048
  s_add_u32 m0, s36, 16384
  s_nop 0
  buffer_load_dwordx4 v9, s[12:15], s39 offen offset:0 lds
  s_waitcnt lgkmcnt(8)
  v_mfma_f32_32x32x16_bf16 v[80:95], v[48:51], v[40:43], v[80:95]
  ds_read_b64_tr_b16 v[24:25], v7 offset:0
  ds_read_b64_tr_b16 v[26:27], v7 offset:2048
  s_waitcnt lgkmcnt(7)
  v_mfma_f32_32x32x16_bf16 v[64:79], v[56:59], v[52:55], v[64:79]
  ds_read_b128 v[28:31], v3 offset:1024
  ds_read_b64_tr_b16 v[32:33], v6 offset:4096
  ds_read_b64_tr_b16 v[34:35], v6 offset:6144
  buffer_load_dwordx4 v10, s[12:15], s39 offen offset:1024 lds
  s_waitcnt lgkmcnt(8)
  v_mfma_f32_32x32x16_bf16 v[80:95], v[60:63], v[52:55], v[80:95]
  ds_read_b64_tr_b16 v[36:37], v7 offset:4096
  ds_read_b64_tr_b16 v[38:39], v7 offset:6144
  s_add_u32 s41, s41, 1
  s_cmp_ge_u32 s41, 23
  s_cbranch_scc1 ogemm_done
  s_waitcnt vmcnt(4)
  s_barrier
  s_waitcnt lgkmcnt(7)
  v_mfma_f32_32x32x16_bf16 v[64:79], v[20:23], v[16:19], v[64:79]
  ds_read_b128 v[40:43], v3 offset:2048
  ds_read_b64_tr_b16 v[44:45], v6 offset:8192
  ds_read_b64_tr_b16 v[46:47], v6 offset:10240
  s_cmp_lt_u32 s37, 64
  s_cselect_b32 s12, s24, s26
  s_cselect_b32 s13, s25, s27
  s_cselect_b32 s14, 0x400000, s42
  s_cselect_b32 s39, 0, 64
  s_sub_u32 s39, s37, s39
  s_lshl_b32 s39, s39, 16
  s_lshl_b32 s40, s37, 12
  s_cmp_lt_u32 s43, 23
  s_cselect_b32 s14, s14, 0
  s_cselect_b32 s40, s40, 0x10000000
  s_add_u32 s37, s37, 1
  s_add_u32 s43, s43, 1
  s_cmp_eq_u32 s43, 7
  s_cselect_b32 s37, s44, s37
  s_add_u32 m0, s36, 32768
  s_nop 0
  buffer_load_dwordx4 v8, s[8:11], s40 offen offset:0 lds
  s_waitcnt lgkmcnt(8)
  v_mfma_f32_32x32x16_bf16 v[80:95], v[24:27], v[16:19], v[80:95]
  ds_read_b64_tr_b16 v[48:49], v7 offset:8192
  ds_read_b64_tr_b16 v[50:51], v7 offset:10240
  s_waitcnt lgkmcnt(7)
  v_mfma_f32_32x32x16_bf16 v[64:79], v[32:35], v[28:31], v[64:79]
  ds_read_b128 v[52:55], v3 offset:3072
  ds_read_b64_tr_b16 v[56:57], v6 offset:12288
  ds_read_b64_tr_b16 v[58:59], v6 offset:14336
  buffer_load_dwordx4 v8, s[8:11], s40 offen offset:1024 lds
  s_waitcnt lgkmcnt(8)
  v_mfma_f32_32x32x16_bf16 v[80:95], v[36:39], v[28:31], v[80:95]
  ds_read_b64_tr_b16 v[60:61], v7 offset:12288
  ds_read_b64_tr_b16 v[62:63], v7 offset:14336
  s_waitcnt lgkmcnt(7)
  v_mfma_f32_32x32x16_bf16 v[64:79], v[44:47], v[40:43], v[64:79]
  ds_read_b128 v[16:19], v3 offset:32768
  ds_read_b64_tr_b16 v[20:21], v6 offset:32768
  ds_read_b64_tr_b16 v[22:23], v6 offset:34816
  s_add_u32 m0, s36, 49152
  s_nop 0
  buffer_load_dwordx4 v9, s[12:15], s39 offen offset:0 lds
  s_waitcnt lgkmcnt(8)
  v_mfma_f32_32x32x16_bf16 v[80:95], v[48:51], v[40:43], v[80:95]
  ds_read_b64_tr_b16 v[24:25], v7 offset:32768
  ds_read_b64_tr_b16 v[26:27], v7 offset:34816
  s_waitcnt lgkmcnt(7)
  v_mfma_f32_32x32x16_bf16 v[64:79], v[56:59], v[52:55], v[64:79]
  ds_read_b128 v[28:31], v3 offset:33792
  ds_read_b64_tr_b16 v[32:33], v6 offset:36864
  ds_read_b64_tr_b16 v[34:35], v6 offset:38912
  buffer_load_dwordx4 v10, s[12:15], s39 offen offset:1024 lds
  s_waitcnt lgkmcnt(8)
  v_mfma_f32_32x32x16_bf16 v[80:95], v[60:63], v[52:55], v[80:95]
  ds_read_b64_tr_b16 v[36:37], v7 offset:36864
  ds_read_b64_tr_b16 v[38:39], v7 offset:38912
  s_add_u32 s41, s41, 1
  s_cmp_ge_u32 s41, 23
  s_cbranch_scc1 ogemm_done
  s_waitcnt vmcnt(4)
  s_barrier
  s_waitcnt lgkmcnt(7)
  v_mfma_f32_32x32x16_bf16 v[64:79], v[20:23], v[16:19], v[64:79]
  ds_read_b128 v[40:43], v3 offset:34816
  ds_read_b64_tr_b16 v[44:45], v6 offset:40960
  ds_read_b64_tr_b16 v[46:47], v6 offset:43008
  s_cmp_lt_u32 s37, 64
  s_cselect_b32 s12, s24, s26
  s_cselect_b32 s13, s25, s27
  s_cselect_b32 s14, 0x400000, s42
  s_cselect_b32 s39, 0, 64
  s_sub_u32 s39, s37, s39
  s_lshl_b32 s39, s39, 16
  s_lshl_b32 s40, s37, 12
  s_cmp_lt_u32 s43, 23
  s_cselect_b32 s14, s14, 0
  s_cselect_b32 s40, s40, 0x10000000
  s_add_u32 s37, s37, 1
  s_add_u32 s43, s43, 1
  s_cmp_eq_u32 s43, 7
  s_cselect_b32 s37, s44, s37
  s_add_u32 m0, s36, 65536
  s_nop 0
  buffer_load_dwordx4 v8, s[8:11], s40 offen offset:0 lds
  s_waitcnt lgkmcnt(8)
  v_mfma_f32_32x32x16_bf16 v[80:95], v[24:27], v[16:19], v[80:95]
  ds_read_b64_tr_b16 v[48:49], v7 offset:40960
  ds_read_b64_tr_b16 v[50:51], v7 offset:43008
  s_waitcnt lgkmcnt(7)
  v_mfma_f32_32x32x16_bf16 v[64:79], v[32:35], v[28:31], v[64:79]
  ds_read_b128 v[52:55], v3 offset:35840
  ds_read_b64_tr_b16 v[56:57], v6 offset:45056
  ds_read_b64_tr_b16 v[58:59], v6 offset:47104
  buffer_load_dwordx4 v8, s[8:11], s40 offen offset:1024 lds
  s_waitcnt lgkmcnt(8)
  v_mfma_f32_32x32x16_bf16 v[80:95], v[36:39], v[28:31], v[80:95]
  ds_read_b64_tr_b16 v[60:61], v7 offset:45056
  ds_read_b64_tr_b16 v[62:63], v7 offset:47104
  s_waitcnt lgkmcnt(7)
  v_mfma_f32_32x32x16_bf16 v[64:79], v[44:47], v[40:43], v[64:79]
  ds_read_b128 v[16:19], v2 offset:0
  ds_read_b64_tr_b16 v[20:21], v4 offset:0
  ds_read_b64_tr_b16 v[22:23], v4 offset:2048
  s_add_u32 m0, s36, 81920
  s_nop 0
  buffer_load_dwordx4 v9, s[12:15], s39 offen offset:0 lds
  s_waitcnt lgkmcnt(8)
  v_mfma_f32_32x32x16_bf16 v[80:95], v[48:51], v[40:43], v[80:95]
  ds_read_b64_tr_b16 v[24:25], v5 offset:0
  ds_read_b64_tr_b16 v[26:27], v5 offset:2048
  s_waitcnt lgkmcnt(7)
  v_mfma_f32_32x32x16_bf16 v[64:79], v[56:59], v[52:55], v[64:79]
  ds_read_b128 v[28:31], v2 offset:1024
  ds_read_b64_tr_b16 v[32:33], v4 offset:4096
  ds_read_b64_tr_b16 v[34:35], v4 offset:6144
  buffer_load_dwordx4 v10, s[12:15], s39 offen offset:1024 lds
  s_waitcnt lgkmcnt(8)
  v_mfma_f32_32x32x16_bf16 v[80:95], v[60:63], v[52:55], v[80:95]
  ds_read_b64_tr_b16 v[36:37], v5 offset:4096
  ds_read_b64_tr_b16 v[38:39], v5 offset:6144
  s_add_u32 s41, s41, 1
  s_cmp_ge_u32 s41, 23
  s_cbranch_scc1 ogemm_done
  s_branch ogemm_loop
ogemm_done:
  s_nop 11
  s_and_b32 s33, s6, 3
  s_lshl_b32 s33, s33, 14
  s_lshl_b32 s34, s6, 13
  v_add_u32 v12, s34, v11
  s_xor_b32 s34, s34, 0x8000
  v_add_u32 v13, s34, v11
  s_lshl_b32 s34, s3, 2
  s_add_u32 s34, s34, s4
  s_lshl_b32 s34, s34, 16
  s_add_u32 s34, s34, s33
  s_lshl_b32 s35, s5, 22
  s_add_u32 s34, s34, s35
  s_add_u32 s34, s34, 0x5000000
  s_lshl_b32 s35, s30, 12
  s_add_u32 s34, s34, s35
  s_add_u32 s35, s34, 4096
  s_nop 3
  s_and_b32 s46, s6, 3
  s_cmp_eq_u32 s46, s5
  s_cbranch_scc1 own_lds
  s_waitcnt lgkmcnt(0)
  v_cvt_pk_bf16_f32 v16, v64, v65
  v_cvt_pk_bf16_f32 v17, v66, v67
  v_cvt_pk_bf16_f32 v18, v68, v69
  v_cvt_pk_bf16_f32 v19, v70, v71
  buffer_store_dwordx4 v[16:19], v11, s[8:11], s34 offen offset:0 sc1
  v_cvt_pk_bf16_f32 v20, v72, v73
  v_cvt_pk_bf16_f32 v21, v74, v75
  v_cvt_pk_bf16_f32 v22, v76, v77
  v_cvt_pk_bf16_f32 v23, v78, v79
  buffer_store_dwordx4 v[20:23], v11, s[8:11], s34 offen offset:1024 sc1
  v_cvt_pk_bf16_f32 v24, v80, v81
  v_cvt_pk_bf16_f32 v25, v82, v83
  v_cvt_pk_bf16_f32 v26, v84, v85
  v_cvt_pk_bf16_f32 v27, v86, v87
  buffer_store_dwordx4 v[24:27], v11, s[8:11], s34 offen offset:2048 sc1
  v_cvt_pk_bf16_f32 v28, v88, v89
  v_cvt_pk_bf16_f32 v29, v90, v91
  v_cvt_pk_bf16_f32 v30, v92, v93
  v_cvt_pk_bf16_f32 v31, v94, v95
  buffer_store_dwordx4 v[28:31], v11, s[8:11], s34 offen offset:3072 sc1
  s_branch ogemm_end
own_lds:
  s_lshl_b32 s46, s30, 13
  s_add_u32 s46, s46, 0x20000
  v_add_u32 v12, s46, v11
  ds_write_b128 v12, v[64:67] offset:0
  ds_write_b128 v12, v[68:71] offset:1024
  ds_write_b128 v12, v[72:75] offset:2048
  ds_write_b128 v12, v[76:79] offset:3072
  ds_write_b128 v12, v[80:83] offset:4096
  ds_write_b128 v12, v[84:87] offset:5120
  ds_write_b128 v12, v[88:91] offset:6144
  ds_write_b128 v12, v[92:95] offset:7168
ogemm_end:
  s_waitcnt vmcnt(0) lgkmcnt(0)
  s_barrier
  s_cmp_lg_u32 s6, 0
  s_cbranch_scc1 tb_wait
  s_add_u32 s46, s49, 32
  s_lshl_b32 s46, s46, 12
  s_add_u32 s46, s46, 0x6400000
  s_mov_b64 exec, 1
  v_mov_b32 v12, 1
  v_mov_b32 v13, 0
  buffer_atomic_add v12, v13, s[8:11], s46 offen sc1
  s_mov_b32 s47, 0
tb_loop:
  buffer_load_dword v14, v13, s[8:11], s46 offen sc1
  s_waitcnt vmcnt(0)
  v_readfirstlane_b32 s48, v14
  s_cmp_ge_u32 s48, 4
  s_cbranch_scc1 tb_done
  s_add_u32 s47, s47, 1
  s_cmp_gt_u32 s47, 40000
  s_cbranch_scc1 tb_done
  s_sleep 4
  s_branch tb_loop
tb_done:
  s_mov_b64 exec, -1
tb_wait:
  s_barrier
reduce_kernel:
  s_lshl_b32 s51, s45, 12
  s_lshl_b32 s47, s6, 10
  s_add_u32 s51, s51, s47
  s_add_u32 s51, s51, 0x5000000
  s_add_u32 s46, s5, 1
  s_and_b32 s46, s46, 3
  s_lshl_b32 s46, s46, 22
  s_add_u32 s46, s46, s51
  buffer_load_dwordx4 v[184:187], v11, s[8:11], s46 offen
  s_add_u32 s46, s5, 2
  s_and_b32 s46, s46, 3
  s_lshl_b32 s46, s46, 22
  s_add_u32 s46, s46, s51
  buffer_load_dwordx4 v[188:191], v11, s[8:11], s46 offen
  s_add_u32 s46, s5, 3
  s_and_b32 s46, s46, 3
  s_lshl_b32 s46, s46, 22
  s_add_u32 s46, s46, s51
  buffer_load_dwordx4 v[192:195], v11, s[8:11], s46 offen
  s_lshl_b32 s46, s6, 11
  s_add_u32 s46, s46, 0x20000
  v_add_u32 v178, s46, v11
  ds_read_b128 v[180:183], v178 offset:0
  ds_read_b128 v[212:215], v178 offset:1024
  v_lshlrev_b32 v200, 16, v196
  v_and_b32 v201, 0xffff0000, v196
  v_lshlrev_b32 v202, 16, v198
  v_and_b32 v203, 0xffff0000, v198
  v_add_f32 v208, v200, v202
  v_add_f32 v209, v201, v203
  v_lshlrev_b32 v200, 16, v197
  v_and_b32 v201, 0xffff0000, v197
  v_lshlrev_b32 v202, 16, v199
  v_and_b32 v203, 0xffff0000, v199
  v_add_f32 v210, v200, v202
  v_add_f32 v211, v201, v203
  v_lshlrev_b32 v232, 16, v228
  v_and_b32 v233, 0xffff0000, v228
  v_lshlrev_b32 v234, 16, v230
  v_and_b32 v235, 0xffff0000, v230
  v_add_f32 v240, v232, v234
  v_add_f32 v241, v233, v235
  v_lshlrev_b32 v232, 16, v229
  v_and_b32 v233, 0xffff0000, v229
  v_lshlrev_b32 v234, 16, v231
  v_and_b32 v235, 0xffff0000, v231
  v_add_f32 v242, v232, v234
  v_add_f32 v243, v233, v235
  s_waitcnt lgkmcnt(0)
  v_add_f32 v180, v180, v208
  v_add_f32 v181, v181, v209
  v_add_f32 v182, v182, v210
  v_add_f32 v183, v183, v211
  v_add_f32 v212, v212, v240
  v_add_f32 v213, v213, v241
  v_add_f32 v214, v214, v242
  v_add_f32 v215, v215, v243
  s_waitcnt vmcnt(2)
  v_lshlrev_b32 v216, 16, v184
  v_and_b32 v217, 0xffff0000, v184
  v_add_f32 v180, v180, v216
  v_add_f32 v181, v181, v217
  v_lshlrev_b32 v218, 16, v185
  v_and_b32 v219, 0xffff0000, v185
  v_add_f32 v182, v182, v218
  v_add_f32 v183, v183, v219
  v_lshlrev_b32 v220, 16, v186
  v_and_b32 v221, 0xffff0000, v186
  v_add_f32 v212, v212, v220
  v_add_f32 v213, v213, v221
  v_lshlrev_b32 v222, 16, v187
  v_and_b32 v223, 0xffff0000, v187
  v_add_f32 v214, v214, v222
  v_add_f32 v215, v215, v223
  s_waitcnt vmcnt(1)
  v_lshlrev_b32 v216, 16, v188
  v_and_b32 v217, 0xffff0000, v188
  v_add_f32 v180, v180, v216
  v_add_f32 v181, v181, v217
  v_lshlrev_b32 v218, 16, v189
  v_and_b32 v219, 0xffff0000, v189
  v_add_f32 v182, v182, v218
  v_add_f32 v183, v183, v219
  v_lshlrev_b32 v220, 16, v190
  v_and_b32 v221, 0xffff0000, v190
  v_add_f32 v212, v212, v220
  v_add_f32 v213, v213, v221
  v_lshlrev_b32 v222, 16, v191
  v_and_b32 v223, 0xffff0000, v191
  v_add_f32 v214, v214, v222
  v_add_f32 v215, v215, v223
  s_waitcnt vmcnt(0)
  v_lshlrev_b32 v216, 16, v192
  v_and_b32 v217, 0xffff0000, v192
  v_add_f32 v180, v180, v216
  v_add_f32 v181, v181, v217
  v_lshlrev_b32 v218, 16, v193
  v_and_b32 v219, 0xffff0000, v193
  v_add_f32 v182, v182, v218
  v_add_f32 v183, v183, v219
  v_lshlrev_b32 v220, 16, v194
  v_and_b32 v221, 0xffff0000, v194
  v_add_f32 v212, v212, v220
  v_add_f32 v213, v213, v221
  v_lshlrev_b32 v222, 16, v195
  v_and_b32 v223, 0xffff0000, v195
  v_add_f32 v214, v214, v222
  v_add_f32 v215, v215, v223
  v_cvt_pk_bf16_f32 v204, v180, v181
  v_cvt_pk_bf16_f32 v205, v182, v183
  v_cvt_pk_bf16_f32 v236, v212, v213
  v_cvt_pk_bf16_f32 v237, v214, v215
  s_nop 1
  v_permlane32_swap_b32 v204, v236
  v_permlane32_swap_b32 v205, v237
  v_lshrrev_b32 v200, 5, v1
  v_lshlrev_b32 v200, 3, v200
  v_add_u32 v200, v206, v200
  v_mov_b32 v206, v236
  v_mov_b32 v207, v237
  buffer_store_dwordx4 v[204:207], v200, s[60:63], 0 offen
  s_endpgm
code_end:
.section .rodata,"a"
.p2align 6
.amdhsa_kernel mega_kernel
  .amdhsa_next_free_vgpr 256
  .amdhsa_next_free_sgpr 102
  .amdhsa_accum_offset 256
  .amdhsa_group_segment_fixed_size 0
  .amdhsa_kernarg_size 112
  .amdhsa_user_sgpr_count 2
  .amdhsa_user_sgpr_kernarg_segment_ptr 1
  .amdhsa_system_sgpr_workgroup_id_x 1
.end_amdhsa_kernel
```
